```python
import torch

def _softmax(x, axis=-1):
    return torch.softmax(x, dim=axis)
def _gelu(x):
    return torch.nn.functional.gelu(x, approximate="tanh")
def _silu(x):
    return torch.nn.functional.silu(x)
def _sigmoid(x):
    return torch.sigmoid(x)
def _layernorm(x, axis=-1, eps=1e-5):
    m = x.mean(dim=axis, keepdim=True)
    v = x.var(dim=axis, keepdim=True, unbiased=False)
    return (x - m) / torch.sqrt(v + eps)
def _scatter_add(tgt, idx, src, axis=0):
    return tgt.clone().index_add_(axis, idx, src)
def _segment_sum(src, seg, n):
    out = torch.zeros((n,) + src.shape[1:], dtype=src.dtype)
    return out.index_add_(0, seg, src)
def _pad(x, pw):
    flat = tuple(v for pair in reversed(pw) for v in pair)
    return torch.nn.functional.pad(x, flat)

kernel_name = 'parallel_sum__ssm_conv_s5__glu_gated_swiglu__prompt'

def setup_inputs():

    _w = (lambda a: (lambda t: t.to(torch.bfloat16) if t.is_floating_point() else t)(torch.as_tensor(a)))
    def _A_setup():
        B, S, D = 1, 2048, 576
        P = D
        Lambda_re = -0.5 * (lambda _x: torch.exp(torch.as_tensor(_x)))((lambda *s: torch.randn(*s, dtype=torch.bfloat16) * 0.2)(P))
        Lambda_im = (lambda *s: torch.randn(*s, dtype=torch.bfloat16) * 0.8)(P) * 1.0
        B_re = (lambda *s: torch.randn(*s, dtype=torch.bfloat16) * 0.2)(P, D) * (D ** -0.5)
        B_im = (lambda *s: torch.randn(*s, dtype=torch.bfloat16) * 0.2)(P, D) * (D ** -0.5)
        C_re = (lambda *s: torch.randn(*s, dtype=torch.bfloat16) * 0.2)(D, P) * (P ** -0.5)
        C_im = (lambda *s: torch.randn(*s, dtype=torch.bfloat16) * 0.2)(D, P) * (P ** -0.5)
        log_dt = (lambda *s: torch.randn(*s, dtype=torch.bfloat16) * 0.2)(P) * 0.3 - 2.0
        Dskip = (lambda *s: torch.randn(*s, dtype=torch.bfloat16) * 0.05)(D)
        return {
            "x": _w((lambda *s: torch.randn(*s, dtype=torch.bfloat16) * 0.05)(B, S, D)),
            "Lambda_re": _w(Lambda_re),
            "Lambda_im": _w(Lambda_im),
            "B_re": _w(B_re),
            "B_im": _w(B_im),
            "C_re": _w(C_re),
            "C_im": _w(C_im),
            "log_dt": _w(log_dt),
            "Dskip": _w(Dskip),
        }
    _A_in = _A_setup()

    def _B_setup():
        B, S, D, F = 1, 2048, 576, 4608
        return {
            "x": _w((lambda *s: torch.randn(*s, dtype=torch.bfloat16) * 0.05)(B, S, D)),
            "w1": _w((lambda *s: torch.randn(*s, dtype=torch.bfloat16) * 0.4)(D, F) * (2.0 / D) ** 0.5),
            "w3": _w((lambda *s: torch.randn(*s, dtype=torch.bfloat16) * 0.4)(D, F) * (2.0 / D) ** 0.5),
            "w2": _w((lambda *s: torch.randn(*s, dtype=torch.bfloat16) * 0.4)(F, D) * (2.0 / F) ** 0.5),
        }
    _B_in = _B_setup()

    return {
        "A_x": _A_in["x"],
        "A_Lambda_re": _A_in["Lambda_re"],
        "A_Lambda_im": _A_in["Lambda_im"],
        "A_B_re": _A_in["B_re"],
        "A_B_im": _A_in["B_im"],
        "A_C_re": _A_in["C_re"],
        "A_C_im": _A_in["C_im"],
        "A_log_dt": _A_in["log_dt"],
        "A_Dskip": _A_in["Dskip"],
        "B_x": _B_in["x"],
        "B_w1": _B_in["w1"],
        "B_w3": _B_in["w3"],
        "B_w2": _B_in["w2"],
    }

def reference(A_x, A_Lambda_re, A_Lambda_im, A_B_re, A_B_im, A_C_re, A_C_im, A_log_dt, A_Dskip, B_x, B_w1, B_w3, B_w2):
    def _A_ref(x, Lambda_re, Lambda_im, B_re, B_im, C_re, C_im, log_dt, Dskip):
        Bsz, L, H = x.shape
        Lam = Lambda_re + 1j * Lambda_im
        Bmat = B_re + 1j * B_im
        Cmat = C_re + 1j * C_im
        dt = torch.exp(log_dt)
        Lam_bar = torch.exp(dt * Lam)
        B_bar = ((Lam_bar - 1.0) / Lam)[:, None] * Bmat
        Bu = torch.einsum("bld,pd->blp", x + 0j, B_bar)
        h = torch.zeros_like(Bu[:, 0, :])
        hs = []
        for t in range(L):
            h = Lam_bar[None, :] * h + Bu[:, t, :]
            hs.append(h)
        hseq = torch.stack(hs, 1)
        y = 2.0 * torch.einsum("blp,dp->bld", hseq, Cmat).real + x * Dskip[None, None, :]
        return y

    def _B_ref(x, w1, w3, w2):
        gate = torch.einsum("bsd,df->bsf", x, w1)
        up = torch.einsum("bsd,df->bsf", x, w3)
        h = _silu(gate) * up
        out = torch.einsum("bsf,fd->bsd", h, w2)
        return out

    x = A_x
    xn = _layernorm(x, axis=-1)
    return x + _A_ref(xn, A_Lambda_re, A_Lambda_im, A_B_re, A_B_im, A_C_re, A_C_im, A_log_dt, A_Dskip) + _B_ref(xn, B_w1, B_w3, B_w2)
```

```asm
; @launch grid=(256,1,1) block=(512,1,1) lds=163840
.amdgcn_target "amdgcn-amd-amdhsa--gfx950"
.text
.globl parallel_sum__ssm_conv_s5__glu_gated_swiglu__prompt_kernel
.p2align 8
.type parallel_sum__ssm_conv_s5__glu_gated_swiglu__prompt_kernel,@function
parallel_sum__ssm_conv_s5__glu_gated_swiglu__prompt_kernel:
    s_cmp_ge_u32 s2, 256
    s_cbranch_scc1 LA_end
    s_load_dwordx16 s[32:47], s[0:1], 0
    s_load_dwordx16 s[48:63], s[0:1], 64
    v_lshrrev_b32 v1, 6, v0
    v_and_b32 v251, 63, v0
    s_and_b32 s87, s2, 7
    v_readfirstlane_b32 s3, v1
    s_lshr_b32 s86, s2, 3
    s_lshr_b32 s7, s87, 1
    s_and_b32 s6, s87, 1
    s_lshl_b32 s6, s6, 3
    s_lshr_b32 s88, s86, 2
    s_add_u32 s6, s6, s88
    s_add_u32 s89, s86, 0
    s_and_b32 s89, s89, 3
    s_and_b32 s4, s3, 3
    s_lshr_b32 s5, s3, 2
    s_lshl_b32 s64, s3, 10
    s_mov_b32 s90, 0x00003f80
    s_mov_b32 s91, 0x3f800000
    s_mov_b32 s97, 0xffff0000
    s_cmp_lg_u32 s3, 7
    s_cbranch_scc1 L_ctv
    s_getpc_b64 s[28:29]
L_pcv:
    s_sub_u32 s28, s28, L_pcv-parallel_sum__ssm_conv_s5__glu_gated_swiglu__prompt_kernel
    s_subb_u32 s29, s29, 0
    s_lshl_b32 s87, s86, 12
    v_and_b32 v10, 31, v251
    v_lshlrev_b32 v10, 7, v10
    v_add_u32_e64 v10, s87, v10
    v_min_u32 v10, L_code_end-parallel_sum__ssm_conv_s5__glu_gated_swiglu__prompt_kernel-4, v10
    v_mov_b32 v11, s29
    v_add_co_u32 v10, vcc, s28, v10
    s_nop 1
    v_addc_co_u32 v11, vcc, 0, v11, vcc
    global_load_dword v255, v[10:11], off
L_ctv:
    v_lshrrev_b32_e64 v4, 5, v251
    v_bfe_u32 v5, v251, 3, 2
    v_lshl_add_u32 v4, v4, 3, v5
    s_lshl_b32 s87, s4, 5
    s_lshl_b32 s88, s5, 4
    s_add_u32 s87, s87, s88
    s_lshl_b32 s88, s6, 7
    s_add_u32 s87, s87, s88
    v_add_u32 v4, s87, v4
    v_mul_u32_u24 v4, 1152, v4
    v_lshrrev_b32 v5, 4, v251
    s_lshl_b32 s87, s5, 2
    v_or_b32 v5, s87, v5
    v_and_b32 v6, 7, v251
    v_xor_b32_e64 v5, v5, v6
    v_lshl_add_u32 v239, v5, 4, v4
    s_cmp_eq_u32 s89, 3
    s_cselect_b32 s87, 0, s89
    s_mul_i32 s68, s87, 384
    s_add_u32 s69, s68, 384
    s_cmp_eq_u32 s69, 1152
    s_cselect_b32 s69, 0, s69
    s_add_u32 s70, s69, 384
    s_cmp_eq_u32 s70, 1152
    s_cselect_b32 s70, 0, s70
    s_lshl_b32 s95, s4, 11
    s_lshl_b32 s87, s5, 10
    s_add_u32 s95, s95, s87
    s_add_u32 s95, s95, 16384
    s_waitcnt lgkmcnt(0)
    s_mov_b32 s8, s32
    s_mov_b32 s9, s33
    s_mov_b32 s10, 2359296
    s_mov_b32 s11, 0x20000
    v_subrev_u32 v195, 256, v0
    s_mul_i32 s87, s7, 288
    v_lshl_add_u32 v7, v195, 1, s87
    s_mov_b32 s28, s34
    s_mov_b32 s29, s35
    s_mov_b32 s30, 1152
    s_mov_b32 s31, 0x20000
    s_lshl_b32 s87, s5, 2
    s_add_u32 s87, s87, s89
    s_cmp_lg_u32 s87, 7
    s_cbranch_scc1 L_nopar
    buffer_load_ushort v190, v7, s[28:31], 0 offen
    s_mov_b32 s28, s36
    s_mov_b32 s29, s37
    buffer_load_ushort v191, v7, s[28:31], 0 offen
    s_mov_b32 s28, s46
    s_mov_b32 s29, s47
    buffer_load_ushort v192, v7, s[28:31], 0 offen
L_nopar:
    s_lshl_b32 s67, s68, 6
    s_add_u32 s67, s67, s95
    s_add_u32 m0, s67, 0
    s_nop 0
    buffer_load_dwordx4 v239, s[8:11], s68 offen offset:0 lds
    s_lshl_b32 s67, s68, 6
    s_add_u32 s67, s67, s95
    s_add_u32 m0, s67, 8064
    s_nop 0
    buffer_load_dwordx4 v239, s[8:11], s68 offen offset:128 lds
    s_lshl_b32 s67, s68, 6
    s_add_u32 s67, s67, s95
    s_add_u32 m0, s67, 16128
    s_nop 0
    buffer_load_dwordx4 v239, s[8:11], s68 offen offset:256 lds
    s_lshl_b32 s67, s69, 6
    s_add_u32 s67, s67, s95
    s_add_u32 m0, s67, 0
    s_nop 0
    buffer_load_dwordx4 v239, s[8:11], s69 offen offset:0 lds
    s_lshl_b32 s67, s69, 6
    s_add_u32 s67, s67, s95
    s_add_u32 m0, s67, 8064
    s_nop 0
    buffer_load_dwordx4 v239, s[8:11], s69 offen offset:128 lds
    s_lshl_b32 s67, s69, 6
    s_add_u32 s67, s67, s95
    s_add_u32 m0, s67, 16128
    s_nop 0
    buffer_load_dwordx4 v239, s[8:11], s69 offen offset:256 lds
    s_lshl_b32 s67, s70, 6
    s_add_u32 s67, s67, s95
    s_add_u32 m0, s67, 0
    s_nop 0
    buffer_load_dwordx4 v239, s[8:11], s70 offen offset:0 lds
    s_lshl_b32 s67, s70, 6
    s_add_u32 s67, s67, s95
    s_add_u32 m0, s67, 8064
    s_nop 0
    buffer_load_dwordx4 v239, s[8:11], s70 offen offset:128 lds
    s_lshl_b32 s67, s70, 6
    s_add_u32 s67, s67, s95
    s_add_u32 m0, s67, 16128
    s_nop 0
    buffer_load_dwordx4 v239, s[8:11], s70 offen offset:256 lds
    s_lshl_b32 s67, s68, 6
    s_add_u32 s67, s67, s95
    s_add_u32 m0, s67, 73728
    s_add_u32 s67, s68, 4608
    buffer_load_dwordx4 v239, s[8:11], s67 offen offset:0 lds
    s_lshl_b32 s67, s68, 6
    s_add_u32 s67, s67, s95
    s_add_u32 m0, s67, 81792
    s_add_u32 s67, s68, 4608
    buffer_load_dwordx4 v239, s[8:11], s67 offen offset:128 lds
    s_cmp_eq_u32 s5, 0
    s_cselect_b32 s12, s52, s54
    s_cselect_b32 s13, s53, s55
    s_mov_b32 s14, 5308416
    s_mov_b32 s15, 0x20000
    s_mov_b32 s16, s38
    s_mov_b32 s17, s39
    s_mov_b32 s18, 663552
    s_mov_b32 s19, 0x20000
    s_mov_b32 s20, s40
    s_mov_b32 s21, s41
    s_mov_b32 s22, 663552
    s_mov_b32 s23, 0x20000
    s_mov_b32 s24, s62
    s_mov_b32 s25, s63
    s_mov_b32 s26, 50331648
    s_mov_b32 s27, 0x20000
    v_lshrrev_b32 v4, 3, v251
    s_lshl_b32 s87, s4, 3
    v_add_u32 v4, s87, v4
    v_mul_u32_u24 v4, 9216, v4
    v_bfe_u32 v5, v251, 4, 1
    s_and_b32 s87, s3, 1
    s_lshl_b32 s87, s87, 1
    v_or_b32_e64 v5, s87, v5
    v_bfe_u32 v6, v251, 1, 2
    v_xor_b32_e64 v5, v5, v6
    v_lshl_add_u32 v4, v5, 5, v4
    v_and_b32_e64 v6, 1, v251
    v_lshl_add_u32 v244, v6, 4, v4
    v_lshrrev_b32 v4, 3, v251
    s_lshl_b32 s87, s3, 3
    v_add_u32_e64 v4, s87, v4
    v_mul_u32_u24 v4, 1152, v4
    v_lshrrev_b32 v5, 4, v251
    s_and_b32 s87, s3, 1
    s_lshl_b32 s87, s87, 2
    v_or_b32 v5, s87, v5
    v_and_b32 v6, 7, v251
    v_xor_b32 v5, v5, v6
    v_lshl_add_u32 v245, v5, 4, v4
    s_lshl_b32 s87, s4, 11
    s_lshl_b32 s88, s5, 13
    s_add_u32 s87, s87, s88
    v_lshl_add_u32 v246, v251, 4, s87
    v_lshrrev_b32 v4, 4, v251
    v_bfe_u32 v5, v251, 2, 2
    v_lshl_add_u32 v6, v4, 3, v5
    v_lshlrev_b32 v6, 7, v6
    v_and_b32 v9, 3, v251
    v_lshl_add_u32 v6, v9, 3, v6
    v_lshrrev_b32 v5, 1, v5
    v_and_b32 v9, 1, v4
    v_lshl_or_b32 v5, v9, 1, v5
    s_lshl_b32 s87, s5, 1
    v_xor_b32 v5, s87, v5
    v_lshl_add_u32 v240, v5, 5, v6
    v_xor_b32 v241, 32, v240
    v_and_b32 v5, 15, v251
    v_lshrrev_b32 v6, 1, v5
    v_xor_b32 v6, v6, v4
    v_lshlrev_b32_e64 v6, 4, v6
    v_lshl_add_u32 v6, v5, 7, v6
    s_lshl_b32 s87, s5, 11
    v_add_u32 v242, s87, v6
    v_xor_b32 v243, 64, v242
    s_lshl_b32 s87, s4, 11
    s_add_u32 s87, s87, 16384
    v_add_u32 v252, s87, v6
    v_xor_b32 v253, 64, v252
    v_cmp_eq_u32 s[74:75], 1, v4
    v_cmp_eq_u32 s[76:77], 2, v4
    v_cmp_eq_u32 s[78:79], 3, v4
    s_cmp_eq_u32 s4, 1
    s_cselect_b64 s[80:81], -1, 0
    s_cmp_eq_u32 s4, 2
    s_cselect_b64 s[82:83], -1, 0
    s_cmp_eq_u32 s4, 3
    s_cselect_b64 s[84:85], -1, 0
    s_lshl_b32 s87, s5, 4
    v_add_u32 v5, s87, v5
    v_mul_u32_u24_e64 v5, 56, v5
    v_add_u32 v254, 147456, v5
    v_mov_b32 v232, 0x3f803f80
    v_mov_b32 v233, 0x3f803f80
    v_mov_b32 v234, 0x3f803f80
    v_mov_b32 v235, 0x3f803f80
    s_mul_i32 s71, s7, 18
    s_mul_i32 s87, s89, 5
    s_add_u32 s71, s71, s87
    s_cmp_lt_u32 s3, 6
    s_cselect_b32 s28, s42, s44
    s_cselect_b32 s29, s43, s45
    s_cmp_lt_u32 s3, 4
    s_cselect_b32 s28, s56, s28
    s_cselect_b32 s29, s57, s29
    s_mov_b32 s30, 663552
    s_cselect_b32 s30, 5308416, s30
    s_mov_b32 s31, 0x20000
    s_mul_i32 s87, s7, 1327104
    s_mul_i32 s88, s86, 41472
    s_add_u32 s87, s87, s88
    s_mul_i32 s88, s3, 10368
    s_add_u32 s72, s87, s88
    s_mul_i32 s87, s86, 20736
    s_and_b32 s88, s3, 1
    s_mul_i32 s88, s88, 10368
    s_add_u32 s87, s87, s88
    s_cmp_lt_u32 s3, 4
    s_cselect_b32 s72, s72, s87
    s_and_b32 s87, s6, 7
    s_mul_i32 s87, s87, 72
    s_mul_i32 s88, s4, 18
    s_add_u32 s87, s87, s88
    s_mul_i32 s98, s87, 9216
    s_lshl_b32 s88, s71, 7
    s_add_u32 s98, s98, s88
    s_lshl_b32 s99, s87, 7
    s_mul_i32 s88, s7, 165888
    s_add_u32 s99, s99, s88
    s_cmp_eq_u32 s5, 0
    s_cselect_b32 s40, s38, s40
    s_cselect_b32 s41, s39, s41
    s_mov_b32 s42, 663552
    s_mov_b32 s43, 0x20000
    s_and_b32 s87, s2, 7
    s_mul_i32 s87, s87, 24
    s_and_b32 s88, s6, 7
    s_mul_i32 s88, s88, 3
    s_add_u32 s87, s87, s88
    s_add_u32 s87, s87, s89
    s_mul_i32 s39, s87, 27648
    s_mul_i32 s88, s3, 6912
    s_add_u32 s39, s39, s88
    s_mul_i32 s87, s87, 3456
    s_and_b32 s88, s3, 1
    s_mul_i32 s88, s88, 1728
    s_add_u32 s87, s87, s88
    s_cmp_lt_u32 s3, 4
    s_cselect_b32 s39, s39, s87
    s_cselect_b32 s37, 7, 2
    s_lshl_b32 s37, s37, 9
    s_movk_i32 s62, 256
    s_mov_b32 s63, 0x20000
    s_cmp_eq_u32 s89, 3
    s_cbranch_scc1 LA_M
    s_add_u32 s99, s98, 256
    s_and_b32 s87, s6, 3
    s_cmp_ge_u32 s87, 5
    s_cselect_b32 s88, 5, 0
    s_sub_u32 s87, s87, s88
    s_add_u32 s65, s71, s87
    s_lshl_b32 s65, s65, 7
    s_add_u32 s98, s71, 5
    s_lshl_b32 s98, s98, 7
    s_add_u32 s66, s65, 128
    s_cmp_eq_u32 s66, s98
    s_cselect_b32 s87, 640, 0
    s_sub_u32 s66, s66, s87
    s_or_b32 s38, s7, s89
    s_or_b32 s38, s38, s3
    s_cmp_lg_u32 s38, 0
    s_cbranch_scc1 L_nosc
    v_bfe_u32 v176, v246, 8, 2
    v_lshlrev_b32 v176, 15, v176
    v_bfe_u32 v177, v246, 4, 4
    v_lshl_add_u32 v176, v177, 7, v176
    s_lshl_b32 s38, s6, 11
    s_add_u32 s38, s38, 23789568
    buffer_load_dword v176, v176, s[24:27], s38 offen sc1
L_nosc:
    s_lshl_b32 s67, s68, 6
    s_add_u32 s67, s67, s95
    s_add_u32 m0, s67, 89856
    s_add_u32 s67, s68, 4608
    buffer_load_dwordx4 v239, s[8:11], s67 offen offset:256 lds
    s_lshl_b32 s67, s69, 6
    s_add_u32 s67, s67, s95
    s_add_u32 m0, s67, 73728
    s_add_u32 s67, s69, 4608
    buffer_load_dwordx4 v239, s[8:11], s67 offen offset:0 lds
    s_waitcnt vmcnt(4)
    s_barrier
    ds_read_b128 v[0:3], v252 offset:0
    ds_read_b128 v[8:11], v253 offset:0
    ds_read_b128 v[16:19], v252 offset:8192
    ds_read_b128 v[24:27], v253 offset:8192
    ds_read_b128 v[32:35], v252 offset:16384
    ds_read_b128 v[40:43], v253 offset:16384
    ds_read_b128 v[48:51], v252 offset:24576
    ds_read_b128 v[56:59], v253 offset:24576
    s_waitcnt lgkmcnt(7)
    v_mfma_f32_16x16x32_bf16 v[200:203], v[232:235], v[0:3], 0
    ds_read_b128 v[64:67], v252 offset:32768
    s_waitcnt lgkmcnt(7)
    v_mfma_f32_16x16x32_bf16 v[200:203], v[232:235], v[8:11], v[200:203]
    ds_read_b128 v[72:75], v253 offset:32768
    s_waitcnt lgkmcnt(7)
    v_mfma_f32_16x16x32_bf16 v[200:203], v[232:235], v[16:19], v[200:203]
    ds_read_b128 v[80:83], v252 offset:40960
    s_waitcnt lgkmcnt(7)
    v_mfma_f32_16x16x32_bf16 v[200:203], v[232:235], v[24:27], v[200:203]
    ds_read_b128 v[88:91], v253 offset:40960
    s_lshl_b32 s67, s69, 6
    s_add_u32 s67, s67, s95
    s_add_u32 m0, s67, 81792
    s_add_u32 s67, s69, 4608
    buffer_load_dwordx4 v239, s[8:11], s67 offen offset:128 lds
    s_waitcnt lgkmcnt(7)
    v_mfma_f32_16x16x32_bf16 v[200:203], v[232:235], v[32:35], v[200:203]
    v_add_u32 v252, 49152, v252
    v_add_u32 v253, 49152, v253
    ds_read_b128 v[96:99], v252 offset:0
    s_waitcnt lgkmcnt(7)
    v_mfma_f32_16x16x32_bf16 v[200:203], v[232:235], v[40:43], v[200:203]
    ds_read_b128 v[104:107], v253 offset:0
    s_waitcnt lgkmcnt(7)
    v_mfma_f32_16x16x32_bf16 v[200:203], v[232:235], v[48:51], v[200:203]
    ds_read_b128 v[112:115], v252 offset:8192
    s_waitcnt lgkmcnt(7)
    v_mfma_f32_16x16x32_bf16 v[200:203], v[232:235], v[56:59], v[200:203]
    ds_read_b128 v[120:123], v253 offset:8192
    s_waitcnt lgkmcnt(7)
    v_mfma_f32_16x16x32_bf16 v[200:203], v[232:235], v[64:67], v[200:203]
    ds_read_b128 v[128:131], v252 offset:16384
    s_waitcnt lgkmcnt(7)
    v_mfma_f32_16x16x32_bf16 v[200:203], v[232:235], v[72:75], v[200:203]
    ds_read_b128 v[136:139], v253 offset:16384
    s_lshl_b32 s67, s69, 6
    s_add_u32 s67, s67, s95
    s_add_u32 m0, s67, 89856
    s_add_u32 s67, s69, 4608
    buffer_load_dwordx4 v239, s[8:11], s67 offen offset:256 lds
    s_waitcnt lgkmcnt(7)
    v_mfma_f32_16x16x32_bf16 v[200:203], v[232:235], v[80:83], v[200:203]
    s_waitcnt lgkmcnt(6)
    v_mfma_f32_16x16x32_bf16 v[200:203], v[232:235], v[88:91], v[200:203]
    s_waitcnt lgkmcnt(5)
    v_mfma_f32_16x16x32_bf16 v[200:203], v[232:235], v[96:99], v[200:203]
    s_waitcnt lgkmcnt(4)
    v_mfma_f32_16x16x32_bf16 v[200:203], v[232:235], v[104:107], v[200:203]
    s_waitcnt lgkmcnt(3)
    v_mfma_f32_16x16x32_bf16 v[200:203], v[232:235], v[112:115], v[200:203]
    s_waitcnt lgkmcnt(2)
    v_mfma_f32_16x16x32_bf16 v[200:203], v[232:235], v[120:123], v[200:203]
    s_lshl_b32 s67, s70, 6
    s_add_u32 s67, s67, s95
    s_add_u32 m0, s67, 73728
    s_add_u32 s67, s70, 4608
    buffer_load_dwordx4 v239, s[8:11], s67 offen offset:0 lds
    s_waitcnt lgkmcnt(1)
    v_mfma_f32_16x16x32_bf16 v[200:203], v[232:235], v[128:131], v[200:203]
    s_waitcnt lgkmcnt(0)
    v_mfma_f32_16x16x32_bf16 v[200:203], v[232:235], v[136:139], v[200:203]
    s_barrier
    v_add_u32 v252, 24576, v252
    v_add_u32 v253, 24576, v253
    s_cmp_lg_u32 s5, 0
    s_cbranch_scc1 L_ngF0
    v_mfma_f32_16x16x32_bf16 v[204:207], v[0:3], v[0:3], 0
    v_mfma_f32_16x16x32_bf16 v[204:207], v[8:11], v[8:11], v[204:207]
    v_mfma_f32_16x16x32_bf16 v[204:207], v[16:19], v[16:19], v[204:207]
    v_mfma_f32_16x16x32_bf16 v[204:207], v[24:27], v[24:27], v[204:207]
    v_mfma_f32_16x16x32_bf16 v[204:207], v[32:35], v[32:35], v[204:207]
    v_mfma_f32_16x16x32_bf16 v[204:207], v[40:43], v[40:43], v[204:207]
    v_mfma_f32_16x16x32_bf16 v[204:207], v[48:51], v[48:51], v[204:207]
    v_mfma_f32_16x16x32_bf16 v[204:207], v[56:59], v[56:59], v[204:207]
    v_mfma_f32_16x16x32_bf16 v[204:207], v[64:67], v[64:67], v[204:207]
    v_mfma_f32_16x16x32_bf16 v[204:207], v[72:75], v[72:75], v[204:207]
    v_mfma_f32_16x16x32_bf16 v[204:207], v[80:83], v[80:83], v[204:207]
    v_mfma_f32_16x16x32_bf16 v[204:207], v[88:91], v[88:91], v[204:207]
    v_mfma_f32_16x16x32_bf16 v[204:207], v[96:99], v[96:99], v[204:207]
    v_mfma_f32_16x16x32_bf16 v[204:207], v[104:107], v[104:107], v[204:207]
    v_mfma_f32_16x16x32_bf16 v[204:207], v[112:115], v[112:115], v[204:207]
    v_mfma_f32_16x16x32_bf16 v[204:207], v[120:123], v[120:123], v[204:207]
    v_mfma_f32_16x16x32_bf16 v[204:207], v[128:131], v[128:131], v[204:207]
    v_mfma_f32_16x16x32_bf16 v[204:207], v[136:139], v[136:139], v[204:207]
L_ngF0:
    s_nop 4
    v_mul_f32 v200, 0x3ae38e39, v200
    v_cvt_pk_bf16_f32 v251, v200, v200
    v_lshlrev_b32 v251, 16, v251
    v_xor_b32 v251, 0x80000000, v251
    v_dot2_f32_bf16 v144, v0, s90, v251
    v_dot2_f32_bf16 v145, v0, s91, v251
    v_dot2_f32_bf16 v146, v1, s90, v251
    v_dot2_f32_bf16 v147, v1, s91, v251
    v_dot2_f32_bf16 v148, v2, s90, v251
    v_dot2_f32_bf16 v149, v2, s91, v251
    v_dot2_f32_bf16 v150, v3, s90, v251
    v_dot2_f32_bf16 v151, v3, s91, v251
    v_cvt_pk_bf16_f32 v0, v144, v145
    v_cvt_pk_bf16_f32 v1, v146, v147
    v_cvt_pk_bf16_f32 v2, v148, v149
    v_cvt_pk_bf16_f32 v3, v150, v151
    v_dot2_f32_bf16 v152, v8, s90, v251
    v_dot2_f32_bf16 v153, v8, s91, v251
    v_dot2_f32_bf16 v154, v9, s90, v251
    v_dot2_f32_bf16 v155, v9, s91, v251
    v_dot2_f32_bf16 v156, v10, s90, v251
    v_dot2_f32_bf16 v157, v10, s91, v251
    v_dot2_f32_bf16 v158, v11, s90, v251
    v_dot2_f32_bf16 v159, v11, s91, v251
    s_lshl_b32 s67, s70, 6
    s_add_u32 s67, s67, s95
    s_add_u32 m0, s67, 81792
    s_add_u32 s67, s70, 4608
    buffer_load_dwordx4 v239, s[8:11], s67 offen offset:128 lds
    v_cvt_pk_bf16_f32 v8, v152, v153
    v_cvt_pk_bf16_f32 v9, v154, v155
    v_cvt_pk_bf16_f32 v10, v156, v157
    v_cvt_pk_bf16_f32 v11, v158, v159
    v_dot2_f32_bf16 v144, v16, s90, v251
    v_dot2_f32_bf16 v145, v16, s91, v251
    v_dot2_f32_bf16 v146, v17, s90, v251
    v_dot2_f32_bf16 v147, v17, s91, v251
    v_dot2_f32_bf16 v148, v18, s90, v251
    v_dot2_f32_bf16 v149, v18, s91, v251
    v_dot2_f32_bf16 v150, v19, s90, v251
    v_dot2_f32_bf16 v151, v19, s91, v251
    v_cvt_pk_bf16_f32 v16, v144, v145
    v_cvt_pk_bf16_f32 v17, v146, v147
    v_cvt_pk_bf16_f32 v18, v148, v149
    v_cvt_pk_bf16_f32 v19, v150, v151
    v_dot2_f32_bf16 v152, v24, s90, v251
    v_dot2_f32_bf16 v153, v24, s91, v251
    v_dot2_f32_bf16 v154, v25, s90, v251
    v_dot2_f32_bf16 v155, v25, s91, v251
    v_dot2_f32_bf16 v156, v26, s90, v251
    v_dot2_f32_bf16 v157, v26, s91, v251
    v_dot2_f32_bf16 v158, v27, s90, v251
    v_dot2_f32_bf16 v159, v27, s91, v251
    s_lshl_b32 s67, s70, 6
    s_add_u32 s67, s67, s95
    s_add_u32 m0, s67, 89856
    s_add_u32 s67, s70, 4608
    buffer_load_dwordx4 v239, s[8:11], s67 offen offset:256 lds
    v_cvt_pk_bf16_f32 v24, v152, v153
    v_cvt_pk_bf16_f32 v25, v154, v155
    v_cvt_pk_bf16_f32 v26, v156, v157
    v_cvt_pk_bf16_f32 v27, v158, v159
    v_dot2_f32_bf16 v144, v32, s90, v251
    v_dot2_f32_bf16 v145, v32, s91, v251
    v_dot2_f32_bf16 v146, v33, s90, v251
    v_dot2_f32_bf16 v147, v33, s91, v251
    v_dot2_f32_bf16 v148, v34, s90, v251
    v_dot2_f32_bf16 v149, v34, s91, v251
    v_dot2_f32_bf16 v150, v35, s90, v251
    v_dot2_f32_bf16 v151, v35, s91, v251
    v_cvt_pk_bf16_f32 v32, v144, v145
    v_cvt_pk_bf16_f32 v33, v146, v147
    v_cvt_pk_bf16_f32 v34, v148, v149
    v_cvt_pk_bf16_f32 v35, v150, v151
    v_dot2_f32_bf16 v152, v40, s90, v251
    v_dot2_f32_bf16 v153, v40, s91, v251
    v_dot2_f32_bf16 v154, v41, s90, v251
    v_dot2_f32_bf16 v155, v41, s91, v251
    v_dot2_f32_bf16 v156, v42, s90, v251
    v_dot2_f32_bf16 v157, v42, s91, v251
    v_dot2_f32_bf16 v158, v43, s90, v251
    v_dot2_f32_bf16 v159, v43, s91, v251
    v_cvt_pk_bf16_f32 v40, v152, v153
    v_cvt_pk_bf16_f32 v41, v154, v155
    v_cvt_pk_bf16_f32 v42, v156, v157
    v_cvt_pk_bf16_f32 v43, v158, v159
    v_dot2_f32_bf16 v144, v48, s90, v251
    v_dot2_f32_bf16 v145, v48, s91, v251
    v_dot2_f32_bf16 v146, v49, s90, v251
    v_dot2_f32_bf16 v147, v49, s91, v251
    v_dot2_f32_bf16 v148, v50, s90, v251
    v_dot2_f32_bf16 v149, v50, s91, v251
    v_dot2_f32_bf16 v150, v51, s90, v251
    v_dot2_f32_bf16 v151, v51, s91, v251
    v_cvt_pk_bf16_f32 v48, v144, v145
    v_cvt_pk_bf16_f32 v49, v146, v147
    v_cvt_pk_bf16_f32 v50, v148, v149
    v_cvt_pk_bf16_f32 v51, v150, v151
    v_dot2_f32_bf16 v152, v56, s90, v251
    v_dot2_f32_bf16 v153, v56, s91, v251
    v_dot2_f32_bf16 v154, v57, s90, v251
    v_dot2_f32_bf16 v155, v57, s91, v251
    v_dot2_f32_bf16 v156, v58, s90, v251
    v_dot2_f32_bf16 v157, v58, s91, v251
    v_dot2_f32_bf16 v158, v59, s90, v251
    v_dot2_f32_bf16 v159, v59, s91, v251
    v_cvt_pk_bf16_f32 v56, v152, v153
    v_cvt_pk_bf16_f32 v57, v154, v155
    v_cvt_pk_bf16_f32 v58, v156, v157
    v_cvt_pk_bf16_f32 v59, v158, v159
    v_dot2_f32_bf16 v144, v64, s90, v251
    v_dot2_f32_bf16 v145, v64, s91, v251
    v_dot2_f32_bf16 v146, v65, s90, v251
    v_dot2_f32_bf16 v147, v65, s91, v251
    v_dot2_f32_bf16 v148, v66, s90, v251
    v_dot2_f32_bf16 v149, v66, s91, v251
    v_dot2_f32_bf16 v150, v67, s90, v251
    v_dot2_f32_bf16 v151, v67, s91, v251
    v_cvt_pk_bf16_f32 v64, v144, v145
    v_cvt_pk_bf16_f32 v65, v146, v147
    v_cvt_pk_bf16_f32 v66, v148, v149
    v_cvt_pk_bf16_f32 v67, v150, v151
    v_dot2_f32_bf16 v152, v72, s90, v251
    v_dot2_f32_bf16 v153, v72, s91, v251
    v_dot2_f32_bf16 v154, v73, s90, v251
    v_dot2_f32_bf16 v155, v73, s91, v251
    v_dot2_f32_bf16 v156, v74, s90, v251
    v_dot2_f32_bf16 v157, v74, s91, v251
    v_dot2_f32_bf16 v158, v75, s90, v251
    v_dot2_f32_bf16 v159, v75, s91, v251
    v_cvt_pk_bf16_f32 v72, v152, v153
    v_cvt_pk_bf16_f32 v73, v154, v155
    v_cvt_pk_bf16_f32 v74, v156, v157
    v_cvt_pk_bf16_f32 v75, v158, v159
    v_dot2_f32_bf16 v144, v80, s90, v251
    v_dot2_f32_bf16 v145, v80, s91, v251
    v_dot2_f32_bf16 v146, v81, s90, v251
    v_dot2_f32_bf16 v147, v81, s91, v251
    v_dot2_f32_bf16 v148, v82, s90, v251
    v_dot2_f32_bf16 v149, v82, s91, v251
    v_dot2_f32_bf16 v150, v83, s90, v251
    v_dot2_f32_bf16 v151, v83, s91, v251
    s_add_u32 m0, s64, 0
    s_add_u32 s67, s65, 0
    buffer_load_dwordx4 v244, s[12:15], s67 offen lds
    v_cvt_pk_bf16_f32 v80, v144, v145
    v_cvt_pk_bf16_f32 v81, v146, v147
    v_cvt_pk_bf16_f32 v82, v148, v149
    v_cvt_pk_bf16_f32 v83, v150, v151
    v_dot2_f32_bf16 v152, v88, s90, v251
    v_dot2_f32_bf16 v153, v88, s91, v251
    v_dot2_f32_bf16 v154, v89, s90, v251
    v_dot2_f32_bf16 v155, v89, s91, v251
    v_dot2_f32_bf16 v156, v90, s90, v251
    v_dot2_f32_bf16 v157, v90, s91, v251
    v_dot2_f32_bf16 v158, v91, s90, v251
    v_dot2_f32_bf16 v159, v91, s91, v251
    v_cvt_pk_bf16_f32 v88, v152, v153
    v_cvt_pk_bf16_f32 v89, v154, v155
    v_cvt_pk_bf16_f32 v90, v156, v157
    v_cvt_pk_bf16_f32 v91, v158, v159
    v_dot2_f32_bf16 v144, v96, s90, v251
    v_dot2_f32_bf16 v145, v96, s91, v251
    v_dot2_f32_bf16 v146, v97, s90, v251
    v_dot2_f32_bf16 v147, v97, s91, v251
    v_dot2_f32_bf16 v148, v98, s90, v251
    v_dot2_f32_bf16 v149, v98, s91, v251
    v_dot2_f32_bf16 v150, v99, s90, v251
    v_dot2_f32_bf16 v151, v99, s91, v251
    s_add_u32 m0, s64, 8192
    s_add_u32 s67, s65, 294912
    buffer_load_dwordx4 v244, s[12:15], s67 offen lds
    v_cvt_pk_bf16_f32 v96, v144, v145
    v_cvt_pk_bf16_f32 v97, v146, v147
    v_cvt_pk_bf16_f32 v98, v148, v149
    v_cvt_pk_bf16_f32 v99, v150, v151
    v_dot2_f32_bf16 v152, v104, s90, v251
    v_dot2_f32_bf16 v153, v104, s91, v251
    v_dot2_f32_bf16 v154, v105, s90, v251
    v_dot2_f32_bf16 v155, v105, s91, v251
    v_dot2_f32_bf16 v156, v106, s90, v251
    v_dot2_f32_bf16 v157, v106, s91, v251
    v_dot2_f32_bf16 v158, v107, s90, v251
    v_dot2_f32_bf16 v159, v107, s91, v251
    v_cvt_pk_bf16_f32 v104, v152, v153
    v_cvt_pk_bf16_f32 v105, v154, v155
    v_cvt_pk_bf16_f32 v106, v156, v157
    v_cvt_pk_bf16_f32 v107, v158, v159
    v_dot2_f32_bf16 v144, v112, s90, v251
    v_dot2_f32_bf16 v145, v112, s91, v251
    v_dot2_f32_bf16 v146, v113, s90, v251
    v_dot2_f32_bf16 v147, v113, s91, v251
    v_dot2_f32_bf16 v148, v114, s90, v251
    v_dot2_f32_bf16 v149, v114, s91, v251
    v_dot2_f32_bf16 v150, v115, s90, v251
    v_dot2_f32_bf16 v151, v115, s91, v251
    s_add_u32 m0, s64, 16384
    s_add_u32 s67, s65, 589824
    buffer_load_dwordx4 v244, s[12:15], s67 offen lds
    v_cvt_pk_bf16_f32 v112, v144, v145
    v_cvt_pk_bf16_f32 v113, v146, v147
    v_cvt_pk_bf16_f32 v114, v148, v149
    v_cvt_pk_bf16_f32 v115, v150, v151
    v_dot2_f32_bf16 v152, v120, s90, v251
    v_dot2_f32_bf16 v153, v120, s91, v251
    v_dot2_f32_bf16 v154, v121, s90, v251
    v_dot2_f32_bf16 v155, v121, s91, v251
    v_dot2_f32_bf16 v156, v122, s90, v251
    v_dot2_f32_bf16 v157, v122, s91, v251
    v_dot2_f32_bf16 v158, v123, s90, v251
    v_dot2_f32_bf16 v159, v123, s91, v251
    v_cvt_pk_bf16_f32 v120, v152, v153
    v_cvt_pk_bf16_f32 v121, v154, v155
    v_cvt_pk_bf16_f32 v122, v156, v157
    v_cvt_pk_bf16_f32 v123, v158, v159
    v_dot2_f32_bf16 v144, v128, s90, v251
    v_dot2_f32_bf16 v145, v128, s91, v251
    v_dot2_f32_bf16 v146, v129, s90, v251
    v_dot2_f32_bf16 v147, v129, s91, v251
    v_dot2_f32_bf16 v148, v130, s90, v251
    v_dot2_f32_bf16 v149, v130, s91, v251
    v_dot2_f32_bf16 v150, v131, s90, v251
    v_dot2_f32_bf16 v151, v131, s91, v251
    s_add_u32 m0, s64, 24576
    s_add_u32 s67, s65, 884736
    buffer_load_dwordx4 v244, s[12:15], s67 offen lds
    v_cvt_pk_bf16_f32 v128, v144, v145
    v_cvt_pk_bf16_f32 v129, v146, v147
    v_cvt_pk_bf16_f32 v130, v148, v149
    v_cvt_pk_bf16_f32 v131, v150, v151
    v_dot2_f32_bf16 v152, v136, s90, v251
    v_dot2_f32_bf16 v153, v136, s91, v251
    v_dot2_f32_bf16 v154, v137, s90, v251
    v_dot2_f32_bf16 v155, v137, s91, v251
    v_dot2_f32_bf16 v156, v138, s90, v251
    v_dot2_f32_bf16 v157, v138, s91, v251
    v_dot2_f32_bf16 v158, v139, s90, v251
    v_dot2_f32_bf16 v159, v139, s91, v251
    s_waitcnt vmcnt(9)
    s_or_b32 s38, s7, s89
    s_or_b32 s38, s38, s3
    s_cmp_lg_u32 s38, 0
    s_cbranch_scc1 L_nonon
    v_readfirstlane_b32 s92, v176
    s_nop 3
L_nonx:
    s_add_u32 s92, s92, 0x9e3779b1
    s_cmp_eq_u32 s92, 0
    s_cbranch_scc1 L_nonx
    v_cmp_eq_u32 vcc, s92, v176
    s_cbranch_vccnz L_nonx
    s_lshr_b32 s38, s6, 2
    s_lshl_b32 s38, s38, 4
    s_add_u32 s38, s38, s6
    s_and_b32 s38, s38, 0x33
    s_lshl_b32 s38, s38, 2
    s_add_u32 s38, s38, 16
    v_mov_b32_e64 v255, s92
    s_mov_b64 exec, 1
    buffer_store_dword v255, off, s[60:63], s38 sc1
    s_mov_b64 exec, -1
L_nonon:
    v_cvt_pk_bf16_f32 v136, v152, v153
    v_cvt_pk_bf16_f32 v137, v154, v155
    v_cvt_pk_bf16_f32 v138, v156, v157
    v_cvt_pk_bf16_f32 v139, v158, v159
    s_waitcnt vmcnt(4)
    s_barrier
    ds_read_b128 v[4:7], v252 offset:0
    ds_read_b128 v[12:15], v253 offset:0
    ds_read_b128 v[20:23], v252 offset:8192
    ds_read_b128 v[28:31], v253 offset:8192
    ds_read_b128 v[36:39], v252 offset:16384
    ds_read_b128 v[44:47], v253 offset:16384
    ds_read_b128 v[52:55], v252 offset:24576
    ds_read_b128 v[60:63], v253 offset:24576
    s_waitcnt lgkmcnt(7)
    v_mfma_f32_16x16x32_bf16 v[196:199], v[232:235], v[4:7], 0
    ds_read_b128 v[68:71], v252 offset:32768
    s_waitcnt lgkmcnt(7)
    v_mfma_f32_16x16x32_bf16 v[196:199], v[232:235], v[12:15], v[196:199]
    ds_read_b128 v[76:79], v253 offset:32768
    s_waitcnt lgkmcnt(7)
    v_mfma_f32_16x16x32_bf16 v[196:199], v[232:235], v[20:23], v[196:199]
    ds_read_b128 v[84:87], v252 offset:40960
    s_waitcnt lgkmcnt(7)
    v_mfma_f32_16x16x32_bf16 v[196:199], v[232:235], v[28:31], v[196:199]
    ds_read_b128 v[92:95], v253 offset:40960
    s_waitcnt lgkmcnt(7)
    v_mfma_f32_16x16x32_bf16 v[196:199], v[232:235], v[36:39], v[196:199]
    v_add_u32 v252, 49152, v252
    v_add_u32 v253, 49152, v253
    ds_read_b128 v[100:103], v252 offset:0
    s_add_u32 m0, s64, 32768
    s_add_u32 s67, s65, 1179648
    buffer_load_dwordx4 v244, s[12:15], s67 offen lds
    s_waitcnt lgkmcnt(7)
    v_mfma_f32_16x16x32_bf16 v[196:199], v[232:235], v[44:47], v[196:199]
    ds_read_b128 v[108:111], v253 offset:0
    s_waitcnt lgkmcnt(7)
    v_mfma_f32_16x16x32_bf16 v[196:199], v[232:235], v[52:55], v[196:199]
    ds_read_b128 v[116:119], v252 offset:8192
    s_waitcnt lgkmcnt(7)
    v_mfma_f32_16x16x32_bf16 v[196:199], v[232:235], v[60:63], v[196:199]
    ds_read_b128 v[124:127], v253 offset:8192
    s_waitcnt lgkmcnt(7)
    v_mfma_f32_16x16x32_bf16 v[196:199], v[232:235], v[68:71], v[196:199]
    ds_read_b128 v[132:135], v252 offset:16384
    s_waitcnt lgkmcnt(7)
    v_mfma_f32_16x16x32_bf16 v[196:199], v[232:235], v[76:79], v[196:199]
    ds_read_b128 v[140:143], v253 offset:16384
    s_waitcnt lgkmcnt(7)
    v_mfma_f32_16x16x32_bf16 v[196:199], v[232:235], v[84:87], v[196:199]
    s_add_u32 m0, s64, 40960
    s_add_u32 s67, s65, 1474560
    buffer_load_dwordx4 v244, s[12:15], s67 offen lds
    s_waitcnt lgkmcnt(6)
    v_mfma_f32_16x16x32_bf16 v[196:199], v[232:235], v[92:95], v[196:199]
    s_waitcnt lgkmcnt(5)
    v_mfma_f32_16x16x32_bf16 v[196:199], v[232:235], v[100:103], v[196:199]
    s_waitcnt lgkmcnt(4)
    v_mfma_f32_16x16x32_bf16 v[196:199], v[232:235], v[108:111], v[196:199]
    s_waitcnt lgkmcnt(3)
    v_mfma_f32_16x16x32_bf16 v[196:199], v[232:235], v[116:119], v[196:199]
    s_waitcnt lgkmcnt(2)
    v_mfma_f32_16x16x32_bf16 v[196:199], v[232:235], v[124:127], v[196:199]
    s_waitcnt lgkmcnt(1)
    v_mfma_f32_16x16x32_bf16 v[196:199], v[232:235], v[132:135], v[196:199]
    s_add_u32 m0, s64, 49152
    s_add_u32 s67, s65, 1769472
    buffer_load_dwordx4 v244, s[12:15], s67 offen lds
    s_waitcnt lgkmcnt(0)
    v_mfma_f32_16x16x32_bf16 v[196:199], v[232:235], v[140:143], v[196:199]
    s_barrier
    s_cmp_lg_u32 s5, 1
    s_cbranch_scc1 L_ngF1
    v_mfma_f32_16x16x32_bf16 v[204:207], v[4:7], v[4:7], 0
    v_mfma_f32_16x16x32_bf16 v[204:207], v[12:15], v[12:15], v[204:207]
    v_mfma_f32_16x16x32_bf16 v[204:207], v[20:23], v[20:23], v[204:207]
    v_mfma_f32_16x16x32_bf16 v[204:207], v[28:31], v[28:31], v[204:207]
    v_mfma_f32_16x16x32_bf16 v[204:207], v[36:39], v[36:39], v[204:207]
    v_mfma_f32_16x16x32_bf16 v[204:207], v[44:47], v[44:47], v[204:207]
    v_mfma_f32_16x16x32_bf16 v[204:207], v[52:55], v[52:55], v[204:207]
    v_mfma_f32_16x16x32_bf16 v[204:207], v[60:63], v[60:63], v[204:207]
    v_mfma_f32_16x16x32_bf16 v[204:207], v[68:71], v[68:71], v[204:207]
    v_mfma_f32_16x16x32_bf16 v[204:207], v[76:79], v[76:79], v[204:207]
    v_mfma_f32_16x16x32_bf16 v[204:207], v[84:87], v[84:87], v[204:207]
    v_mfma_f32_16x16x32_bf16 v[204:207], v[92:95], v[92:95], v[204:207]
    v_mfma_f32_16x16x32_bf16 v[204:207], v[100:103], v[100:103], v[204:207]
    v_mfma_f32_16x16x32_bf16 v[204:207], v[108:111], v[108:111], v[204:207]
    v_mfma_f32_16x16x32_bf16 v[204:207], v[116:119], v[116:119], v[204:207]
    v_mfma_f32_16x16x32_bf16 v[204:207], v[124:127], v[124:127], v[204:207]
    v_mfma_f32_16x16x32_bf16 v[204:207], v[132:135], v[132:135], v[204:207]
    v_mfma_f32_16x16x32_bf16 v[204:207], v[140:143], v[140:143], v[204:207]
L_ngF1:
    s_nop 4
    v_mul_f32 v196, 0x3ae38e39, v196
    v_cvt_pk_bf16_f32 v247, v196, v196
    v_lshlrev_b32 v247, 16, v247
    v_xor_b32 v247, 0x80000000, v247
    v_dot2_f32_bf16 v144, v4, s90, v247
    v_dot2_f32_bf16 v145, v4, s91, v247
    v_dot2_f32_bf16 v146, v5, s90, v247
    v_dot2_f32_bf16 v147, v5, s91, v247
    v_dot2_f32_bf16 v148, v6, s90, v247
    v_dot2_f32_bf16 v149, v6, s91, v247
    v_dot2_f32_bf16 v150, v7, s90, v247
    v_dot2_f32_bf16 v151, v7, s91, v247
    s_add_u32 m0, s64, 57344
    s_add_u32 s67, s65, 2064384
    buffer_load_dwordx4 v244, s[12:15], s67 offen lds
    v_cvt_pk_bf16_f32 v4, v144, v145
    v_cvt_pk_bf16_f32 v5, v146, v147
    v_cvt_pk_bf16_f32 v6, v148, v149
    v_cvt_pk_bf16_f32 v7, v150, v151
    v_dot2_f32_bf16 v152, v12, s90, v247
    v_dot2_f32_bf16 v153, v12, s91, v247
    v_dot2_f32_bf16 v154, v13, s90, v247
    v_dot2_f32_bf16 v155, v13, s91, v247
    v_dot2_f32_bf16 v156, v14, s90, v247
    v_dot2_f32_bf16 v157, v14, s91, v247
    v_dot2_f32_bf16 v158, v15, s90, v247
    v_dot2_f32_bf16 v159, v15, s91, v247
    v_cvt_pk_bf16_f32 v12, v152, v153
    v_cvt_pk_bf16_f32 v13, v154, v155
    v_cvt_pk_bf16_f32 v14, v156, v157
    v_cvt_pk_bf16_f32 v15, v158, v159
    v_dot2_f32_bf16 v144, v20, s90, v247
    v_dot2_f32_bf16 v145, v20, s91, v247
    v_dot2_f32_bf16 v146, v21, s90, v247
    v_dot2_f32_bf16 v147, v21, s91, v247
    v_dot2_f32_bf16 v148, v22, s90, v247
    v_dot2_f32_bf16 v149, v22, s91, v247
    v_dot2_f32_bf16 v150, v23, s90, v247
    v_dot2_f32_bf16 v151, v23, s91, v247
    s_add_u32 m0, s64, 65536
    s_add_u32 s67, s65, 2359296
    buffer_load_dwordx4 v244, s[12:15], s67 offen lds
    v_cvt_pk_bf16_f32 v20, v144, v145
    v_cvt_pk_bf16_f32 v21, v146, v147
    v_cvt_pk_bf16_f32 v22, v148, v149
    v_cvt_pk_bf16_f32 v23, v150, v151
    v_dot2_f32_bf16 v152, v28, s90, v247
    v_dot2_f32_bf16 v153, v28, s91, v247
    v_dot2_f32_bf16 v154, v29, s90, v247
    v_dot2_f32_bf16 v155, v29, s91, v247
    v_dot2_f32_bf16 v156, v30, s90, v247
    v_dot2_f32_bf16 v157, v30, s91, v247
    v_dot2_f32_bf16 v158, v31, s90, v247
    v_dot2_f32_bf16 v159, v31, s91, v247
    v_cvt_pk_bf16_f32 v28, v152, v153
    v_cvt_pk_bf16_f32 v29, v154, v155
    v_cvt_pk_bf16_f32 v30, v156, v157
    v_cvt_pk_bf16_f32 v31, v158, v159
    v_dot2_f32_bf16 v144, v36, s90, v247
    v_dot2_f32_bf16 v145, v36, s91, v247
    v_dot2_f32_bf16 v146, v37, s90, v247
    v_dot2_f32_bf16 v147, v37, s91, v247
    v_dot2_f32_bf16 v148, v38, s90, v247
    v_dot2_f32_bf16 v149, v38, s91, v247
    v_dot2_f32_bf16 v150, v39, s90, v247
    v_dot2_f32_bf16 v151, v39, s91, v247
    s_add_u32 m0, s64, 73728
    s_add_u32 s67, s65, 2654208
    buffer_load_dwordx4 v244, s[12:15], s67 offen lds
    v_cvt_pk_bf16_f32 v36, v144, v145
    v_cvt_pk_bf16_f32 v37, v146, v147
    v_cvt_pk_bf16_f32 v38, v148, v149
    v_cvt_pk_bf16_f32 v39, v150, v151
    v_dot2_f32_bf16 v152, v44, s90, v247
    v_dot2_f32_bf16 v153, v44, s91, v247
    v_dot2_f32_bf16 v154, v45, s90, v247
    v_dot2_f32_bf16 v155, v45, s91, v247
    v_dot2_f32_bf16 v156, v46, s90, v247
    v_dot2_f32_bf16 v157, v46, s91, v247
    v_dot2_f32_bf16 v158, v47, s90, v247
    v_dot2_f32_bf16 v159, v47, s91, v247
    v_cvt_pk_bf16_f32 v44, v152, v153
    v_cvt_pk_bf16_f32 v45, v154, v155
    v_cvt_pk_bf16_f32 v46, v156, v157
    v_cvt_pk_bf16_f32 v47, v158, v159
    v_dot2_f32_bf16 v144, v52, s90, v247
    v_dot2_f32_bf16 v145, v52, s91, v247
    v_dot2_f32_bf16 v146, v53, s90, v247
    v_dot2_f32_bf16 v147, v53, s91, v247
    v_dot2_f32_bf16 v148, v54, s90, v247
    v_dot2_f32_bf16 v149, v54, s91, v247
    v_dot2_f32_bf16 v150, v55, s90, v247
    v_dot2_f32_bf16 v151, v55, s91, v247
    s_add_u32 m0, s64, 81920
    s_add_u32 s67, s65, 2949120
    buffer_load_dwordx4 v244, s[12:15], s67 offen lds
    v_cvt_pk_bf16_f32 v52, v144, v145
    v_cvt_pk_bf16_f32 v53, v146, v147
    v_cvt_pk_bf16_f32 v54, v148, v149
    v_cvt_pk_bf16_f32 v55, v150, v151
    v_dot2_f32_bf16 v152, v60, s90, v247
    v_dot2_f32_bf16 v153, v60, s91, v247
    v_dot2_f32_bf16 v154, v61, s90, v247
    v_dot2_f32_bf16 v155, v61, s91, v247
    v_dot2_f32_bf16 v156, v62, s90, v247
    v_dot2_f32_bf16 v157, v62, s91, v247
    v_dot2_f32_bf16 v158, v63, s90, v247
    v_dot2_f32_bf16 v159, v63, s91, v247
    v_cvt_pk_bf16_f32 v60, v152, v153
    v_cvt_pk_bf16_f32 v61, v154, v155
    v_cvt_pk_bf16_f32 v62, v156, v157
    v_cvt_pk_bf16_f32 v63, v158, v159
    v_dot2_f32_bf16 v144, v68, s90, v247
    v_dot2_f32_bf16 v145, v68, s91, v247
    v_dot2_f32_bf16 v146, v69, s90, v247
    v_dot2_f32_bf16 v147, v69, s91, v247
    v_dot2_f32_bf16 v148, v70, s90, v247
    v_dot2_f32_bf16 v149, v70, s91, v247
    v_dot2_f32_bf16 v150, v71, s90, v247
    v_dot2_f32_bf16 v151, v71, s91, v247
    s_add_u32 m0, s64, 90112
    s_add_u32 s67, s65, 3244032
    buffer_load_dwordx4 v244, s[12:15], s67 offen lds
    v_cvt_pk_bf16_f32 v68, v144, v145
    v_cvt_pk_bf16_f32 v69, v146, v147
    v_cvt_pk_bf16_f32 v70, v148, v149
    v_cvt_pk_bf16_f32 v71, v150, v151
    v_dot2_f32_bf16 v152, v76, s90, v247
    v_dot2_f32_bf16 v153, v76, s91, v247
    v_dot2_f32_bf16 v154, v77, s90, v247
    v_dot2_f32_bf16 v155, v77, s91, v247
    v_dot2_f32_bf16 v156, v78, s90, v247
    v_dot2_f32_bf16 v157, v78, s91, v247
    v_dot2_f32_bf16 v158, v79, s90, v247
    v_dot2_f32_bf16 v159, v79, s91, v247
    v_cvt_pk_bf16_f32 v76, v152, v153
    v_cvt_pk_bf16_f32 v77, v154, v155
    v_cvt_pk_bf16_f32 v78, v156, v157
    v_cvt_pk_bf16_f32 v79, v158, v159
    v_dot2_f32_bf16 v144, v84, s90, v247
    v_dot2_f32_bf16 v145, v84, s91, v247
    v_dot2_f32_bf16 v146, v85, s90, v247
    v_dot2_f32_bf16 v147, v85, s91, v247
    v_dot2_f32_bf16 v148, v86, s90, v247
    v_dot2_f32_bf16 v149, v86, s91, v247
    v_dot2_f32_bf16 v150, v87, s90, v247
    v_dot2_f32_bf16 v151, v87, s91, v247
    v_cvt_pk_bf16_f32 v84, v144, v145
    v_cvt_pk_bf16_f32 v85, v146, v147
    v_cvt_pk_bf16_f32 v86, v148, v149
    v_cvt_pk_bf16_f32 v87, v150, v151
    v_dot2_f32_bf16 v152, v92, s90, v247
    v_dot2_f32_bf16 v153, v92, s91, v247
    v_dot2_f32_bf16 v154, v93, s90, v247
    v_dot2_f32_bf16 v155, v93, s91, v247
    v_dot2_f32_bf16 v156, v94, s90, v247
    v_dot2_f32_bf16 v157, v94, s91, v247
    v_dot2_f32_bf16 v158, v95, s90, v247
    v_dot2_f32_bf16 v159, v95, s91, v247
    v_cvt_pk_bf16_f32 v92, v152, v153
    v_cvt_pk_bf16_f32 v93, v154, v155
    v_cvt_pk_bf16_f32 v94, v156, v157
    v_cvt_pk_bf16_f32 v95, v158, v159
    v_dot2_f32_bf16 v144, v100, s90, v247
    v_dot2_f32_bf16 v145, v100, s91, v247
    v_dot2_f32_bf16 v146, v101, s90, v247
    v_dot2_f32_bf16 v147, v101, s91, v247
    v_dot2_f32_bf16 v148, v102, s90, v247
    v_dot2_f32_bf16 v149, v102, s91, v247
    v_dot2_f32_bf16 v150, v103, s90, v247
    v_dot2_f32_bf16 v151, v103, s91, v247
    v_cvt_pk_bf16_f32 v100, v144, v145
    v_cvt_pk_bf16_f32 v101, v146, v147
    v_cvt_pk_bf16_f32 v102, v148, v149
    v_cvt_pk_bf16_f32 v103, v150, v151
    v_dot2_f32_bf16 v152, v108, s90, v247
    v_dot2_f32_bf16 v153, v108, s91, v247
    v_dot2_f32_bf16 v154, v109, s90, v247
    v_dot2_f32_bf16 v155, v109, s91, v247
    v_dot2_f32_bf16 v156, v110, s90, v247
    v_dot2_f32_bf16 v157, v110, s91, v247
    v_dot2_f32_bf16 v158, v111, s90, v247
    v_dot2_f32_bf16 v159, v111, s91, v247
    v_cvt_pk_bf16_f32 v108, v152, v153
    v_cvt_pk_bf16_f32 v109, v154, v155
    v_cvt_pk_bf16_f32 v110, v156, v157
    v_cvt_pk_bf16_f32 v111, v158, v159
    v_dot2_f32_bf16 v144, v116, s90, v247
    v_dot2_f32_bf16 v145, v116, s91, v247
    v_dot2_f32_bf16 v146, v117, s90, v247
    v_dot2_f32_bf16 v147, v117, s91, v247
    v_dot2_f32_bf16 v148, v118, s90, v247
    v_dot2_f32_bf16 v149, v118, s91, v247
    v_dot2_f32_bf16 v150, v119, s90, v247
    v_dot2_f32_bf16 v151, v119, s91, v247
    v_cvt_pk_bf16_f32 v116, v144, v145
    v_cvt_pk_bf16_f32 v117, v146, v147
    v_cvt_pk_bf16_f32 v118, v148, v149
    v_cvt_pk_bf16_f32 v119, v150, v151
    v_dot2_f32_bf16 v152, v124, s90, v247
    v_dot2_f32_bf16 v153, v124, s91, v247
    v_dot2_f32_bf16 v154, v125, s90, v247
    v_dot2_f32_bf16 v155, v125, s91, v247
    v_dot2_f32_bf16 v156, v126, s90, v247
    v_dot2_f32_bf16 v157, v126, s91, v247
    v_dot2_f32_bf16 v158, v127, s90, v247
    v_dot2_f32_bf16 v159, v127, s91, v247
    v_cvt_pk_bf16_f32 v124, v152, v153
    v_cvt_pk_bf16_f32 v125, v154, v155
    v_cvt_pk_bf16_f32 v126, v156, v157
    v_cvt_pk_bf16_f32 v127, v158, v159
    v_dot2_f32_bf16 v144, v132, s90, v247
    v_dot2_f32_bf16 v145, v132, s91, v247
    v_dot2_f32_bf16 v146, v133, s90, v247
    v_dot2_f32_bf16 v147, v133, s91, v247
    v_dot2_f32_bf16 v148, v134, s90, v247
    v_dot2_f32_bf16 v149, v134, s91, v247
    v_dot2_f32_bf16 v150, v135, s90, v247
    v_dot2_f32_bf16 v151, v135, s91, v247
    v_cvt_pk_bf16_f32 v132, v144, v145
    v_cvt_pk_bf16_f32 v133, v146, v147
    v_cvt_pk_bf16_f32 v134, v148, v149
    v_cvt_pk_bf16_f32 v135, v150, v151
    v_dot2_f32_bf16 v152, v140, s90, v247
    v_dot2_f32_bf16 v153, v140, s91, v247
    v_dot2_f32_bf16 v154, v141, s90, v247
    v_dot2_f32_bf16 v155, v141, s91, v247
    v_dot2_f32_bf16 v156, v142, s90, v247
    v_dot2_f32_bf16 v157, v142, s91, v247
    v_dot2_f32_bf16 v158, v143, s90, v247
    v_dot2_f32_bf16 v159, v143, s91, v247
    v_cvt_pk_bf16_f32 v140, v152, v153
    v_cvt_pk_bf16_f32 v141, v154, v155
    v_cvt_pk_bf16_f32 v142, v156, v157
    v_cvt_pk_bf16_f32 v143, v158, v159
    s_cmp_eq_u32 s5, 0
    s_cbranch_scc1 L_ownF
    v_mov_b32 v200, v196
    v_mov_b32 v251, v247
L_ownF:
    s_waitcnt vmcnt(6)
    s_barrier
    ds_read_b64_tr_b16 v[208:209], v240 offset:0
    ds_read_b64_tr_b16 v[210:211], v240 offset:512
    ds_read_b64_tr_b16 v[212:213], v240 offset:4096
    ds_read_b64_tr_b16 v[214:215], v240 offset:4608
    ds_read_b64_tr_b16 v[216:217], v241 offset:0
    ds_read_b64_tr_b16 v[218:219], v241 offset:512
    ds_read_b64_tr_b16 v[220:221], v241 offset:4096
    ds_read_b64_tr_b16 v[222:223], v241 offset:4608
    s_mov_b32 s70, 0
    s_waitcnt lgkmcnt(4)
    v_mfma_f32_16x16x32_bf16 v[144:147], v[208:211], v[0:3], 0
    ds_read_b64_tr_b16 v[224:225], v240 offset:8192
    v_mfma_f32_16x16x32_bf16 v[148:151], v[208:211], v[4:7], 0
    ds_read_b64_tr_b16 v[226:227], v240 offset:8704
    v_bfe_u32 v238, v246, 4, 2
    v_mfma_f32_16x16x32_bf16 v[156:159], v[212:215], v[4:7], 0
    ds_read_b64_tr_b16 v[228:229], v240 offset:12288
    v_mfma_f32_16x16x32_bf16 v[152:155], v[212:215], v[0:3], 0
    ds_read_b64_tr_b16 v[230:231], v240 offset:12800
    v_cmp_eq_u32 s[32:33], 1, v238
    s_waitcnt lgkmcnt(4)
    v_mfma_f32_16x16x32_bf16 v[160:163], v[216:219], v[0:3], 0
    ds_read_b64_tr_b16 v[208:209], v241 offset:8192
    v_mfma_f32_16x16x32_bf16 v[164:167], v[216:219], v[4:7], 0
    ds_read_b64_tr_b16 v[210:211], v241 offset:8704
    v_cmp_eq_u32 s[34:35], 2, v238
    s_add_u32 m0, s64, 98304
    s_add_u32 s67, s65, 3538944
    buffer_load_dwordx4 v244, s[12:15], s67 offen lds
    v_mfma_f32_16x16x32_bf16 v[172:175], v[220:223], v[4:7], 0
    ds_read_b64_tr_b16 v[212:213], v241 offset:12288
    v_mfma_f32_16x16x32_bf16 v[168:171], v[220:223], v[0:3], 0
    ds_read_b64_tr_b16 v[214:215], v241 offset:12800
    s_waitcnt lgkmcnt(4)
    v_mfma_f32_16x16x32_bf16 v[144:147], v[224:227], v[8:11], v[144:147]
    ds_read_b64_tr_b16 v[216:217], v240 offset:16384
    v_cmp_eq_u32 vcc, 3, v238
    v_mfma_f32_16x16x32_bf16 v[148:151], v[224:227], v[12:15], v[148:151]
    ds_read_b64_tr_b16 v[218:219], v240 offset:16896
    v_mfma_f32_16x16x32_bf16 v[156:159], v[228:231], v[12:15], v[156:159]
    ds_read_b64_tr_b16 v[220:221], v240 offset:20480
    v_bfe_u32 v238, v246, 4, 4
    v_mfma_f32_16x16x32_bf16 v[152:155], v[228:231], v[8:11], v[152:155]
    ds_read_b64_tr_b16 v[222:223], v240 offset:20992
    s_waitcnt lgkmcnt(4)
    v_mfma_f32_16x16x32_bf16 v[160:163], v[208:211], v[8:11], v[160:163]
    ds_read_b64_tr_b16 v[224:225], v241 offset:16384
    v_bfe_u32 v239, v246, 6, 2
    v_mfma_f32_16x16x32_bf16 v[164:167], v[208:211], v[12:15], v[164:167]
    ds_read_b64_tr_b16 v[226:227], v241 offset:16896
    s_add_u32 m0, s64, 106496
    s_add_u32 s67, s65, 3833856
    buffer_load_dwordx4 v244, s[12:15], s67 offen lds
    v_mfma_f32_16x16x32_bf16 v[172:175], v[212:215], v[12:15], v[172:175]
    ds_read_b64_tr_b16 v[228:229], v241 offset:20480
    v_lshlrev_b32_e64 v238, 2, v238
    v_mfma_f32_16x16x32_bf16 v[168:171], v[212:215], v[8:11], v[168:171]
    ds_read_b64_tr_b16 v[230:231], v241 offset:20992
    s_waitcnt lgkmcnt(4)
    v_mfma_f32_16x16x32_bf16 v[144:147], v[216:219], v[16:19], v[144:147]
    ds_read_b64_tr_b16 v[208:209], v240 offset:24576
    v_mfma_f32_16x16x32_bf16 v[148:151], v[216:219], v[20:23], v[148:151]
    ds_read_b64_tr_b16 v[210:211], v240 offset:25088
    v_lshl_add_u32 v238, v239, 6, v238
    v_mfma_f32_16x16x32_bf16 v[156:159], v[220:223], v[20:23], v[156:159]
    ds_read_b64_tr_b16 v[212:213], v240 offset:28672
    v_mfma_f32_16x16x32_bf16 v[152:155], v[220:223], v[16:19], v[152:155]
    ds_read_b64_tr_b16 v[214:215], v240 offset:29184
    v_cndmask_b32_e64 v204, v204, v205, s[32:33]
    s_waitcnt lgkmcnt(4)
    v_mfma_f32_16x16x32_bf16 v[160:163], v[224:227], v[16:19], v[160:163]
    ds_read_b64_tr_b16 v[216:217], v241 offset:24576
    v_mfma_f32_16x16x32_bf16 v[164:167], v[224:227], v[20:23], v[164:167]
    ds_read_b64_tr_b16 v[218:219], v241 offset:25088
    v_cndmask_b32_e64 v204, v204, v206, s[34:35]
    s_add_u32 m0, s64, 114688
    s_add_u32 s67, s65, 4128768
    buffer_load_dwordx4 v244, s[12:15], s67 offen lds
    v_mfma_f32_16x16x32_bf16 v[172:175], v[228:231], v[20:23], v[172:175]
    ds_read_b64_tr_b16 v[220:221], v241 offset:28672
    v_mfma_f32_16x16x32_bf16 v[168:171], v[228:231], v[16:19], v[168:171]
    ds_read_b64_tr_b16 v[222:223], v241 offset:29184
    s_waitcnt lgkmcnt(4)
    v_mfma_f32_16x16x32_bf16 v[144:147], v[208:211], v[24:27], v[144:147]
    ds_read_b64_tr_b16 v[224:225], v240 offset:32768
    v_cndmask_b32 v204, v204, v207, vcc
    v_mfma_f32_16x16x32_bf16 v[148:151], v[208:211], v[28:31], v[148:151]
    ds_read_b64_tr_b16 v[226:227], v240 offset:33280
    v_mfma_f32_16x16x32_bf16 v[156:159], v[212:215], v[28:31], v[156:159]
    ds_read_b64_tr_b16 v[228:229], v240 offset:36864
    v_mfma_f32_16x16x32_bf16 v[152:155], v[212:215], v[24:27], v[152:155]
    ds_read_b64_tr_b16 v[230:231], v240 offset:37376
    s_waitcnt lgkmcnt(4)
    v_mfma_f32_16x16x32_bf16 v[160:163], v[216:219], v[24:27], v[160:163]
    ds_read_b64_tr_b16 v[208:209], v241 offset:32768
    v_mfma_f32_16x16x32_bf16 v[164:167], v[216:219], v[28:31], v[164:167]
    ds_read_b64_tr_b16 v[210:211], v241 offset:33280
    s_add_u32 m0, s64, 122880
    s_add_u32 s67, s65, 4423680
    buffer_load_dwordx4 v244, s[12:15], s67 offen lds
    v_mfma_f32_16x16x32_bf16 v[172:175], v[220:223], v[28:31], v[172:175]
    ds_read_b64_tr_b16 v[212:213], v241 offset:36864
    v_mfma_f32_16x16x32_bf16 v[168:171], v[220:223], v[24:27], v[168:171]
    ds_read_b64_tr_b16 v[214:215], v241 offset:37376
    s_waitcnt lgkmcnt(4)
    v_mfma_f32_16x16x32_bf16 v[144:147], v[224:227], v[32:35], v[144:147]
    ds_read_b64_tr_b16 v[216:217], v240 offset:40960
    ds_bpermute_b32 v205, v238, v204
    v_mfma_f32_16x16x32_bf16 v[148:151], v[224:227], v[36:39], v[148:151]
    ds_read_b64_tr_b16 v[218:219], v240 offset:41472
    v_mfma_f32_16x16x32_bf16 v[156:159], v[228:231], v[36:39], v[156:159]
    ds_read_b64_tr_b16 v[220:221], v240 offset:45056
    v_mfma_f32_16x16x32_bf16 v[152:155], v[228:231], v[32:35], v[152:155]
    ds_read_b64_tr_b16 v[222:223], v240 offset:45568
    s_waitcnt lgkmcnt(5)
    v_mfma_f32_16x16x32_bf16 v[160:163], v[208:211], v[32:35], v[160:163]
    ds_read_b64_tr_b16 v[224:225], v241 offset:40960
    v_mfma_f32_16x16x32_bf16 v[164:167], v[208:211], v[36:39], v[164:167]
    ds_read_b64_tr_b16 v[226:227], v241 offset:41472
    s_add_u32 m0, s64, 131072
    s_add_u32 s67, s65, 4718592
    buffer_load_dwordx4 v244, s[12:15], s67 offen lds
    v_mfma_f32_16x16x32_bf16 v[172:175], v[212:215], v[36:39], v[172:175]
    ds_read_b64_tr_b16 v[228:229], v241 offset:45056
    v_mfma_f32_16x16x32_bf16 v[168:171], v[212:215], v[32:35], v[168:171]
    ds_read_b64_tr_b16 v[230:231], v241 offset:45568
    s_waitcnt lgkmcnt(4)
    v_mfma_f32_16x16x32_bf16 v[144:147], v[216:219], v[40:43], v[144:147]
    v_mul_f32_e64 v200, v200, v200
    v_mfma_f32_16x16x32_bf16 v[148:151], v[216:219], v[44:47], v[148:151]
    s_mov_b32 s88, 0x3ae38e39
    v_mfma_f32_16x16x32_bf16 v[156:159], v[220:223], v[44:47], v[156:159]
    v_mfma_f32_16x16x32_bf16 v[152:155], v[220:223], v[40:43], v[152:155]
    v_fma_f32 v205, v205, s88, -v200
    s_waitcnt lgkmcnt(0)
    v_mfma_f32_16x16x32_bf16 v[160:163], v[224:227], v[40:43], v[160:163]
    v_mfma_f32_16x16x32_bf16 v[164:167], v[224:227], v[44:47], v[164:167]
    v_max_f32 v205, 0, v205
    s_add_u32 m0, s64, 139264
    s_add_u32 s67, s65, 5013504
    buffer_load_dwordx4 v244, s[12:15], s67 offen lds
    s_lshr_b32 s38, s6, 2
    s_lshl_b32 s38, s38, 4
    s_add_u32 s38, s38, s6
    s_and_b32 s38, s38, 0x33
    s_lshl_b32 s38, s38, 2
    s_add_u32 s38, s38, 16
    s_cmp_eq_u32 s3, 0
    s_cselect_b32 s38, s38, 1073741824
    buffer_load_dword v192, off, s[60:63], s38 sc1
    v_mfma_f32_16x16x32_bf16 v[172:175], v[228:231], v[44:47], v[172:175]
    v_mfma_f32_16x16x32_bf16 v[168:171], v[228:231], v[40:43], v[168:171]
    s_waitcnt vmcnt(5)
    s_barrier
    v_add_u32 v240, 49152, v240
    v_add_u32 v241, 49152, v241
    ds_read_b64_tr_b16 v[208:209], v240 offset:0
    ds_read_b64_tr_b16 v[210:211], v240 offset:512
    ds_read_b64_tr_b16 v[212:213], v240 offset:4096
    ds_read_b64_tr_b16 v[214:215], v240 offset:4608
    ds_read_b64_tr_b16 v[216:217], v241 offset:0
    ds_read_b64_tr_b16 v[218:219], v241 offset:512
    ds_read_b64_tr_b16 v[220:221], v241 offset:4096
    ds_read_b64_tr_b16 v[222:223], v241 offset:4608
    s_waitcnt lgkmcnt(4)
    v_mfma_f32_16x16x32_bf16 v[144:147], v[208:211], v[48:51], v[144:147]
    ds_read_b64_tr_b16 v[224:225], v240 offset:8192
    v_cvt_pk_bf16_f32 v205, v205, v205
    v_mfma_f32_16x16x32_bf16 v[148:151], v[208:211], v[52:55], v[148:151]
    ds_read_b64_tr_b16 v[226:227], v240 offset:8704
    v_mfma_f32_16x16x32_bf16 v[156:159], v[212:215], v[52:55], v[156:159]
    ds_read_b64_tr_b16 v[228:229], v240 offset:12288
    v_lshlrev_b32 v205, 16, v205
    v_mfma_f32_16x16x32_bf16 v[152:155], v[212:215], v[48:51], v[152:155]
    ds_read_b64_tr_b16 v[230:231], v240 offset:12800
    s_waitcnt lgkmcnt(4)
    v_mfma_f32_16x16x32_bf16 v[160:163], v[216:219], v[48:51], v[160:163]
    ds_read_b64_tr_b16 v[208:209], v241 offset:8192
    v_add_f32 v205, 0x3727c5ac, v205
    v_mfma_f32_16x16x32_bf16 v[164:167], v[216:219], v[52:55], v[164:167]
    ds_read_b64_tr_b16 v[210:211], v241 offset:8704
    s_add_u32 m0, s64, 0
    s_add_u32 s67, s66, 0
    buffer_load_dwordx4 v244, s[12:15], s67 offen lds
    v_mfma_f32_16x16x32_bf16 v[172:175], v[220:223], v[52:55], v[172:175]
    ds_read_b64_tr_b16 v[212:213], v241 offset:12288
    v_cvt_pk_bf16_f32 v205, v205, v205
    v_mfma_f32_16x16x32_bf16 v[168:171], v[220:223], v[48:51], v[168:171]
    ds_read_b64_tr_b16 v[214:215], v241 offset:12800
    s_waitcnt lgkmcnt(4)
    v_mfma_f32_16x16x32_bf16 v[144:147], v[224:227], v[56:59], v[144:147]
    ds_read_b64_tr_b16 v[216:217], v240 offset:16384
    v_mfma_f32_16x16x32_bf16 v[148:151], v[224:227], v[60:63], v[148:151]
    ds_read_b64_tr_b16 v[218:219], v240 offset:16896
    v_lshlrev_b32_e64 v205, 16, v205
    v_mfma_f32_16x16x32_bf16 v[156:159], v[228:231], v[60:63], v[156:159]
    ds_read_b64_tr_b16 v[220:221], v240 offset:20480
    v_mfma_f32_16x16x32_bf16 v[152:155], v[228:231], v[56:59], v[152:155]
    ds_read_b64_tr_b16 v[222:223], v240 offset:20992
    s_waitcnt lgkmcnt(4)
    v_mfma_f32_16x16x32_bf16 v[160:163], v[208:211], v[56:59], v[160:163]
    ds_read_b64_tr_b16 v[224:225], v241 offset:16384
    v_sqrt_f32 v205, v205
    v_mfma_f32_16x16x32_bf16 v[164:167], v[208:211], v[60:63], v[164:167]
    ds_read_b64_tr_b16 v[226:227], v241 offset:16896
    s_add_u32 m0, s64, 8192
    s_add_u32 s67, s66, 294912
    buffer_load_dwordx4 v244, s[12:15], s67 offen lds
    v_mfma_f32_16x16x32_bf16 v[172:175], v[212:215], v[60:63], v[172:175]
    ds_read_b64_tr_b16 v[228:229], v241 offset:20480
    v_mfma_f32_16x16x32_bf16 v[168:171], v[212:215], v[56:59], v[168:171]
    ds_read_b64_tr_b16 v[230:231], v241 offset:20992
    s_waitcnt lgkmcnt(4)
    v_mfma_f32_16x16x32_bf16 v[144:147], v[216:219], v[64:67], v[144:147]
    ds_read_b64_tr_b16 v[208:209], v240 offset:24576
    v_xor_b32 v204, 0x80000000, v251
    v_mfma_f32_16x16x32_bf16 v[148:151], v[216:219], v[68:71], v[148:151]
    ds_read_b64_tr_b16 v[210:211], v240 offset:25088
    v_mfma_f32_16x16x32_bf16 v[156:159], v[220:223], v[68:71], v[156:159]
    ds_read_b64_tr_b16 v[212:213], v240 offset:28672
    v_cvt_pk_bf16_f32 v205, v205, v205
    v_mfma_f32_16x16x32_bf16 v[152:155], v[220:223], v[64:67], v[152:155]
    ds_read_b64_tr_b16 v[214:215], v240 offset:29184
    s_waitcnt lgkmcnt(4)
    v_mfma_f32_16x16x32_bf16 v[160:163], v[224:227], v[64:67], v[160:163]
    ds_read_b64_tr_b16 v[216:217], v241 offset:24576
    v_lshlrev_b32_e64 v205, 16, v205
    v_mfma_f32_16x16x32_bf16 v[164:167], v[224:227], v[68:71], v[164:167]
    ds_read_b64_tr_b16 v[218:219], v241 offset:25088
    s_add_u32 m0, s64, 16384
    s_add_u32 s67, s66, 589824
    buffer_load_dwordx4 v244, s[12:15], s67 offen lds
    v_mfma_f32_16x16x32_bf16 v[172:175], v[228:231], v[68:71], v[172:175]
    ds_read_b64_tr_b16 v[220:221], v241 offset:28672
    v_mfma_f32_16x16x32_bf16 v[168:171], v[228:231], v[64:67], v[168:171]
    ds_read_b64_tr_b16 v[222:223], v241 offset:29184
    s_waitcnt lgkmcnt(4)
    v_mfma_f32_16x16x32_bf16 v[144:147], v[208:211], v[72:75], v[144:147]
    ds_read_b64_tr_b16 v[224:225], v240 offset:32768
    v_rcp_f32 v205, v205
    v_mfma_f32_16x16x32_bf16 v[148:151], v[208:211], v[76:79], v[148:151]
    ds_read_b64_tr_b16 v[226:227], v240 offset:33280
    v_mfma_f32_16x16x32_bf16 v[156:159], v[212:215], v[76:79], v[156:159]
    ds_read_b64_tr_b16 v[228:229], v240 offset:36864
    v_mfma_f32_16x16x32_bf16 v[152:155], v[212:215], v[72:75], v[152:155]
    ds_read_b64_tr_b16 v[230:231], v240 offset:37376
    v_bfe_u32 v236, v246, 6, 2
    s_waitcnt lgkmcnt(4)
    v_mfma_f32_16x16x32_bf16 v[160:163], v[216:219], v[72:75], v[160:163]
    ds_read_b64_tr_b16 v[208:209], v241 offset:32768
    v_mfma_f32_16x16x32_bf16 v[164:167], v[216:219], v[76:79], v[164:167]
    ds_read_b64_tr_b16 v[210:211], v241 offset:33280
    v_bfe_u32 v237, v246, 4, 2
    s_add_u32 m0, s64, 24576
    s_add_u32 s67, s66, 884736
    buffer_load_dwordx4 v244, s[12:15], s67 offen lds
    v_mfma_f32_16x16x32_bf16 v[172:175], v[220:223], v[76:79], v[172:175]
    ds_read_b64_tr_b16 v[212:213], v241 offset:36864
    v_mfma_f32_16x16x32_bf16 v[168:171], v[220:223], v[72:75], v[168:171]
    ds_read_b64_tr_b16 v[214:215], v241 offset:37376
    s_lshl_b32 s87, s4, 7
    s_add_u32 s87, s87, 162816
    s_waitcnt lgkmcnt(4)
    v_mfma_f32_16x16x32_bf16 v[144:147], v[224:227], v[80:83], v[144:147]
    ds_read_b64_tr_b16 v[216:217], v240 offset:40960
    v_mfma_f32_16x16x32_bf16 v[148:151], v[224:227], v[84:87], v[148:151]
    ds_read_b64_tr_b16 v[218:219], v240 offset:41472
    v_lshl_add_u32 v236, v236, 5, s87
    v_mfma_f32_16x16x32_bf16 v[156:159], v[228:231], v[84:87], v[156:159]
    ds_read_b64_tr_b16 v[220:221], v240 offset:45056
    v_mfma_f32_16x16x32_bf16 v[152:155], v[228:231], v[80:83], v[152:155]
    ds_read_b64_tr_b16 v[222:223], v240 offset:45568
    v_lshl_add_u32 v236, v237, 2, v236
    s_waitcnt lgkmcnt(4)
    v_mfma_f32_16x16x32_bf16 v[160:163], v[208:211], v[80:83], v[160:163]
    ds_read_b64_tr_b16 v[224:225], v241 offset:40960
    v_mfma_f32_16x16x32_bf16 v[164:167], v[208:211], v[84:87], v[164:167]
    ds_read_b64_tr_b16 v[226:227], v241 offset:41472
    v_lshl_add_u32 v236, s5, 4, v236
    s_add_u32 m0, s64, 32768
    s_add_u32 s67, s66, 1179648
    buffer_load_dwordx4 v244, s[12:15], s67 offen lds
    v_mfma_f32_16x16x32_bf16 v[172:175], v[212:215], v[84:87], v[172:175]
    ds_read_b64_tr_b16 v[228:229], v241 offset:45056
    v_mfma_f32_16x16x32_bf16 v[168:171], v[212:215], v[80:83], v[168:171]
    ds_read_b64_tr_b16 v[230:231], v241 offset:45568
    ds_write_b32 v236, v204 offset:512
    ds_write_b32 v236, v205
    s_waitcnt lgkmcnt(6)
    v_mfma_f32_16x16x32_bf16 v[144:147], v[216:219], v[88:91], v[144:147]
    v_add_u32 v240, 49152, v240
    v_add_u32 v241, 49152, v241
    ds_read_b64_tr_b16 v[208:209], v240 offset:0
    v_mfma_f32_16x16x32_bf16 v[148:151], v[216:219], v[92:95], v[148:151]
    ds_read_b64_tr_b16 v[210:211], v240 offset:512
    v_mfma_f32_16x16x32_bf16 v[156:159], v[220:223], v[92:95], v[156:159]
    ds_read_b64_tr_b16 v[212:213], v240 offset:4096
    v_mfma_f32_16x16x32_bf16 v[152:155], v[220:223], v[88:91], v[152:155]
    ds_read_b64_tr_b16 v[214:215], v240 offset:4608
    s_waitcnt lgkmcnt(6)
    v_mfma_f32_16x16x32_bf16 v[160:163], v[224:227], v[88:91], v[160:163]
    ds_read_b64_tr_b16 v[216:217], v241 offset:0
    v_mfma_f32_16x16x32_bf16 v[164:167], v[224:227], v[92:95], v[164:167]
    ds_read_b64_tr_b16 v[218:219], v241 offset:512
    s_add_u32 m0, s64, 40960
    s_add_u32 s67, s66, 1474560
    buffer_load_dwordx4 v244, s[12:15], s67 offen lds
    v_mfma_f32_16x16x32_bf16 v[172:175], v[228:231], v[92:95], v[172:175]
    ds_read_b64_tr_b16 v[220:221], v241 offset:4096
    v_mfma_f32_16x16x32_bf16 v[168:171], v[228:231], v[88:91], v[168:171]
    ds_read_b64_tr_b16 v[222:223], v241 offset:4608
    s_waitcnt vmcnt(5) lgkmcnt(8)
    s_barrier
    s_waitcnt lgkmcnt(4)
    v_mfma_f32_16x16x32_bf16 v[144:147], v[208:211], v[96:99], v[144:147]
    ds_read_b64_tr_b16 v[224:225], v240 offset:8192
    v_mfma_f32_16x16x32_bf16 v[148:151], v[208:211], v[100:103], v[148:151]
    ds_read_b64_tr_b16 v[226:227], v240 offset:8704
    v_mfma_f32_16x16x32_bf16 v[156:159], v[212:215], v[100:103], v[156:159]
    ds_read_b64_tr_b16 v[228:229], v240 offset:12288
    v_mfma_f32_16x16x32_bf16 v[152:155], v[212:215], v[96:99], v[152:155]
    ds_read_b64_tr_b16 v[230:231], v240 offset:12800
    s_waitcnt lgkmcnt(4)
    v_mfma_f32_16x16x32_bf16 v[160:163], v[216:219], v[96:99], v[160:163]
    ds_read_b64_tr_b16 v[208:209], v241 offset:8192
    v_mfma_f32_16x16x32_bf16 v[164:167], v[216:219], v[100:103], v[164:167]
    ds_read_b64_tr_b16 v[210:211], v241 offset:8704
    s_add_u32 m0, s64, 49152
    s_add_u32 s67, s66, 1769472
    buffer_load_dwordx4 v244, s[12:15], s67 offen lds
    v_bfe_u32 v255, v246, 4, 6
    v_min_u32_e64 v255, 5, v255
    v_mul_u32_u24 v255, 9216, v255
    s_and_b32 s38, s6, 7
    s_mul_i32 s38, s38, 3
    s_add_u32 s38, s38, s89
    s_lshl_b32 s38, s38, 2
    s_add_u32 s38, s38, s4
    s_mul_i32 s38, s38, 55296
    s_mul_i32 s92, s7, 2304
    s_add_u32 s38, s38, s92
    s_add_u32 s38, s38, 1920
    buffer_load_dword v255, v255, s[12:15], s38 offen
    v_bfe_u32 v255, v246, 4, 6
    v_min_u32_e64 v255, 5, v255
    v_mul_u32_u24 v255, 9216, v255
    s_and_b32 s38, s6, 7
    s_mul_i32 s38, s38, 3
    s_add_u32 s38, s38, s89
    s_lshl_b32 s38, s38, 2
    s_add_u32 s38, s38, s4
    s_mul_i32 s38, s38, 55296
    s_mul_i32 s92, s7, 2304
    s_add_u32 s38, s38, s92
    s_add_u32 s38, s38, 2048
    buffer_load_dword v255, v255, s[12:15], s38 offen
    v_bfe_u32 v255, v246, 4, 6
    v_min_u32_e64 v255, 5, v255
    v_mul_u32_u24 v255, 9216, v255
    s_and_b32 s38, s6, 7
    s_mul_i32 s38, s38, 3
    s_add_u32 s38, s38, s89
    s_lshl_b32 s38, s38, 2
    s_add_u32 s38, s38, s4
    s_mul_i32 s38, s38, 55296
    s_mul_i32 s92, s7, 2304
    s_add_u32 s38, s38, s92
    s_add_u32 s38, s38, 2176
    buffer_load_dword v255, v255, s[12:15], s38 offen
    v_mfma_f32_16x16x32_bf16 v[172:175], v[220:223], v[100:103], v[172:175]
    ds_read_b64_tr_b16 v[212:213], v241 offset:12288
    v_mfma_f32_16x16x32_bf16 v[168:171], v[220:223], v[96:99], v[168:171]
    ds_read_b64_tr_b16 v[214:215], v241 offset:12800
    s_waitcnt lgkmcnt(4)
    v_mfma_f32_16x16x32_bf16 v[144:147], v[224:227], v[104:107], v[144:147]
    ds_read_b64_tr_b16 v[216:217], v240 offset:16384
    v_mfma_f32_16x16x32_bf16 v[148:151], v[224:227], v[108:111], v[148:151]
    ds_read_b64_tr_b16 v[218:219], v240 offset:16896
    v_mfma_f32_16x16x32_bf16 v[156:159], v[228:231], v[108:111], v[156:159]
    ds_read_b64_tr_b16 v[220:221], v240 offset:20480
    v_mfma_f32_16x16x32_bf16 v[152:155], v[228:231], v[104:107], v[152:155]
    ds_read_b64_tr_b16 v[222:223], v240 offset:20992
    s_waitcnt lgkmcnt(4)
    v_mfma_f32_16x16x32_bf16 v[160:163], v[208:211], v[104:107], v[160:163]
    ds_read_b64_tr_b16 v[224:225], v241 offset:16384
    v_mfma_f32_16x16x32_bf16 v[164:167], v[208:211], v[108:111], v[164:167]
    ds_read_b64_tr_b16 v[226:227], v241 offset:16896
    s_add_u32 m0, s64, 57344
    s_add_u32 s67, s66, 2064384
    buffer_load_dwordx4 v244, s[12:15], s67 offen lds
    v_mfma_f32_16x16x32_bf16 v[172:175], v[212:215], v[108:111], v[172:175]
    ds_read_b64_tr_b16 v[228:229], v241 offset:20480
    v_mfma_f32_16x16x32_bf16 v[168:171], v[212:215], v[104:107], v[168:171]
    ds_read_b64_tr_b16 v[230:231], v241 offset:20992
    s_waitcnt lgkmcnt(4)
    v_mfma_f32_16x16x32_bf16 v[144:147], v[216:219], v[112:115], v[144:147]
    ds_read_b64_tr_b16 v[208:209], v240 offset:24576
    v_mfma_f32_16x16x32_bf16 v[148:151], v[216:219], v[116:119], v[148:151]
    ds_read_b64_tr_b16 v[210:211], v240 offset:25088
    v_mfma_f32_16x16x32_bf16 v[156:159], v[220:223], v[116:119], v[156:159]
    ds_read_b64_tr_b16 v[212:213], v240 offset:28672
    v_mfma_f32_16x16x32_bf16 v[152:155], v[220:223], v[112:115], v[152:155]
    ds_read_b64_tr_b16 v[214:215], v240 offset:29184
    s_waitcnt lgkmcnt(4)
    v_mfma_f32_16x16x32_bf16 v[160:163], v[224:227], v[112:115], v[160:163]
    ds_read_b64_tr_b16 v[216:217], v241 offset:24576
    v_mfma_f32_16x16x32_bf16 v[164:167], v[224:227], v[116:119], v[164:167]
    ds_read_b64_tr_b16 v[218:219], v241 offset:25088
    s_add_u32 m0, s64, 65536
    s_add_u32 s67, s66, 2359296
    buffer_load_dwordx4 v244, s[12:15], s67 offen lds
    v_mfma_f32_16x16x32_bf16 v[172:175], v[228:231], v[116:119], v[172:175]
    ds_read_b64_tr_b16 v[220:221], v241 offset:28672
    v_mfma_f32_16x16x32_bf16 v[168:171], v[228:231], v[112:115], v[168:171]
    ds_read_b64_tr_b16 v[222:223], v241 offset:29184
    s_waitcnt lgkmcnt(4)
    v_mfma_f32_16x16x32_bf16 v[144:147], v[208:211], v[120:123], v[144:147]
    ds_read_b64_tr_b16 v[224:225], v240 offset:32768
    v_mfma_f32_16x16x32_bf16 v[148:151], v[208:211], v[124:127], v[148:151]
    ds_read_b64_tr_b16 v[226:227], v240 offset:33280
    v_mfma_f32_16x16x32_bf16 v[156:159], v[212:215], v[124:127], v[156:159]
    ds_read_b64_tr_b16 v[228:229], v240 offset:36864
    v_mfma_f32_16x16x32_bf16 v[152:155], v[212:215], v[120:123], v[152:155]
    ds_read_b64_tr_b16 v[230:231], v240 offset:37376
    s_waitcnt lgkmcnt(4)
    v_mfma_f32_16x16x32_bf16 v[160:163], v[216:219], v[120:123], v[160:163]
    ds_read_b64_tr_b16 v[208:209], v241 offset:32768
    v_mfma_f32_16x16x32_bf16 v[164:167], v[216:219], v[124:127], v[164:167]
    ds_read_b64_tr_b16 v[210:211], v241 offset:33280
    s_add_u32 m0, s64, 73728
    s_add_u32 s67, s66, 2654208
    buffer_load_dwordx4 v244, s[12:15], s67 offen lds
    v_mfma_f32_16x16x32_bf16 v[172:175], v[220:223], v[124:127], v[172:175]
    ds_read_b64_tr_b16 v[212:213], v241 offset:36864
    v_mfma_f32_16x16x32_bf16 v[168:171], v[220:223], v[120:123], v[168:171]
    ds_read_b64_tr_b16 v[214:215], v241 offset:37376
    s_waitcnt lgkmcnt(4)
    v_mfma_f32_16x16x32_bf16 v[144:147], v[224:227], v[128:131], v[144:147]
    ds_read_b64_tr_b16 v[216:217], v240 offset:40960
    v_bfe_u32 v236, v246, 6, 2
    v_bfe_u32 v237, v246, 4, 2
    v_mfma_f32_16x16x32_bf16 v[148:151], v[224:227], v[132:135], v[148:151]
    ds_read_b64_tr_b16 v[218:219], v240 offset:41472
    s_lshl_b32 s87, s4, 7
    s_add_u32 s87, s87, 162816
    v_lshl_add_u32 v236, v236, 5, s87
    v_mfma_f32_16x16x32_bf16 v[156:159], v[228:231], v[132:135], v[156:159]
    ds_read_b64_tr_b16 v[220:221], v240 offset:45056
    v_lshl_add_u32 v236, v237, 2, v236
    ds_read_b32 v249, v236
    v_mfma_f32_16x16x32_bf16 v[152:155], v[228:231], v[128:131], v[152:155]
    ds_read_b64_tr_b16 v[222:223], v240 offset:45568
    s_waitcnt lgkmcnt(5)
    v_mfma_f32_16x16x32_bf16 v[160:163], v[208:211], v[128:131], v[160:163]
    ds_read_b64_tr_b16 v[224:225], v241 offset:40960
    ds_read_b32 v250, v236 offset:16
    v_mfma_f32_16x16x32_bf16 v[164:167], v[208:211], v[132:135], v[164:167]
    ds_read_b64_tr_b16 v[226:227], v241 offset:41472
    s_waitcnt lgkmcnt(1)
    s_add_u32 m0, s64, 81920
    s_add_u32 s67, s66, 2949120
    buffer_load_dwordx4 v244, s[12:15], s67 offen lds
    v_mfma_f32_16x16x32_bf16 v[172:175], v[212:215], v[132:135], v[172:175]
    ds_read_b64_tr_b16 v[228:229], v241 offset:45056
    v_mul_f32 v247, 0xbfb8aa3b, v249
    v_mul_f32_e64 v249, v249, v249
    v_mfma_f32_16x16x32_bf16 v[168:171], v[212:215], v[128:131], v[168:171]
    ds_read_b64_tr_b16 v[230:231], v241 offset:45568
    v_mul_f32 v248, 0xbfb8aa3b, v250
    v_mul_f32_e64 v250, v250, v250
    v_mfma_f32_16x16x32_bf16 v[144:147], v[216:219], v[136:139], v[144:147]
    v_subrev_u32 v240, 98304, v240
    v_subrev_u32 v241, 98304, v241
    ds_read_b64_tr_b16 v[208:209], v240 offset:0
    v_mfma_f32_16x16x32_bf16 v[148:151], v[216:219], v[140:143], v[148:151]
    ds_read_b64_tr_b16 v[210:211], v240 offset:512
    v_mfma_f32_16x16x32_bf16 v[156:159], v[220:223], v[140:143], v[156:159]
    ds_read_b64_tr_b16 v[212:213], v240 offset:4096
    v_mfma_f32_16x16x32_bf16 v[152:155], v[220:223], v[136:139], v[152:155]
    ds_read_b64_tr_b16 v[214:215], v240 offset:4608
    s_waitcnt lgkmcnt(4)
    v_mfma_f32_16x16x32_bf16 v[160:163], v[224:227], v[136:139], v[160:163]
    ds_read_b64_tr_b16 v[216:217], v241 offset:0
    v_mfma_f32_16x16x32_bf16 v[164:167], v[224:227], v[140:143], v[164:167]
    ds_read_b64_tr_b16 v[218:219], v241 offset:512
    s_add_u32 m0, s64, 90112
    s_add_u32 s67, s66, 3244032
    buffer_load_dwordx4 v244, s[12:15], s67 offen lds
    v_mfma_f32_16x16x32_bf16 v[172:175], v[228:231], v[140:143], v[172:175]
    ds_read_b64_tr_b16 v[220:221], v241 offset:4096
    v_mfma_f32_16x16x32_bf16 v[168:171], v[228:231], v[136:139], v[168:171]
    ds_read_b64_tr_b16 v[222:223], v241 offset:4608
    s_cmp_lg_u32 s3, 0
    s_cbranch_scc1 L_ntF
    s_mov_b32 s93, 0
L_ntlF:
    v_readfirstlane_b32 s96, v192
    s_nop 3
    s_cmp_lg_u32 s96, 0
    s_cbranch_scc1 L_ntF
    s_add_u32 s93, s93, 1
    s_cmp_gt_u32 s93, 60000
    s_cbranch_scc1 L_ntF
    s_sleep 8
    s_lshr_b32 s38, s6, 2
    s_lshl_b32 s38, s38, 4
    s_add_u32 s38, s38, s6
    s_and_b32 s38, s38, 0x33
    s_lshl_b32 s38, s38, 2
    s_add_u32 s38, s38, 16
    buffer_load_dword v192, off, s[60:63], s38 sc1
    s_waitcnt vmcnt(0)
    s_branch L_ntlF
L_ntF:
    s_lshl_b32 s97, s6, 2
    s_add_u32 s97, s97, s7
    s_lshl_b32 s97, s97, 2
    s_add_u32 s97, s97, s89
    s_lshl_b32 s97, s97, 7
    s_add_u32 s97, s97, 23789568
    s_load_dwordx2 s[44:45], s[0:1], 96
    s_mov_b32 s46, 5308416
    s_mov_b32 s47, 0x20000
    s_and_b32 s87, s6, 7
    s_mul_i32 s87, s87, 3
    s_add_u32 s87, s87, s89
    s_lshl_b32 s87, s87, 3
    s_add_u32 s87, s87, s3
    s_mul_i32 s72, s87, 6912
    s_mul_i32 s87, s7, 1327104
    s_add_u32 s72, s72, s87
    s_waitcnt lgkmcnt(0)
LA_F1:
    s_mul_i32 s68, s6, 1179648
    s_lshl_b32 s87, s65, 7
    s_add_u32 s68, s68, s87
    s_mov_b32 s65, s66
    s_add_u32 s66, s65, 128
    s_cmp_eq_u32 s66, s98
    s_cselect_b32 s87, 640, 0
    s_sub_u32 s66, s66, s87
    s_waitcnt vmcnt(5)
    s_barrier
    s_waitcnt lgkmcnt(4)
    v_mfma_f32_16x16x32_bf16 v[176:179], v[208:211], v[0:3], 0
    ds_read_b64_tr_b16 v[224:225], v240 offset:8192
    v_mul_f32 v232, v144, v247
    v_mfma_f32_16x16x32_bf16 v[180:183], v[208:211], v[4:7], 0
    ds_read_b64_tr_b16 v[226:227], v240 offset:8704
    v_mul_f32_e64 v233, v145, v247
    v_mfma_f32_16x16x32_bf16 v[188:191], v[212:215], v[4:7], 0
    ds_read_b64_tr_b16 v[228:229], v240 offset:12288
    v_mul_f32_e64 v234, v146, v247
    v_mfma_f32_16x16x32_bf16 v[184:187], v[212:215], v[0:3], 0
    ds_read_b64_tr_b16 v[230:231], v240 offset:12800
    v_mul_f32 v235, v147, v247
    s_waitcnt lgkmcnt(4)
    v_mfma_f32_16x16x32_bf16 v[192:195], v[216:219], v[0:3], 0
    ds_read_b64_tr_b16 v[208:209], v241 offset:8192
    v_exp_f32_e64 v232, v232
    v_mfma_f32_16x16x32_bf16 v[196:199], v[216:219], v[4:7], 0
    ds_read_b64_tr_b16 v[210:211], v241 offset:8704
    s_add_u32 m0, s64, 98304
    s_add_u32 s67, s65, 3538944
    buffer_load_dwordx4 v244, s[12:15], s67 offen lds
    v_bfe_u32 v255, v246, 4, 6
    v_min_u32 v255, 27, v255
    v_lshlrev_b32 v255, 7, v255
    buffer_load_dword v255, v255, s[28:31], s39 offen
    s_add_u32 s39, s39, s37
    v_mfma_f32_16x16x32_bf16 v[204:207], v[220:223], v[4:7], 0
    ds_read_b64_tr_b16 v[212:213], v241 offset:12288
    v_exp_f32 v233, v233
    v_mfma_f32_16x16x32_bf16 v[200:203], v[220:223], v[0:3], 0
    ds_read_b64_tr_b16 v[214:215], v241 offset:12800
    s_waitcnt lgkmcnt(4)
    v_mfma_f32_16x16x32_bf16 v[176:179], v[224:227], v[8:11], v[176:179]
    ds_read_b64_tr_b16 v[216:217], v240 offset:16384
    v_exp_f32 v234, v234
    v_mfma_f32_16x16x32_bf16 v[180:183], v[224:227], v[12:15], v[180:183]
    ds_read_b64_tr_b16 v[218:219], v240 offset:16896
    v_exp_f32_e64 v235, v235
    v_mfma_f32_16x16x32_bf16 v[188:191], v[228:231], v[12:15], v[188:191]
    ds_read_b64_tr_b16 v[220:221], v240 offset:20480
    v_mfma_f32_16x16x32_bf16 v[184:187], v[228:231], v[8:11], v[184:187]
    ds_read_b64_tr_b16 v[222:223], v240 offset:20992
    v_mul_f32 v152, v152, v249
    s_waitcnt lgkmcnt(4)
    v_mfma_f32_16x16x32_bf16 v[192:195], v[208:211], v[8:11], v[192:195]
    ds_read_b64_tr_b16 v[224:225], v241 offset:16384
    v_mul_f32 v153, v153, v249
    v_mul_f32 v154, v154, v249
    v_mfma_f32_16x16x32_bf16 v[196:199], v[208:211], v[12:15], v[196:199]
    ds_read_b64_tr_b16 v[226:227], v241 offset:16896
    v_mul_f32_e64 v155, v155, v249
    s_add_u32 m0, s64, 106496
    s_add_u32 s67, s65, 3833856
    buffer_load_dwordx4 v244, s[12:15], s67 offen lds
    v_mfma_f32_16x16x32_bf16 v[204:207], v[212:215], v[12:15], v[204:207]
    ds_read_b64_tr_b16 v[228:229], v241 offset:20480
    v_add_f32_e64 v232, 1.0, v232
    v_mfma_f32_16x16x32_bf16 v[200:203], v[212:215], v[8:11], v[200:203]
    ds_read_b64_tr_b16 v[230:231], v241 offset:20992
    v_add_f32 v233, 1.0, v233
    s_waitcnt lgkmcnt(4)
    v_mfma_f32_16x16x32_bf16 v[176:179], v[216:219], v[16:19], v[176:179]
    ds_read_b64_tr_b16 v[208:209], v240 offset:24576
    v_add_f32_e64 v234, 1.0, v234
    v_mfma_f32_16x16x32_bf16 v[180:183], v[216:219], v[20:23], v[180:183]
    ds_read_b64_tr_b16 v[210:211], v240 offset:25088
    v_add_f32_e64 v235, 1.0, v235
    v_mfma_f32_16x16x32_bf16 v[188:191], v[220:223], v[20:23], v[188:191]
    ds_read_b64_tr_b16 v[212:213], v240 offset:28672
    v_rcp_f32_e64 v232, v232
    v_mfma_f32_16x16x32_bf16 v[184:187], v[220:223], v[16:19], v[184:187]
    ds_read_b64_tr_b16 v[214:215], v240 offset:29184
    s_waitcnt lgkmcnt(4)
    v_mfma_f32_16x16x32_bf16 v[192:195], v[224:227], v[16:19], v[192:195]
    ds_read_b64_tr_b16 v[216:217], v241 offset:24576
    v_rcp_f32 v233, v233
    v_mfma_f32_16x16x32_bf16 v[196:199], v[224:227], v[20:23], v[196:199]
    ds_read_b64_tr_b16 v[218:219], v241 offset:25088
    s_add_u32 m0, s64, 114688
    s_add_u32 s67, s65, 4128768
    buffer_load_dwordx4 v244, s[12:15], s67 offen lds
    v_mfma_f32_16x16x32_bf16 v[204:207], v[228:231], v[20:23], v[204:207]
    ds_read_b64_tr_b16 v[220:221], v241 offset:28672
    v_rcp_f32_e64 v234, v234
    v_mfma_f32_16x16x32_bf16 v[200:203], v[228:231], v[16:19], v[200:203]
    ds_read_b64_tr_b16 v[222:223], v241 offset:29184
    s_waitcnt lgkmcnt(4)
    v_mfma_f32_16x16x32_bf16 v[176:179], v[208:211], v[24:27], v[176:179]
    ds_read_b64_tr_b16 v[224:225], v240 offset:32768
    v_rcp_f32 v235, v235
    v_mfma_f32_16x16x32_bf16 v[180:183], v[208:211], v[28:31], v[180:183]
    ds_read_b64_tr_b16 v[226:227], v240 offset:33280
    v_mul_f32_e64 v144, v144, v232
    v_mfma_f32_16x16x32_bf16 v[188:191], v[212:215], v[28:31], v[188:191]
    ds_read_b64_tr_b16 v[228:229], v240 offset:36864
    v_mul_f32_e64 v145, v145, v233
    v_mfma_f32_16x16x32_bf16 v[184:187], v[212:215], v[24:27], v[184:187]
    ds_read_b64_tr_b16 v[230:231], v240 offset:37376
    v_mul_f32 v146, v146, v234
    s_waitcnt lgkmcnt(4)
    v_mfma_f32_16x16x32_bf16 v[192:195], v[216:219], v[24:27], v[192:195]
    ds_read_b64_tr_b16 v[208:209], v241 offset:32768
    v_mul_f32 v147, v147, v235
    v_mul_f32 v152, v152, v144
    v_mfma_f32_16x16x32_bf16 v[196:199], v[216:219], v[28:31], v[196:199]
    ds_read_b64_tr_b16 v[210:211], v241 offset:33280
    v_mul_f32_e64 v153, v153, v145
    s_add_u32 m0, s64, 122880
    s_add_u32 s67, s65, 4423680
    buffer_load_dwordx4 v244, s[12:15], s67 offen lds
    v_mfma_f32_16x16x32_bf16 v[204:207], v[220:223], v[28:31], v[204:207]
    ds_read_b64_tr_b16 v[212:213], v241 offset:36864
    v_mul_f32_e64 v154, v154, v146
    v_mfma_f32_16x16x32_bf16 v[200:203], v[220:223], v[24:27], v[200:203]
    ds_read_b64_tr_b16 v[214:215], v241 offset:37376
    v_mul_f32 v155, v155, v147
    s_waitcnt lgkmcnt(4)
    v_mfma_f32_16x16x32_bf16 v[176:179], v[224:227], v[32:35], v[176:179]
    ds_read_b64_tr_b16 v[216:217], v240 offset:40960
    v_mul_f32_e64 v232, v160, v247
    v_mfma_f32_16x16x32_bf16 v[180:183], v[224:227], v[36:39], v[180:183]
    ds_read_b64_tr_b16 v[218:219], v240 offset:41472
    v_mul_f32_e64 v233, v161, v247
    v_mfma_f32_16x16x32_bf16 v[188:191], v[228:231], v[36:39], v[188:191]
    ds_read_b64_tr_b16 v[220:221], v240 offset:45056
    v_mul_f32_e64 v234, v162, v247
    v_mfma_f32_16x16x32_bf16 v[184:187], v[228:231], v[32:35], v[184:187]
    ds_read_b64_tr_b16 v[222:223], v240 offset:45568
    v_mul_f32 v235, v163, v247
    s_waitcnt lgkmcnt(4)
    v_mfma_f32_16x16x32_bf16 v[192:195], v[208:211], v[32:35], v[192:195]
    ds_read_b64_tr_b16 v[224:225], v241 offset:40960
    v_exp_f32_e64 v232, v232
    v_mfma_f32_16x16x32_bf16 v[196:199], v[208:211], v[36:39], v[196:199]
    ds_read_b64_tr_b16 v[226:227], v241 offset:41472
    s_add_u32 m0, s64, 131072
    s_add_u32 s67, s65, 4718592
    buffer_load_dwordx4 v244, s[12:15], s67 offen lds
    v_mfma_f32_16x16x32_bf16 v[204:207], v[212:215], v[36:39], v[204:207]
    ds_read_b64_tr_b16 v[228:229], v241 offset:45056
    v_exp_f32_e64 v233, v233
    v_mfma_f32_16x16x32_bf16 v[200:203], v[212:215], v[32:35], v[200:203]
    ds_read_b64_tr_b16 v[230:231], v241 offset:45568
    s_waitcnt lgkmcnt(4)
    v_mfma_f32_16x16x32_bf16 v[176:179], v[216:219], v[40:43], v[176:179]
    v_add_u32 v240, 49152, v240
    v_add_u32 v241, 49152, v241
    ds_read_b64_tr_b16 v[208:209], v240 offset:0
    v_exp_f32 v234, v234
    v_mfma_f32_16x16x32_bf16 v[180:183], v[216:219], v[44:47], v[180:183]
    ds_read_b64_tr_b16 v[210:211], v240 offset:512
    v_exp_f32_e64 v235, v235
    v_mfma_f32_16x16x32_bf16 v[188:191], v[220:223], v[44:47], v[188:191]
    ds_read_b64_tr_b16 v[212:213], v240 offset:4096
    v_mfma_f32_16x16x32_bf16 v[184:187], v[220:223], v[40:43], v[184:187]
    ds_read_b64_tr_b16 v[214:215], v240 offset:4608
    v_mul_f32 v168, v168, v249
    s_waitcnt lgkmcnt(4)
    v_mfma_f32_16x16x32_bf16 v[192:195], v[224:227], v[40:43], v[192:195]
    ds_read_b64_tr_b16 v[216:217], v241 offset:0
    v_mul_f32_e64 v169, v169, v249
    v_mfma_f32_16x16x32_bf16 v[196:199], v[224:227], v[44:47], v[196:199]
    ds_read_b64_tr_b16 v[218:219], v241 offset:512
    v_mul_f32 v170, v170, v249
    v_mul_f32 v171, v171, v249
    s_add_u32 m0, s64, 139264
    s_add_u32 s67, s65, 5013504
    buffer_load_dwordx4 v244, s[12:15], s67 offen lds
    v_mfma_f32_16x16x32_bf16 v[204:207], v[228:231], v[44:47], v[204:207]
    ds_read_b64_tr_b16 v[220:221], v241 offset:4096
    v_add_f32_e64 v232, 1.0, v232
    v_mfma_f32_16x16x32_bf16 v[200:203], v[228:231], v[40:43], v[200:203]
    ds_read_b64_tr_b16 v[222:223], v241 offset:4608
    v_add_f32 v233, 1.0, v233
    s_waitcnt vmcnt(5)
    s_barrier
    s_waitcnt lgkmcnt(4)
    v_mfma_f32_16x16x32_bf16 v[176:179], v[208:211], v[48:51], v[176:179]
    ds_read_b64_tr_b16 v[224:225], v240 offset:8192
    v_add_f32_e64 v234, 1.0, v234
    v_mfma_f32_16x16x32_bf16 v[180:183], v[208:211], v[52:55], v[180:183]
    ds_read_b64_tr_b16 v[226:227], v240 offset:8704
    v_add_f32_e64 v235, 1.0, v235
    v_mfma_f32_16x16x32_bf16 v[188:191], v[212:215], v[52:55], v[188:191]
    ds_read_b64_tr_b16 v[228:229], v240 offset:12288
    v_rcp_f32_e64 v232, v232
    v_mfma_f32_16x16x32_bf16 v[184:187], v[212:215], v[48:51], v[184:187]
    ds_read_b64_tr_b16 v[230:231], v240 offset:12800
    s_waitcnt lgkmcnt(4)
    v_mfma_f32_16x16x32_bf16 v[192:195], v[216:219], v[48:51], v[192:195]
    ds_read_b64_tr_b16 v[208:209], v241 offset:8192
    v_rcp_f32 v233, v233
    v_mfma_f32_16x16x32_bf16 v[196:199], v[216:219], v[52:55], v[196:199]
    ds_read_b64_tr_b16 v[210:211], v241 offset:8704
    s_add_u32 m0, s64, 0
    s_add_u32 s67, s66, 0
    buffer_load_dwordx4 v244, s[12:15], s67 offen lds
    s_cmp_lg_u32 s3, 0
    s_cbranch_scc1 L_fs1
    s_cmp_eq_u32 s70, 0
    s_cbranch_scc1 L_fs1
    s_add_u32 s38, s97, 0
    v_mov_b32_e64 v239, s96
    s_mov_b64 exec, 1
    buffer_store_dword v239, off, s[24:27], s38 sc1
    s_mov_b64 exec, -1
L_fs1:
    v_mfma_f32_16x16x32_bf16 v[204:207], v[220:223], v[52:55], v[204:207]
    ds_read_b64_tr_b16 v[212:213], v241 offset:12288
    v_rcp_f32 v234, v234
    v_mfma_f32_16x16x32_bf16 v[200:203], v[220:223], v[48:51], v[200:203]
    ds_read_b64_tr_b16 v[214:215], v241 offset:12800
    s_waitcnt lgkmcnt(4)
    v_mfma_f32_16x16x32_bf16 v[176:179], v[224:227], v[56:59], v[176:179]
    ds_read_b64_tr_b16 v[216:217], v240 offset:16384
    v_rcp_f32 v235, v235
    v_mfma_f32_16x16x32_bf16 v[180:183], v[224:227], v[60:63], v[180:183]
    ds_read_b64_tr_b16 v[218:219], v240 offset:16896
    v_mul_f32_e64 v160, v160, v232
    v_mfma_f32_16x16x32_bf16 v[188:191], v[228:231], v[60:63], v[188:191]
    ds_read_b64_tr_b16 v[220:221], v240 offset:20480
    v_mul_f32_e64 v161, v161, v233
    v_mfma_f32_16x16x32_bf16 v[184:187], v[228:231], v[56:59], v[184:187]
    ds_read_b64_tr_b16 v[222:223], v240 offset:20992
    v_mul_f32 v162, v162, v234
    s_waitcnt lgkmcnt(4)
    v_mfma_f32_16x16x32_bf16 v[192:195], v[208:211], v[56:59], v[192:195]
    ds_read_b64_tr_b16 v[224:225], v241 offset:16384
    v_mul_f32_e64 v163, v163, v235
    v_mfma_f32_16x16x32_bf16 v[196:199], v[208:211], v[60:63], v[196:199]
    ds_read_b64_tr_b16 v[226:227], v241 offset:16896
    v_mul_f32 v168, v168, v160
    v_mul_f32 v169, v169, v161
    s_add_u32 m0, s64, 8192
    s_add_u32 s67, s66, 294912
    buffer_load_dwordx4 v244, s[12:15], s67 offen lds
    v_mfma_f32_16x16x32_bf16 v[204:207], v[212:215], v[60:63], v[204:207]
    ds_read_b64_tr_b16 v[228:229], v241 offset:20480
    v_mul_f32_e64 v170, v170, v162
    v_mfma_f32_16x16x32_bf16 v[200:203], v[212:215], v[56:59], v[200:203]
    ds_read_b64_tr_b16 v[230:231], v241 offset:20992
    v_mul_f32 v171, v171, v163
    s_waitcnt lgkmcnt(4)
    v_mfma_f32_16x16x32_bf16 v[176:179], v[216:219], v[64:67], v[176:179]
    ds_read_b64_tr_b16 v[208:209], v240 offset:24576
    v_cvt_pk_bf16_f32 v144, v152, v153
    v_mfma_f32_16x16x32_bf16 v[180:183], v[216:219], v[68:71], v[180:183]
    ds_read_b64_tr_b16 v[210:211], v240 offset:25088
    v_cvt_pk_bf16_f32 v145, v154, v155
    v_mfma_f32_16x16x32_bf16 v[188:191], v[220:223], v[68:71], v[188:191]
    ds_read_b64_tr_b16 v[212:213], v240 offset:28672
    v_cvt_pk_bf16_f32 v146, v168, v169
    v_mfma_f32_16x16x32_bf16 v[184:187], v[220:223], v[64:67], v[184:187]
    ds_read_b64_tr_b16 v[214:215], v240 offset:29184
    v_cvt_pk_bf16_f32 v147, v170, v171
    buffer_store_dwordx4 v[144:147], v246, s[24:27], s68 offen offset:0 sc1
    s_waitcnt lgkmcnt(4)
    v_mfma_f32_16x16x32_bf16 v[192:195], v[224:227], v[64:67], v[192:195]
    ds_read_b64_tr_b16 v[216:217], v241 offset:24576
    v_mul_f32 v232, v148, v248
    v_mfma_f32_16x16x32_bf16 v[196:199], v[224:227], v[68:71], v[196:199]
    ds_read_b64_tr_b16 v[218:219], v241 offset:25088
    v_mul_f32_e64 v233, v149, v248
    s_add_u32 m0, s64, 16384
    s_add_u32 s67, s66, 589824
    buffer_load_dwordx4 v244, s[12:15], s67 offen lds
    v_mfma_f32_16x16x32_bf16 v[204:207], v[228:231], v[68:71], v[204:207]
    ds_read_b64_tr_b16 v[220:221], v241 offset:28672
    v_mul_f32_e64 v234, v150, v248
    v_mfma_f32_16x16x32_bf16 v[200:203], v[228:231], v[64:67], v[200:203]
    ds_read_b64_tr_b16 v[222:223], v241 offset:29184
    v_mul_f32 v235, v151, v248
    s_waitcnt lgkmcnt(4)
    v_mfma_f32_16x16x32_bf16 v[176:179], v[208:211], v[72:75], v[176:179]
    ds_read_b64_tr_b16 v[224:225], v240 offset:32768
    v_exp_f32_e64 v232, v232
    v_mfma_f32_16x16x32_bf16 v[180:183], v[208:211], v[76:79], v[180:183]
    ds_read_b64_tr_b16 v[226:227], v240 offset:33280
    v_mfma_f32_16x16x32_bf16 v[188:191], v[212:215], v[76:79], v[188:191]
    ds_read_b64_tr_b16 v[228:229], v240 offset:36864
    v_exp_f32_e64 v233, v233
    v_mfma_f32_16x16x32_bf16 v[184:187], v[212:215], v[72:75], v[184:187]
    ds_read_b64_tr_b16 v[230:231], v240 offset:37376
    s_waitcnt lgkmcnt(4)
    v_mfma_f32_16x16x32_bf16 v[192:195], v[216:219], v[72:75], v[192:195]
    ds_read_b64_tr_b16 v[208:209], v241 offset:32768
    v_exp_f32 v234, v234
    v_mfma_f32_16x16x32_bf16 v[196:199], v[216:219], v[76:79], v[196:199]
    ds_read_b64_tr_b16 v[210:211], v241 offset:33280
    v_exp_f32_e64 v235, v235
    s_add_u32 m0, s64, 24576
    s_add_u32 s67, s66, 884736
    buffer_load_dwordx4 v244, s[12:15], s67 offen lds
    v_mfma_f32_16x16x32_bf16 v[204:207], v[220:223], v[76:79], v[204:207]
    ds_read_b64_tr_b16 v[212:213], v241 offset:36864
    v_mfma_f32_16x16x32_bf16 v[200:203], v[220:223], v[72:75], v[200:203]
    ds_read_b64_tr_b16 v[214:215], v241 offset:37376
    v_mul_f32 v156, v156, v250
    s_waitcnt lgkmcnt(4)
    v_mfma_f32_16x16x32_bf16 v[176:179], v[224:227], v[80:83], v[176:179]
    ds_read_b64_tr_b16 v[216:217], v240 offset:40960
    v_mul_f32 v157, v157, v250
    v_mul_f32 v158, v158, v250
    v_mfma_f32_16x16x32_bf16 v[180:183], v[224:227], v[84:87], v[180:183]
    ds_read_b64_tr_b16 v[218:219], v240 offset:41472
    v_mul_f32_e64 v159, v159, v250
    v_mfma_f32_16x16x32_bf16 v[188:191], v[228:231], v[84:87], v[188:191]
    ds_read_b64_tr_b16 v[220:221], v240 offset:45056
    v_add_f32_e64 v232, 1.0, v232
    v_mfma_f32_16x16x32_bf16 v[184:187], v[228:231], v[80:83], v[184:187]
    ds_read_b64_tr_b16 v[222:223], v240 offset:45568
    v_add_f32 v233, 1.0, v233
    s_waitcnt lgkmcnt(4)
    v_mfma_f32_16x16x32_bf16 v[192:195], v[208:211], v[80:83], v[192:195]
    ds_read_b64_tr_b16 v[224:225], v241 offset:40960
    v_add_f32_e64 v234, 1.0, v234
    v_mfma_f32_16x16x32_bf16 v[196:199], v[208:211], v[84:87], v[196:199]
    ds_read_b64_tr_b16 v[226:227], v241 offset:41472
    v_add_f32_e64 v235, 1.0, v235
    s_add_u32 m0, s64, 32768
    s_add_u32 s67, s66, 1179648
    buffer_load_dwordx4 v244, s[12:15], s67 offen lds
    v_mfma_f32_16x16x32_bf16 v[204:207], v[212:215], v[84:87], v[204:207]
    ds_read_b64_tr_b16 v[228:229], v241 offset:45056
    v_rcp_f32_e64 v232, v232
    v_mfma_f32_16x16x32_bf16 v[200:203], v[212:215], v[80:83], v[200:203]
    ds_read_b64_tr_b16 v[230:231], v241 offset:45568
    s_waitcnt lgkmcnt(4)
    v_mfma_f32_16x16x32_bf16 v[176:179], v[216:219], v[88:91], v[176:179]
    v_add_u32 v240, 49152, v240
    v_add_u32 v241, 49152, v241
    ds_read_b64_tr_b16 v[208:209], v240 offset:0
    v_rcp_f32 v233, v233
    v_mfma_f32_16x16x32_bf16 v[180:183], v[216:219], v[92:95], v[180:183]
    ds_read_b64_tr_b16 v[210:211], v240 offset:512
    v_mfma_f32_16x16x32_bf16 v[188:191], v[220:223], v[92:95], v[188:191]
    ds_read_b64_tr_b16 v[212:213], v240 offset:4096
    v_rcp_f32_e64 v234, v234
    v_mfma_f32_16x16x32_bf16 v[184:187], v[220:223], v[88:91], v[184:187]
    ds_read_b64_tr_b16 v[214:215], v240 offset:4608
    s_waitcnt lgkmcnt(4)
    v_mfma_f32_16x16x32_bf16 v[192:195], v[224:227], v[88:91], v[192:195]
    ds_read_b64_tr_b16 v[216:217], v241 offset:0
    v_rcp_f32 v235, v235
    v_mfma_f32_16x16x32_bf16 v[196:199], v[224:227], v[92:95], v[196:199]
    ds_read_b64_tr_b16 v[218:219], v241 offset:512
    v_mul_f32_e64 v148, v148, v232
    s_add_u32 m0, s64, 40960
    s_add_u32 s67, s66, 1474560
    buffer_load_dwordx4 v244, s[12:15], s67 offen lds
    v_mfma_f32_16x16x32_bf16 v[204:207], v[228:231], v[92:95], v[204:207]
    ds_read_b64_tr_b16 v[220:221], v241 offset:4096
    v_mul_f32_e64 v149, v149, v233
    v_mfma_f32_16x16x32_bf16 v[200:203], v[228:231], v[88:91], v[200:203]
    ds_read_b64_tr_b16 v[222:223], v241 offset:4608
    v_mul_f32 v150, v150, v234
    s_waitcnt vmcnt(5)
    s_barrier
    s_waitcnt lgkmcnt(4)
    v_mfma_f32_16x16x32_bf16 v[176:179], v[208:211], v[96:99], v[176:179]
    ds_read_b64_tr_b16 v[224:225], v240 offset:8192
    v_mul_f32 v151, v151, v235
    v_mul_f32 v156, v156, v148
    v_mfma_f32_16x16x32_bf16 v[180:183], v[208:211], v[100:103], v[180:183]
    ds_read_b64_tr_b16 v[226:227], v240 offset:8704
    v_mul_f32_e64 v157, v157, v149
    v_mfma_f32_16x16x32_bf16 v[188:191], v[212:215], v[100:103], v[188:191]
    ds_read_b64_tr_b16 v[228:229], v240 offset:12288
    v_mul_f32_e64 v158, v158, v150
    v_mfma_f32_16x16x32_bf16 v[184:187], v[212:215], v[96:99], v[184:187]
    ds_read_b64_tr_b16 v[230:231], v240 offset:12800
    v_mul_f32 v159, v159, v151
    s_waitcnt lgkmcnt(4)
    v_mfma_f32_16x16x32_bf16 v[192:195], v[216:219], v[96:99], v[192:195]
    ds_read_b64_tr_b16 v[208:209], v241 offset:8192
    v_mul_f32_e64 v232, v164, v248
    v_mfma_f32_16x16x32_bf16 v[196:199], v[216:219], v[100:103], v[196:199]
    ds_read_b64_tr_b16 v[210:211], v241 offset:8704
    v_mul_f32_e64 v233, v165, v248
    s_add_u32 m0, s64, 49152
    s_add_u32 s67, s66, 1769472
    buffer_load_dwordx4 v244, s[12:15], s67 offen lds
    v_mfma_f32_16x16x32_bf16 v[204:207], v[220:223], v[100:103], v[204:207]
    ds_read_b64_tr_b16 v[212:213], v241 offset:12288
    v_mul_f32_e64 v234, v166, v248
    v_mfma_f32_16x16x32_bf16 v[200:203], v[220:223], v[96:99], v[200:203]
    ds_read_b64_tr_b16 v[214:215], v241 offset:12800
    v_mul_f32 v235, v167, v248
    s_waitcnt lgkmcnt(4)
    v_mfma_f32_16x16x32_bf16 v[176:179], v[224:227], v[104:107], v[176:179]
    ds_read_b64_tr_b16 v[216:217], v240 offset:16384
    v_exp_f32_e64 v232, v232
    v_mfma_f32_16x16x32_bf16 v[180:183], v[224:227], v[108:111], v[180:183]
    ds_read_b64_tr_b16 v[218:219], v240 offset:16896
    v_mfma_f32_16x16x32_bf16 v[188:191], v[228:231], v[108:111], v[188:191]
    ds_read_b64_tr_b16 v[220:221], v240 offset:20480
    v_exp_f32_e64 v233, v233
    v_mfma_f32_16x16x32_bf16 v[184:187], v[228:231], v[104:107], v[184:187]
    ds_read_b64_tr_b16 v[222:223], v240 offset:20992
    s_waitcnt lgkmcnt(4)
    v_mfma_f32_16x16x32_bf16 v[192:195], v[208:211], v[104:107], v[192:195]
    ds_read_b64_tr_b16 v[224:225], v241 offset:16384
    v_exp_f32 v234, v234
    v_mfma_f32_16x16x32_bf16 v[196:199], v[208:211], v[108:111], v[196:199]
    ds_read_b64_tr_b16 v[226:227], v241 offset:16896
    v_exp_f32_e64 v235, v235
    s_add_u32 m0, s64, 57344
    s_add_u32 s67, s66, 2064384
    buffer_load_dwordx4 v244, s[12:15], s67 offen lds
    v_mfma_f32_16x16x32_bf16 v[204:207], v[212:215], v[108:111], v[204:207]
    ds_read_b64_tr_b16 v[228:229], v241 offset:20480
    v_mfma_f32_16x16x32_bf16 v[200:203], v[212:215], v[104:107], v[200:203]
    ds_read_b64_tr_b16 v[230:231], v241 offset:20992
    v_mul_f32 v172, v172, v250
    s_waitcnt lgkmcnt(4)
    v_mfma_f32_16x16x32_bf16 v[176:179], v[216:219], v[112:115], v[176:179]
    ds_read_b64_tr_b16 v[208:209], v240 offset:24576
    v_mul_f32_e64 v173, v173, v250
    v_mfma_f32_16x16x32_bf16 v[180:183], v[216:219], v[116:119], v[180:183]
    ds_read_b64_tr_b16 v[210:211], v240 offset:25088
    v_mul_f32 v174, v174, v250
    v_mul_f32 v175, v175, v250
    v_mfma_f32_16x16x32_bf16 v[188:191], v[220:223], v[116:119], v[188:191]
    ds_read_b64_tr_b16 v[212:213], v240 offset:28672
    v_add_f32_e64 v232, 1.0, v232
    v_mfma_f32_16x16x32_bf16 v[184:187], v[220:223], v[112:115], v[184:187]
    ds_read_b64_tr_b16 v[214:215], v240 offset:29184
    v_add_f32 v233, 1.0, v233
    s_waitcnt lgkmcnt(4)
    v_mfma_f32_16x16x32_bf16 v[192:195], v[224:227], v[112:115], v[192:195]
    ds_read_b64_tr_b16 v[216:217], v241 offset:24576
    v_add_f32_e64 v234, 1.0, v234
    v_mfma_f32_16x16x32_bf16 v[196:199], v[224:227], v[116:119], v[196:199]
    ds_read_b64_tr_b16 v[218:219], v241 offset:25088
    v_add_f32_e64 v235, 1.0, v235
    s_add_u32 m0, s64, 65536
    s_add_u32 s67, s66, 2359296
    buffer_load_dwordx4 v244, s[12:15], s67 offen lds
    v_mfma_f32_16x16x32_bf16 v[204:207], v[228:231], v[116:119], v[204:207]
    ds_read_b64_tr_b16 v[220:221], v241 offset:28672
    v_rcp_f32_e64 v232, v232
    v_mfma_f32_16x16x32_bf16 v[200:203], v[228:231], v[112:115], v[200:203]
    ds_read_b64_tr_b16 v[222:223], v241 offset:29184
    s_waitcnt lgkmcnt(4)
    v_mfma_f32_16x16x32_bf16 v[176:179], v[208:211], v[120:123], v[176:179]
    ds_read_b64_tr_b16 v[224:225], v240 offset:32768
    v_rcp_f32 v233, v233
    v_mfma_f32_16x16x32_bf16 v[180:183], v[208:211], v[124:127], v[180:183]
    ds_read_b64_tr_b16 v[226:227], v240 offset:33280
    v_mfma_f32_16x16x32_bf16 v[188:191], v[212:215], v[124:127], v[188:191]
    ds_read_b64_tr_b16 v[228:229], v240 offset:36864
    v_rcp_f32_e64 v234, v234
    v_mfma_f32_16x16x32_bf16 v[184:187], v[212:215], v[120:123], v[184:187]
    ds_read_b64_tr_b16 v[230:231], v240 offset:37376
    s_waitcnt lgkmcnt(4)
    v_mfma_f32_16x16x32_bf16 v[192:195], v[216:219], v[120:123], v[192:195]
    ds_read_b64_tr_b16 v[208:209], v241 offset:32768
    v_rcp_f32 v235, v235
    v_mfma_f32_16x16x32_bf16 v[196:199], v[216:219], v[124:127], v[196:199]
    ds_read_b64_tr_b16 v[210:211], v241 offset:33280
    v_mul_f32_e64 v164, v164, v232
    s_add_u32 m0, s64, 73728
    s_add_u32 s67, s66, 2654208
    buffer_load_dwordx4 v244, s[12:15], s67 offen lds
    v_mfma_f32_16x16x32_bf16 v[204:207], v[220:223], v[124:127], v[204:207]
    ds_read_b64_tr_b16 v[212:213], v241 offset:36864
    v_mul_f32_e64 v165, v165, v233
    v_mfma_f32_16x16x32_bf16 v[200:203], v[220:223], v[120:123], v[200:203]
    ds_read_b64_tr_b16 v[214:215], v241 offset:37376
    v_mul_f32 v166, v166, v234
    s_waitcnt lgkmcnt(4)
    v_mfma_f32_16x16x32_bf16 v[176:179], v[224:227], v[128:131], v[176:179]
    ds_read_b64_tr_b16 v[216:217], v240 offset:40960
    v_mul_f32_e64 v167, v167, v235
    v_mfma_f32_16x16x32_bf16 v[180:183], v[224:227], v[132:135], v[180:183]
    ds_read_b64_tr_b16 v[218:219], v240 offset:41472
    v_mul_f32 v172, v172, v164
    v_mul_f32 v173, v173, v165
    v_mfma_f32_16x16x32_bf16 v[188:191], v[228:231], v[132:135], v[188:191]
    ds_read_b64_tr_b16 v[220:221], v240 offset:45056
    v_mul_f32_e64 v174, v174, v166
    v_mfma_f32_16x16x32_bf16 v[184:187], v[228:231], v[128:131], v[184:187]
    ds_read_b64_tr_b16 v[222:223], v240 offset:45568
    v_mul_f32 v175, v175, v167
    s_waitcnt lgkmcnt(4)
    v_mfma_f32_16x16x32_bf16 v[192:195], v[208:211], v[128:131], v[192:195]
    ds_read_b64_tr_b16 v[224:225], v241 offset:40960
    v_cvt_pk_bf16_f32 v148, v156, v157
    v_mfma_f32_16x16x32_bf16 v[196:199], v[208:211], v[132:135], v[196:199]
    ds_read_b64_tr_b16 v[226:227], v241 offset:41472
    v_cvt_pk_bf16_f32 v149, v158, v159
    s_add_u32 m0, s64, 81920
    s_add_u32 s67, s66, 2949120
    buffer_load_dwordx4 v244, s[12:15], s67 offen lds
    v_mfma_f32_16x16x32_bf16 v[204:207], v[212:215], v[132:135], v[204:207]
    ds_read_b64_tr_b16 v[228:229], v241 offset:45056
    v_cvt_pk_bf16_f32 v150, v172, v173
    v_mfma_f32_16x16x32_bf16 v[200:203], v[212:215], v[128:131], v[200:203]
    ds_read_b64_tr_b16 v[230:231], v241 offset:45568
    v_cvt_pk_bf16_f32 v151, v174, v175
    buffer_store_dwordx4 v[148:151], v246, s[24:27], s68 offen offset:1024 sc1
    s_waitcnt lgkmcnt(4)
    v_mfma_f32_16x16x32_bf16 v[176:179], v[216:219], v[136:139], v[176:179]
    v_subrev_u32 v240, 98304, v240
    v_subrev_u32 v241, 98304, v241
    ds_read_b64_tr_b16 v[208:209], v240 offset:0
    v_mfma_f32_16x16x32_bf16 v[180:183], v[216:219], v[140:143], v[180:183]
    ds_read_b64_tr_b16 v[210:211], v240 offset:512
    v_mfma_f32_16x16x32_bf16 v[188:191], v[220:223], v[140:143], v[188:191]
    ds_read_b64_tr_b16 v[212:213], v240 offset:4096
    v_mfma_f32_16x16x32_bf16 v[184:187], v[220:223], v[136:139], v[184:187]
    ds_read_b64_tr_b16 v[214:215], v240 offset:4608
    s_waitcnt lgkmcnt(4)
    v_mfma_f32_16x16x32_bf16 v[192:195], v[224:227], v[136:139], v[192:195]
    ds_read_b64_tr_b16 v[216:217], v241 offset:0
    v_mfma_f32_16x16x32_bf16 v[196:199], v[224:227], v[140:143], v[196:199]
    ds_read_b64_tr_b16 v[218:219], v241 offset:512
    s_add_u32 m0, s64, 90112
    s_add_u32 s67, s66, 3244032
    buffer_load_dwordx4 v244, s[12:15], s67 offen lds
    v_mfma_f32_16x16x32_bf16 v[204:207], v[228:231], v[140:143], v[204:207]
    ds_read_b64_tr_b16 v[220:221], v241 offset:4096
    v_mfma_f32_16x16x32_bf16 v[200:203], v[228:231], v[136:139], v[200:203]
    ds_read_b64_tr_b16 v[222:223], v241 offset:4608
    s_cmp_lg_u32 s70, 0
    s_cbranch_scc1 LA_FL
    s_mul_i32 s68, s6, 1179648
    s_lshl_b32 s87, s65, 7
    s_add_u32 s68, s68, s87
    s_mov_b32 s65, s66
    s_add_u32 s66, s65, 128
    s_cmp_eq_u32 s66, s98
    s_cselect_b32 s87, 640, 0
    s_sub_u32 s66, s66, s87
    s_waitcnt vmcnt(5)
    s_barrier
    s_waitcnt lgkmcnt(4)
    v_mfma_f32_16x16x32_bf16 v[144:147], v[208:211], v[0:3], 0
    ds_read_b64_tr_b16 v[224:225], v240 offset:8192
    v_mul_f32_e64 v232, v176, v247
    v_mfma_f32_16x16x32_bf16 v[148:151], v[208:211], v[4:7], 0
    ds_read_b64_tr_b16 v[226:227], v240 offset:8704
    v_mul_f32_e64 v233, v177, v247
    v_mfma_f32_16x16x32_bf16 v[156:159], v[212:215], v[4:7], 0
    ds_read_b64_tr_b16 v[228:229], v240 offset:12288
    v_mul_f32_e64 v234, v178, v247
    v_mfma_f32_16x16x32_bf16 v[152:155], v[212:215], v[0:3], 0
    ds_read_b64_tr_b16 v[230:231], v240 offset:12800
    v_mul_f32 v235, v179, v247
    s_waitcnt lgkmcnt(4)
    v_mfma_f32_16x16x32_bf16 v[160:163], v[216:219], v[0:3], 0
    ds_read_b64_tr_b16 v[208:209], v241 offset:8192
    v_exp_f32_e64 v232, v232
    v_mfma_f32_16x16x32_bf16 v[164:167], v[216:219], v[4:7], 0
    ds_read_b64_tr_b16 v[210:211], v241 offset:8704
    s_add_u32 m0, s64, 98304
    s_add_u32 s67, s65, 3538944
    buffer_load_dwordx4 v244, s[12:15], s67 offen lds
    s_add_u32 s99, s99, 1073741824
    v_mfma_f32_16x16x32_bf16 v[172:175], v[220:223], v[4:7], 0
    ds_read_b64_tr_b16 v[212:213], v241 offset:12288
    v_exp_f32 v233, v233
    v_mfma_f32_16x16x32_bf16 v[168:171], v[220:223], v[0:3], 0
    ds_read_b64_tr_b16 v[214:215], v241 offset:12800
    s_waitcnt lgkmcnt(4)
    v_mfma_f32_16x16x32_bf16 v[144:147], v[224:227], v[8:11], v[144:147]
    ds_read_b64_tr_b16 v[216:217], v240 offset:16384
    v_exp_f32 v234, v234
    v_mfma_f32_16x16x32_bf16 v[148:151], v[224:227], v[12:15], v[148:151]
    ds_read_b64_tr_b16 v[218:219], v240 offset:16896
    v_exp_f32_e64 v235, v235
    v_mfma_f32_16x16x32_bf16 v[156:159], v[228:231], v[12:15], v[156:159]
    ds_read_b64_tr_b16 v[220:221], v240 offset:20480
    v_mfma_f32_16x16x32_bf16 v[152:155], v[228:231], v[8:11], v[152:155]
    ds_read_b64_tr_b16 v[222:223], v240 offset:20992
    v_mul_f32 v184, v184, v249
    s_waitcnt lgkmcnt(4)
    v_mfma_f32_16x16x32_bf16 v[160:163], v[208:211], v[8:11], v[160:163]
    ds_read_b64_tr_b16 v[224:225], v241 offset:16384
    v_mul_f32 v185, v185, v249
    v_mul_f32 v186, v186, v249
    v_mfma_f32_16x16x32_bf16 v[164:167], v[208:211], v[12:15], v[164:167]
    ds_read_b64_tr_b16 v[226:227], v241 offset:16896
    v_mul_f32_e64 v187, v187, v249
    s_add_u32 m0, s64, 106496
    s_add_u32 s67, s65, 3833856
    buffer_load_dwordx4 v244, s[12:15], s67 offen lds
    v_mfma_f32_16x16x32_bf16 v[172:175], v[212:215], v[12:15], v[172:175]
    ds_read_b64_tr_b16 v[228:229], v241 offset:20480
    v_add_f32_e64 v232, 1.0, v232
    v_mfma_f32_16x16x32_bf16 v[168:171], v[212:215], v[8:11], v[168:171]
    ds_read_b64_tr_b16 v[230:231], v241 offset:20992
    v_add_f32 v233, 1.0, v233
    s_waitcnt lgkmcnt(4)
    v_mfma_f32_16x16x32_bf16 v[144:147], v[216:219], v[16:19], v[144:147]
    ds_read_b64_tr_b16 v[208:209], v240 offset:24576
    v_add_f32_e64 v234, 1.0, v234
    v_mfma_f32_16x16x32_bf16 v[148:151], v[216:219], v[20:23], v[148:151]
    ds_read_b64_tr_b16 v[210:211], v240 offset:25088
    v_add_f32_e64 v235, 1.0, v235
    v_mfma_f32_16x16x32_bf16 v[156:159], v[220:223], v[20:23], v[156:159]
    ds_read_b64_tr_b16 v[212:213], v240 offset:28672
    v_rcp_f32_e64 v232, v232
    v_mfma_f32_16x16x32_bf16 v[152:155], v[220:223], v[16:19], v[152:155]
    ds_read_b64_tr_b16 v[214:215], v240 offset:29184
    s_waitcnt lgkmcnt(4)
    v_mfma_f32_16x16x32_bf16 v[160:163], v[224:227], v[16:19], v[160:163]
    ds_read_b64_tr_b16 v[216:217], v241 offset:24576
    v_rcp_f32 v233, v233
    v_mfma_f32_16x16x32_bf16 v[164:167], v[224:227], v[20:23], v[164:167]
    ds_read_b64_tr_b16 v[218:219], v241 offset:25088
    s_add_u32 m0, s64, 114688
    s_add_u32 s67, s65, 4128768
    buffer_load_dwordx4 v244, s[12:15], s67 offen lds
    v_mfma_f32_16x16x32_bf16 v[172:175], v[228:231], v[20:23], v[172:175]
    ds_read_b64_tr_b16 v[220:221], v241 offset:28672
    v_rcp_f32_e64 v234, v234
    v_mfma_f32_16x16x32_bf16 v[168:171], v[228:231], v[16:19], v[168:171]
    ds_read_b64_tr_b16 v[222:223], v241 offset:29184
    s_waitcnt lgkmcnt(4)
    v_mfma_f32_16x16x32_bf16 v[144:147], v[208:211], v[24:27], v[144:147]
    ds_read_b64_tr_b16 v[224:225], v240 offset:32768
    v_rcp_f32 v235, v235
    v_mfma_f32_16x16x32_bf16 v[148:151], v[208:211], v[28:31], v[148:151]
    ds_read_b64_tr_b16 v[226:227], v240 offset:33280
    v_mul_f32_e64 v176, v176, v232
    v_mfma_f32_16x16x32_bf16 v[156:159], v[212:215], v[28:31], v[156:159]
    ds_read_b64_tr_b16 v[228:229], v240 offset:36864
    v_mul_f32_e64 v177, v177, v233
    v_mfma_f32_16x16x32_bf16 v[152:155], v[212:215], v[24:27], v[152:155]
    ds_read_b64_tr_b16 v[230:231], v240 offset:37376
    v_mul_f32 v178, v178, v234
    s_waitcnt lgkmcnt(4)
    v_mfma_f32_16x16x32_bf16 v[160:163], v[216:219], v[24:27], v[160:163]
    ds_read_b64_tr_b16 v[208:209], v241 offset:32768
    v_mul_f32 v179, v179, v235
    v_mul_f32 v184, v184, v176
    v_mfma_f32_16x16x32_bf16 v[164:167], v[216:219], v[28:31], v[164:167]
    ds_read_b64_tr_b16 v[210:211], v241 offset:33280
    v_mul_f32_e64 v185, v185, v177
    s_add_u32 m0, s64, 122880
    s_add_u32 s67, s65, 4423680
    buffer_load_dwordx4 v244, s[12:15], s67 offen lds
    v_mfma_f32_16x16x32_bf16 v[172:175], v[220:223], v[28:31], v[172:175]
    ds_read_b64_tr_b16 v[212:213], v241 offset:36864
    v_mul_f32_e64 v186, v186, v178
    v_mfma_f32_16x16x32_bf16 v[168:171], v[220:223], v[24:27], v[168:171]
    ds_read_b64_tr_b16 v[214:215], v241 offset:37376
    v_mul_f32 v187, v187, v179
    s_waitcnt lgkmcnt(4)
    v_mfma_f32_16x16x32_bf16 v[144:147], v[224:227], v[32:35], v[144:147]
    ds_read_b64_tr_b16 v[216:217], v240 offset:40960
    v_mul_f32_e64 v232, v192, v247
    v_mfma_f32_16x16x32_bf16 v[148:151], v[224:227], v[36:39], v[148:151]
    ds_read_b64_tr_b16 v[218:219], v240 offset:41472
    v_mul_f32_e64 v233, v193, v247
    v_mfma_f32_16x16x32_bf16 v[156:159], v[228:231], v[36:39], v[156:159]
    ds_read_b64_tr_b16 v[220:221], v240 offset:45056
    v_mul_f32_e64 v234, v194, v247
    v_mfma_f32_16x16x32_bf16 v[152:155], v[228:231], v[32:35], v[152:155]
    ds_read_b64_tr_b16 v[222:223], v240 offset:45568
    v_mul_f32 v235, v195, v247
    s_waitcnt lgkmcnt(4)
    v_mfma_f32_16x16x32_bf16 v[160:163], v[208:211], v[32:35], v[160:163]
    ds_read_b64_tr_b16 v[224:225], v241 offset:40960
    v_exp_f32_e64 v232, v232
    v_mfma_f32_16x16x32_bf16 v[164:167], v[208:211], v[36:39], v[164:167]
    ds_read_b64_tr_b16 v[226:227], v241 offset:41472
    s_add_u32 m0, s64, 131072
    s_add_u32 s67, s65, 4718592
    buffer_load_dwordx4 v244, s[12:15], s67 offen lds
    v_mfma_f32_16x16x32_bf16 v[172:175], v[212:215], v[36:39], v[172:175]
    ds_read_b64_tr_b16 v[228:229], v241 offset:45056
    v_exp_f32_e64 v233, v233
    v_mfma_f32_16x16x32_bf16 v[168:171], v[212:215], v[32:35], v[168:171]
    ds_read_b64_tr_b16 v[230:231], v241 offset:45568
    s_waitcnt lgkmcnt(4)
    v_mfma_f32_16x16x32_bf16 v[144:147], v[216:219], v[40:43], v[144:147]
    v_add_u32 v240, 49152, v240
    v_add_u32 v241, 49152, v241
    ds_read_b64_tr_b16 v[208:209], v240 offset:0
    v_exp_f32 v234, v234
    v_mfma_f32_16x16x32_bf16 v[148:151], v[216:219], v[44:47], v[148:151]
    ds_read_b64_tr_b16 v[210:211], v240 offset:512
    v_exp_f32_e64 v235, v235
    v_mfma_f32_16x16x32_bf16 v[156:159], v[220:223], v[44:47], v[156:159]
    ds_read_b64_tr_b16 v[212:213], v240 offset:4096
    v_mfma_f32_16x16x32_bf16 v[152:155], v[220:223], v[40:43], v[152:155]
    ds_read_b64_tr_b16 v[214:215], v240 offset:4608
    v_mul_f32 v200, v200, v249
    s_waitcnt lgkmcnt(4)
    v_mfma_f32_16x16x32_bf16 v[160:163], v[224:227], v[40:43], v[160:163]
    ds_read_b64_tr_b16 v[216:217], v241 offset:0
    v_mul_f32_e64 v201, v201, v249
    v_mfma_f32_16x16x32_bf16 v[164:167], v[224:227], v[44:47], v[164:167]
    ds_read_b64_tr_b16 v[218:219], v241 offset:512
    v_mul_f32 v202, v202, v249
    v_mul_f32 v203, v203, v249
    s_add_u32 m0, s64, 139264
    s_add_u32 s67, s65, 5013504
    buffer_load_dwordx4 v244, s[12:15], s67 offen lds
    v_mfma_f32_16x16x32_bf16 v[172:175], v[228:231], v[44:47], v[172:175]
    ds_read_b64_tr_b16 v[220:221], v241 offset:4096
    v_add_f32_e64 v232, 1.0, v232
    v_mfma_f32_16x16x32_bf16 v[168:171], v[228:231], v[40:43], v[168:171]
    ds_read_b64_tr_b16 v[222:223], v241 offset:4608
    v_add_f32 v233, 1.0, v233
    s_waitcnt vmcnt(5)
    s_barrier
    s_waitcnt lgkmcnt(4)
    v_mfma_f32_16x16x32_bf16 v[144:147], v[208:211], v[48:51], v[144:147]
    ds_read_b64_tr_b16 v[224:225], v240 offset:8192
    v_add_f32_e64 v234, 1.0, v234
    v_mfma_f32_16x16x32_bf16 v[148:151], v[208:211], v[52:55], v[148:151]
    ds_read_b64_tr_b16 v[226:227], v240 offset:8704
    v_add_f32_e64 v235, 1.0, v235
    v_mfma_f32_16x16x32_bf16 v[156:159], v[212:215], v[52:55], v[156:159]
    ds_read_b64_tr_b16 v[228:229], v240 offset:12288
    v_rcp_f32_e64 v232, v232
    v_mfma_f32_16x16x32_bf16 v[152:155], v[212:215], v[48:51], v[152:155]
    ds_read_b64_tr_b16 v[230:231], v240 offset:12800
    s_waitcnt lgkmcnt(4)
    v_mfma_f32_16x16x32_bf16 v[160:163], v[216:219], v[48:51], v[160:163]
    ds_read_b64_tr_b16 v[208:209], v241 offset:8192
    v_rcp_f32 v233, v233
    v_mfma_f32_16x16x32_bf16 v[164:167], v[216:219], v[52:55], v[164:167]
    ds_read_b64_tr_b16 v[210:211], v241 offset:8704
    s_add_u32 m0, s64, 0
    s_add_u32 s67, s66, 0
    buffer_load_dwordx4 v244, s[12:15], s67 offen lds
    v_mfma_f32_16x16x32_bf16 v[172:175], v[220:223], v[52:55], v[172:175]
    ds_read_b64_tr_b16 v[212:213], v241 offset:12288
    v_rcp_f32_e64 v234, v234
    v_mfma_f32_16x16x32_bf16 v[168:171], v[220:223], v[48:51], v[168:171]
    ds_read_b64_tr_b16 v[214:215], v241 offset:12800
    s_waitcnt lgkmcnt(4)
    v_mfma_f32_16x16x32_bf16 v[144:147], v[224:227], v[56:59], v[144:147]
    ds_read_b64_tr_b16 v[216:217], v240 offset:16384
    v_rcp_f32 v235, v235
    v_mfma_f32_16x16x32_bf16 v[148:151], v[224:227], v[60:63], v[148:151]
    ds_read_b64_tr_b16 v[218:219], v240 offset:16896
    v_mul_f32_e64 v192, v192, v232
    v_mfma_f32_16x16x32_bf16 v[156:159], v[228:231], v[60:63], v[156:159]
    ds_read_b64_tr_b16 v[220:221], v240 offset:20480
    v_mul_f32_e64 v193, v193, v233
    v_mfma_f32_16x16x32_bf16 v[152:155], v[228:231], v[56:59], v[152:155]
    ds_read_b64_tr_b16 v[222:223], v240 offset:20992
    v_mul_f32 v194, v194, v234
    s_waitcnt lgkmcnt(4)
    v_mfma_f32_16x16x32_bf16 v[160:163], v[208:211], v[56:59], v[160:163]
    ds_read_b64_tr_b16 v[224:225], v241 offset:16384
    v_mul_f32_e64 v195, v195, v235
    v_mfma_f32_16x16x32_bf16 v[164:167], v[208:211], v[60:63], v[164:167]
    ds_read_b64_tr_b16 v[226:227], v241 offset:16896
    v_mul_f32 v200, v200, v192
    v_mul_f32 v201, v201, v193
    s_add_u32 m0, s64, 8192
    s_add_u32 s67, s66, 294912
    buffer_load_dwordx4 v244, s[12:15], s67 offen lds
    v_mfma_f32_16x16x32_bf16 v[172:175], v[212:215], v[60:63], v[172:175]
    ds_read_b64_tr_b16 v[228:229], v241 offset:20480
    v_mul_f32_e64 v202, v202, v194
    v_mfma_f32_16x16x32_bf16 v[168:171], v[212:215], v[56:59], v[168:171]
    ds_read_b64_tr_b16 v[230:231], v241 offset:20992
    v_mul_f32 v203, v203, v195
    s_waitcnt lgkmcnt(4)
    v_mfma_f32_16x16x32_bf16 v[144:147], v[216:219], v[64:67], v[144:147]
    ds_read_b64_tr_b16 v[208:209], v240 offset:24576
    v_cvt_pk_bf16_f32 v176, v184, v185
    v_mfma_f32_16x16x32_bf16 v[148:151], v[216:219], v[68:71], v[148:151]
    ds_read_b64_tr_b16 v[210:211], v240 offset:25088
    v_cvt_pk_bf16_f32 v177, v186, v187
    v_mfma_f32_16x16x32_bf16 v[156:159], v[220:223], v[68:71], v[156:159]
    ds_read_b64_tr_b16 v[212:213], v240 offset:28672
    v_cvt_pk_bf16_f32 v178, v200, v201
    v_mfma_f32_16x16x32_bf16 v[152:155], v[220:223], v[64:67], v[152:155]
    ds_read_b64_tr_b16 v[214:215], v240 offset:29184
    v_cvt_pk_bf16_f32 v179, v202, v203
    buffer_store_dwordx4 v[176:179], v246, s[24:27], s68 offen offset:0 sc1
    s_waitcnt lgkmcnt(4)
    v_mfma_f32_16x16x32_bf16 v[160:163], v[224:227], v[64:67], v[160:163]
    ds_read_b64_tr_b16 v[216:217], v241 offset:24576
    v_mul_f32 v232, v180, v248
    v_mfma_f32_16x16x32_bf16 v[164:167], v[224:227], v[68:71], v[164:167]
    ds_read_b64_tr_b16 v[218:219], v241 offset:25088
    v_mul_f32_e64 v233, v181, v248
    s_add_u32 m0, s64, 16384
    s_add_u32 s67, s66, 589824
    buffer_load_dwordx4 v244, s[12:15], s67 offen lds
    v_mfma_f32_16x16x32_bf16 v[172:175], v[228:231], v[68:71], v[172:175]
    ds_read_b64_tr_b16 v[220:221], v241 offset:28672
    v_mul_f32_e64 v234, v182, v248
    v_mfma_f32_16x16x32_bf16 v[168:171], v[228:231], v[64:67], v[168:171]
    ds_read_b64_tr_b16 v[222:223], v241 offset:29184
    v_mul_f32 v235, v183, v248
    s_waitcnt lgkmcnt(4)
    v_mfma_f32_16x16x32_bf16 v[144:147], v[208:211], v[72:75], v[144:147]
    ds_read_b64_tr_b16 v[224:225], v240 offset:32768
    v_exp_f32_e64 v232, v232
    v_mfma_f32_16x16x32_bf16 v[148:151], v[208:211], v[76:79], v[148:151]
    ds_read_b64_tr_b16 v[226:227], v240 offset:33280
    v_mfma_f32_16x16x32_bf16 v[156:159], v[212:215], v[76:79], v[156:159]
    ds_read_b64_tr_b16 v[228:229], v240 offset:36864
    v_exp_f32_e64 v233, v233
    v_mfma_f32_16x16x32_bf16 v[152:155], v[212:215], v[72:75], v[152:155]
    ds_read_b64_tr_b16 v[230:231], v240 offset:37376
    s_waitcnt lgkmcnt(4)
    v_mfma_f32_16x16x32_bf16 v[160:163], v[216:219], v[72:75], v[160:163]
    ds_read_b64_tr_b16 v[208:209], v241 offset:32768
    v_exp_f32 v234, v234
    v_mfma_f32_16x16x32_bf16 v[164:167], v[216:219], v[76:79], v[164:167]
    ds_read_b64_tr_b16 v[210:211], v241 offset:33280
    v_exp_f32_e64 v235, v235
    s_add_u32 m0, s64, 24576
    s_add_u32 s67, s66, 884736
    buffer_load_dwordx4 v244, s[12:15], s67 offen lds
    v_mfma_f32_16x16x32_bf16 v[172:175], v[220:223], v[76:79], v[172:175]
    ds_read_b64_tr_b16 v[212:213], v241 offset:36864
    v_mfma_f32_16x16x32_bf16 v[168:171], v[220:223], v[72:75], v[168:171]
    ds_read_b64_tr_b16 v[214:215], v241 offset:37376
    v_mul_f32 v188, v188, v250
    s_waitcnt lgkmcnt(4)
    v_mfma_f32_16x16x32_bf16 v[144:147], v[224:227], v[80:83], v[144:147]
    ds_read_b64_tr_b16 v[216:217], v240 offset:40960
    v_mul_f32 v189, v189, v250
    v_mul_f32 v190, v190, v250
    v_mfma_f32_16x16x32_bf16 v[148:151], v[224:227], v[84:87], v[148:151]
    ds_read_b64_tr_b16 v[218:219], v240 offset:41472
    v_mul_f32_e64 v191, v191, v250
    v_mfma_f32_16x16x32_bf16 v[156:159], v[228:231], v[84:87], v[156:159]
    ds_read_b64_tr_b16 v[220:221], v240 offset:45056
    v_add_f32_e64 v232, 1.0, v232
    v_mfma_f32_16x16x32_bf16 v[152:155], v[228:231], v[80:83], v[152:155]
    ds_read_b64_tr_b16 v[222:223], v240 offset:45568
    v_add_f32 v233, 1.0, v233
    s_waitcnt lgkmcnt(4)
    v_mfma_f32_16x16x32_bf16 v[160:163], v[208:211], v[80:83], v[160:163]
    ds_read_b64_tr_b16 v[224:225], v241 offset:40960
    v_add_f32_e64 v234, 1.0, v234
    v_mfma_f32_16x16x32_bf16 v[164:167], v[208:211], v[84:87], v[164:167]
    ds_read_b64_tr_b16 v[226:227], v241 offset:41472
    v_add_f32_e64 v235, 1.0, v235
    s_add_u32 m0, s64, 32768
    s_add_u32 s67, s66, 1179648
    buffer_load_dwordx4 v244, s[12:15], s67 offen lds
    v_mfma_f32_16x16x32_bf16 v[172:175], v[212:215], v[84:87], v[172:175]
    ds_read_b64_tr_b16 v[228:229], v241 offset:45056
    v_rcp_f32_e64 v232, v232
    v_mfma_f32_16x16x32_bf16 v[168:171], v[212:215], v[80:83], v[168:171]
    ds_read_b64_tr_b16 v[230:231], v241 offset:45568
    s_waitcnt lgkmcnt(4)
    v_mfma_f32_16x16x32_bf16 v[144:147], v[216:219], v[88:91], v[144:147]
    v_add_u32 v240, 49152, v240
    v_add_u32 v241, 49152, v241
    ds_read_b64_tr_b16 v[208:209], v240 offset:0
    v_rcp_f32 v233, v233
    v_mfma_f32_16x16x32_bf16 v[148:151], v[216:219], v[92:95], v[148:151]
    ds_read_b64_tr_b16 v[210:211], v240 offset:512
    v_mfma_f32_16x16x32_bf16 v[156:159], v[220:223], v[92:95], v[156:159]
    ds_read_b64_tr_b16 v[212:213], v240 offset:4096
    v_rcp_f32_e64 v234, v234
    v_mfma_f32_16x16x32_bf16 v[152:155], v[220:223], v[88:91], v[152:155]
    ds_read_b64_tr_b16 v[214:215], v240 offset:4608
    s_waitcnt lgkmcnt(4)
    v_mfma_f32_16x16x32_bf16 v[160:163], v[224:227], v[88:91], v[160:163]
    ds_read_b64_tr_b16 v[216:217], v241 offset:0
    v_rcp_f32 v235, v235
    v_mfma_f32_16x16x32_bf16 v[164:167], v[224:227], v[92:95], v[164:167]
    ds_read_b64_tr_b16 v[218:219], v241 offset:512
    v_mul_f32_e64 v180, v180, v232
    s_add_u32 m0, s64, 40960
    s_add_u32 s67, s66, 1474560
    buffer_load_dwordx4 v244, s[12:15], s67 offen lds
    v_mfma_f32_16x16x32_bf16 v[172:175], v[228:231], v[92:95], v[172:175]
    ds_read_b64_tr_b16 v[220:221], v241 offset:4096
    v_mul_f32_e64 v181, v181, v233
    v_mfma_f32_16x16x32_bf16 v[168:171], v[228:231], v[88:91], v[168:171]
    ds_read_b64_tr_b16 v[222:223], v241 offset:4608
    v_mul_f32 v182, v182, v234
    s_waitcnt vmcnt(5)
    s_barrier
    s_waitcnt lgkmcnt(4)
    v_mfma_f32_16x16x32_bf16 v[144:147], v[208:211], v[96:99], v[144:147]
    ds_read_b64_tr_b16 v[224:225], v240 offset:8192
    v_mul_f32 v183, v183, v235
    v_mul_f32 v188, v188, v180
    v_mfma_f32_16x16x32_bf16 v[148:151], v[208:211], v[100:103], v[148:151]
    ds_read_b64_tr_b16 v[226:227], v240 offset:8704
    v_mul_f32_e64 v189, v189, v181
    v_mfma_f32_16x16x32_bf16 v[156:159], v[212:215], v[100:103], v[156:159]
    ds_read_b64_tr_b16 v[228:229], v240 offset:12288
    v_mul_f32_e64 v190, v190, v182
    v_mfma_f32_16x16x32_bf16 v[152:155], v[212:215], v[96:99], v[152:155]
    ds_read_b64_tr_b16 v[230:231], v240 offset:12800
    v_mul_f32 v191, v191, v183
    s_waitcnt lgkmcnt(4)
    v_mfma_f32_16x16x32_bf16 v[160:163], v[216:219], v[96:99], v[160:163]
    ds_read_b64_tr_b16 v[208:209], v241 offset:8192
    v_mul_f32_e64 v232, v196, v248
    v_mfma_f32_16x16x32_bf16 v[164:167], v[216:219], v[100:103], v[164:167]
    ds_read_b64_tr_b16 v[210:211], v241 offset:8704
    v_mul_f32_e64 v233, v197, v248
    s_add_u32 m0, s64, 49152
    s_add_u32 s67, s66, 1769472
    buffer_load_dwordx4 v244, s[12:15], s67 offen lds
    v_mfma_f32_16x16x32_bf16 v[172:175], v[220:223], v[100:103], v[172:175]
    ds_read_b64_tr_b16 v[212:213], v241 offset:12288
    v_mul_f32_e64 v234, v198, v248
    v_mfma_f32_16x16x32_bf16 v[168:171], v[220:223], v[96:99], v[168:171]
    ds_read_b64_tr_b16 v[214:215], v241 offset:12800
    v_mul_f32 v235, v199, v248
    s_waitcnt lgkmcnt(4)
    v_mfma_f32_16x16x32_bf16 v[144:147], v[224:227], v[104:107], v[144:147]
    ds_read_b64_tr_b16 v[216:217], v240 offset:16384
    v_exp_f32_e64 v232, v232
    v_mfma_f32_16x16x32_bf16 v[148:151], v[224:227], v[108:111], v[148:151]
    ds_read_b64_tr_b16 v[218:219], v240 offset:16896
    v_mfma_f32_16x16x32_bf16 v[156:159], v[228:231], v[108:111], v[156:159]
    ds_read_b64_tr_b16 v[220:221], v240 offset:20480
    v_exp_f32_e64 v233, v233
    v_mfma_f32_16x16x32_bf16 v[152:155], v[228:231], v[104:107], v[152:155]
    ds_read_b64_tr_b16 v[222:223], v240 offset:20992
    s_waitcnt lgkmcnt(4)
    v_mfma_f32_16x16x32_bf16 v[160:163], v[208:211], v[104:107], v[160:163]
    ds_read_b64_tr_b16 v[224:225], v241 offset:16384
    v_exp_f32 v234, v234
    v_mfma_f32_16x16x32_bf16 v[164:167], v[208:211], v[108:111], v[164:167]
    ds_read_b64_tr_b16 v[226:227], v241 offset:16896
    v_exp_f32_e64 v235, v235
    s_add_u32 m0, s64, 57344
    s_add_u32 s67, s66, 2064384
    buffer_load_dwordx4 v244, s[12:15], s67 offen lds
    v_mfma_f32_16x16x32_bf16 v[172:175], v[212:215], v[108:111], v[172:175]
    ds_read_b64_tr_b16 v[228:229], v241 offset:20480
    v_mfma_f32_16x16x32_bf16 v[168:171], v[212:215], v[104:107], v[168:171]
    ds_read_b64_tr_b16 v[230:231], v241 offset:20992
    v_mul_f32 v204, v204, v250
    s_waitcnt lgkmcnt(4)
    v_mfma_f32_16x16x32_bf16 v[144:147], v[216:219], v[112:115], v[144:147]
    ds_read_b64_tr_b16 v[208:209], v240 offset:24576
    v_mul_f32_e64 v205, v205, v250
    v_mfma_f32_16x16x32_bf16 v[148:151], v[216:219], v[116:119], v[148:151]
    ds_read_b64_tr_b16 v[210:211], v240 offset:25088
    v_mul_f32 v206, v206, v250
    v_mul_f32 v207, v207, v250
    v_mfma_f32_16x16x32_bf16 v[156:159], v[220:223], v[116:119], v[156:159]
    ds_read_b64_tr_b16 v[212:213], v240 offset:28672
    v_add_f32_e64 v232, 1.0, v232
    v_mfma_f32_16x16x32_bf16 v[152:155], v[220:223], v[112:115], v[152:155]
    ds_read_b64_tr_b16 v[214:215], v240 offset:29184
    v_add_f32 v233, 1.0, v233
    s_waitcnt lgkmcnt(4)
    v_mfma_f32_16x16x32_bf16 v[160:163], v[224:227], v[112:115], v[160:163]
    ds_read_b64_tr_b16 v[216:217], v241 offset:24576
    v_add_f32_e64 v234, 1.0, v234
    v_mfma_f32_16x16x32_bf16 v[164:167], v[224:227], v[116:119], v[164:167]
    ds_read_b64_tr_b16 v[218:219], v241 offset:25088
    v_add_f32_e64 v235, 1.0, v235
    s_add_u32 m0, s64, 65536
    s_add_u32 s67, s66, 2359296
    buffer_load_dwordx4 v244, s[12:15], s67 offen lds
    v_mfma_f32_16x16x32_bf16 v[172:175], v[228:231], v[116:119], v[172:175]
    ds_read_b64_tr_b16 v[220:221], v241 offset:28672
    v_rcp_f32_e64 v232, v232
    v_mfma_f32_16x16x32_bf16 v[168:171], v[228:231], v[112:115], v[168:171]
    ds_read_b64_tr_b16 v[222:223], v241 offset:29184
    s_waitcnt lgkmcnt(4)
    v_mfma_f32_16x16x32_bf16 v[144:147], v[208:211], v[120:123], v[144:147]
    ds_read_b64_tr_b16 v[224:225], v240 offset:32768
    v_rcp_f32 v233, v233
    v_mfma_f32_16x16x32_bf16 v[148:151], v[208:211], v[124:127], v[148:151]
    ds_read_b64_tr_b16 v[226:227], v240 offset:33280
    v_mfma_f32_16x16x32_bf16 v[156:159], v[212:215], v[124:127], v[156:159]
    ds_read_b64_tr_b16 v[228:229], v240 offset:36864
    v_rcp_f32_e64 v234, v234
    v_mfma_f32_16x16x32_bf16 v[152:155], v[212:215], v[120:123], v[152:155]
    ds_read_b64_tr_b16 v[230:231], v240 offset:37376
    s_waitcnt lgkmcnt(4)
    v_mfma_f32_16x16x32_bf16 v[160:163], v[216:219], v[120:123], v[160:163]
    ds_read_b64_tr_b16 v[208:209], v241 offset:32768
    v_rcp_f32 v235, v235
    v_mfma_f32_16x16x32_bf16 v[164:167], v[216:219], v[124:127], v[164:167]
    ds_read_b64_tr_b16 v[210:211], v241 offset:33280
    v_mul_f32_e64 v196, v196, v232
    s_add_u32 m0, s64, 73728
    s_add_u32 s67, s66, 2654208
    buffer_load_dwordx4 v244, s[12:15], s67 offen lds
    v_mfma_f32_16x16x32_bf16 v[172:175], v[220:223], v[124:127], v[172:175]
    ds_read_b64_tr_b16 v[212:213], v241 offset:36864
    v_mul_f32_e64 v197, v197, v233
    v_mfma_f32_16x16x32_bf16 v[168:171], v[220:223], v[120:123], v[168:171]
    ds_read_b64_tr_b16 v[214:215], v241 offset:37376
    v_mul_f32 v198, v198, v234
    s_waitcnt lgkmcnt(4)
    v_mfma_f32_16x16x32_bf16 v[144:147], v[224:227], v[128:131], v[144:147]
    ds_read_b64_tr_b16 v[216:217], v240 offset:40960
    v_mul_f32_e64 v199, v199, v235
    v_mfma_f32_16x16x32_bf16 v[148:151], v[224:227], v[132:135], v[148:151]
    ds_read_b64_tr_b16 v[218:219], v240 offset:41472
    v_mul_f32 v204, v204, v196
    v_mul_f32 v205, v205, v197
    v_mfma_f32_16x16x32_bf16 v[156:159], v[228:231], v[132:135], v[156:159]
    ds_read_b64_tr_b16 v[220:221], v240 offset:45056
    v_mul_f32_e64 v206, v206, v198
    v_mfma_f32_16x16x32_bf16 v[152:155], v[228:231], v[128:131], v[152:155]
    ds_read_b64_tr_b16 v[222:223], v240 offset:45568
    v_mul_f32 v207, v207, v199
    s_waitcnt lgkmcnt(4)
    v_mfma_f32_16x16x32_bf16 v[160:163], v[208:211], v[128:131], v[160:163]
    ds_read_b64_tr_b16 v[224:225], v241 offset:40960
    v_cvt_pk_bf16_f32 v180, v188, v189
    v_mfma_f32_16x16x32_bf16 v[164:167], v[208:211], v[132:135], v[164:167]
    ds_read_b64_tr_b16 v[226:227], v241 offset:41472
    v_cvt_pk_bf16_f32 v181, v190, v191
    s_add_u32 m0, s64, 81920
    s_add_u32 s67, s66, 2949120
    buffer_load_dwordx4 v244, s[12:15], s67 offen lds
    v_mfma_f32_16x16x32_bf16 v[172:175], v[212:215], v[132:135], v[172:175]
    ds_read_b64_tr_b16 v[228:229], v241 offset:45056
    v_cvt_pk_bf16_f32 v182, v204, v205
    v_mfma_f32_16x16x32_bf16 v[168:171], v[212:215], v[128:131], v[168:171]
    ds_read_b64_tr_b16 v[230:231], v241 offset:45568
    v_cvt_pk_bf16_f32 v183, v206, v207
    buffer_store_dwordx4 v[180:183], v246, s[24:27], s68 offen offset:1024 sc1
    s_waitcnt lgkmcnt(4)
    v_mfma_f32_16x16x32_bf16 v[144:147], v[216:219], v[136:139], v[144:147]
    v_subrev_u32 v240, 98304, v240
    v_subrev_u32 v241, 98304, v241
    ds_read_b64_tr_b16 v[208:209], v240 offset:0
    v_mfma_f32_16x16x32_bf16 v[148:151], v[216:219], v[140:143], v[148:151]
    ds_read_b64_tr_b16 v[210:211], v240 offset:512
    v_mfma_f32_16x16x32_bf16 v[156:159], v[220:223], v[140:143], v[156:159]
    ds_read_b64_tr_b16 v[212:213], v240 offset:4096
    v_mfma_f32_16x16x32_bf16 v[152:155], v[220:223], v[136:139], v[152:155]
    ds_read_b64_tr_b16 v[214:215], v240 offset:4608
    s_waitcnt lgkmcnt(4)
    v_mfma_f32_16x16x32_bf16 v[160:163], v[224:227], v[136:139], v[160:163]
    ds_read_b64_tr_b16 v[216:217], v241 offset:0
    v_mfma_f32_16x16x32_bf16 v[164:167], v[224:227], v[140:143], v[164:167]
    ds_read_b64_tr_b16 v[218:219], v241 offset:512
    s_add_u32 m0, s64, 90112
    s_add_u32 s67, s66, 3244032
    buffer_load_dwordx4 v244, s[12:15], s67 offen lds
    v_mfma_f32_16x16x32_bf16 v[172:175], v[228:231], v[140:143], v[172:175]
    ds_read_b64_tr_b16 v[220:221], v241 offset:4096
    v_mfma_f32_16x16x32_bf16 v[168:171], v[228:231], v[136:139], v[168:171]
    ds_read_b64_tr_b16 v[222:223], v241 offset:4608
    s_mov_b32 s70, 1
    s_branch LA_F1
LA_FL:
    s_mul_i32 s68, s6, 1179648
    s_lshl_b32 s87, s65, 7
    s_add_u32 s68, s68, s87
    s_mov_b32 s65, s66
    s_waitcnt vmcnt(5)
    s_barrier
    s_waitcnt lgkmcnt(4)
    v_mfma_f32_16x16x32_bf16 v[144:147], v[208:211], v[0:3], 0
    ds_read_b64_tr_b16 v[224:225], v240 offset:8192
    v_mul_f32_e64 v232, v176, v247
    s_mov_b32 s8, s44
    s_mov_b32 s9, s45
    s_mov_b32 s10, 5308416
    s_mov_b32 s11, 0x20000
    s_mul_i32 s73, s7, 1327104
    s_mul_i32 s38, s89, 384
    s_add_u32 s73, s73, s38
    v_mfma_f32_16x16x32_bf16 v[148:151], v[208:211], v[4:7], 0
    ds_read_b64_tr_b16 v[226:227], v240 offset:8704
    v_mul_f32 v233, v177, v247
    s_mul_i32 s66, s6, 144
    s_mul_i32 s38, s7, 36
    s_add_u32 s66, s66, s38
    s_lshl_b32 s66, s66, 13
    s_mul_i32 s72, s5, 12288
    s_lshl_b32 s38, s4, 10
    s_add_u32 s72, s72, s38
    v_mfma_f32_16x16x32_bf16 v[156:159], v[212:215], v[4:7], 0
    ds_read_b64_tr_b16 v[228:229], v240 offset:12288
    v_mul_f32_e64 v234, v178, v247
    s_and_b32 s38, s6, 3
    s_cmp_ge_u32 s38, 5
    s_cselect_b32 s74, 5, 0
    s_sub_u32 s74, s38, s74
    s_and_b32 s38, s6, 7
    s_mul_i32 s79, s38, 43
    s_lshr_b32 s79, s79, 7
    s_mul_i32 s79, s79, 3
    s_sub_u32 s79, s38, s79
    v_mfma_f32_16x16x32_bf16 v[152:155], v[212:215], v[0:3], 0
    ds_read_b64_tr_b16 v[230:231], v240 offset:12800
    v_mul_f32 v235, v179, v247
    s_add_u32 s75, s74, 1
    s_cmp_eq_u32 s75, 5
    s_cselect_b32 s75, 0, s75
    s_add_u32 s76, s75, 1
    s_cmp_eq_u32 s76, 5
    s_cselect_b32 s76, 0, s76
    s_waitcnt lgkmcnt(4)
    v_mfma_f32_16x16x32_bf16 v[160:163], v[216:219], v[0:3], 0
    ds_read_b64_tr_b16 v[208:209], v241 offset:8192
    v_exp_f32_e64 v232, v232
    s_add_u32 s77, s76, 1
    s_cmp_eq_u32 s77, 5
    s_cselect_b32 s77, 0, s77
    s_add_u32 s78, s77, 1
    s_cmp_eq_u32 s78, 5
    s_cselect_b32 s78, 0, s78
    v_mfma_f32_16x16x32_bf16 v[164:167], v[216:219], v[4:7], 0
    ds_read_b64_tr_b16 v[210:211], v241 offset:8704
    s_add_u32 s80, s79, 1
    s_cmp_eq_u32 s80, 3
    s_cselect_b32 s80, 0, s80
    s_add_u32 s81, s80, 1
    s_cmp_eq_u32 s81, 3
    s_cselect_b32 s81, 0, s81
    s_add_u32 m0, s64, 98304
    s_add_u32 s67, s65, 3538944
    buffer_load_dwordx4 v244, s[12:15], s67 offen lds
    v_mfma_f32_16x16x32_bf16 v[172:175], v[220:223], v[4:7], 0
    ds_read_b64_tr_b16 v[212:213], v241 offset:12288
    v_exp_f32_e64 v233, v233
    v_mfma_f32_16x16x32_bf16 v[168:171], v[220:223], v[0:3], 0
    ds_read_b64_tr_b16 v[214:215], v241 offset:12800
    v_bfe_u32 v236, v246, 7, 3
    s_waitcnt lgkmcnt(4)
    v_mfma_f32_16x16x32_bf16 v[144:147], v[224:227], v[8:11], v[144:147]
    ds_read_b64_tr_b16 v[216:217], v240 offset:16384
    v_exp_f32 v234, v234
    v_mfma_f32_16x16x32_bf16 v[148:151], v[224:227], v[12:15], v[148:151]
    ds_read_b64_tr_b16 v[218:219], v240 offset:16896
    v_exp_f32_e64 v235, v235
    v_lshl_add_u32 v236, s3, 3, v236
    v_mfma_f32_16x16x32_bf16 v[156:159], v[228:231], v[12:15], v[156:159]
    ds_read_b64_tr_b16 v[220:221], v240 offset:20480
    v_mfma_f32_16x16x32_bf16 v[152:155], v[228:231], v[8:11], v[152:155]
    ds_read_b64_tr_b16 v[222:223], v240 offset:20992
    v_mul_f32_e64 v184, v184, v249
    v_mul_u32_u24 v236, 1152, v236
    s_waitcnt lgkmcnt(4)
    v_mfma_f32_16x16x32_bf16 v[160:163], v[208:211], v[8:11], v[160:163]
    ds_read_b64_tr_b16 v[224:225], v241 offset:16384
    v_mul_f32 v185, v185, v249
    v_mul_f32_e64 v186, v186, v249
    v_mfma_f32_16x16x32_bf16 v[164:167], v[208:211], v[12:15], v[164:167]
    ds_read_b64_tr_b16 v[226:227], v241 offset:16896
    v_mul_f32_e64 v187, v187, v249
    v_bfe_u32 v237, v246, 8, 2
    s_add_u32 m0, s64, 106496
    s_add_u32 s67, s65, 3833856
    buffer_load_dwordx4 v244, s[12:15], s67 offen lds
    v_mfma_f32_16x16x32_bf16 v[172:175], v[212:215], v[12:15], v[172:175]
    ds_read_b64_tr_b16 v[228:229], v241 offset:20480
    v_add_f32_e64 v232, 1.0, v232
    v_mfma_f32_16x16x32_bf16 v[168:171], v[212:215], v[8:11], v[168:171]
    ds_read_b64_tr_b16 v[230:231], v241 offset:20992
    v_add_f32_e64 v233, 1.0, v233
    v_bfe_u32 v238, v246, 5, 2
    s_waitcnt lgkmcnt(4)
    v_mfma_f32_16x16x32_bf16 v[144:147], v[216:219], v[16:19], v[144:147]
    ds_read_b64_tr_b16 v[208:209], v240 offset:24576
    v_add_f32 v234, 1.0, v234
    v_mfma_f32_16x16x32_bf16 v[148:151], v[216:219], v[20:23], v[148:151]
    ds_read_b64_tr_b16 v[210:211], v240 offset:25088
    v_add_f32 v235, 1.0, v235
    v_xor_b32 v237, v237, v238
    v_mfma_f32_16x16x32_bf16 v[156:159], v[220:223], v[20:23], v[156:159]
    ds_read_b64_tr_b16 v[212:213], v240 offset:28672
    v_rcp_f32_e64 v232, v232
    v_mfma_f32_16x16x32_bf16 v[152:155], v[220:223], v[16:19], v[152:155]
    ds_read_b64_tr_b16 v[214:215], v240 offset:29184
    v_lshl_add_u32 v236, v237, 5, v236
    s_waitcnt lgkmcnt(4)
    v_mfma_f32_16x16x32_bf16 v[160:163], v[224:227], v[16:19], v[160:163]
    ds_read_b64_tr_b16 v[216:217], v241 offset:24576
    v_rcp_f32 v233, v233
    v_mfma_f32_16x16x32_bf16 v[164:167], v[224:227], v[20:23], v[164:167]
    ds_read_b64_tr_b16 v[218:219], v241 offset:25088
    v_bfe_u32 v237, v246, 4, 1
    s_add_u32 m0, s64, 114688
    s_add_u32 s67, s65, 4128768
    buffer_load_dwordx4 v244, s[12:15], s67 offen lds
    v_mfma_f32_16x16x32_bf16 v[172:175], v[228:231], v[20:23], v[172:175]
    ds_read_b64_tr_b16 v[220:221], v241 offset:28672
    v_rcp_f32_e64 v234, v234
    v_mfma_f32_16x16x32_bf16 v[168:171], v[228:231], v[16:19], v[168:171]
    ds_read_b64_tr_b16 v[222:223], v241 offset:29184
    v_lshl_add_u32 v254, v237, 4, v236
    s_waitcnt lgkmcnt(4)
    v_mfma_f32_16x16x32_bf16 v[144:147], v[208:211], v[24:27], v[144:147]
    ds_read_b64_tr_b16 v[224:225], v240 offset:32768
    v_rcp_f32 v235, v235
    v_mfma_f32_16x16x32_bf16 v[148:151], v[208:211], v[28:31], v[148:151]
    ds_read_b64_tr_b16 v[226:227], v240 offset:33280
    v_mul_f32_e64 v176, v176, v232
    v_mfma_f32_16x16x32_bf16 v[156:159], v[212:215], v[28:31], v[156:159]
    ds_read_b64_tr_b16 v[228:229], v240 offset:36864
    v_mul_f32_e64 v177, v177, v233
    v_mfma_f32_16x16x32_bf16 v[152:155], v[212:215], v[24:27], v[152:155]
    ds_read_b64_tr_b16 v[230:231], v240 offset:37376
    v_mul_f32 v178, v178, v234
    s_waitcnt lgkmcnt(4)
    v_mfma_f32_16x16x32_bf16 v[160:163], v[216:219], v[24:27], v[160:163]
    ds_read_b64_tr_b16 v[208:209], v241 offset:32768
    v_mul_f32 v179, v179, v235
    v_mul_f32 v184, v184, v176
    v_bfe_u32 v238, v246, 4, 2
    v_min_u32 v238, 2, v238
    v_lshlrev_b32_e64 v238, 7, v238
    s_lshl_b32 s38, s89, 7
    s_sub_u32 s71, s97, s38
    s_add_u32 s71, s71, 0
    s_cmp_eq_u32 s3, 0
    s_cselect_b32 s38, s71, 1073741824
    buffer_load_dword v237, v238, s[24:27], s38 offen sc1
    v_mfma_f32_16x16x32_bf16 v[164:167], v[216:219], v[28:31], v[164:167]
    ds_read_b64_tr_b16 v[210:211], v241 offset:33280
    v_mul_f32_e64 v185, v185, v177
    s_add_u32 m0, s64, 122880
    s_add_u32 s67, s65, 4423680
    buffer_load_dwordx4 v244, s[12:15], s67 offen lds
    v_mfma_f32_16x16x32_bf16 v[172:175], v[220:223], v[28:31], v[172:175]
    ds_read_b64_tr_b16 v[212:213], v241 offset:36864
    v_mul_f32_e64 v186, v186, v178
    v_mfma_f32_16x16x32_bf16 v[168:171], v[220:223], v[24:27], v[168:171]
    ds_read_b64_tr_b16 v[214:215], v241 offset:37376
    v_mul_f32 v187, v187, v179
    s_waitcnt lgkmcnt(4)
    v_mfma_f32_16x16x32_bf16 v[144:147], v[224:227], v[32:35], v[144:147]
    ds_read_b64_tr_b16 v[216:217], v240 offset:40960
    v_mul_f32_e64 v232, v192, v247
    v_mfma_f32_16x16x32_bf16 v[148:151], v[224:227], v[36:39], v[148:151]
    ds_read_b64_tr_b16 v[218:219], v240 offset:41472
    v_mul_f32_e64 v233, v193, v247
    v_mfma_f32_16x16x32_bf16 v[156:159], v[228:231], v[36:39], v[156:159]
    ds_read_b64_tr_b16 v[220:221], v240 offset:45056
    v_mul_f32_e64 v234, v194, v247
    v_mfma_f32_16x16x32_bf16 v[152:155], v[228:231], v[32:35], v[152:155]
    ds_read_b64_tr_b16 v[222:223], v240 offset:45568
    v_mul_f32 v235, v195, v247
    s_waitcnt lgkmcnt(4)
    v_mfma_f32_16x16x32_bf16 v[160:163], v[208:211], v[32:35], v[160:163]
    ds_read_b64_tr_b16 v[224:225], v241 offset:40960
    v_exp_f32_e64 v232, v232
    v_mfma_f32_16x16x32_bf16 v[164:167], v[208:211], v[36:39], v[164:167]
    ds_read_b64_tr_b16 v[226:227], v241 offset:41472
    s_add_u32 m0, s64, 131072
    s_add_u32 s67, s65, 4718592
    buffer_load_dwordx4 v244, s[12:15], s67 offen lds
    v_mfma_f32_16x16x32_bf16 v[172:175], v[212:215], v[36:39], v[172:175]
    ds_read_b64_tr_b16 v[228:229], v241 offset:45056
    v_exp_f32_e64 v233, v233
    v_mfma_f32_16x16x32_bf16 v[168:171], v[212:215], v[32:35], v[168:171]
    ds_read_b64_tr_b16 v[230:231], v241 offset:45568
    s_waitcnt lgkmcnt(4)
    v_mfma_f32_16x16x32_bf16 v[144:147], v[216:219], v[40:43], v[144:147]
    v_add_u32 v240, 49152, v240
    v_add_u32 v241, 49152, v241
    ds_read_b64_tr_b16 v[208:209], v240 offset:0
    v_exp_f32 v234, v234
    v_mfma_f32_16x16x32_bf16 v[148:151], v[216:219], v[44:47], v[148:151]
    ds_read_b64_tr_b16 v[210:211], v240 offset:512
    v_exp_f32_e64 v235, v235
    v_mfma_f32_16x16x32_bf16 v[156:159], v[220:223], v[44:47], v[156:159]
    ds_read_b64_tr_b16 v[212:213], v240 offset:4096
    v_mfma_f32_16x16x32_bf16 v[152:155], v[220:223], v[40:43], v[152:155]
    ds_read_b64_tr_b16 v[214:215], v240 offset:4608
    v_mul_f32 v200, v200, v249
    s_waitcnt lgkmcnt(4)
    v_mfma_f32_16x16x32_bf16 v[160:163], v[224:227], v[40:43], v[160:163]
    ds_read_b64_tr_b16 v[216:217], v241 offset:0
    v_mul_f32_e64 v201, v201, v249
    v_mfma_f32_16x16x32_bf16 v[164:167], v[224:227], v[44:47], v[164:167]
    ds_read_b64_tr_b16 v[218:219], v241 offset:512
    v_mul_f32 v202, v202, v249
    v_mul_f32 v203, v203, v249
    s_add_u32 m0, s64, 139264
    s_add_u32 s67, s65, 5013504
    buffer_load_dwordx4 v244, s[12:15], s67 offen lds
    v_mfma_f32_16x16x32_bf16 v[172:175], v[228:231], v[44:47], v[172:175]
    ds_read_b64_tr_b16 v[220:221], v241 offset:4096
    v_add_f32_e64 v232, 1.0, v232
    v_mfma_f32_16x16x32_bf16 v[168:171], v[228:231], v[40:43], v[168:171]
    ds_read_b64_tr_b16 v[222:223], v241 offset:4608
    v_add_f32 v233, 1.0, v233
    s_waitcnt vmcnt(6)
    s_waitcnt vmcnt(3)
    s_cmp_lg_u32 s3, 0
    s_cbranch_scc1 L_fc2
    s_mov_b32 s93, 0
L_fl2:
    v_cmp_ne_u32 vcc, s96, v237
    s_cbranch_vccz L_fc2
    s_add_u32 s93, s93, 1
    s_cmp_gt_u32 s93, 60000
    s_cbranch_scc1 L_fc2
    s_sleep 4
    buffer_load_dword v237, v238, s[24:27], s71 offen sc1
    s_waitcnt vmcnt(0)
    s_branch L_fl2
L_fc2:
    s_barrier
    s_waitcnt lgkmcnt(4)
    v_mfma_f32_16x16x32_bf16 v[144:147], v[208:211], v[48:51], v[144:147]
    ds_read_b64_tr_b16 v[224:225], v240 offset:8192
    v_add_f32 v234, 1.0, v234
    v_mfma_f32_16x16x32_bf16 v[148:151], v[208:211], v[52:55], v[148:151]
    ds_read_b64_tr_b16 v[226:227], v240 offset:8704
    v_add_f32_e64 v235, 1.0, v235
    v_mfma_f32_16x16x32_bf16 v[156:159], v[212:215], v[52:55], v[156:159]
    ds_read_b64_tr_b16 v[228:229], v240 offset:12288
    v_rcp_f32_e64 v232, v232
    v_mfma_f32_16x16x32_bf16 v[152:155], v[212:215], v[48:51], v[152:155]
    ds_read_b64_tr_b16 v[230:231], v240 offset:12800
    s_waitcnt lgkmcnt(4)
    v_mfma_f32_16x16x32_bf16 v[160:163], v[216:219], v[48:51], v[160:163]
    ds_read_b64_tr_b16 v[208:209], v241 offset:8192
    v_rcp_f32 v233, v233
    v_mfma_f32_16x16x32_bf16 v[164:167], v[216:219], v[52:55], v[164:167]
    ds_read_b64_tr_b16 v[210:211], v241 offset:8704
    s_cmp_lg_u32 s3, 0
    s_cbranch_scc1 L_fs3
    s_add_u32 s38, s97, 98304
    v_mov_b32 v239, s96
    s_mov_b64 exec, 1
    buffer_store_dword v239, off, s[24:27], s38 sc1
    s_mov_b64 exec, -1
L_fs3:
    v_mfma_f32_16x16x32_bf16 v[172:175], v[220:223], v[52:55], v[172:175]
    ds_read_b64_tr_b16 v[212:213], v241 offset:12288
    v_rcp_f32 v234, v234
    v_mfma_f32_16x16x32_bf16 v[168:171], v[220:223], v[48:51], v[168:171]
    ds_read_b64_tr_b16 v[214:215], v241 offset:12800
    s_waitcnt lgkmcnt(4)
    v_mfma_f32_16x16x32_bf16 v[144:147], v[224:227], v[56:59], v[144:147]
    ds_read_b64_tr_b16 v[216:217], v240 offset:16384
    v_rcp_f32 v235, v235
    v_mfma_f32_16x16x32_bf16 v[148:151], v[224:227], v[60:63], v[148:151]
    ds_read_b64_tr_b16 v[218:219], v240 offset:16896
    v_mul_f32_e64 v192, v192, v232
    v_mfma_f32_16x16x32_bf16 v[156:159], v[228:231], v[60:63], v[156:159]
    ds_read_b64_tr_b16 v[220:221], v240 offset:20480
    v_mul_f32_e64 v193, v193, v233
    v_mfma_f32_16x16x32_bf16 v[152:155], v[228:231], v[56:59], v[152:155]
    ds_read_b64_tr_b16 v[222:223], v240 offset:20992
    v_mul_f32 v194, v194, v234
    s_waitcnt lgkmcnt(4)
    v_mfma_f32_16x16x32_bf16 v[160:163], v[208:211], v[56:59], v[160:163]
    ds_read_b64_tr_b16 v[224:225], v241 offset:16384
    v_mul_f32_e64 v195, v195, v235
    v_mfma_f32_16x16x32_bf16 v[164:167], v[208:211], v[60:63], v[164:167]
    ds_read_b64_tr_b16 v[226:227], v241 offset:16896
    v_mul_f32 v200, v200, v192
    v_mul_f32 v201, v201, v193
    s_mul_i32 s67, s74, 73728
    s_add_u32 s67, s67, s73
    s_add_u32 m0, s72, 0
    s_add_u32 s67, s67, 0
    buffer_load_dwordx4 v254, s[8:11], s67 offen offset:0 lds
    s_mul_i32 s67, s74, 73728
    s_add_u32 s67, s67, s73
    s_add_u32 m0, s72, 3968
    s_add_u32 s67, s67, 0
    buffer_load_dwordx4 v254, s[8:11], s67 offen offset:128 lds
    v_mfma_f32_16x16x32_bf16 v[172:175], v[212:215], v[60:63], v[172:175]
    ds_read_b64_tr_b16 v[228:229], v241 offset:20480
    v_mul_f32 v202, v202, v194
    v_mfma_f32_16x16x32_bf16 v[168:171], v[212:215], v[56:59], v[168:171]
    ds_read_b64_tr_b16 v[230:231], v241 offset:20992
    v_mul_f32 v203, v203, v195
    s_waitcnt lgkmcnt(4)
    v_mfma_f32_16x16x32_bf16 v[144:147], v[216:219], v[64:67], v[144:147]
    ds_read_b64_tr_b16 v[208:209], v240 offset:24576
    v_cvt_pk_bf16_f32 v176, v184, v185
    v_mfma_f32_16x16x32_bf16 v[148:151], v[216:219], v[68:71], v[148:151]
    ds_read_b64_tr_b16 v[210:211], v240 offset:25088
    v_cvt_pk_bf16_f32 v177, v186, v187
    v_mfma_f32_16x16x32_bf16 v[156:159], v[220:223], v[68:71], v[156:159]
    ds_read_b64_tr_b16 v[212:213], v240 offset:28672
    v_cvt_pk_bf16_f32 v178, v200, v201
    v_mfma_f32_16x16x32_bf16 v[152:155], v[220:223], v[64:67], v[152:155]
    ds_read_b64_tr_b16 v[214:215], v240 offset:29184
    v_cvt_pk_bf16_f32 v179, v202, v203
    buffer_store_dwordx4 v[176:179], v246, s[24:27], s68 offen offset:0 sc1
    s_waitcnt lgkmcnt(4)
    v_mfma_f32_16x16x32_bf16 v[160:163], v[224:227], v[64:67], v[160:163]
    ds_read_b64_tr_b16 v[216:217], v241 offset:24576
    v_mul_f32 v232, v180, v248
    v_mfma_f32_16x16x32_bf16 v[164:167], v[224:227], v[68:71], v[164:167]
    ds_read_b64_tr_b16 v[218:219], v241 offset:25088
    v_mul_f32_e64 v233, v181, v248
    s_mul_i32 s67, s74, 73728
    s_add_u32 s67, s67, s73
    s_add_u32 m0, s72, 7936
    s_add_u32 s67, s67, 0
    buffer_load_dwordx4 v254, s[8:11], s67 offen offset:256 lds
    s_lshl_b32 s87, s74, 14
    s_add_u32 s87, s87, s66
    s_add_u32 s87, s87, 0
    buffer_load_dwordx4 v[0:3], v246, s[24:27], s87 offen sc1
    buffer_load_dwordx4 v[4:7], v246, s[24:27], s87 offen offset:1024 sc1
    v_mfma_f32_16x16x32_bf16 v[172:175], v[228:231], v[68:71], v[172:175]
    ds_read_b64_tr_b16 v[220:221], v241 offset:28672
    v_mul_f32 v234, v182, v248
    v_mfma_f32_16x16x32_bf16 v[168:171], v[228:231], v[64:67], v[168:171]
    ds_read_b64_tr_b16 v[222:223], v241 offset:29184
    v_mul_f32 v235, v183, v248
    s_waitcnt lgkmcnt(4)
    v_mfma_f32_16x16x32_bf16 v[144:147], v[208:211], v[72:75], v[144:147]
    ds_read_b64_tr_b16 v[224:225], v240 offset:32768
    v_exp_f32_e64 v232, v232
    v_mfma_f32_16x16x32_bf16 v[148:151], v[208:211], v[76:79], v[148:151]
    ds_read_b64_tr_b16 v[226:227], v240 offset:33280
    v_mfma_f32_16x16x32_bf16 v[156:159], v[212:215], v[76:79], v[156:159]
    ds_read_b64_tr_b16 v[228:229], v240 offset:36864
    v_exp_f32_e64 v233, v233
    v_mfma_f32_16x16x32_bf16 v[152:155], v[212:215], v[72:75], v[152:155]
    ds_read_b64_tr_b16 v[230:231], v240 offset:37376
    s_waitcnt lgkmcnt(4)
    v_mfma_f32_16x16x32_bf16 v[160:163], v[216:219], v[72:75], v[160:163]
    ds_read_b64_tr_b16 v[208:209], v241 offset:32768
    v_exp_f32 v234, v234
    v_mfma_f32_16x16x32_bf16 v[164:167], v[216:219], v[76:79], v[164:167]
    ds_read_b64_tr_b16 v[210:211], v241 offset:33280
    v_exp_f32_e64 v235, v235
    s_mul_i32 s67, s74, 73728
    s_add_u32 s67, s67, s73
    s_add_u32 m0, s72, 24576
    s_add_u32 s67, s67, 368640
    buffer_load_dwordx4 v254, s[8:11], s67 offen offset:0 lds
    s_mul_i32 s67, s74, 73728
    s_add_u32 s67, s67, s73
    s_add_u32 m0, s72, 28544
    s_add_u32 s67, s67, 368640
    buffer_load_dwordx4 v254, s[8:11], s67 offen offset:128 lds
    v_mfma_f32_16x16x32_bf16 v[172:175], v[220:223], v[76:79], v[172:175]
    ds_read_b64_tr_b16 v[212:213], v241 offset:36864
    v_mfma_f32_16x16x32_bf16 v[168:171], v[220:223], v[72:75], v[168:171]
    ds_read_b64_tr_b16 v[214:215], v241 offset:37376
    v_mul_f32 v188, v188, v250
    s_waitcnt lgkmcnt(4)
    v_mfma_f32_16x16x32_bf16 v[144:147], v[224:227], v[80:83], v[144:147]
    ds_read_b64_tr_b16 v[216:217], v240 offset:40960
    v_mul_f32 v189, v189, v250
    v_mul_f32 v190, v190, v250
    v_mfma_f32_16x16x32_bf16 v[148:151], v[224:227], v[84:87], v[148:151]
    ds_read_b64_tr_b16 v[218:219], v240 offset:41472
    v_mul_f32_e64 v191, v191, v250
    v_mfma_f32_16x16x32_bf16 v[156:159], v[228:231], v[84:87], v[156:159]
    ds_read_b64_tr_b16 v[220:221], v240 offset:45056
    v_add_f32_e64 v232, 1.0, v232
    v_mfma_f32_16x16x32_bf16 v[152:155], v[228:231], v[80:83], v[152:155]
    ds_read_b64_tr_b16 v[222:223], v240 offset:45568
    v_add_f32 v233, 1.0, v233
    s_waitcnt lgkmcnt(4)
    v_mfma_f32_16x16x32_bf16 v[160:163], v[208:211], v[80:83], v[160:163]
    ds_read_b64_tr_b16 v[224:225], v241 offset:40960
    v_add_f32_e64 v234, 1.0, v234
    v_mfma_f32_16x16x32_bf16 v[164:167], v[208:211], v[84:87], v[164:167]
    ds_read_b64_tr_b16 v[226:227], v241 offset:41472
    v_add_f32_e64 v235, 1.0, v235
    s_mul_i32 s67, s74, 73728
    s_add_u32 s67, s67, s73
    s_add_u32 m0, s72, 32512
    s_add_u32 s67, s67, 368640
    buffer_load_dwordx4 v254, s[8:11], s67 offen offset:256 lds
    s_lshl_b32 s87, s74, 14
    s_add_u32 s87, s87, s66
    s_add_u32 s87, s87, 81920
    buffer_load_dwordx4 v[8:11], v246, s[24:27], s87 offen sc1
    buffer_load_dwordx4 v[12:15], v246, s[24:27], s87 offen offset:1024 sc1
    v_mfma_f32_16x16x32_bf16 v[172:175], v[212:215], v[84:87], v[172:175]
    ds_read_b64_tr_b16 v[228:229], v241 offset:45056
    v_rcp_f32 v232, v232
    v_mfma_f32_16x16x32_bf16 v[168:171], v[212:215], v[80:83], v[168:171]
    ds_read_b64_tr_b16 v[230:231], v241 offset:45568
    s_waitcnt lgkmcnt(4)
    v_mfma_f32_16x16x32_bf16 v[144:147], v[216:219], v[88:91], v[144:147]
    v_add_u32 v240, 49152, v240
    v_add_u32 v241, 49152, v241
    ds_read_b64_tr_b16 v[208:209], v240 offset:0
    v_rcp_f32 v233, v233
    v_mfma_f32_16x16x32_bf16 v[148:151], v[216:219], v[92:95], v[148:151]
    ds_read_b64_tr_b16 v[210:211], v240 offset:512
    v_mfma_f32_16x16x32_bf16 v[156:159], v[220:223], v[92:95], v[156:159]
    ds_read_b64_tr_b16 v[212:213], v240 offset:4096
    v_rcp_f32_e64 v234, v234
    v_mfma_f32_16x16x32_bf16 v[152:155], v[220:223], v[88:91], v[152:155]
    ds_read_b64_tr_b16 v[214:215], v240 offset:4608
    s_waitcnt lgkmcnt(4)
    v_mfma_f32_16x16x32_bf16 v[160:163], v[224:227], v[88:91], v[160:163]
    ds_read_b64_tr_b16 v[216:217], v241 offset:0
    v_rcp_f32 v235, v235
    v_mfma_f32_16x16x32_bf16 v[164:167], v[224:227], v[92:95], v[164:167]
    ds_read_b64_tr_b16 v[218:219], v241 offset:512
    v_mul_f32_e64 v180, v180, v232
    v_mfma_f32_16x16x32_bf16 v[172:175], v[228:231], v[92:95], v[172:175]
    ds_read_b64_tr_b16 v[220:221], v241 offset:4096
    v_mul_f32_e64 v181, v181, v233
    v_mfma_f32_16x16x32_bf16 v[168:171], v[228:231], v[88:91], v[168:171]
    ds_read_b64_tr_b16 v[222:223], v241 offset:4608
    v_mul_f32 v182, v182, v234
    s_waitcnt vmcnt(10)
    s_barrier
    s_waitcnt lgkmcnt(4)
    v_mfma_f32_16x16x32_bf16 v[144:147], v[208:211], v[96:99], v[144:147]
    ds_read_b64_tr_b16 v[224:225], v240 offset:8192
    v_mul_f32 v183, v183, v235
    v_mul_f32 v188, v188, v180
    v_mfma_f32_16x16x32_bf16 v[148:151], v[208:211], v[100:103], v[148:151]
    ds_read_b64_tr_b16 v[226:227], v240 offset:8704
    v_mul_f32_e64 v189, v189, v181
    v_mfma_f32_16x16x32_bf16 v[156:159], v[212:215], v[100:103], v[156:159]
    ds_read_b64_tr_b16 v[228:229], v240 offset:12288
    v_mul_f32_e64 v190, v190, v182
    v_mfma_f32_16x16x32_bf16 v[152:155], v[212:215], v[96:99], v[152:155]
    ds_read_b64_tr_b16 v[230:231], v240 offset:12800
    v_mul_f32 v191, v191, v183
    s_waitcnt lgkmcnt(4)
    v_mfma_f32_16x16x32_bf16 v[160:163], v[216:219], v[96:99], v[160:163]
    ds_read_b64_tr_b16 v[208:209], v241 offset:8192
    v_mul_f32_e64 v232, v196, v248
    v_mfma_f32_16x16x32_bf16 v[164:167], v[216:219], v[100:103], v[164:167]
    ds_read_b64_tr_b16 v[210:211], v241 offset:8704
    v_mul_f32_e64 v233, v197, v248
    s_mul_i32 s67, s74, 73728
    s_add_u32 s67, s67, s73
    s_add_u32 m0, s72, 49152
    s_add_u32 s67, s67, 737280
    buffer_load_dwordx4 v254, s[8:11], s67 offen offset:0 lds
    s_mul_i32 s67, s74, 73728
    s_add_u32 s67, s67, s73
    s_add_u32 m0, s72, 53120
    s_add_u32 s67, s67, 737280
    buffer_load_dwordx4 v254, s[8:11], s67 offen offset:128 lds
    v_mfma_f32_16x16x32_bf16 v[172:175], v[220:223], v[100:103], v[172:175]
    ds_read_b64_tr_b16 v[212:213], v241 offset:12288
    v_mul_f32_e64 v234, v198, v248
    v_mfma_f32_16x16x32_bf16 v[168:171], v[220:223], v[96:99], v[168:171]
    ds_read_b64_tr_b16 v[214:215], v241 offset:12800
    v_mul_f32 v235, v199, v248
    s_waitcnt lgkmcnt(4)
    v_mfma_f32_16x16x32_bf16 v[144:147], v[224:227], v[104:107], v[144:147]
    ds_read_b64_tr_b16 v[216:217], v240 offset:16384
    v_exp_f32_e64 v232, v232
    v_mfma_f32_16x16x32_bf16 v[148:151], v[224:227], v[108:111], v[148:151]
    ds_read_b64_tr_b16 v[218:219], v240 offset:16896
    v_mfma_f32_16x16x32_bf16 v[156:159], v[228:231], v[108:111], v[156:159]
    ds_read_b64_tr_b16 v[220:221], v240 offset:20480
    v_exp_f32_e64 v233, v233
    v_mfma_f32_16x16x32_bf16 v[152:155], v[228:231], v[104:107], v[152:155]
    ds_read_b64_tr_b16 v[222:223], v240 offset:20992
    s_waitcnt lgkmcnt(4)
    v_mfma_f32_16x16x32_bf16 v[160:163], v[208:211], v[104:107], v[160:163]
    ds_read_b64_tr_b16 v[224:225], v241 offset:16384
    v_exp_f32 v234, v234
    v_mfma_f32_16x16x32_bf16 v[164:167], v[208:211], v[108:111], v[164:167]
    ds_read_b64_tr_b16 v[226:227], v241 offset:16896
    v_exp_f32_e64 v235, v235
    s_mul_i32 s67, s74, 73728
    s_add_u32 s67, s67, s73
    s_add_u32 m0, s72, 57088
    s_add_u32 s67, s67, 737280
    buffer_load_dwordx4 v254, s[8:11], s67 offen offset:256 lds
    s_mul_i32 s67, s75, 73728
    s_add_u32 s67, s67, s73
    s_add_u32 m0, s72, 73728
    s_add_u32 s67, s67, 0
    buffer_load_dwordx4 v254, s[8:11], s67 offen offset:0 lds
    v_mfma_f32_16x16x32_bf16 v[172:175], v[212:215], v[108:111], v[172:175]
    ds_read_b64_tr_b16 v[228:229], v241 offset:20480
    v_mfma_f32_16x16x32_bf16 v[168:171], v[212:215], v[104:107], v[168:171]
    ds_read_b64_tr_b16 v[230:231], v241 offset:20992
    v_mul_f32_e64 v204, v204, v250
    s_waitcnt lgkmcnt(4)
    v_mfma_f32_16x16x32_bf16 v[144:147], v[216:219], v[112:115], v[144:147]
    ds_read_b64_tr_b16 v[208:209], v240 offset:24576
    v_mul_f32_e64 v205, v205, v250
    v_mfma_f32_16x16x32_bf16 v[148:151], v[216:219], v[116:119], v[148:151]
    ds_read_b64_tr_b16 v[210:211], v240 offset:25088
    v_mul_f32 v206, v206, v250
    v_mul_f32 v207, v207, v250
    v_mfma_f32_16x16x32_bf16 v[156:159], v[220:223], v[116:119], v[156:159]
    ds_read_b64_tr_b16 v[212:213], v240 offset:28672
    v_add_f32_e64 v232, 1.0, v232
    v_mfma_f32_16x16x32_bf16 v[152:155], v[220:223], v[112:115], v[152:155]
    ds_read_b64_tr_b16 v[214:215], v240 offset:29184
    v_add_f32 v233, 1.0, v233
    s_waitcnt lgkmcnt(4)
    v_mfma_f32_16x16x32_bf16 v[160:163], v[224:227], v[112:115], v[160:163]
    ds_read_b64_tr_b16 v[216:217], v241 offset:24576
    v_add_f32_e64 v234, 1.0, v234
    v_mfma_f32_16x16x32_bf16 v[164:167], v[224:227], v[116:119], v[164:167]
    ds_read_b64_tr_b16 v[218:219], v241 offset:25088
    v_add_f32_e64 v235, 1.0, v235
    s_mul_i32 s67, s75, 73728
    s_add_u32 s67, s67, s73
    s_add_u32 m0, s72, 77696
    s_add_u32 s67, s67, 0
    buffer_load_dwordx4 v254, s[8:11], s67 offen offset:128 lds
    s_mul_i32 s67, s75, 73728
    s_add_u32 s67, s67, s73
    s_add_u32 m0, s72, 81664
    s_add_u32 s67, s67, 0
    buffer_load_dwordx4 v254, s[8:11], s67 offen offset:256 lds
    v_mfma_f32_16x16x32_bf16 v[172:175], v[228:231], v[116:119], v[172:175]
    ds_read_b64_tr_b16 v[220:221], v241 offset:28672
    v_rcp_f32_e64 v232, v232
    v_mfma_f32_16x16x32_bf16 v[168:171], v[228:231], v[112:115], v[168:171]
    ds_read_b64_tr_b16 v[222:223], v241 offset:29184
    s_waitcnt lgkmcnt(4)
    v_mfma_f32_16x16x32_bf16 v[144:147], v[208:211], v[120:123], v[144:147]
    ds_read_b64_tr_b16 v[224:225], v240 offset:32768
    v_rcp_f32 v233, v233
    v_mfma_f32_16x16x32_bf16 v[148:151], v[208:211], v[124:127], v[148:151]
    ds_read_b64_tr_b16 v[226:227], v240 offset:33280
    v_mfma_f32_16x16x32_bf16 v[156:159], v[212:215], v[124:127], v[156:159]
    ds_read_b64_tr_b16 v[228:229], v240 offset:36864
    v_rcp_f32_e64 v234, v234
    v_mfma_f32_16x16x32_bf16 v[152:155], v[212:215], v[120:123], v[152:155]
    ds_read_b64_tr_b16 v[230:231], v240 offset:37376
    s_waitcnt lgkmcnt(4)
    v_mfma_f32_16x16x32_bf16 v[160:163], v[216:219], v[120:123], v[160:163]
    ds_read_b64_tr_b16 v[208:209], v241 offset:32768
    v_rcp_f32 v235, v235
    v_mfma_f32_16x16x32_bf16 v[164:167], v[216:219], v[124:127], v[164:167]
    ds_read_b64_tr_b16 v[210:211], v241 offset:33280
    v_mul_f32_e64 v196, v196, v232
    v_mfma_f32_16x16x32_bf16 v[172:175], v[220:223], v[124:127], v[172:175]
    ds_read_b64_tr_b16 v[212:213], v241 offset:36864
    v_mul_f32_e64 v197, v197, v233
    v_mfma_f32_16x16x32_bf16 v[168:171], v[220:223], v[120:123], v[168:171]
    ds_read_b64_tr_b16 v[214:215], v241 offset:37376
    v_mul_f32 v198, v198, v234
    s_waitcnt lgkmcnt(4)
    v_mfma_f32_16x16x32_bf16 v[144:147], v[224:227], v[128:131], v[144:147]
    ds_read_b64_tr_b16 v[216:217], v240 offset:40960
    v_mul_f32_e64 v199, v199, v235
    v_mfma_f32_16x16x32_bf16 v[148:151], v[224:227], v[132:135], v[148:151]
    ds_read_b64_tr_b16 v[218:219], v240 offset:41472
    v_mul_f32 v204, v204, v196
    v_mul_f32 v205, v205, v197
    v_mfma_f32_16x16x32_bf16 v[156:159], v[228:231], v[132:135], v[156:159]
    ds_read_b64_tr_b16 v[220:221], v240 offset:45056
    v_mul_f32_e64 v206, v206, v198
    v_mfma_f32_16x16x32_bf16 v[152:155], v[228:231], v[128:131], v[152:155]
    ds_read_b64_tr_b16 v[222:223], v240 offset:45568
    v_mul_f32 v207, v207, v199
    s_waitcnt lgkmcnt(4)
    v_mfma_f32_16x16x32_bf16 v[160:163], v[208:211], v[128:131], v[160:163]
    ds_read_b64_tr_b16 v[224:225], v241 offset:40960
    v_cvt_pk_bf16_f32 v180, v188, v189
    v_bfe_u32 v238, v246, 4, 2
    v_min_u32 v238, 2, v238
    v_lshlrev_b32 v238, 7, v238
    s_lshl_b32 s38, s89, 7
    s_sub_u32 s71, s97, s38
    s_add_u32 s71, s71, 98304
    s_cmp_eq_u32 s3, 0
    s_cselect_b32 s38, s71, 1073741824
    buffer_load_dword v237, v238, s[24:27], s38 offen sc1
    v_mfma_f32_16x16x32_bf16 v[164:167], v[208:211], v[132:135], v[164:167]
    ds_read_b64_tr_b16 v[226:227], v241 offset:41472
    v_cvt_pk_bf16_f32 v181, v190, v191
    v_mfma_f32_16x16x32_bf16 v[172:175], v[212:215], v[132:135], v[172:175]
    ds_read_b64_tr_b16 v[228:229], v241 offset:45056
    v_cvt_pk_bf16_f32 v182, v204, v205
    v_mfma_f32_16x16x32_bf16 v[168:171], v[212:215], v[128:131], v[168:171]
    ds_read_b64_tr_b16 v[230:231], v241 offset:45568
    v_cvt_pk_bf16_f32 v183, v206, v207
    buffer_store_dwordx4 v[180:183], v246, s[24:27], s68 offen offset:1024 sc1
    s_waitcnt lgkmcnt(4)
    v_mfma_f32_16x16x32_bf16 v[144:147], v[216:219], v[136:139], v[144:147]
    v_mfma_f32_16x16x32_bf16 v[148:151], v[216:219], v[140:143], v[148:151]
    v_mfma_f32_16x16x32_bf16 v[156:159], v[220:223], v[140:143], v[156:159]
    v_mfma_f32_16x16x32_bf16 v[152:155], v[220:223], v[136:139], v[152:155]
    s_waitcnt lgkmcnt(0)
    v_mfma_f32_16x16x32_bf16 v[160:163], v[224:227], v[136:139], v[160:163]
    v_mfma_f32_16x16x32_bf16 v[164:167], v[224:227], v[140:143], v[164:167]
    v_mfma_f32_16x16x32_bf16 v[172:175], v[228:231], v[140:143], v[172:175]
    v_mfma_f32_16x16x32_bf16 v[168:171], v[228:231], v[136:139], v[168:171]
    v_subrev_u32 v240, 98304, v240
    v_subrev_u32 v241, 98304, v241
    s_mul_i32 s68, s6, 1179648
    s_lshl_b32 s87, s65, 7
    s_add_u32 s68, s68, s87
    s_waitcnt vmcnt(0)
    s_cmp_lg_u32 s3, 0
    s_cbranch_scc1 L_fc4
    s_mov_b32 s93, 0
L_fl4:
    v_cmp_ne_u32 vcc, s96, v237
    s_cbranch_vccz L_fc4
    s_add_u32 s93, s93, 1
    s_cmp_gt_u32 s93, 60000
    s_cbranch_scc1 L_fc4
    s_sleep 4
    buffer_load_dword v237, v238, s[24:27], s71 offen sc1
    s_waitcnt vmcnt(0)
    s_branch L_fl4
L_fc4:
    s_barrier
    v_bfe_u32 v125, v246, 4, 6
    v_lshrrev_b32_e64 v130, 4, v125
    v_bfe_u32 v131, v125, 2, 2
    v_lshl_add_u32 v129, v130, 2, v131
    v_lshlrev_b32 v129, 7, v129
    v_and_b32 v132, 3, v125
    v_lshl_add_u32 v129, v132, 3, v129
    s_mul_i32 s67, s5, 12288
    v_add_u32 v129, s67, v129
    v_lshrrev_b32 v131, 1, v131
    v_and_b32_e64 v132, 1, v130
    v_lshl_or_b32 v131, v132, 1, v131
    v_lshl_add_u32 v112, v131, 5, v129
    v_xor_b32 v113, 32, v112
    v_xor_b32 v114, 64, v112
    v_xor_b32 v115, 96, v112
    v_add_u32 v116, 49152, v112
    v_add_u32 v117, 49152, v113
    v_add_u32 v118, 49152, v114
    v_add_u32 v119, 49152, v115
    v_add_u32 v120, 98304, v112
    v_add_u32 v121, 98304, v113
    v_add_u32 v122, 98304, v114
    v_add_u32 v123, 98304, v115
    v_mul_f32 v232, v144, v247
    v_mul_f32 v233, v145, v247
    v_mul_f32 v234, v146, v247
    v_mul_f32 v235, v147, v247
    v_exp_f32 v232, v232
    v_exp_f32 v233, v233
    v_exp_f32 v234, v234
    v_exp_f32 v235, v235
    v_mul_f32 v152, v152, v249
    v_mul_f32 v153, v153, v249
    v_mul_f32 v154, v154, v249
    v_mul_f32 v155, v155, v249
    v_add_f32 v232, 1.0, v232
    v_add_f32 v233, 1.0, v233
    v_add_f32 v234, 1.0, v234
    v_add_f32 v235, 1.0, v235
    v_rcp_f32 v232, v232
    v_rcp_f32 v233, v233
    v_rcp_f32 v234, v234
    v_rcp_f32 v235, v235
    v_mul_f32 v144, v144, v232
    v_mul_f32 v145, v145, v233
    v_mul_f32 v146, v146, v234
    v_mul_f32 v147, v147, v235
    v_mul_f32 v152, v152, v144
    v_mul_f32 v153, v153, v145
    v_mul_f32 v154, v154, v146
    v_mul_f32 v155, v155, v147
    v_mul_f32 v232, v160, v247
    v_mul_f32 v233, v161, v247
    v_mul_f32 v234, v162, v247
    v_mul_f32 v235, v163, v247
    v_exp_f32 v232, v232
    v_exp_f32 v233, v233
    v_exp_f32 v234, v234
    v_exp_f32 v235, v235
    v_mul_f32 v168, v168, v249
    v_mul_f32 v169, v169, v249
    v_mul_f32 v170, v170, v249
    v_mul_f32 v171, v171, v249
    v_add_f32 v232, 1.0, v232
    v_add_f32 v233, 1.0, v233
    v_add_f32 v234, 1.0, v234
    v_add_f32 v235, 1.0, v235
    v_rcp_f32 v232, v232
    v_rcp_f32 v233, v233
    v_rcp_f32 v234, v234
    v_rcp_f32 v235, v235
    v_mul_f32 v160, v160, v232
    v_mul_f32 v161, v161, v233
    v_mul_f32 v162, v162, v234
    v_mul_f32 v163, v163, v235
    v_mul_f32 v168, v168, v160
    v_mul_f32 v169, v169, v161
    v_mul_f32 v170, v170, v162
    v_mul_f32 v171, v171, v163
    v_cvt_pk_bf16_f32 v144, v152, v153
    v_cvt_pk_bf16_f32 v145, v154, v155
    v_cvt_pk_bf16_f32 v146, v168, v169
    v_cvt_pk_bf16_f32 v147, v170, v171
    buffer_store_dwordx4 v[144:147], v246, s[24:27], s68 offen offset:0 sc1
    v_mul_f32 v232, v148, v248
    v_mul_f32 v233, v149, v248
    v_mul_f32 v234, v150, v248
    v_mul_f32 v235, v151, v248
    v_exp_f32 v232, v232
    v_exp_f32 v233, v233
    v_exp_f32 v234, v234
    v_exp_f32 v235, v235
    v_mul_f32 v156, v156, v250
    v_mul_f32 v157, v157, v250
    v_mul_f32 v158, v158, v250
    v_mul_f32 v159, v159, v250
    v_add_f32 v232, 1.0, v232
    v_add_f32 v233, 1.0, v233
    v_add_f32 v234, 1.0, v234
    v_add_f32 v235, 1.0, v235
    v_rcp_f32 v232, v232
    v_rcp_f32 v233, v233
    v_rcp_f32 v234, v234
    v_rcp_f32 v235, v235
    v_mul_f32 v148, v148, v232
    v_mul_f32 v149, v149, v233
    v_mul_f32 v150, v150, v234
    v_mul_f32 v151, v151, v235
    v_mul_f32 v156, v156, v148
    v_mul_f32 v157, v157, v149
    v_mul_f32 v158, v158, v150
    v_mul_f32 v159, v159, v151
    v_mul_f32 v232, v164, v248
    v_mul_f32 v233, v165, v248
    v_mul_f32 v234, v166, v248
    v_mul_f32 v235, v167, v248
    v_exp_f32 v232, v232
    v_exp_f32 v233, v233
    v_exp_f32 v234, v234
    v_exp_f32 v235, v235
    v_mul_f32 v172, v172, v250
    v_mul_f32 v173, v173, v250
    v_mul_f32 v174, v174, v250
    v_mul_f32 v175, v175, v250
    v_add_f32 v232, 1.0, v232
    v_add_f32 v233, 1.0, v233
    v_add_f32 v234, 1.0, v234
    v_add_f32 v235, 1.0, v235
    v_rcp_f32 v232, v232
    v_rcp_f32 v233, v233
    v_rcp_f32 v234, v234
    v_rcp_f32 v235, v235
    v_mul_f32 v164, v164, v232
    v_mul_f32 v165, v165, v233
    v_mul_f32 v166, v166, v234
    v_mul_f32 v167, v167, v235
    v_mul_f32 v172, v172, v164
    v_mul_f32 v173, v173, v165
    v_mul_f32 v174, v174, v166
    v_mul_f32 v175, v175, v167
    v_cvt_pk_bf16_f32 v148, v156, v157
    v_cvt_pk_bf16_f32 v149, v158, v159
    v_cvt_pk_bf16_f32 v150, v172, v173
    v_cvt_pk_bf16_f32 v151, v174, v175
    buffer_store_dwordx4 v[148:151], v246, s[24:27], s68 offen offset:1024 sc1
    v_and_b32 v127, 3, v125
    v_lshlrev_b32 v130, 7, v127
    v_min_u32 v127, 2, v127
    v_lshlrev_b32 v127, 7, v127
    s_lshl_b32 s38, s89, 7
    s_sub_u32 s71, s97, s38
    s_add_u32 s71, s71, 32768
    s_barrier
    ds_read_b64_tr_b16 v[48:49], v112 offset:0
    ds_read_b64_tr_b16 v[50:51], v112 offset:2048
    ds_read_b64_tr_b16 v[52:53], v113 offset:0
    ds_read_b64_tr_b16 v[54:55], v113 offset:2048
    ds_read_b64_tr_b16 v[56:57], v114 offset:0
    ds_read_b64_tr_b16 v[58:59], v114 offset:2048
    ds_read_b64_tr_b16 v[60:61], v115 offset:0
    ds_read_b64_tr_b16 v[62:63], v115 offset:2048
    s_waitcnt lgkmcnt(4)
    v_mfma_f32_16x16x32_bf16 v[144:147], v[48:51], v[0:3], 0
    ds_read_b64_tr_b16 v[64:65], v112 offset:4096
    v_mfma_f32_16x16x32_bf16 v[192:195], v[48:51], v[4:7], 0
    ds_read_b64_tr_b16 v[66:67], v112 offset:6144
    s_lshl_b32 s87, s74, 14
    s_add_u32 s87, s87, s66
    s_add_u32 s87, s87, 163840
    buffer_load_dwordx4 v[16:19], v246, s[24:27], s87 offen sc1
    buffer_load_dwordx4 v[20:23], v246, s[24:27], s87 offen offset:1024 sc1
    v_mfma_f32_16x16x32_bf16 v[148:151], v[52:55], v[0:3], 0
    ds_read_b64_tr_b16 v[68:69], v113 offset:4096
    v_mfma_f32_16x16x32_bf16 v[196:199], v[52:55], v[4:7], 0
    ds_read_b64_tr_b16 v[70:71], v113 offset:6144
    s_lshl_b32 s87, s75, 14
    s_add_u32 s87, s87, s66
    s_add_u32 s87, s87, 0
    buffer_load_dwordx4 v[24:27], v246, s[24:27], s87 offen sc1
    buffer_load_dwordx4 v[28:31], v246, s[24:27], s87 offen offset:1024 sc1
    s_waitcnt lgkmcnt(4)
    v_mfma_f32_16x16x32_bf16 v[152:155], v[56:59], v[0:3], 0
    ds_read_b64_tr_b16 v[48:49], v114 offset:4096
    v_mfma_f32_16x16x32_bf16 v[200:203], v[56:59], v[4:7], 0
    ds_read_b64_tr_b16 v[50:51], v114 offset:6144
    v_mfma_f32_16x16x32_bf16 v[156:159], v[60:63], v[0:3], 0
    ds_read_b64_tr_b16 v[52:53], v115 offset:4096
    s_lshl_b32 s87, s75, 14
    s_add_u32 s87, s87, s66
    s_add_u32 s87, s87, 81920
    buffer_load_dwordx4 v[32:35], v246, s[24:27], s87 offen sc1
    buffer_load_dwordx4 v[36:39], v246, s[24:27], s87 offen offset:1024 sc1
    v_mfma_f32_16x16x32_bf16 v[204:207], v[60:63], v[4:7], 0
    ds_read_b64_tr_b16 v[54:55], v115 offset:6144
    s_waitcnt lgkmcnt(4)
    v_mfma_f32_16x16x32_bf16 v[160:163], v[64:67], v[0:3], 0
    ds_read_b64_tr_b16 v[56:57], v112 offset:8192
    v_mfma_f32_16x16x32_bf16 v[208:211], v[64:67], v[4:7], 0
    ds_read_b64_tr_b16 v[58:59], v112 offset:10240
    s_mul_i32 s67, s75, 73728
    s_add_u32 s67, s67, s73
    s_add_u32 m0, s72, 98304
    s_add_u32 s67, s67, 368640
    buffer_load_dwordx4 v254, s[8:11], s67 offen offset:0 lds
    v_mfma_f32_16x16x32_bf16 v[164:167], v[68:71], v[0:3], 0
    ds_read_b64_tr_b16 v[60:61], v113 offset:8192
    v_mfma_f32_16x16x32_bf16 v[212:215], v[68:71], v[4:7], 0
    ds_read_b64_tr_b16 v[62:63], v113 offset:10240
    s_mul_i32 s67, s75, 73728
    s_add_u32 s67, s67, s73
    s_add_u32 m0, s72, 102272
    s_add_u32 s67, s67, 368640
    buffer_load_dwordx4 v254, s[8:11], s67 offen offset:128 lds
    s_waitcnt lgkmcnt(4)
    v_mfma_f32_16x16x32_bf16 v[168:171], v[48:51], v[0:3], 0
    ds_read_b64_tr_b16 v[64:65], v114 offset:8192
    v_mfma_f32_16x16x32_bf16 v[216:219], v[48:51], v[4:7], 0
    ds_read_b64_tr_b16 v[66:67], v114 offset:10240
    v_mfma_f32_16x16x32_bf16 v[172:175], v[52:55], v[0:3], 0
    ds_read_b64_tr_b16 v[68:69], v115 offset:8192
    s_mul_i32 s67, s75, 73728
    s_add_u32 s67, s67, s73
    s_add_u32 m0, s72, 106240
    s_add_u32 s67, s67, 368640
    buffer_load_dwordx4 v254, s[8:11], s67 offen offset:256 lds
    v_mfma_f32_16x16x32_bf16 v[220:223], v[52:55], v[4:7], 0
    ds_read_b64_tr_b16 v[70:71], v115 offset:10240
    s_waitcnt lgkmcnt(4)
    v_mfma_f32_16x16x32_bf16 v[176:179], v[56:59], v[0:3], 0
    ds_read_b64_tr_b16 v[48:49], v112 offset:24576
    v_mfma_f32_16x16x32_bf16 v[224:227], v[56:59], v[4:7], 0
    ds_read_b64_tr_b16 v[50:51], v112 offset:26624
    s_mul_i32 s67, s75, 73728
    s_add_u32 s67, s67, s73
    s_add_u32 m0, s72, 122880
    s_add_u32 s67, s67, 737280
    buffer_load_dwordx4 v254, s[8:11], s67 offen offset:0 lds
    v_mfma_f32_16x16x32_bf16 v[180:183], v[60:63], v[0:3], 0
    ds_read_b64_tr_b16 v[52:53], v113 offset:24576
    v_mfma_f32_16x16x32_bf16 v[228:231], v[60:63], v[4:7], 0
    ds_read_b64_tr_b16 v[54:55], v113 offset:26624
    s_mul_i32 s67, s75, 73728
    s_add_u32 s67, s67, s73
    s_add_u32 m0, s72, 126848
    s_add_u32 s67, s67, 737280
    buffer_load_dwordx4 v254, s[8:11], s67 offen offset:128 lds
    s_waitcnt lgkmcnt(4)
    v_mfma_f32_16x16x32_bf16 v[184:187], v[64:67], v[0:3], 0
    ds_read_b64_tr_b16 v[56:57], v114 offset:24576
    v_mfma_f32_16x16x32_bf16 v[232:235], v[64:67], v[4:7], 0
    ds_read_b64_tr_b16 v[58:59], v114 offset:26624
    v_mfma_f32_16x16x32_bf16 v[188:191], v[68:71], v[0:3], 0
    ds_read_b64_tr_b16 v[60:61], v115 offset:24576
    s_mul_i32 s67, s75, 73728
    s_add_u32 s67, s67, s73
    s_add_u32 m0, s72, 130816
    s_add_u32 s67, s67, 737280
    buffer_load_dwordx4 v254, s[8:11], s67 offen offset:256 lds
    v_mfma_f32_16x16x32_bf16 v[236:239], v[68:71], v[4:7], 0
    ds_read_b64_tr_b16 v[62:63], v115 offset:26624
    s_waitcnt vmcnt(12)
    s_barrier
    s_waitcnt lgkmcnt(4)
    v_mfma_f32_16x16x32_bf16 v[144:147], v[48:51], v[8:11], v[144:147]
    ds_read_b64_tr_b16 v[64:65], v112 offset:28672
    v_mfma_f32_16x16x32_bf16 v[192:195], v[48:51], v[12:15], v[192:195]
    ds_read_b64_tr_b16 v[66:67], v112 offset:30720
    s_cmp_lg_u32 s3, 0
    s_cbranch_scc1 L_fs5
    s_add_u32 s38, s97, 32768
    v_mov_b32_e64 v129, s96
    s_mov_b64 exec, 1
    buffer_store_dword v129, off, s[24:27], s38 sc1
    s_mov_b64 exec, -1
L_fs5:
    v_mfma_f32_16x16x32_bf16 v[148:151], v[52:55], v[8:11], v[148:151]
    ds_read_b64_tr_b16 v[68:69], v113 offset:28672
    v_mfma_f32_16x16x32_bf16 v[196:199], v[52:55], v[12:15], v[196:199]
    ds_read_b64_tr_b16 v[70:71], v113 offset:30720
    s_waitcnt lgkmcnt(4)
    v_mfma_f32_16x16x32_bf16 v[152:155], v[56:59], v[8:11], v[152:155]
    ds_read_b64_tr_b16 v[48:49], v114 offset:28672
    v_mfma_f32_16x16x32_bf16 v[200:203], v[56:59], v[12:15], v[200:203]
    ds_read_b64_tr_b16 v[50:51], v114 offset:30720
    s_lshl_b32 s87, s75, 14
    s_add_u32 s87, s87, s66
    s_add_u32 s87, s87, 163840
    buffer_load_dwordx4 v[40:43], v246, s[24:27], s87 offen sc1
    buffer_load_dwordx4 v[44:47], v246, s[24:27], s87 offen offset:1024 sc1
    v_mfma_f32_16x16x32_bf16 v[156:159], v[60:63], v[8:11], v[156:159]
    ds_read_b64_tr_b16 v[52:53], v115 offset:28672
    v_mfma_f32_16x16x32_bf16 v[204:207], v[60:63], v[12:15], v[204:207]
    ds_read_b64_tr_b16 v[54:55], v115 offset:30720
    s_waitcnt lgkmcnt(4)
    v_mfma_f32_16x16x32_bf16 v[160:163], v[64:67], v[8:11], v[160:163]
    ds_read_b64_tr_b16 v[56:57], v112 offset:32768
    v_mfma_f32_16x16x32_bf16 v[208:211], v[64:67], v[12:15], v[208:211]
    ds_read_b64_tr_b16 v[58:59], v112 offset:34816
    v_mfma_f32_16x16x32_bf16 v[164:167], v[68:71], v[8:11], v[164:167]
    ds_read_b64_tr_b16 v[60:61], v113 offset:32768
    s_mul_i32 s67, s76, 73728
    s_add_u32 s67, s67, s73
    s_add_u32 m0, s72, 0
    s_add_u32 s67, s67, 0
    buffer_load_dwordx4 v254, s[8:11], s67 offen offset:0 lds
    v_mfma_f32_16x16x32_bf16 v[212:215], v[68:71], v[12:15], v[212:215]
    ds_read_b64_tr_b16 v[62:63], v113 offset:34816
    s_waitcnt lgkmcnt(4)
    v_mfma_f32_16x16x32_bf16 v[168:171], v[48:51], v[8:11], v[168:171]
    ds_read_b64_tr_b16 v[64:65], v114 offset:32768
    v_mfma_f32_16x16x32_bf16 v[216:219], v[48:51], v[12:15], v[216:219]
    ds_read_b64_tr_b16 v[66:67], v114 offset:34816
    v_mfma_f32_16x16x32_bf16 v[172:175], v[52:55], v[8:11], v[172:175]
    ds_read_b64_tr_b16 v[68:69], v115 offset:32768
    v_mfma_f32_16x16x32_bf16 v[220:223], v[52:55], v[12:15], v[220:223]
    ds_read_b64_tr_b16 v[70:71], v115 offset:34816
    s_mul_i32 s67, s76, 73728
    s_add_u32 s67, s67, s73
    s_add_u32 m0, s72, 3968
    s_add_u32 s67, s67, 0
    buffer_load_dwordx4 v254, s[8:11], s67 offen offset:128 lds
    s_waitcnt lgkmcnt(4)
    v_mfma_f32_16x16x32_bf16 v[176:179], v[56:59], v[8:11], v[176:179]
    ds_read_b64_tr_b16 v[48:49], v116 offset:0
    v_mfma_f32_16x16x32_bf16 v[224:227], v[56:59], v[12:15], v[224:227]
    ds_read_b64_tr_b16 v[50:51], v116 offset:2048
    v_mfma_f32_16x16x32_bf16 v[180:183], v[60:63], v[8:11], v[180:183]
    ds_read_b64_tr_b16 v[52:53], v117 offset:0
    v_mfma_f32_16x16x32_bf16 v[228:231], v[60:63], v[12:15], v[228:231]
    ds_read_b64_tr_b16 v[54:55], v117 offset:2048
    s_waitcnt lgkmcnt(4)
    v_mfma_f32_16x16x32_bf16 v[184:187], v[64:67], v[8:11], v[184:187]
    ds_read_b64_tr_b16 v[56:57], v118 offset:0
    s_mul_i32 s67, s76, 73728
    s_add_u32 s67, s67, s73
    s_add_u32 m0, s72, 7936
    s_add_u32 s67, s67, 0
    buffer_load_dwordx4 v254, s[8:11], s67 offen offset:256 lds
    v_mfma_f32_16x16x32_bf16 v[232:235], v[64:67], v[12:15], v[232:235]
    ds_read_b64_tr_b16 v[58:59], v118 offset:2048
    v_mfma_f32_16x16x32_bf16 v[188:191], v[68:71], v[8:11], v[188:191]
    ds_read_b64_tr_b16 v[60:61], v119 offset:0
    v_mfma_f32_16x16x32_bf16 v[236:239], v[68:71], v[12:15], v[236:239]
    ds_read_b64_tr_b16 v[62:63], v119 offset:2048
    s_waitcnt vmcnt(15)
    s_barrier
    s_waitcnt lgkmcnt(4)
    v_mfma_f32_16x16x32_bf16 v[144:147], v[48:51], v[16:19], v[144:147]
    ds_read_b64_tr_b16 v[64:65], v116 offset:4096
    v_mfma_f32_16x16x32_bf16 v[192:195], v[48:51], v[20:23], v[192:195]
    ds_read_b64_tr_b16 v[66:67], v116 offset:6144
    s_lshl_b32 s87, s76, 14
    s_add_u32 s87, s87, s66
    s_add_u32 s87, s87, 0
    buffer_load_dwordx4 v[0:3], v246, s[24:27], s87 offen sc1
    buffer_load_dwordx4 v[4:7], v246, s[24:27], s87 offen offset:1024 sc1
    v_mfma_f32_16x16x32_bf16 v[148:151], v[52:55], v[16:19], v[148:151]
    ds_read_b64_tr_b16 v[68:69], v117 offset:4096
    v_mfma_f32_16x16x32_bf16 v[196:199], v[52:55], v[20:23], v[196:199]
    ds_read_b64_tr_b16 v[70:71], v117 offset:6144
    s_waitcnt lgkmcnt(4)
    v_mfma_f32_16x16x32_bf16 v[152:155], v[56:59], v[16:19], v[152:155]
    ds_read_b64_tr_b16 v[48:49], v118 offset:4096
    v_mfma_f32_16x16x32_bf16 v[200:203], v[56:59], v[20:23], v[200:203]
    ds_read_b64_tr_b16 v[50:51], v118 offset:6144
    v_mfma_f32_16x16x32_bf16 v[156:159], v[60:63], v[16:19], v[156:159]
    ds_read_b64_tr_b16 v[52:53], v119 offset:4096
    v_mfma_f32_16x16x32_bf16 v[204:207], v[60:63], v[20:23], v[204:207]
    ds_read_b64_tr_b16 v[54:55], v119 offset:6144
    s_mul_i32 s67, s76, 73728
    s_add_u32 s67, s67, s73
    s_add_u32 m0, s72, 24576
    s_add_u32 s67, s67, 368640
    buffer_load_dwordx4 v254, s[8:11], s67 offen offset:0 lds
    s_waitcnt lgkmcnt(4)
    v_mfma_f32_16x16x32_bf16 v[160:163], v[64:67], v[16:19], v[160:163]
    ds_read_b64_tr_b16 v[56:57], v116 offset:8192
    v_mfma_f32_16x16x32_bf16 v[208:211], v[64:67], v[20:23], v[208:211]
    ds_read_b64_tr_b16 v[58:59], v116 offset:10240
    v_mfma_f32_16x16x32_bf16 v[164:167], v[68:71], v[16:19], v[164:167]
    ds_read_b64_tr_b16 v[60:61], v117 offset:8192
    v_mfma_f32_16x16x32_bf16 v[212:215], v[68:71], v[20:23], v[212:215]
    ds_read_b64_tr_b16 v[62:63], v117 offset:10240
    s_waitcnt lgkmcnt(4)
    v_mfma_f32_16x16x32_bf16 v[168:171], v[48:51], v[16:19], v[168:171]
    ds_read_b64_tr_b16 v[64:65], v118 offset:8192
    v_mfma_f32_16x16x32_bf16 v[216:219], v[48:51], v[20:23], v[216:219]
    ds_read_b64_tr_b16 v[66:67], v118 offset:10240
    s_mul_i32 s67, s76, 73728
    s_add_u32 s67, s67, s73
    s_add_u32 m0, s72, 28544
    s_add_u32 s67, s67, 368640
    buffer_load_dwordx4 v254, s[8:11], s67 offen offset:128 lds
    v_mfma_f32_16x16x32_bf16 v[172:175], v[52:55], v[16:19], v[172:175]
    ds_read_b64_tr_b16 v[68:69], v119 offset:8192
    v_mfma_f32_16x16x32_bf16 v[220:223], v[52:55], v[20:23], v[220:223]
    ds_read_b64_tr_b16 v[70:71], v119 offset:10240
    s_waitcnt lgkmcnt(4)
    v_mfma_f32_16x16x32_bf16 v[176:179], v[56:59], v[16:19], v[176:179]
    ds_read_b64_tr_b16 v[48:49], v116 offset:24576
    v_mfma_f32_16x16x32_bf16 v[224:227], v[56:59], v[20:23], v[224:227]
    ds_read_b64_tr_b16 v[50:51], v116 offset:26624
    v_mfma_f32_16x16x32_bf16 v[180:183], v[60:63], v[16:19], v[180:183]
    ds_read_b64_tr_b16 v[52:53], v117 offset:24576
    v_mfma_f32_16x16x32_bf16 v[228:231], v[60:63], v[20:23], v[228:231]
    ds_read_b64_tr_b16 v[54:55], v117 offset:26624
    s_mul_i32 s67, s76, 73728
    s_add_u32 s67, s67, s73
    s_add_u32 m0, s72, 32512
    s_add_u32 s67, s67, 368640
    buffer_load_dwordx4 v254, s[8:11], s67 offen offset:256 lds
    s_waitcnt lgkmcnt(4)
    v_mfma_f32_16x16x32_bf16 v[184:187], v[64:67], v[16:19], v[184:187]
    ds_read_b64_tr_b16 v[56:57], v118 offset:24576
    v_mfma_f32_16x16x32_bf16 v[232:235], v[64:67], v[20:23], v[232:235]
    ds_read_b64_tr_b16 v[58:59], v118 offset:26624
    v_mfma_f32_16x16x32_bf16 v[188:191], v[68:71], v[16:19], v[188:191]
    ds_read_b64_tr_b16 v[60:61], v119 offset:24576
    v_mfma_f32_16x16x32_bf16 v[236:239], v[68:71], v[20:23], v[236:239]
    ds_read_b64_tr_b16 v[62:63], v119 offset:26624
    s_waitcnt vmcnt(13)
    s_barrier
    s_waitcnt lgkmcnt(4)
    v_mfma_f32_16x16x32_bf16 v[144:147], v[48:51], v[24:27], v[144:147]
    ds_read_b64_tr_b16 v[64:65], v116 offset:28672
    v_mfma_f32_16x16x32_bf16 v[192:195], v[48:51], v[28:31], v[192:195]
    ds_read_b64_tr_b16 v[66:67], v116 offset:30720
    s_cmp_eq_u32 s3, 0
    s_cselect_b32 s38, s71, 1073741824
    buffer_load_dword v128, v127, s[24:27], s38 offen sc1
    v_mfma_f32_16x16x32_bf16 v[148:151], v[52:55], v[24:27], v[148:151]
    ds_read_b64_tr_b16 v[68:69], v117 offset:28672
    v_mfma_f32_16x16x32_bf16 v[196:199], v[52:55], v[28:31], v[196:199]
    ds_read_b64_tr_b16 v[70:71], v117 offset:30720
    s_waitcnt lgkmcnt(4)
    v_mfma_f32_16x16x32_bf16 v[152:155], v[56:59], v[24:27], v[152:155]
    ds_read_b64_tr_b16 v[48:49], v118 offset:28672
    v_mfma_f32_16x16x32_bf16 v[200:203], v[56:59], v[28:31], v[200:203]
    ds_read_b64_tr_b16 v[50:51], v118 offset:30720
    s_lshl_b32 s87, s76, 14
    s_add_u32 s87, s87, s66
    s_add_u32 s87, s87, 81920
    buffer_load_dwordx4 v[8:11], v246, s[24:27], s87 offen sc1
    buffer_load_dwordx4 v[12:15], v246, s[24:27], s87 offen offset:1024 sc1
    v_mfma_f32_16x16x32_bf16 v[156:159], v[60:63], v[24:27], v[156:159]
    ds_read_b64_tr_b16 v[52:53], v119 offset:28672
    v_mfma_f32_16x16x32_bf16 v[204:207], v[60:63], v[28:31], v[204:207]
    ds_read_b64_tr_b16 v[54:55], v119 offset:30720
    s_waitcnt lgkmcnt(4)
    v_mfma_f32_16x16x32_bf16 v[160:163], v[64:67], v[24:27], v[160:163]
    ds_read_b64_tr_b16 v[56:57], v116 offset:32768
    v_mfma_f32_16x16x32_bf16 v[208:211], v[64:67], v[28:31], v[208:211]
    ds_read_b64_tr_b16 v[58:59], v116 offset:34816
    v_mfma_f32_16x16x32_bf16 v[164:167], v[68:71], v[24:27], v[164:167]
    ds_read_b64_tr_b16 v[60:61], v117 offset:32768
    s_mul_i32 s67, s76, 73728
    s_add_u32 s67, s67, s73
    s_add_u32 m0, s72, 49152
    s_add_u32 s67, s67, 737280
    buffer_load_dwordx4 v254, s[8:11], s67 offen offset:0 lds
    v_mfma_f32_16x16x32_bf16 v[212:215], v[68:71], v[28:31], v[212:215]
    ds_read_b64_tr_b16 v[62:63], v117 offset:34816
    s_waitcnt lgkmcnt(4)
    v_mfma_f32_16x16x32_bf16 v[168:171], v[48:51], v[24:27], v[168:171]
    ds_read_b64_tr_b16 v[64:65], v118 offset:32768
    v_mfma_f32_16x16x32_bf16 v[216:219], v[48:51], v[28:31], v[216:219]
    ds_read_b64_tr_b16 v[66:67], v118 offset:34816
    v_mfma_f32_16x16x32_bf16 v[172:175], v[52:55], v[24:27], v[172:175]
    ds_read_b64_tr_b16 v[68:69], v119 offset:32768
    v_mfma_f32_16x16x32_bf16 v[220:223], v[52:55], v[28:31], v[220:223]
    ds_read_b64_tr_b16 v[70:71], v119 offset:34816
    s_mul_i32 s67, s76, 73728
    s_add_u32 s67, s67, s73
    s_add_u32 m0, s72, 53120
    s_add_u32 s67, s67, 737280
    buffer_load_dwordx4 v254, s[8:11], s67 offen offset:128 lds
    s_waitcnt lgkmcnt(4)
    v_mfma_f32_16x16x32_bf16 v[176:179], v[56:59], v[24:27], v[176:179]
    ds_read_b64_tr_b16 v[48:49], v120 offset:0
    v_mfma_f32_16x16x32_bf16 v[224:227], v[56:59], v[28:31], v[224:227]
    ds_read_b64_tr_b16 v[50:51], v120 offset:2048
    v_mfma_f32_16x16x32_bf16 v[180:183], v[60:63], v[24:27], v[180:183]
    ds_read_b64_tr_b16 v[52:53], v121 offset:0
    v_mfma_f32_16x16x32_bf16 v[228:231], v[60:63], v[28:31], v[228:231]
    ds_read_b64_tr_b16 v[54:55], v121 offset:2048
    s_waitcnt lgkmcnt(4)
    v_mfma_f32_16x16x32_bf16 v[184:187], v[64:67], v[24:27], v[184:187]
    ds_read_b64_tr_b16 v[56:57], v122 offset:0
    s_mul_i32 s67, s76, 73728
    s_add_u32 s67, s67, s73
    s_add_u32 m0, s72, 57088
    s_add_u32 s67, s67, 737280
    buffer_load_dwordx4 v254, s[8:11], s67 offen offset:256 lds
    v_mfma_f32_16x16x32_bf16 v[232:235], v[64:67], v[28:31], v[232:235]
    ds_read_b64_tr_b16 v[58:59], v122 offset:2048
    v_mfma_f32_16x16x32_bf16 v[188:191], v[68:71], v[24:27], v[188:191]
    ds_read_b64_tr_b16 v[60:61], v123 offset:0
    v_mfma_f32_16x16x32_bf16 v[236:239], v[68:71], v[28:31], v[236:239]
    ds_read_b64_tr_b16 v[62:63], v123 offset:2048
    s_waitcnt vmcnt(16)
    s_barrier
    s_waitcnt lgkmcnt(4)
    v_mfma_f32_16x16x32_bf16 v[144:147], v[48:51], v[32:35], v[144:147]
    ds_read_b64_tr_b16 v[64:65], v120 offset:4096
    v_mfma_f32_16x16x32_bf16 v[192:195], v[48:51], v[36:39], v[192:195]
    ds_read_b64_tr_b16 v[66:67], v120 offset:6144
    s_lshl_b32 s87, s76, 14
    s_add_u32 s87, s87, s66
    s_add_u32 s87, s87, 163840
    buffer_load_dwordx4 v[16:19], v246, s[24:27], s87 offen sc1
    buffer_load_dwordx4 v[20:23], v246, s[24:27], s87 offen offset:1024 sc1
    v_mfma_f32_16x16x32_bf16 v[148:151], v[52:55], v[32:35], v[148:151]
    ds_read_b64_tr_b16 v[68:69], v121 offset:4096
    v_mfma_f32_16x16x32_bf16 v[196:199], v[52:55], v[36:39], v[196:199]
    ds_read_b64_tr_b16 v[70:71], v121 offset:6144
    s_waitcnt lgkmcnt(4)
    v_mfma_f32_16x16x32_bf16 v[152:155], v[56:59], v[32:35], v[152:155]
    ds_read_b64_tr_b16 v[48:49], v122 offset:4096
    v_mfma_f32_16x16x32_bf16 v[200:203], v[56:59], v[36:39], v[200:203]
    ds_read_b64_tr_b16 v[50:51], v122 offset:6144
    v_mfma_f32_16x16x32_bf16 v[156:159], v[60:63], v[32:35], v[156:159]
    ds_read_b64_tr_b16 v[52:53], v123 offset:4096
    v_mfma_f32_16x16x32_bf16 v[204:207], v[60:63], v[36:39], v[204:207]
    ds_read_b64_tr_b16 v[54:55], v123 offset:6144
    s_mul_i32 s67, s77, 73728
    s_add_u32 s67, s67, s73
    s_add_u32 m0, s72, 73728
    s_add_u32 s67, s67, 0
    buffer_load_dwordx4 v254, s[8:11], s67 offen offset:0 lds
    s_waitcnt lgkmcnt(4)
    v_mfma_f32_16x16x32_bf16 v[160:163], v[64:67], v[32:35], v[160:163]
    ds_read_b64_tr_b16 v[56:57], v120 offset:8192
    v_mfma_f32_16x16x32_bf16 v[208:211], v[64:67], v[36:39], v[208:211]
    ds_read_b64_tr_b16 v[58:59], v120 offset:10240
    v_mfma_f32_16x16x32_bf16 v[164:167], v[68:71], v[32:35], v[164:167]
    ds_read_b64_tr_b16 v[60:61], v121 offset:8192
    v_mfma_f32_16x16x32_bf16 v[212:215], v[68:71], v[36:39], v[212:215]
    ds_read_b64_tr_b16 v[62:63], v121 offset:10240
    s_waitcnt lgkmcnt(4)
    v_mfma_f32_16x16x32_bf16 v[168:171], v[48:51], v[32:35], v[168:171]
    ds_read_b64_tr_b16 v[64:65], v122 offset:8192
    v_mfma_f32_16x16x32_bf16 v[216:219], v[48:51], v[36:39], v[216:219]
    ds_read_b64_tr_b16 v[66:67], v122 offset:10240
    s_mul_i32 s67, s77, 73728
    s_add_u32 s67, s67, s73
    s_add_u32 m0, s72, 77696
    s_add_u32 s67, s67, 0
    buffer_load_dwordx4 v254, s[8:11], s67 offen offset:128 lds
    v_mfma_f32_16x16x32_bf16 v[172:175], v[52:55], v[32:35], v[172:175]
    ds_read_b64_tr_b16 v[68:69], v123 offset:8192
    v_mfma_f32_16x16x32_bf16 v[220:223], v[52:55], v[36:39], v[220:223]
    ds_read_b64_tr_b16 v[70:71], v123 offset:10240
    s_waitcnt lgkmcnt(4)
    v_mfma_f32_16x16x32_bf16 v[176:179], v[56:59], v[32:35], v[176:179]
    ds_read_b64_tr_b16 v[48:49], v120 offset:24576
    v_mfma_f32_16x16x32_bf16 v[224:227], v[56:59], v[36:39], v[224:227]
    ds_read_b64_tr_b16 v[50:51], v120 offset:26624
    v_mfma_f32_16x16x32_bf16 v[180:183], v[60:63], v[32:35], v[180:183]
    ds_read_b64_tr_b16 v[52:53], v121 offset:24576
    v_mfma_f32_16x16x32_bf16 v[228:231], v[60:63], v[36:39], v[228:231]
    ds_read_b64_tr_b16 v[54:55], v121 offset:26624
    s_mul_i32 s67, s77, 73728
    s_add_u32 s67, s67, s73
    s_add_u32 m0, s72, 81664
    s_add_u32 s67, s67, 0
    buffer_load_dwordx4 v254, s[8:11], s67 offen offset:256 lds
    s_waitcnt lgkmcnt(4)
    v_mfma_f32_16x16x32_bf16 v[184:187], v[64:67], v[32:35], v[184:187]
    ds_read_b64_tr_b16 v[56:57], v122 offset:24576
    v_mfma_f32_16x16x32_bf16 v[232:235], v[64:67], v[36:39], v[232:235]
    ds_read_b64_tr_b16 v[58:59], v122 offset:26624
    v_mfma_f32_16x16x32_bf16 v[188:191], v[68:71], v[32:35], v[188:191]
    ds_read_b64_tr_b16 v[60:61], v123 offset:24576
    v_mfma_f32_16x16x32_bf16 v[236:239], v[68:71], v[36:39], v[236:239]
    ds_read_b64_tr_b16 v[62:63], v123 offset:26624
    s_waitcnt vmcnt(16)
    s_waitcnt vmcnt(10)
    s_cmp_lg_u32 s3, 0
    s_cbranch_scc1 L_fc6
    s_mov_b32 s93, 0
L_fl6:
    v_cmp_ne_u32 vcc, s96, v128
    s_cbranch_vccz L_fc6
    s_add_u32 s93, s93, 1
    s_cmp_gt_u32 s93, 60000
    s_cbranch_scc1 L_fc6
    s_sleep 4
    buffer_load_dword v128, v127, s[24:27], s71 offen sc1
    s_waitcnt vmcnt(0)
    s_branch L_fl6
L_fc6:
    s_barrier
    s_waitcnt lgkmcnt(4)
    v_mfma_f32_16x16x32_bf16 v[144:147], v[48:51], v[40:43], v[144:147]
    ds_read_b64_tr_b16 v[64:65], v120 offset:28672
    v_mfma_f32_16x16x32_bf16 v[192:195], v[48:51], v[44:47], v[192:195]
    ds_read_b64_tr_b16 v[66:67], v120 offset:30720
    s_lshl_b32 s87, s77, 14
    s_add_u32 s87, s87, s66
    s_add_u32 s87, s87, 0
    buffer_load_dwordx4 v[24:27], v246, s[24:27], s87 offen sc1
    buffer_load_dwordx4 v[28:31], v246, s[24:27], s87 offen offset:1024 sc1
    v_mfma_f32_16x16x32_bf16 v[148:151], v[52:55], v[40:43], v[148:151]
    ds_read_b64_tr_b16 v[68:69], v121 offset:28672
    v_mfma_f32_16x16x32_bf16 v[196:199], v[52:55], v[44:47], v[196:199]
    ds_read_b64_tr_b16 v[70:71], v121 offset:30720
    s_waitcnt lgkmcnt(4)
    v_mfma_f32_16x16x32_bf16 v[152:155], v[56:59], v[40:43], v[152:155]
    ds_read_b64_tr_b16 v[48:49], v122 offset:28672
    v_mfma_f32_16x16x32_bf16 v[200:203], v[56:59], v[44:47], v[200:203]
    ds_read_b64_tr_b16 v[50:51], v122 offset:30720
    v_mfma_f32_16x16x32_bf16 v[156:159], v[60:63], v[40:43], v[156:159]
    ds_read_b64_tr_b16 v[52:53], v123 offset:28672
    v_mfma_f32_16x16x32_bf16 v[204:207], v[60:63], v[44:47], v[204:207]
    ds_read_b64_tr_b16 v[54:55], v123 offset:30720
    s_mul_i32 s67, s77, 73728
    s_add_u32 s67, s67, s73
    s_add_u32 m0, s72, 98304
    s_add_u32 s67, s67, 368640
    buffer_load_dwordx4 v254, s[8:11], s67 offen offset:0 lds
    s_waitcnt lgkmcnt(4)
    v_mfma_f32_16x16x32_bf16 v[160:163], v[64:67], v[40:43], v[160:163]
    ds_read_b64_tr_b16 v[56:57], v120 offset:32768
    v_mfma_f32_16x16x32_bf16 v[208:211], v[64:67], v[44:47], v[208:211]
    ds_read_b64_tr_b16 v[58:59], v120 offset:34816
    v_mfma_f32_16x16x32_bf16 v[164:167], v[68:71], v[40:43], v[164:167]
    ds_read_b64_tr_b16 v[60:61], v121 offset:32768
    v_mfma_f32_16x16x32_bf16 v[212:215], v[68:71], v[44:47], v[212:215]
    ds_read_b64_tr_b16 v[62:63], v121 offset:34816
    s_waitcnt lgkmcnt(4)
    v_mfma_f32_16x16x32_bf16 v[168:171], v[48:51], v[40:43], v[168:171]
    ds_read_b64_tr_b16 v[64:65], v122 offset:32768
    v_mfma_f32_16x16x32_bf16 v[216:219], v[48:51], v[44:47], v[216:219]
    ds_read_b64_tr_b16 v[66:67], v122 offset:34816
    s_mul_i32 s67, s77, 73728
    s_add_u32 s67, s67, s73
    s_add_u32 m0, s72, 102272
    s_add_u32 s67, s67, 368640
    buffer_load_dwordx4 v254, s[8:11], s67 offen offset:128 lds
    v_mfma_f32_16x16x32_bf16 v[172:175], v[52:55], v[40:43], v[172:175]
    ds_read_b64_tr_b16 v[68:69], v123 offset:32768
    v_mfma_f32_16x16x32_bf16 v[220:223], v[52:55], v[44:47], v[220:223]
    ds_read_b64_tr_b16 v[70:71], v123 offset:34816
    s_waitcnt lgkmcnt(4)
    v_mfma_f32_16x16x32_bf16 v[176:179], v[56:59], v[40:43], v[176:179]
    ds_read_b64_tr_b16 v[48:49], v112 offset:0
    v_mfma_f32_16x16x32_bf16 v[224:227], v[56:59], v[44:47], v[224:227]
    ds_read_b64_tr_b16 v[50:51], v112 offset:2048
    v_mfma_f32_16x16x32_bf16 v[180:183], v[60:63], v[40:43], v[180:183]
    ds_read_b64_tr_b16 v[52:53], v113 offset:0
    v_mfma_f32_16x16x32_bf16 v[228:231], v[60:63], v[44:47], v[228:231]
    ds_read_b64_tr_b16 v[54:55], v113 offset:2048
    s_mul_i32 s67, s77, 73728
    s_add_u32 s67, s67, s73
    s_add_u32 m0, s72, 106240
    s_add_u32 s67, s67, 368640
    buffer_load_dwordx4 v254, s[8:11], s67 offen offset:256 lds
    s_waitcnt lgkmcnt(4)
    v_mfma_f32_16x16x32_bf16 v[184:187], v[64:67], v[40:43], v[184:187]
    ds_read_b64_tr_b16 v[56:57], v114 offset:0
    v_mfma_f32_16x16x32_bf16 v[232:235], v[64:67], v[44:47], v[232:235]
    ds_read_b64_tr_b16 v[58:59], v114 offset:2048
    v_mfma_f32_16x16x32_bf16 v[188:191], v[68:71], v[40:43], v[188:191]
    ds_read_b64_tr_b16 v[60:61], v115 offset:0
    v_mfma_f32_16x16x32_bf16 v[236:239], v[68:71], v[44:47], v[236:239]
    ds_read_b64_tr_b16 v[62:63], v115 offset:2048
    s_barrier
    s_waitcnt lgkmcnt(4)
    v_mfma_f32_16x16x32_bf16 v[144:147], v[48:51], v[0:3], v[144:147]
    ds_read_b64_tr_b16 v[64:65], v112 offset:4096
    v_mfma_f32_16x16x32_bf16 v[192:195], v[48:51], v[4:7], v[192:195]
    ds_read_b64_tr_b16 v[66:67], v112 offset:6144
    s_lshl_b32 s87, s77, 14
    s_add_u32 s87, s87, s66
    s_add_u32 s87, s87, 81920
    buffer_load_dwordx4 v[32:35], v246, s[24:27], s87 offen sc1
    buffer_load_dwordx4 v[36:39], v246, s[24:27], s87 offen offset:1024 sc1
    v_mfma_f32_16x16x32_bf16 v[148:151], v[52:55], v[0:3], v[148:151]
    ds_read_b64_tr_b16 v[68:69], v113 offset:4096
    v_mfma_f32_16x16x32_bf16 v[196:199], v[52:55], v[4:7], v[196:199]
    ds_read_b64_tr_b16 v[70:71], v113 offset:6144
    s_waitcnt lgkmcnt(4)
    v_mfma_f32_16x16x32_bf16 v[152:155], v[56:59], v[0:3], v[152:155]
    ds_read_b64_tr_b16 v[48:49], v114 offset:4096
    v_mfma_f32_16x16x32_bf16 v[200:203], v[56:59], v[4:7], v[200:203]
    ds_read_b64_tr_b16 v[50:51], v114 offset:6144
    v_mfma_f32_16x16x32_bf16 v[156:159], v[60:63], v[0:3], v[156:159]
    ds_read_b64_tr_b16 v[52:53], v115 offset:4096
    v_mfma_f32_16x16x32_bf16 v[204:207], v[60:63], v[4:7], v[204:207]
    ds_read_b64_tr_b16 v[54:55], v115 offset:6144
    s_mul_i32 s67, s77, 73728
    s_add_u32 s67, s67, s73
    s_add_u32 m0, s72, 122880
    s_add_u32 s67, s67, 737280
    buffer_load_dwordx4 v254, s[8:11], s67 offen offset:0 lds
    s_waitcnt lgkmcnt(4)
    v_mfma_f32_16x16x32_bf16 v[160:163], v[64:67], v[0:3], v[160:163]
    ds_read_b64_tr_b16 v[56:57], v112 offset:8192
    v_mfma_f32_16x16x32_bf16 v[208:211], v[64:67], v[4:7], v[208:211]
    ds_read_b64_tr_b16 v[58:59], v112 offset:10240
    v_mfma_f32_16x16x32_bf16 v[164:167], v[68:71], v[0:3], v[164:167]
    ds_read_b64_tr_b16 v[60:61], v113 offset:8192
    v_mfma_f32_16x16x32_bf16 v[212:215], v[68:71], v[4:7], v[212:215]
    ds_read_b64_tr_b16 v[62:63], v113 offset:10240
    s_waitcnt lgkmcnt(4)
    v_mfma_f32_16x16x32_bf16 v[168:171], v[48:51], v[0:3], v[168:171]
    ds_read_b64_tr_b16 v[64:65], v114 offset:8192
    v_mfma_f32_16x16x32_bf16 v[216:219], v[48:51], v[4:7], v[216:219]
    ds_read_b64_tr_b16 v[66:67], v114 offset:10240
    s_mul_i32 s67, s77, 73728
    s_add_u32 s67, s67, s73
    s_add_u32 m0, s72, 126848
    s_add_u32 s67, s67, 737280
    buffer_load_dwordx4 v254, s[8:11], s67 offen offset:128 lds
    v_mfma_f32_16x16x32_bf16 v[172:175], v[52:55], v[0:3], v[172:175]
    ds_read_b64_tr_b16 v[68:69], v115 offset:8192
    v_mfma_f32_16x16x32_bf16 v[220:223], v[52:55], v[4:7], v[220:223]
    ds_read_b64_tr_b16 v[70:71], v115 offset:10240
    s_waitcnt lgkmcnt(4)
    v_mfma_f32_16x16x32_bf16 v[176:179], v[56:59], v[0:3], v[176:179]
    ds_read_b64_tr_b16 v[48:49], v112 offset:24576
    v_mfma_f32_16x16x32_bf16 v[224:227], v[56:59], v[4:7], v[224:227]
    ds_read_b64_tr_b16 v[50:51], v112 offset:26624
    v_mfma_f32_16x16x32_bf16 v[180:183], v[60:63], v[0:3], v[180:183]
    ds_read_b64_tr_b16 v[52:53], v113 offset:24576
    v_mfma_f32_16x16x32_bf16 v[228:231], v[60:63], v[4:7], v[228:231]
    ds_read_b64_tr_b16 v[54:55], v113 offset:26624
    s_mul_i32 s67, s77, 73728
    s_add_u32 s67, s67, s73
    s_add_u32 m0, s72, 130816
    s_add_u32 s67, s67, 737280
    buffer_load_dwordx4 v254, s[8:11], s67 offen offset:256 lds
    s_waitcnt lgkmcnt(4)
    v_mfma_f32_16x16x32_bf16 v[184:187], v[64:67], v[0:3], v[184:187]
    ds_read_b64_tr_b16 v[56:57], v114 offset:24576
    v_mfma_f32_16x16x32_bf16 v[232:235], v[64:67], v[4:7], v[232:235]
    ds_read_b64_tr_b16 v[58:59], v114 offset:26624
    v_mfma_f32_16x16x32_bf16 v[188:191], v[68:71], v[0:3], v[188:191]
    ds_read_b64_tr_b16 v[60:61], v115 offset:24576
    v_mfma_f32_16x16x32_bf16 v[236:239], v[68:71], v[4:7], v[236:239]
    ds_read_b64_tr_b16 v[62:63], v115 offset:26624
    s_waitcnt vmcnt(15)
    s_barrier
    s_waitcnt lgkmcnt(4)
    v_mfma_f32_16x16x32_bf16 v[144:147], v[48:51], v[8:11], v[144:147]
    ds_read_b64_tr_b16 v[64:65], v112 offset:28672
    v_mfma_f32_16x16x32_bf16 v[192:195], v[48:51], v[12:15], v[192:195]
    ds_read_b64_tr_b16 v[66:67], v112 offset:30720
    s_lshl_b32 s87, s77, 14
    s_add_u32 s87, s87, s66
    s_add_u32 s87, s87, 163840
    buffer_load_dwordx4 v[40:43], v246, s[24:27], s87 offen sc1
    buffer_load_dwordx4 v[44:47], v246, s[24:27], s87 offen offset:1024 sc1
    v_mfma_f32_16x16x32_bf16 v[148:151], v[52:55], v[8:11], v[148:151]
    ds_read_b64_tr_b16 v[68:69], v113 offset:28672
    v_mfma_f32_16x16x32_bf16 v[196:199], v[52:55], v[12:15], v[196:199]
    ds_read_b64_tr_b16 v[70:71], v113 offset:30720
    s_waitcnt lgkmcnt(4)
    v_mfma_f32_16x16x32_bf16 v[152:155], v[56:59], v[8:11], v[152:155]
    ds_read_b64_tr_b16 v[48:49], v114 offset:28672
    v_mfma_f32_16x16x32_bf16 v[200:203], v[56:59], v[12:15], v[200:203]
    ds_read_b64_tr_b16 v[50:51], v114 offset:30720
    v_mfma_f32_16x16x32_bf16 v[156:159], v[60:63], v[8:11], v[156:159]
    ds_read_b64_tr_b16 v[52:53], v115 offset:28672
    v_mfma_f32_16x16x32_bf16 v[204:207], v[60:63], v[12:15], v[204:207]
    ds_read_b64_tr_b16 v[54:55], v115 offset:30720
    s_mul_i32 s67, s78, 73728
    s_add_u32 s67, s67, s73
    s_add_u32 m0, s72, 0
    s_add_u32 s67, s67, 0
    buffer_load_dwordx4 v254, s[8:11], s67 offen offset:0 lds
    s_waitcnt lgkmcnt(4)
    v_mfma_f32_16x16x32_bf16 v[160:163], v[64:67], v[8:11], v[160:163]
    ds_read_b64_tr_b16 v[56:57], v112 offset:32768
    v_mfma_f32_16x16x32_bf16 v[208:211], v[64:67], v[12:15], v[208:211]
    ds_read_b64_tr_b16 v[58:59], v112 offset:34816
    v_mfma_f32_16x16x32_bf16 v[164:167], v[68:71], v[8:11], v[164:167]
    ds_read_b64_tr_b16 v[60:61], v113 offset:32768
    v_mfma_f32_16x16x32_bf16 v[212:215], v[68:71], v[12:15], v[212:215]
    ds_read_b64_tr_b16 v[62:63], v113 offset:34816
    s_waitcnt lgkmcnt(4)
    v_mfma_f32_16x16x32_bf16 v[168:171], v[48:51], v[8:11], v[168:171]
    ds_read_b64_tr_b16 v[64:65], v114 offset:32768
    v_mfma_f32_16x16x32_bf16 v[216:219], v[48:51], v[12:15], v[216:219]
    ds_read_b64_tr_b16 v[66:67], v114 offset:34816
    s_mul_i32 s67, s78, 73728
    s_add_u32 s67, s67, s73
    s_add_u32 m0, s72, 3968
    s_add_u32 s67, s67, 0
    buffer_load_dwordx4 v254, s[8:11], s67 offen offset:128 lds
    v_mfma_f32_16x16x32_bf16 v[172:175], v[52:55], v[8:11], v[172:175]
    ds_read_b64_tr_b16 v[68:69], v115 offset:32768
    v_mfma_f32_16x16x32_bf16 v[220:223], v[52:55], v[12:15], v[220:223]
    ds_read_b64_tr_b16 v[70:71], v115 offset:34816
    s_waitcnt lgkmcnt(4)
    v_mfma_f32_16x16x32_bf16 v[176:179], v[56:59], v[8:11], v[176:179]
    ds_read_b64_tr_b16 v[48:49], v116 offset:0
    v_mfma_f32_16x16x32_bf16 v[224:227], v[56:59], v[12:15], v[224:227]
    ds_read_b64_tr_b16 v[50:51], v116 offset:2048
    v_mfma_f32_16x16x32_bf16 v[180:183], v[60:63], v[8:11], v[180:183]
    ds_read_b64_tr_b16 v[52:53], v117 offset:0
    v_mfma_f32_16x16x32_bf16 v[228:231], v[60:63], v[12:15], v[228:231]
    ds_read_b64_tr_b16 v[54:55], v117 offset:2048
    s_mul_i32 s67, s78, 73728
    s_add_u32 s67, s67, s73
    s_add_u32 m0, s72, 7936
    s_add_u32 s67, s67, 0
    buffer_load_dwordx4 v254, s[8:11], s67 offen offset:256 lds
    s_waitcnt lgkmcnt(4)
    v_mfma_f32_16x16x32_bf16 v[184:187], v[64:67], v[8:11], v[184:187]
    ds_read_b64_tr_b16 v[56:57], v118 offset:0
    v_mfma_f32_16x16x32_bf16 v[232:235], v[64:67], v[12:15], v[232:235]
    ds_read_b64_tr_b16 v[58:59], v118 offset:2048
    v_mfma_f32_16x16x32_bf16 v[188:191], v[68:71], v[8:11], v[188:191]
    ds_read_b64_tr_b16 v[60:61], v119 offset:0
    v_mfma_f32_16x16x32_bf16 v[236:239], v[68:71], v[12:15], v[236:239]
    ds_read_b64_tr_b16 v[62:63], v119 offset:2048
    s_waitcnt vmcnt(15)
    s_barrier
    s_waitcnt lgkmcnt(4)
    v_mfma_f32_16x16x32_bf16 v[144:147], v[48:51], v[16:19], v[144:147]
    ds_read_b64_tr_b16 v[64:65], v116 offset:4096
    v_mfma_f32_16x16x32_bf16 v[192:195], v[48:51], v[20:23], v[192:195]
    ds_read_b64_tr_b16 v[66:67], v116 offset:6144
    s_lshl_b32 s87, s78, 14
    s_add_u32 s87, s87, s66
    s_add_u32 s87, s87, 0
    buffer_load_dwordx4 v[0:3], v246, s[24:27], s87 offen sc1
    buffer_load_dwordx4 v[4:7], v246, s[24:27], s87 offen offset:1024 sc1
    v_mfma_f32_16x16x32_bf16 v[148:151], v[52:55], v[16:19], v[148:151]
    ds_read_b64_tr_b16 v[68:69], v117 offset:4096
    v_mfma_f32_16x16x32_bf16 v[196:199], v[52:55], v[20:23], v[196:199]
    ds_read_b64_tr_b16 v[70:71], v117 offset:6144
    s_waitcnt lgkmcnt(4)
    v_mfma_f32_16x16x32_bf16 v[152:155], v[56:59], v[16:19], v[152:155]
    ds_read_b64_tr_b16 v[48:49], v118 offset:4096
    v_mfma_f32_16x16x32_bf16 v[200:203], v[56:59], v[20:23], v[200:203]
    ds_read_b64_tr_b16 v[50:51], v118 offset:6144
    v_mfma_f32_16x16x32_bf16 v[156:159], v[60:63], v[16:19], v[156:159]
    ds_read_b64_tr_b16 v[52:53], v119 offset:4096
    v_mfma_f32_16x16x32_bf16 v[204:207], v[60:63], v[20:23], v[204:207]
    ds_read_b64_tr_b16 v[54:55], v119 offset:6144
    s_mul_i32 s67, s78, 73728
    s_add_u32 s67, s67, s73
    s_add_u32 m0, s72, 24576
    s_add_u32 s67, s67, 368640
    buffer_load_dwordx4 v254, s[8:11], s67 offen offset:0 lds
    s_waitcnt lgkmcnt(4)
    v_mfma_f32_16x16x32_bf16 v[160:163], v[64:67], v[16:19], v[160:163]
    ds_read_b64_tr_b16 v[56:57], v116 offset:8192
    v_mfma_f32_16x16x32_bf16 v[208:211], v[64:67], v[20:23], v[208:211]
    ds_read_b64_tr_b16 v[58:59], v116 offset:10240
    v_mfma_f32_16x16x32_bf16 v[164:167], v[68:71], v[16:19], v[164:167]
    ds_read_b64_tr_b16 v[60:61], v117 offset:8192
    v_mfma_f32_16x16x32_bf16 v[212:215], v[68:71], v[20:23], v[212:215]
    ds_read_b64_tr_b16 v[62:63], v117 offset:10240
    s_waitcnt lgkmcnt(4)
    v_mfma_f32_16x16x32_bf16 v[168:171], v[48:51], v[16:19], v[168:171]
    ds_read_b64_tr_b16 v[64:65], v118 offset:8192
    v_mfma_f32_16x16x32_bf16 v[216:219], v[48:51], v[20:23], v[216:219]
    ds_read_b64_tr_b16 v[66:67], v118 offset:10240
    s_mul_i32 s67, s78, 73728
    s_add_u32 s67, s67, s73
    s_add_u32 m0, s72, 28544
    s_add_u32 s67, s67, 368640
    buffer_load_dwordx4 v254, s[8:11], s67 offen offset:128 lds
    v_mfma_f32_16x16x32_bf16 v[172:175], v[52:55], v[16:19], v[172:175]
    ds_read_b64_tr_b16 v[68:69], v119 offset:8192
    v_mfma_f32_16x16x32_bf16 v[220:223], v[52:55], v[20:23], v[220:223]
    ds_read_b64_tr_b16 v[70:71], v119 offset:10240
    s_waitcnt lgkmcnt(4)
    v_mfma_f32_16x16x32_bf16 v[176:179], v[56:59], v[16:19], v[176:179]
    ds_read_b64_tr_b16 v[48:49], v116 offset:24576
    v_mfma_f32_16x16x32_bf16 v[224:227], v[56:59], v[20:23], v[224:227]
    ds_read_b64_tr_b16 v[50:51], v116 offset:26624
    v_mfma_f32_16x16x32_bf16 v[180:183], v[60:63], v[16:19], v[180:183]
    ds_read_b64_tr_b16 v[52:53], v117 offset:24576
    v_mfma_f32_16x16x32_bf16 v[228:231], v[60:63], v[20:23], v[228:231]
    ds_read_b64_tr_b16 v[54:55], v117 offset:26624
    s_mul_i32 s67, s78, 73728
    s_add_u32 s67, s67, s73
    s_add_u32 m0, s72, 32512
    s_add_u32 s67, s67, 368640
    buffer_load_dwordx4 v254, s[8:11], s67 offen offset:256 lds
    s_waitcnt lgkmcnt(4)
    v_mfma_f32_16x16x32_bf16 v[184:187], v[64:67], v[16:19], v[184:187]
    ds_read_b64_tr_b16 v[56:57], v118 offset:24576
    v_mfma_f32_16x16x32_bf16 v[232:235], v[64:67], v[20:23], v[232:235]
    ds_read_b64_tr_b16 v[58:59], v118 offset:26624
    v_mfma_f32_16x16x32_bf16 v[188:191], v[68:71], v[16:19], v[188:191]
    ds_read_b64_tr_b16 v[60:61], v119 offset:24576
    v_mfma_f32_16x16x32_bf16 v[236:239], v[68:71], v[20:23], v[236:239]
    ds_read_b64_tr_b16 v[62:63], v119 offset:26624
    s_waitcnt vmcnt(15)
    s_barrier
    s_waitcnt lgkmcnt(4)
    v_mfma_f32_16x16x32_bf16 v[144:147], v[48:51], v[24:27], v[144:147]
    ds_read_b64_tr_b16 v[64:65], v116 offset:28672
    v_mfma_f32_16x16x32_bf16 v[192:195], v[48:51], v[28:31], v[192:195]
    ds_read_b64_tr_b16 v[66:67], v116 offset:30720
    s_lshl_b32 s87, s78, 14
    s_add_u32 s87, s87, s66
    s_add_u32 s87, s87, 81920
    buffer_load_dwordx4 v[8:11], v246, s[24:27], s87 offen sc1
    buffer_load_dwordx4 v[12:15], v246, s[24:27], s87 offen offset:1024 sc1
    v_mfma_f32_16x16x32_bf16 v[148:151], v[52:55], v[24:27], v[148:151]
    ds_read_b64_tr_b16 v[68:69], v117 offset:28672
    v_mfma_f32_16x16x32_bf16 v[196:199], v[52:55], v[28:31], v[196:199]
    ds_read_b64_tr_b16 v[70:71], v117 offset:30720
    s_waitcnt lgkmcnt(4)
    v_mfma_f32_16x16x32_bf16 v[152:155], v[56:59], v[24:27], v[152:155]
    ds_read_b64_tr_b16 v[48:49], v118 offset:28672
    v_mfma_f32_16x16x32_bf16 v[200:203], v[56:59], v[28:31], v[200:203]
    ds_read_b64_tr_b16 v[50:51], v118 offset:30720
    v_mfma_f32_16x16x32_bf16 v[156:159], v[60:63], v[24:27], v[156:159]
    ds_read_b64_tr_b16 v[52:53], v119 offset:28672
    v_mfma_f32_16x16x32_bf16 v[204:207], v[60:63], v[28:31], v[204:207]
    ds_read_b64_tr_b16 v[54:55], v119 offset:30720
    s_mul_i32 s67, s78, 73728
    s_add_u32 s67, s67, s73
    s_add_u32 m0, s72, 49152
    s_add_u32 s67, s67, 737280
    buffer_load_dwordx4 v254, s[8:11], s67 offen offset:0 lds
    s_waitcnt lgkmcnt(4)
    v_mfma_f32_16x16x32_bf16 v[160:163], v[64:67], v[24:27], v[160:163]
    ds_read_b64_tr_b16 v[56:57], v116 offset:32768
    v_mfma_f32_16x16x32_bf16 v[208:211], v[64:67], v[28:31], v[208:211]
    ds_read_b64_tr_b16 v[58:59], v116 offset:34816
    v_mfma_f32_16x16x32_bf16 v[164:167], v[68:71], v[24:27], v[164:167]
    ds_read_b64_tr_b16 v[60:61], v117 offset:32768
    v_mfma_f32_16x16x32_bf16 v[212:215], v[68:71], v[28:31], v[212:215]
    ds_read_b64_tr_b16 v[62:63], v117 offset:34816
    s_waitcnt lgkmcnt(4)
    v_mfma_f32_16x16x32_bf16 v[168:171], v[48:51], v[24:27], v[168:171]
    ds_read_b64_tr_b16 v[64:65], v118 offset:32768
    v_mfma_f32_16x16x32_bf16 v[216:219], v[48:51], v[28:31], v[216:219]
    ds_read_b64_tr_b16 v[66:67], v118 offset:34816
    s_mul_i32 s67, s78, 73728
    s_add_u32 s67, s67, s73
    s_add_u32 m0, s72, 53120
    s_add_u32 s67, s67, 737280
    buffer_load_dwordx4 v254, s[8:11], s67 offen offset:128 lds
    v_mfma_f32_16x16x32_bf16 v[172:175], v[52:55], v[24:27], v[172:175]
    ds_read_b64_tr_b16 v[68:69], v119 offset:32768
    v_mfma_f32_16x16x32_bf16 v[220:223], v[52:55], v[28:31], v[220:223]
    ds_read_b64_tr_b16 v[70:71], v119 offset:34816
    s_waitcnt lgkmcnt(4)
    v_mfma_f32_16x16x32_bf16 v[176:179], v[56:59], v[24:27], v[176:179]
    ds_read_b64_tr_b16 v[48:49], v120 offset:0
    v_mfma_f32_16x16x32_bf16 v[224:227], v[56:59], v[28:31], v[224:227]
    ds_read_b64_tr_b16 v[50:51], v120 offset:2048
    v_mfma_f32_16x16x32_bf16 v[180:183], v[60:63], v[24:27], v[180:183]
    ds_read_b64_tr_b16 v[52:53], v121 offset:0
    v_mfma_f32_16x16x32_bf16 v[228:231], v[60:63], v[28:31], v[228:231]
    ds_read_b64_tr_b16 v[54:55], v121 offset:2048
    s_mul_i32 s67, s78, 73728
    s_add_u32 s67, s67, s73
    s_add_u32 m0, s72, 57088
    s_add_u32 s67, s67, 737280
    buffer_load_dwordx4 v254, s[8:11], s67 offen offset:256 lds
    s_waitcnt lgkmcnt(4)
    v_mfma_f32_16x16x32_bf16 v[184:187], v[64:67], v[24:27], v[184:187]
    ds_read_b64_tr_b16 v[56:57], v122 offset:0
    v_mfma_f32_16x16x32_bf16 v[232:235], v[64:67], v[28:31], v[232:235]
    ds_read_b64_tr_b16 v[58:59], v122 offset:2048
    v_mfma_f32_16x16x32_bf16 v[188:191], v[68:71], v[24:27], v[188:191]
    ds_read_b64_tr_b16 v[60:61], v123 offset:0
    v_mfma_f32_16x16x32_bf16 v[236:239], v[68:71], v[28:31], v[236:239]
    ds_read_b64_tr_b16 v[62:63], v123 offset:2048
    s_waitcnt vmcnt(15)
    s_barrier
    s_waitcnt lgkmcnt(4)
    v_mfma_f32_16x16x32_bf16 v[144:147], v[48:51], v[32:35], v[144:147]
    ds_read_b64_tr_b16 v[64:65], v120 offset:4096
    v_mfma_f32_16x16x32_bf16 v[192:195], v[48:51], v[36:39], v[192:195]
    ds_read_b64_tr_b16 v[66:67], v120 offset:6144
    s_lshl_b32 s87, s78, 14
    s_add_u32 s87, s87, s66
    s_add_u32 s87, s87, 163840
    buffer_load_dwordx4 v[16:19], v246, s[24:27], s87 offen sc1
    buffer_load_dwordx4 v[20:23], v246, s[24:27], s87 offen offset:1024 sc1
    v_mfma_f32_16x16x32_bf16 v[148:151], v[52:55], v[32:35], v[148:151]
    ds_read_b64_tr_b16 v[68:69], v121 offset:4096
    v_mfma_f32_16x16x32_bf16 v[196:199], v[52:55], v[36:39], v[196:199]
    ds_read_b64_tr_b16 v[70:71], v121 offset:6144
    s_waitcnt lgkmcnt(4)
    v_mfma_f32_16x16x32_bf16 v[152:155], v[56:59], v[32:35], v[152:155]
    ds_read_b64_tr_b16 v[48:49], v122 offset:4096
    v_mfma_f32_16x16x32_bf16 v[200:203], v[56:59], v[36:39], v[200:203]
    ds_read_b64_tr_b16 v[50:51], v122 offset:6144
    v_mfma_f32_16x16x32_bf16 v[156:159], v[60:63], v[32:35], v[156:159]
    ds_read_b64_tr_b16 v[52:53], v123 offset:4096
    v_mfma_f32_16x16x32_bf16 v[204:207], v[60:63], v[36:39], v[204:207]
    ds_read_b64_tr_b16 v[54:55], v123 offset:6144
    s_mul_i32 s67, s79, 73728
    s_add_u32 s67, s67, s73
    s_add_u32 m0, s72, 73728
    s_add_u32 s67, s67, 1105920
    buffer_load_dwordx4 v254, s[8:11], s67 offen offset:0 lds
    s_waitcnt lgkmcnt(4)
    v_mfma_f32_16x16x32_bf16 v[160:163], v[64:67], v[32:35], v[160:163]
    ds_read_b64_tr_b16 v[56:57], v120 offset:8192
    v_mfma_f32_16x16x32_bf16 v[208:211], v[64:67], v[36:39], v[208:211]
    ds_read_b64_tr_b16 v[58:59], v120 offset:10240
    v_mfma_f32_16x16x32_bf16 v[164:167], v[68:71], v[32:35], v[164:167]
    ds_read_b64_tr_b16 v[60:61], v121 offset:8192
    v_mfma_f32_16x16x32_bf16 v[212:215], v[68:71], v[36:39], v[212:215]
    ds_read_b64_tr_b16 v[62:63], v121 offset:10240
    s_waitcnt lgkmcnt(4)
    v_mfma_f32_16x16x32_bf16 v[168:171], v[48:51], v[32:35], v[168:171]
    ds_read_b64_tr_b16 v[64:65], v122 offset:8192
    v_mfma_f32_16x16x32_bf16 v[216:219], v[48:51], v[36:39], v[216:219]
    ds_read_b64_tr_b16 v[66:67], v122 offset:10240
    s_mul_i32 s67, s79, 73728
    s_add_u32 s67, s67, s73
    s_add_u32 m0, s72, 77696
    s_add_u32 s67, s67, 1105920
    buffer_load_dwordx4 v254, s[8:11], s67 offen offset:128 lds
    v_mfma_f32_16x16x32_bf16 v[172:175], v[52:55], v[32:35], v[172:175]
    ds_read_b64_tr_b16 v[68:69], v123 offset:8192
    v_mfma_f32_16x16x32_bf16 v[220:223], v[52:55], v[36:39], v[220:223]
    ds_read_b64_tr_b16 v[70:71], v123 offset:10240
    s_waitcnt lgkmcnt(4)
    v_mfma_f32_16x16x32_bf16 v[176:179], v[56:59], v[32:35], v[176:179]
    ds_read_b64_tr_b16 v[48:49], v120 offset:24576
    v_mfma_f32_16x16x32_bf16 v[224:227], v[56:59], v[36:39], v[224:227]
    ds_read_b64_tr_b16 v[50:51], v120 offset:26624
    v_mfma_f32_16x16x32_bf16 v[180:183], v[60:63], v[32:35], v[180:183]
    ds_read_b64_tr_b16 v[52:53], v121 offset:24576
    v_mfma_f32_16x16x32_bf16 v[228:231], v[60:63], v[36:39], v[228:231]
    ds_read_b64_tr_b16 v[54:55], v121 offset:26624
    s_mul_i32 s67, s79, 73728
    s_add_u32 s67, s67, s73
    s_add_u32 m0, s72, 81664
    s_add_u32 s67, s67, 1105920
    buffer_load_dwordx4 v254, s[8:11], s67 offen offset:256 lds
    s_waitcnt lgkmcnt(4)
    v_mfma_f32_16x16x32_bf16 v[184:187], v[64:67], v[32:35], v[184:187]
    ds_read_b64_tr_b16 v[56:57], v122 offset:24576
    v_mfma_f32_16x16x32_bf16 v[232:235], v[64:67], v[36:39], v[232:235]
    ds_read_b64_tr_b16 v[58:59], v122 offset:26624
    v_mfma_f32_16x16x32_bf16 v[188:191], v[68:71], v[32:35], v[188:191]
    ds_read_b64_tr_b16 v[60:61], v123 offset:24576
    v_mfma_f32_16x16x32_bf16 v[236:239], v[68:71], v[36:39], v[236:239]
    ds_read_b64_tr_b16 v[62:63], v123 offset:26624
    s_waitcnt vmcnt(15)
    s_barrier
    s_waitcnt lgkmcnt(4)
    v_mfma_f32_16x16x32_bf16 v[144:147], v[48:51], v[40:43], v[144:147]
    ds_read_b64_tr_b16 v[64:65], v120 offset:28672
    v_mfma_f32_16x16x32_bf16 v[192:195], v[48:51], v[44:47], v[192:195]
    ds_read_b64_tr_b16 v[66:67], v120 offset:30720
    s_cmp_eq_u32 s3, 0
    s_cselect_b32 s38, s71, 1073741824
    buffer_load_dword v128, v130, s[24:27], s38 offen sc1
    v_mfma_f32_16x16x32_bf16 v[148:151], v[52:55], v[40:43], v[148:151]
    ds_read_b64_tr_b16 v[68:69], v121 offset:28672
    v_mfma_f32_16x16x32_bf16 v[196:199], v[52:55], v[44:47], v[196:199]
    ds_read_b64_tr_b16 v[70:71], v121 offset:30720
    s_waitcnt lgkmcnt(4)
    v_mfma_f32_16x16x32_bf16 v[152:155], v[56:59], v[40:43], v[152:155]
    ds_read_b64_tr_b16 v[48:49], v122 offset:28672
    v_mfma_f32_16x16x32_bf16 v[200:203], v[56:59], v[44:47], v[200:203]
    ds_read_b64_tr_b16 v[50:51], v122 offset:30720
    v_mfma_f32_16x16x32_bf16 v[156:159], v[60:63], v[40:43], v[156:159]
    ds_read_b64_tr_b16 v[52:53], v123 offset:28672
    v_mfma_f32_16x16x32_bf16 v[204:207], v[60:63], v[44:47], v[204:207]
    ds_read_b64_tr_b16 v[54:55], v123 offset:30720
    s_mul_i32 s67, s80, 73728
    s_add_u32 s67, s67, s73
    s_add_u32 m0, s72, 98304
    s_add_u32 s67, s67, 1105920
    buffer_load_dwordx4 v254, s[8:11], s67 offen offset:0 lds
    s_waitcnt lgkmcnt(4)
    v_mfma_f32_16x16x32_bf16 v[160:163], v[64:67], v[40:43], v[160:163]
    ds_read_b64_tr_b16 v[56:57], v120 offset:32768
    v_mfma_f32_16x16x32_bf16 v[208:211], v[64:67], v[44:47], v[208:211]
    ds_read_b64_tr_b16 v[58:59], v120 offset:34816
    v_mfma_f32_16x16x32_bf16 v[164:167], v[68:71], v[40:43], v[164:167]
    ds_read_b64_tr_b16 v[60:61], v121 offset:32768
    v_mfma_f32_16x16x32_bf16 v[212:215], v[68:71], v[44:47], v[212:215]
    ds_read_b64_tr_b16 v[62:63], v121 offset:34816
    s_waitcnt lgkmcnt(4)
    v_mfma_f32_16x16x32_bf16 v[168:171], v[48:51], v[40:43], v[168:171]
    ds_read_b64_tr_b16 v[64:65], v122 offset:32768
    v_mfma_f32_16x16x32_bf16 v[216:219], v[48:51], v[44:47], v[216:219]
    ds_read_b64_tr_b16 v[66:67], v122 offset:34816
    s_mul_i32 s67, s80, 73728
    s_add_u32 s67, s67, s73
    s_add_u32 m0, s72, 102272
    s_add_u32 s67, s67, 1105920
    buffer_load_dwordx4 v254, s[8:11], s67 offen offset:128 lds
    v_mfma_f32_16x16x32_bf16 v[172:175], v[52:55], v[40:43], v[172:175]
    ds_read_b64_tr_b16 v[68:69], v123 offset:32768
    v_mfma_f32_16x16x32_bf16 v[220:223], v[52:55], v[44:47], v[220:223]
    ds_read_b64_tr_b16 v[70:71], v123 offset:34816
    s_waitcnt lgkmcnt(4)
    v_mfma_f32_16x16x32_bf16 v[176:179], v[56:59], v[40:43], v[176:179]
    ds_read_b64_tr_b16 v[48:49], v112 offset:0
    v_mfma_f32_16x16x32_bf16 v[224:227], v[56:59], v[44:47], v[224:227]
    ds_read_b64_tr_b16 v[50:51], v112 offset:2048
    v_mfma_f32_16x16x32_bf16 v[180:183], v[60:63], v[40:43], v[180:183]
    ds_read_b64_tr_b16 v[52:53], v113 offset:0
    v_mfma_f32_16x16x32_bf16 v[228:231], v[60:63], v[44:47], v[228:231]
    ds_read_b64_tr_b16 v[54:55], v113 offset:2048
    s_mul_i32 s67, s80, 73728
    s_add_u32 s67, s67, s73
    s_add_u32 m0, s72, 106240
    s_add_u32 s67, s67, 1105920
    buffer_load_dwordx4 v254, s[8:11], s67 offen offset:256 lds
    s_waitcnt lgkmcnt(4)
    v_mfma_f32_16x16x32_bf16 v[184:187], v[64:67], v[40:43], v[184:187]
    ds_read_b64_tr_b16 v[56:57], v114 offset:0
    v_mfma_f32_16x16x32_bf16 v[232:235], v[64:67], v[44:47], v[232:235]
    ds_read_b64_tr_b16 v[58:59], v114 offset:2048
    v_mfma_f32_16x16x32_bf16 v[188:191], v[68:71], v[40:43], v[188:191]
    ds_read_b64_tr_b16 v[60:61], v115 offset:0
    v_mfma_f32_16x16x32_bf16 v[236:239], v[68:71], v[44:47], v[236:239]
    ds_read_b64_tr_b16 v[62:63], v115 offset:2048
    s_waitcnt vmcnt(14)
    s_barrier
    s_waitcnt lgkmcnt(4)
    v_mfma_f32_16x16x32_bf16 v[144:147], v[48:51], v[0:3], v[144:147]
    ds_read_b64_tr_b16 v[64:65], v112 offset:4096
    v_mfma_f32_16x16x32_bf16 v[192:195], v[48:51], v[4:7], v[192:195]
    ds_read_b64_tr_b16 v[66:67], v112 offset:6144
    s_mul_i32 s67, s81, 73728
    s_add_u32 s67, s67, s73
    s_add_u32 m0, s72, 122880
    s_add_u32 s67, s67, 1105920
    buffer_load_dwordx4 v254, s[8:11], s67 offen offset:0 lds
    v_mfma_f32_16x16x32_bf16 v[148:151], v[52:55], v[0:3], v[148:151]
    ds_read_b64_tr_b16 v[68:69], v113 offset:4096
    v_mfma_f32_16x16x32_bf16 v[196:199], v[52:55], v[4:7], v[196:199]
    ds_read_b64_tr_b16 v[70:71], v113 offset:6144
    s_waitcnt lgkmcnt(4)
    v_mfma_f32_16x16x32_bf16 v[152:155], v[56:59], v[0:3], v[152:155]
    ds_read_b64_tr_b16 v[48:49], v114 offset:4096
    v_mfma_f32_16x16x32_bf16 v[200:203], v[56:59], v[4:7], v[200:203]
    ds_read_b64_tr_b16 v[50:51], v114 offset:6144
    v_mfma_f32_16x16x32_bf16 v[156:159], v[60:63], v[0:3], v[156:159]
    ds_read_b64_tr_b16 v[52:53], v115 offset:4096
    v_mfma_f32_16x16x32_bf16 v[204:207], v[60:63], v[4:7], v[204:207]
    ds_read_b64_tr_b16 v[54:55], v115 offset:6144
    s_waitcnt lgkmcnt(4)
    v_mfma_f32_16x16x32_bf16 v[160:163], v[64:67], v[0:3], v[160:163]
    ds_read_b64_tr_b16 v[56:57], v112 offset:8192
    v_mfma_f32_16x16x32_bf16 v[208:211], v[64:67], v[4:7], v[208:211]
    ds_read_b64_tr_b16 v[58:59], v112 offset:10240
    s_mul_i32 s67, s81, 73728
    s_add_u32 s67, s67, s73
    s_add_u32 m0, s72, 126848
    s_add_u32 s67, s67, 1105920
    buffer_load_dwordx4 v254, s[8:11], s67 offen offset:128 lds
    v_mfma_f32_16x16x32_bf16 v[164:167], v[68:71], v[0:3], v[164:167]
    ds_read_b64_tr_b16 v[60:61], v113 offset:8192
    v_mfma_f32_16x16x32_bf16 v[212:215], v[68:71], v[4:7], v[212:215]
    ds_read_b64_tr_b16 v[62:63], v113 offset:10240
    s_waitcnt lgkmcnt(4)
    v_mfma_f32_16x16x32_bf16 v[168:171], v[48:51], v[0:3], v[168:171]
    ds_read_b64_tr_b16 v[64:65], v114 offset:8192
    v_mfma_f32_16x16x32_bf16 v[216:219], v[48:51], v[4:7], v[216:219]
    ds_read_b64_tr_b16 v[66:67], v114 offset:10240
    v_mfma_f32_16x16x32_bf16 v[172:175], v[52:55], v[0:3], v[172:175]
    ds_read_b64_tr_b16 v[68:69], v115 offset:8192
    v_mfma_f32_16x16x32_bf16 v[220:223], v[52:55], v[4:7], v[220:223]
    ds_read_b64_tr_b16 v[70:71], v115 offset:10240
    s_waitcnt lgkmcnt(4)
    v_mfma_f32_16x16x32_bf16 v[176:179], v[56:59], v[0:3], v[176:179]
    ds_read_b64_tr_b16 v[48:49], v112 offset:24576
    v_mfma_f32_16x16x32_bf16 v[224:227], v[56:59], v[4:7], v[224:227]
    ds_read_b64_tr_b16 v[50:51], v112 offset:26624
    s_mul_i32 s67, s81, 73728
    s_add_u32 s67, s67, s73
    s_add_u32 m0, s72, 130816
    s_add_u32 s67, s67, 1105920
    buffer_load_dwordx4 v254, s[8:11], s67 offen offset:256 lds
    v_mfma_f32_16x16x32_bf16 v[180:183], v[60:63], v[0:3], v[180:183]
    ds_read_b64_tr_b16 v[52:53], v113 offset:24576
    v_mfma_f32_16x16x32_bf16 v[228:231], v[60:63], v[4:7], v[228:231]
    ds_read_b64_tr_b16 v[54:55], v113 offset:26624
    s_waitcnt lgkmcnt(4)
    v_mfma_f32_16x16x32_bf16 v[184:187], v[64:67], v[0:3], v[184:187]
    ds_read_b64_tr_b16 v[56:57], v114 offset:24576
    v_mfma_f32_16x16x32_bf16 v[232:235], v[64:67], v[4:7], v[232:235]
    ds_read_b64_tr_b16 v[58:59], v114 offset:26624
    v_mfma_f32_16x16x32_bf16 v[188:191], v[68:71], v[0:3], v[188:191]
    ds_read_b64_tr_b16 v[60:61], v115 offset:24576
    v_mfma_f32_16x16x32_bf16 v[236:239], v[68:71], v[4:7], v[236:239]
    ds_read_b64_tr_b16 v[62:63], v115 offset:26624
    s_waitcnt vmcnt(12)
    s_waitcnt vmcnt(6)
    s_cmp_lg_u32 s3, 0
    s_cbranch_scc1 L_fc7
    s_mov_b32 s93, 0
L_fl7:
    v_cmp_ne_u32 vcc, s96, v128
    s_cbranch_vccz L_fc7
    s_add_u32 s93, s93, 1
    s_cmp_gt_u32 s93, 60000
    s_cbranch_scc1 L_fc7
    s_sleep 4
    buffer_load_dword v128, v130, s[24:27], s71 offen sc1
    s_waitcnt vmcnt(0)
    s_branch L_fl7
L_fc7:
    s_barrier
    s_waitcnt lgkmcnt(4)
    v_mfma_f32_16x16x32_bf16 v[144:147], v[48:51], v[8:11], v[144:147]
    ds_read_b64_tr_b16 v[64:65], v112 offset:28672
    s_load_dwordx2 s[12:13], s[0:1], 0
    s_load_dwordx2 s[16:17], s[0:1], 64
    s_load_dwordx2 s[20:21], s[0:1], 104
    v_add_u32_e64 v99, 0, v125
    v_mfma_f32_16x16x32_bf16 v[192:195], v[48:51], v[12:15], v[192:195]
    ds_read_b64_tr_b16 v[66:67], v112 offset:30720
    s_lshl_b32 s87, s79, 14
    s_add_u32 s87, s87, s66
    s_add_u32 s87, s87, 245760
    buffer_load_dwordx4 v[24:27], v246, s[24:27], s87 offen sc1
    buffer_load_dwordx4 v[28:31], v246, s[24:27], s87 offen offset:1024 sc1
    v_mul_u32_u24 v104, 1366, v99
    v_mfma_f32_16x16x32_bf16 v[148:151], v[52:55], v[8:11], v[148:151]
    ds_read_b64_tr_b16 v[68:69], v113 offset:28672
    v_lshrrev_b32 v104, 16, v104
    v_mul_u32_u24 v100, 48, v104
    v_mfma_f32_16x16x32_bf16 v[196:199], v[52:55], v[12:15], v[196:199]
    ds_read_b64_tr_b16 v[70:71], v113 offset:30720
    v_sub_u32 v108, v99, v100
    s_waitcnt lgkmcnt(4)
    v_mfma_f32_16x16x32_bf16 v[152:155], v[56:59], v[8:11], v[152:155]
    ds_read_b64_tr_b16 v[48:49], v114 offset:28672
    v_lshl_add_u32 v104, s3, 2, v104
    v_lshlrev_b32_e64 v101, 3, v108
    v_mfma_f32_16x16x32_bf16 v[200:203], v[56:59], v[12:15], v[200:203]
    ds_read_b64_tr_b16 v[50:51], v114 offset:30720
    v_mul_u32_u24 v96, 1152, v104
    v_mfma_f32_16x16x32_bf16 v[156:159], v[60:63], v[8:11], v[156:159]
    ds_read_b64_tr_b16 v[52:53], v115 offset:28672
    v_add_u32_e64 v96, v96, v101
    v_mfma_f32_16x16x32_bf16 v[204:207], v[60:63], v[12:15], v[204:207]
    ds_read_b64_tr_b16 v[54:55], v115 offset:30720
    v_add_u32_e64 v99, 64, v125
    v_mul_u32_u24 v105, 1366, v99
    s_waitcnt lgkmcnt(4)
    v_mfma_f32_16x16x32_bf16 v[160:163], v[64:67], v[8:11], v[160:163]
    ds_read_b64_tr_b16 v[56:57], v112 offset:32768
    v_lshrrev_b32 v105, 16, v105
    v_mfma_f32_16x16x32_bf16 v[208:211], v[64:67], v[12:15], v[208:211]
    ds_read_b64_tr_b16 v[58:59], v112 offset:34816
    s_lshl_b32 s87, s80, 14
    s_add_u32 s87, s87, s66
    s_add_u32 s87, s87, 245760
    buffer_load_dwordx4 v[32:35], v246, s[24:27], s87 offen sc1
    buffer_load_dwordx4 v[36:39], v246, s[24:27], s87 offen offset:1024 sc1
    v_mul_u32_u24_e64 v100, 48, v105
    v_mfma_f32_16x16x32_bf16 v[164:167], v[68:71], v[8:11], v[164:167]
    ds_read_b64_tr_b16 v[60:61], v113 offset:32768
    v_sub_u32_e64 v109, v99, v100
    v_lshl_add_u32 v105, s3, 2, v105
    v_mfma_f32_16x16x32_bf16 v[212:215], v[68:71], v[12:15], v[212:215]
    ds_read_b64_tr_b16 v[62:63], v113 offset:34816
    v_lshlrev_b32 v102, 3, v109
    s_waitcnt lgkmcnt(4)
    v_mfma_f32_16x16x32_bf16 v[168:171], v[48:51], v[8:11], v[168:171]
    ds_read_b64_tr_b16 v[64:65], v114 offset:32768
    v_mul_u32_u24 v97, 1152, v105
    v_mfma_f32_16x16x32_bf16 v[216:219], v[48:51], v[12:15], v[216:219]
    ds_read_b64_tr_b16 v[66:67], v114 offset:34816
    v_add_u32_e64 v97, v97, v102
    v_add_u32 v99, 128, v125
    v_mfma_f32_16x16x32_bf16 v[172:175], v[52:55], v[8:11], v[172:175]
    ds_read_b64_tr_b16 v[68:69], v115 offset:32768
    v_mul_u32_u24 v106, 1366, v99
    v_mfma_f32_16x16x32_bf16 v[220:223], v[52:55], v[12:15], v[220:223]
    ds_read_b64_tr_b16 v[70:71], v115 offset:34816
    v_lshrrev_b32 v106, 16, v106
    v_mul_u32_u24_e64 v100, 48, v106
    s_waitcnt lgkmcnt(4)
    v_mfma_f32_16x16x32_bf16 v[176:179], v[56:59], v[8:11], v[176:179]
    ds_read_b64_tr_b16 v[48:49], v116 offset:0
    v_sub_u32_e64 v110, v99, v100
    v_mfma_f32_16x16x32_bf16 v[224:227], v[56:59], v[12:15], v[224:227]
    ds_read_b64_tr_b16 v[50:51], v116 offset:2048
    s_lshl_b32 s87, s81, 14
    s_add_u32 s87, s87, s66
    s_add_u32 s87, s87, 245760
    buffer_load_dwordx4 v[40:43], v246, s[24:27], s87 offen sc1
    buffer_load_dwordx4 v[44:47], v246, s[24:27], s87 offen offset:1024 sc1
    v_lshl_add_u32 v106, s3, 2, v106
    v_mfma_f32_16x16x32_bf16 v[180:183], v[60:63], v[8:11], v[180:183]
    ds_read_b64_tr_b16 v[52:53], v117 offset:0
    v_lshlrev_b32_e64 v103, 3, v110
    v_mul_u32_u24 v98, 1152, v106
    v_mfma_f32_16x16x32_bf16 v[228:231], v[60:63], v[12:15], v[228:231]
    ds_read_b64_tr_b16 v[54:55], v117 offset:2048
    v_add_u32 v98, v98, v103
    s_waitcnt lgkmcnt(4)
    v_mfma_f32_16x16x32_bf16 v[184:187], v[64:67], v[8:11], v[184:187]
    ds_read_b64_tr_b16 v[56:57], v118 offset:0
    s_mul_i32 s40, s89, 384
    s_lshl_b32 s41, s6, 7
    s_lshl_b32 s42, s7, 5
    s_add_u32 s41, s41, s42
    s_mul_i32 s41, s41, 1152
    s_add_u32 s41, s41, s40
    s_lshl_b32 s43, s41, 1
    s_waitcnt lgkmcnt(0)
    s_mov_b32 s14, 2359296
    s_mov_b32 s15, 0x20000
    s_movk_i32 s18, 1152
    s_mov_b32 s19, 0x20000
    s_mov_b32 s22, 4718592
    s_mov_b32 s23, 0x20000
    s_lshl_b32 s42, s7, 7
    s_add_u32 s42, s42, 162816
    buffer_load_dwordx2 v[84:85], v96, s[12:15], s41 offen
    buffer_load_dwordx2 v[90:91], v101, s[16:19], s40 offen
    buffer_load_dwordx2 v[86:87], v97, s[12:15], s41 offen
    buffer_load_dwordx2 v[92:93], v102, s[16:19], s40 offen
    buffer_load_dwordx2 v[88:89], v98, s[12:15], s41 offen
    buffer_load_dwordx2 v[94:95], v103, s[16:19], s40 offen
    v_mfma_f32_16x16x32_bf16 v[232:235], v[64:67], v[12:15], v[232:235]
    ds_read_b64_tr_b16 v[58:59], v118 offset:2048
    v_lshl_add_u32 v99, v104, 2, s42
    ds_read_b32 v240, v99 offset:512
    ds_read_b32 v241, v99
    v_mfma_f32_16x16x32_bf16 v[188:191], v[68:71], v[8:11], v[188:191]
    ds_read_b64_tr_b16 v[60:61], v119 offset:0
    v_lshl_add_u32 v99, v105, 2, s42
    ds_read_b32 v242, v99 offset:512
    ds_read_b32 v243, v99
    v_mfma_f32_16x16x32_bf16 v[236:239], v[68:71], v[12:15], v[236:239]
    ds_read_b64_tr_b16 v[62:63], v119 offset:2048
    v_lshl_add_u32 v99, v106, 2, s42
    ds_read_b32 v244, v99 offset:512
    ds_read_b32 v245, v99
    s_barrier
    s_waitcnt lgkmcnt(10)
    v_mfma_f32_16x16x32_bf16 v[144:147], v[48:51], v[16:19], v[144:147]
    ds_read_b64_tr_b16 v[64:65], v116 offset:4096
    v_mfma_f32_16x16x32_bf16 v[192:195], v[48:51], v[20:23], v[192:195]
    ds_read_b64_tr_b16 v[66:67], v116 offset:6144
    v_mfma_f32_16x16x32_bf16 v[148:151], v[52:55], v[16:19], v[148:151]
    ds_read_b64_tr_b16 v[68:69], v117 offset:4096
    v_mfma_f32_16x16x32_bf16 v[196:199], v[52:55], v[20:23], v[196:199]
    ds_read_b64_tr_b16 v[70:71], v117 offset:6144
    s_waitcnt lgkmcnt(6)
    v_mfma_f32_16x16x32_bf16 v[152:155], v[56:59], v[16:19], v[152:155]
    ds_read_b64_tr_b16 v[48:49], v118 offset:4096
    v_mfma_f32_16x16x32_bf16 v[200:203], v[56:59], v[20:23], v[200:203]
    ds_read_b64_tr_b16 v[50:51], v118 offset:6144
    v_mfma_f32_16x16x32_bf16 v[156:159], v[60:63], v[16:19], v[156:159]
    ds_read_b64_tr_b16 v[52:53], v119 offset:4096
    v_mfma_f32_16x16x32_bf16 v[204:207], v[60:63], v[20:23], v[204:207]
    ds_read_b64_tr_b16 v[54:55], v119 offset:6144
    s_waitcnt lgkmcnt(4)
    v_mfma_f32_16x16x32_bf16 v[160:163], v[64:67], v[16:19], v[160:163]
    ds_read_b64_tr_b16 v[56:57], v116 offset:8192
    v_mfma_f32_16x16x32_bf16 v[208:211], v[64:67], v[20:23], v[208:211]
    ds_read_b64_tr_b16 v[58:59], v116 offset:10240
    v_mfma_f32_16x16x32_bf16 v[164:167], v[68:71], v[16:19], v[164:167]
    ds_read_b64_tr_b16 v[60:61], v117 offset:8192
    v_mfma_f32_16x16x32_bf16 v[212:215], v[68:71], v[20:23], v[212:215]
    ds_read_b64_tr_b16 v[62:63], v117 offset:10240
    s_waitcnt lgkmcnt(4)
    v_mfma_f32_16x16x32_bf16 v[168:171], v[48:51], v[16:19], v[168:171]
    ds_read_b64_tr_b16 v[64:65], v118 offset:8192
    v_mfma_f32_16x16x32_bf16 v[216:219], v[48:51], v[20:23], v[216:219]
    ds_read_b64_tr_b16 v[66:67], v118 offset:10240
    v_mfma_f32_16x16x32_bf16 v[172:175], v[52:55], v[16:19], v[172:175]
    ds_read_b64_tr_b16 v[68:69], v119 offset:8192
    v_mfma_f32_16x16x32_bf16 v[220:223], v[52:55], v[20:23], v[220:223]
    ds_read_b64_tr_b16 v[70:71], v119 offset:10240
    s_waitcnt lgkmcnt(4)
    v_mfma_f32_16x16x32_bf16 v[176:179], v[56:59], v[16:19], v[176:179]
    ds_read_b64_tr_b16 v[48:49], v116 offset:24576
    v_mfma_f32_16x16x32_bf16 v[224:227], v[56:59], v[20:23], v[224:227]
    ds_read_b64_tr_b16 v[50:51], v116 offset:26624
    v_mfma_f32_16x16x32_bf16 v[180:183], v[60:63], v[16:19], v[180:183]
    ds_read_b64_tr_b16 v[52:53], v117 offset:24576
    v_mfma_f32_16x16x32_bf16 v[228:231], v[60:63], v[20:23], v[228:231]
    ds_read_b64_tr_b16 v[54:55], v117 offset:26624
    s_waitcnt lgkmcnt(4)
    v_mfma_f32_16x16x32_bf16 v[184:187], v[64:67], v[16:19], v[184:187]
    ds_read_b64_tr_b16 v[56:57], v118 offset:24576
    v_mfma_f32_16x16x32_bf16 v[232:235], v[64:67], v[20:23], v[232:235]
    ds_read_b64_tr_b16 v[58:59], v118 offset:26624
    v_mfma_f32_16x16x32_bf16 v[188:191], v[68:71], v[16:19], v[188:191]
    ds_read_b64_tr_b16 v[60:61], v119 offset:24576
    v_mfma_f32_16x16x32_bf16 v[236:239], v[68:71], v[20:23], v[236:239]
    ds_read_b64_tr_b16 v[62:63], v119 offset:26624
    s_waitcnt vmcnt(10)
    s_barrier
    s_waitcnt lgkmcnt(4)
    v_mfma_f32_16x16x32_bf16 v[144:147], v[48:51], v[24:27], v[144:147]
    ds_read_b64_tr_b16 v[64:65], v116 offset:28672
    s_waitcnt vmcnt(0)
    v_lshlrev_b32 v72, 16, v84
    v_and_b32 v73, 0xffff0000, v84
    v_mfma_f32_16x16x32_bf16 v[192:195], v[48:51], v[28:31], v[192:195]
    ds_read_b64_tr_b16 v[66:67], v116 offset:30720
    v_lshlrev_b32_e64 v74, 16, v85
    v_and_b32 v75, 0xffff0000, v85
    v_mfma_f32_16x16x32_bf16 v[148:151], v[52:55], v[24:27], v[148:151]
    ds_read_b64_tr_b16 v[68:69], v117 offset:28672
    v_lshlrev_b32_e64 v136, 16, v90
    v_and_b32 v137, 0xffff0000, v90
    v_mfma_f32_16x16x32_bf16 v[196:199], v[52:55], v[28:31], v[196:199]
    ds_read_b64_tr_b16 v[70:71], v117 offset:30720
    v_lshlrev_b32_e64 v138, 16, v91
    v_and_b32 v139, 0xffff0000, v91
    s_waitcnt lgkmcnt(4)
    v_mfma_f32_16x16x32_bf16 v[152:155], v[56:59], v[24:27], v[152:155]
    ds_read_b64_tr_b16 v[48:49], v118 offset:28672
    v_sub_f32 v132, v72, v240
    v_sub_f32_e64 v133, v73, v240
    v_mfma_f32_16x16x32_bf16 v[200:203], v[56:59], v[28:31], v[200:203]
    ds_read_b64_tr_b16 v[50:51], v118 offset:30720
    v_sub_f32 v134, v74, v240
    v_sub_f32 v135, v75, v240
    v_mfma_f32_16x16x32_bf16 v[156:159], v[60:63], v[24:27], v[156:159]
    ds_read_b64_tr_b16 v[52:53], v119 offset:28672
    v_cvt_pk_bf16_f32 v132, v132, v133
    v_cvt_pk_bf16_f32 v134, v134, v135
    v_mfma_f32_16x16x32_bf16 v[204:207], v[60:63], v[28:31], v[204:207]
    ds_read_b64_tr_b16 v[54:55], v119 offset:30720
    v_and_b32 v133, 0xffff0000, v132
    v_lshlrev_b32 v132, 16, v132
    s_waitcnt lgkmcnt(4)
    v_mfma_f32_16x16x32_bf16 v[160:163], v[64:67], v[24:27], v[160:163]
    ds_read_b64_tr_b16 v[56:57], v116 offset:32768
    v_and_b32 v135, 0xffff0000, v134
    v_lshlrev_b32_e64 v134, 16, v134
    v_mfma_f32_16x16x32_bf16 v[208:211], v[64:67], v[28:31], v[208:211]
    ds_read_b64_tr_b16 v[58:59], v116 offset:34816
    v_mul_f32 v132, v132, v241
    v_mul_f32 v133, v133, v241
    v_mfma_f32_16x16x32_bf16 v[164:167], v[68:71], v[24:27], v[164:167]
    ds_read_b64_tr_b16 v[60:61], v117 offset:32768
    v_mul_f32_e64 v134, v134, v241
    v_mfma_f32_16x16x32_bf16 v[212:215], v[68:71], v[28:31], v[212:215]
    ds_read_b64_tr_b16 v[62:63], v117 offset:34816
    v_mul_f32_e64 v135, v135, v241
    v_cvt_pk_bf16_f32 v132, v132, v133
    s_waitcnt lgkmcnt(4)
    v_mfma_f32_16x16x32_bf16 v[168:171], v[48:51], v[24:27], v[168:171]
    ds_read_b64_tr_b16 v[64:65], v118 offset:32768
    v_cvt_pk_bf16_f32 v134, v134, v135
    v_and_b32 v133, 0xffff0000, v132
    v_mfma_f32_16x16x32_bf16 v[216:219], v[48:51], v[28:31], v[216:219]
    ds_read_b64_tr_b16 v[66:67], v118 offset:34816
    v_lshlrev_b32 v132, 16, v132
    v_and_b32 v135, 0xffff0000, v134
    v_mfma_f32_16x16x32_bf16 v[172:175], v[52:55], v[24:27], v[172:175]
    ds_read_b64_tr_b16 v[68:69], v119 offset:32768
    v_lshlrev_b32 v134, 16, v134
    v_mul_f32 v132, v132, v136
    v_mfma_f32_16x16x32_bf16 v[220:223], v[52:55], v[28:31], v[220:223]
    ds_read_b64_tr_b16 v[70:71], v119 offset:34816
    v_mul_f32 v133, v133, v137
    v_mul_f32_e64 v134, v134, v138
    s_waitcnt lgkmcnt(4)
    v_mfma_f32_16x16x32_bf16 v[176:179], v[56:59], v[24:27], v[176:179]
    ds_read_b64_tr_b16 v[48:49], v120 offset:0
    v_mul_f32_e64 v135, v135, v139
    v_cvt_pk_bf16_f32 v132, v132, v133
    v_mfma_f32_16x16x32_bf16 v[224:227], v[56:59], v[28:31], v[224:227]
    ds_read_b64_tr_b16 v[50:51], v120 offset:2048
    v_cvt_pk_bf16_f32 v134, v134, v135
    v_and_b32 v133, 0xffff0000, v132
    v_mfma_f32_16x16x32_bf16 v[180:183], v[60:63], v[24:27], v[180:183]
    ds_read_b64_tr_b16 v[52:53], v121 offset:0
    v_lshlrev_b32_e64 v132, 16, v132
    v_and_b32 v135, 0xffff0000, v134
    v_mfma_f32_16x16x32_bf16 v[228:231], v[60:63], v[28:31], v[228:231]
    ds_read_b64_tr_b16 v[54:55], v121 offset:2048
    v_lshlrev_b32 v134, 16, v134
    v_add_f32_e64 v72, v72, v132
    s_waitcnt lgkmcnt(4)
    v_mfma_f32_16x16x32_bf16 v[184:187], v[64:67], v[24:27], v[184:187]
    ds_read_b64_tr_b16 v[56:57], v122 offset:0
    v_add_f32 v73, v73, v133
    v_add_f32 v74, v74, v134
    v_mfma_f32_16x16x32_bf16 v[232:235], v[64:67], v[28:31], v[232:235]
    ds_read_b64_tr_b16 v[58:59], v122 offset:2048
    v_add_f32 v75, v75, v135
    v_lshlrev_b32 v76, 16, v86
    v_mfma_f32_16x16x32_bf16 v[188:191], v[68:71], v[24:27], v[188:191]
    ds_read_b64_tr_b16 v[60:61], v123 offset:0
    v_and_b32 v77, 0xffff0000, v86
    v_lshlrev_b32_e64 v78, 16, v87
    v_mfma_f32_16x16x32_bf16 v[236:239], v[68:71], v[28:31], v[236:239]
    ds_read_b64_tr_b16 v[62:63], v123 offset:2048
    v_and_b32 v79, 0xffff0000, v87
    v_lshlrev_b32_e64 v136, 16, v92
    s_barrier
    s_waitcnt lgkmcnt(4)
    v_mfma_f32_16x16x32_bf16 v[144:147], v[48:51], v[32:35], v[144:147]
    ds_read_b64_tr_b16 v[64:65], v120 offset:4096
    v_and_b32 v137, 0xffff0000, v92
    v_lshlrev_b32_e64 v138, 16, v93
    v_mfma_f32_16x16x32_bf16 v[192:195], v[48:51], v[36:39], v[192:195]
    ds_read_b64_tr_b16 v[66:67], v120 offset:6144
    v_and_b32 v139, 0xffff0000, v93
    v_sub_f32_e64 v132, v76, v242
    v_mfma_f32_16x16x32_bf16 v[148:151], v[52:55], v[32:35], v[148:151]
    ds_read_b64_tr_b16 v[68:69], v121 offset:4096
    v_sub_f32 v133, v77, v242
    v_sub_f32 v134, v78, v242
    v_mfma_f32_16x16x32_bf16 v[196:199], v[52:55], v[36:39], v[196:199]
    ds_read_b64_tr_b16 v[70:71], v121 offset:6144
    v_sub_f32_e64 v135, v79, v242
    v_cvt_pk_bf16_f32 v132, v132, v133
    s_waitcnt lgkmcnt(4)
    v_mfma_f32_16x16x32_bf16 v[152:155], v[56:59], v[32:35], v[152:155]
    ds_read_b64_tr_b16 v[48:49], v122 offset:4096
    v_cvt_pk_bf16_f32 v134, v134, v135
    v_and_b32 v133, 0xffff0000, v132
    v_mfma_f32_16x16x32_bf16 v[200:203], v[56:59], v[36:39], v[200:203]
    ds_read_b64_tr_b16 v[50:51], v122 offset:6144
    v_lshlrev_b32 v132, 16, v132
    v_and_b32 v135, 0xffff0000, v134
    v_mfma_f32_16x16x32_bf16 v[156:159], v[60:63], v[32:35], v[156:159]
    ds_read_b64_tr_b16 v[52:53], v123 offset:4096
    v_lshlrev_b32 v134, 16, v134
    v_mul_f32 v132, v132, v243
    v_mfma_f32_16x16x32_bf16 v[204:207], v[60:63], v[36:39], v[204:207]
    ds_read_b64_tr_b16 v[54:55], v123 offset:6144
    v_mul_f32 v133, v133, v243
    v_mul_f32_e64 v134, v134, v243
    s_waitcnt lgkmcnt(4)
    v_mfma_f32_16x16x32_bf16 v[160:163], v[64:67], v[32:35], v[160:163]
    ds_read_b64_tr_b16 v[56:57], v120 offset:8192
    v_mul_f32_e64 v135, v135, v243
    v_cvt_pk_bf16_f32 v132, v132, v133
    v_mfma_f32_16x16x32_bf16 v[208:211], v[64:67], v[36:39], v[208:211]
    ds_read_b64_tr_b16 v[58:59], v120 offset:10240
    v_cvt_pk_bf16_f32 v134, v134, v135
    v_and_b32 v133, 0xffff0000, v132
    v_mfma_f32_16x16x32_bf16 v[164:167], v[68:71], v[32:35], v[164:167]
    ds_read_b64_tr_b16 v[60:61], v121 offset:8192
    v_lshlrev_b32_e64 v132, 16, v132
    v_and_b32 v135, 0xffff0000, v134
    v_mfma_f32_16x16x32_bf16 v[212:215], v[68:71], v[36:39], v[212:215]
    ds_read_b64_tr_b16 v[62:63], v121 offset:10240
    v_lshlrev_b32 v134, 16, v134
    v_mul_f32_e64 v132, v132, v136
    s_waitcnt lgkmcnt(4)
    v_mfma_f32_16x16x32_bf16 v[168:171], v[48:51], v[32:35], v[168:171]
    ds_read_b64_tr_b16 v[64:65], v122 offset:8192
    v_mul_f32 v133, v133, v137
    v_mul_f32 v134, v134, v138
    v_mfma_f32_16x16x32_bf16 v[216:219], v[48:51], v[36:39], v[216:219]
    ds_read_b64_tr_b16 v[66:67], v122 offset:10240
    v_mul_f32_e64 v135, v135, v139
    v_cvt_pk_bf16_f32 v132, v132, v133
    v_mfma_f32_16x16x32_bf16 v[172:175], v[52:55], v[32:35], v[172:175]
    ds_read_b64_tr_b16 v[68:69], v123 offset:8192
    v_cvt_pk_bf16_f32 v134, v134, v135
    v_and_b32 v133, 0xffff0000, v132
    v_mfma_f32_16x16x32_bf16 v[220:223], v[52:55], v[36:39], v[220:223]
    ds_read_b64_tr_b16 v[70:71], v123 offset:10240
    v_lshlrev_b32_e64 v132, 16, v132
    v_and_b32 v135, 0xffff0000, v134
    s_waitcnt lgkmcnt(4)
    v_mfma_f32_16x16x32_bf16 v[176:179], v[56:59], v[32:35], v[176:179]
    ds_read_b64_tr_b16 v[48:49], v120 offset:24576
    v_lshlrev_b32 v134, 16, v134
    v_add_f32_e64 v76, v76, v132
    v_mfma_f32_16x16x32_bf16 v[224:227], v[56:59], v[36:39], v[224:227]
    ds_read_b64_tr_b16 v[50:51], v120 offset:26624
    v_add_f32 v77, v77, v133
    v_add_f32 v78, v78, v134
    v_mfma_f32_16x16x32_bf16 v[180:183], v[60:63], v[32:35], v[180:183]
    ds_read_b64_tr_b16 v[52:53], v121 offset:24576
    v_add_f32 v79, v79, v135
    v_lshlrev_b32 v80, 16, v88
    v_mfma_f32_16x16x32_bf16 v[228:231], v[60:63], v[36:39], v[228:231]
    ds_read_b64_tr_b16 v[54:55], v121 offset:26624
    v_and_b32 v81, 0xffff0000, v88
    v_lshlrev_b32 v82, 16, v89
    s_waitcnt lgkmcnt(4)
    v_mfma_f32_16x16x32_bf16 v[184:187], v[64:67], v[32:35], v[184:187]
    ds_read_b64_tr_b16 v[56:57], v122 offset:24576
    v_and_b32 v83, 0xffff0000, v89
    v_lshlrev_b32_e64 v136, 16, v94
    v_mfma_f32_16x16x32_bf16 v[232:235], v[64:67], v[36:39], v[232:235]
    ds_read_b64_tr_b16 v[58:59], v122 offset:26624
    v_and_b32 v137, 0xffff0000, v94
    v_lshlrev_b32_e64 v138, 16, v95
    v_mfma_f32_16x16x32_bf16 v[188:191], v[68:71], v[32:35], v[188:191]
    ds_read_b64_tr_b16 v[60:61], v123 offset:24576
    v_and_b32 v139, 0xffff0000, v95
    v_sub_f32_e64 v132, v80, v244
    v_mfma_f32_16x16x32_bf16 v[236:239], v[68:71], v[36:39], v[236:239]
    ds_read_b64_tr_b16 v[62:63], v123 offset:26624
    v_sub_f32 v133, v81, v244
    v_sub_f32 v134, v82, v244
    s_barrier
    s_waitcnt lgkmcnt(4)
    v_mfma_f32_16x16x32_bf16 v[144:147], v[48:51], v[40:43], v[144:147]
    ds_read_b64_tr_b16 v[64:65], v120 offset:28672
    v_sub_f32_e64 v135, v83, v244
    v_cvt_pk_bf16_f32 v132, v132, v133
    v_mfma_f32_16x16x32_bf16 v[192:195], v[48:51], v[44:47], v[192:195]
    ds_read_b64_tr_b16 v[66:67], v120 offset:30720
    v_cvt_pk_bf16_f32 v134, v134, v135
    v_and_b32 v133, 0xffff0000, v132
    v_mfma_f32_16x16x32_bf16 v[148:151], v[52:55], v[40:43], v[148:151]
    ds_read_b64_tr_b16 v[68:69], v121 offset:28672
    v_lshlrev_b32_e64 v132, 16, v132
    v_and_b32 v135, 0xffff0000, v134
    v_mfma_f32_16x16x32_bf16 v[196:199], v[52:55], v[44:47], v[196:199]
    ds_read_b64_tr_b16 v[70:71], v121 offset:30720
    v_lshlrev_b32 v134, 16, v134
    s_waitcnt lgkmcnt(4)
    v_mfma_f32_16x16x32_bf16 v[152:155], v[56:59], v[40:43], v[152:155]
    ds_read_b64_tr_b16 v[48:49], v122 offset:28672
    v_mul_f32 v132, v132, v245
    v_mul_f32 v133, v133, v245
    v_mfma_f32_16x16x32_bf16 v[200:203], v[56:59], v[44:47], v[200:203]
    ds_read_b64_tr_b16 v[50:51], v122 offset:30720
    v_mul_f32 v134, v134, v245
    v_mul_f32 v135, v135, v245
    v_mfma_f32_16x16x32_bf16 v[156:159], v[60:63], v[40:43], v[156:159]
    ds_read_b64_tr_b16 v[52:53], v123 offset:28672
    v_cvt_pk_bf16_f32 v132, v132, v133
    v_cvt_pk_bf16_f32 v134, v134, v135
    v_mfma_f32_16x16x32_bf16 v[204:207], v[60:63], v[44:47], v[204:207]
    ds_read_b64_tr_b16 v[54:55], v123 offset:30720
    v_and_b32 v133, 0xffff0000, v132
    v_lshlrev_b32 v132, 16, v132
    s_waitcnt lgkmcnt(4)
    v_mfma_f32_16x16x32_bf16 v[160:163], v[64:67], v[40:43], v[160:163]
    ds_read_b64_tr_b16 v[56:57], v120 offset:32768
    v_and_b32 v135, 0xffff0000, v134
    v_lshlrev_b32_e64 v134, 16, v134
    v_mfma_f32_16x16x32_bf16 v[208:211], v[64:67], v[44:47], v[208:211]
    ds_read_b64_tr_b16 v[58:59], v120 offset:34816
    v_mul_f32 v132, v132, v136
    v_mul_f32 v133, v133, v137
    v_mfma_f32_16x16x32_bf16 v[164:167], v[68:71], v[40:43], v[164:167]
    ds_read_b64_tr_b16 v[60:61], v121 offset:32768
    v_mul_f32 v134, v134, v138
    v_mul_f32 v135, v135, v139
    v_mfma_f32_16x16x32_bf16 v[212:215], v[68:71], v[44:47], v[212:215]
    ds_read_b64_tr_b16 v[62:63], v121 offset:34816
    v_cvt_pk_bf16_f32 v132, v132, v133
    v_cvt_pk_bf16_f32 v134, v134, v135
    s_waitcnt lgkmcnt(4)
    v_mfma_f32_16x16x32_bf16 v[168:171], v[48:51], v[40:43], v[168:171]
    ds_read_b64_tr_b16 v[64:65], v122 offset:32768
    v_and_b32 v133, 0xffff0000, v132
    v_lshlrev_b32 v132, 16, v132
    v_mfma_f32_16x16x32_bf16 v[216:219], v[48:51], v[44:47], v[216:219]
    ds_read_b64_tr_b16 v[66:67], v122 offset:34816
    v_and_b32 v135, 0xffff0000, v134
    v_lshlrev_b32_e64 v134, 16, v134
    v_mfma_f32_16x16x32_bf16 v[172:175], v[52:55], v[40:43], v[172:175]
    ds_read_b64_tr_b16 v[68:69], v123 offset:32768
    v_add_f32 v80, v80, v132
    v_add_f32 v81, v81, v133
    v_mfma_f32_16x16x32_bf16 v[220:223], v[52:55], v[44:47], v[220:223]
    ds_read_b64_tr_b16 v[70:71], v123 offset:34816
    v_add_f32 v82, v82, v134
    v_add_f32_e64 v83, v83, v135
    s_waitcnt lgkmcnt(4)
    v_mfma_f32_16x16x32_bf16 v[176:179], v[56:59], v[40:43], v[176:179]
    v_bfe_u32 v140, v125, 2, 2
    v_and_b32_e64 v141, 3, v125
    v_mfma_f32_16x16x32_bf16 v[224:227], v[56:59], v[44:47], v[224:227]
    v_lshl_add_u32 v140, v140, 3, v141
    v_mul_u32_u24 v140, 784, v140
    v_mfma_f32_16x16x32_bf16 v[180:183], v[60:63], v[40:43], v[180:183]
    v_lshrrev_b32_e64 v141, 4, v125
    v_lshl_add_u32 v140, v141, 4, v140
    v_mfma_f32_16x16x32_bf16 v[228:231], v[60:63], v[44:47], v[228:231]
    v_lshlrev_b32_e64 v141, 4, v125
    v_mul_u32_u24 v104, 784, v104
    s_waitcnt lgkmcnt(0)
    v_mfma_f32_16x16x32_bf16 v[184:187], v[64:67], v[40:43], v[184:187]
    v_lshl_add_u32 v104, v108, 4, v104
    v_lshlrev_b32 v96, 1, v96
    v_mfma_f32_16x16x32_bf16 v[232:235], v[64:67], v[44:47], v[232:235]
    v_mul_u32_u24 v105, 784, v105
    v_lshl_add_u32 v105, v109, 4, v105
    v_mfma_f32_16x16x32_bf16 v[188:191], v[68:71], v[40:43], v[188:191]
    v_lshlrev_b32_e64 v97, 1, v97
    v_mul_u32_u24 v106, 784, v106
    v_mfma_f32_16x16x32_bf16 v[236:239], v[68:71], v[44:47], v[236:239]
    v_lshl_add_u32 v106, v110, 4, v106
    v_lshlrev_b32 v98, 1, v98
    s_nop 4
    s_mul_i32 s67, s3, 12288
    v_add_u32 v100, s67, v141
    s_xor_b32 s67, s3, 4
    s_mul_i32 s67, s67, 12288
    v_add_u32_e64 v101, s67, v141
    s_cmp_lg_u32 s5, 0
    s_cbranch_scc1 LB_e1
    ds_write_b128 v100, v[168:171] offset:0
    ds_write_b128 v100, v[172:175] offset:1024
    ds_write_b128 v100, v[176:179] offset:2048
    ds_write_b128 v100, v[180:183] offset:3072
    ds_write_b128 v100, v[184:187] offset:4096
    ds_write_b128 v100, v[188:191] offset:5120
    ds_write_b128 v100, v[216:219] offset:6144
    ds_write_b128 v100, v[220:223] offset:7168
    ds_write_b128 v100, v[224:227] offset:8192
    ds_write_b128 v100, v[228:231] offset:9216
    ds_write_b128 v100, v[232:235] offset:10240
    ds_write_b128 v100, v[236:239] offset:11264
    s_lshl_b32 s67, s7, 4
    s_add_u32 s67, s67, s6
    s_mul_i32 s67, s67, 3
    s_add_u32 s67, s67, s89
    s_lshl_b32 s67, s67, 2
    s_add_u32 s67, s67, s4
    s_mul_i32 s67, s67, 12288
    s_add_u32 s67, s67, 24117248
    s_add_u32 s87, s67, 6144
    v_add_u32 v102, 100352, v140
    s_waitcnt lgkmcnt(0)
    s_barrier
    ds_read_b128 v[168:171], v101 offset:0
    ds_read_b128 v[172:175], v101 offset:1024
    ds_read_b128 v[176:179], v101 offset:2048
    ds_read_b128 v[180:183], v101 offset:3072
    ds_read_b128 v[184:187], v101 offset:4096
    ds_read_b128 v[188:191], v101 offset:5120
    ds_read_b128 v[216:219], v101 offset:6144
    ds_read_b128 v[220:223], v101 offset:7168
    ds_read_b128 v[224:227], v101 offset:8192
    ds_read_b128 v[228:231], v101 offset:9216
    ds_read_b128 v[232:235], v101 offset:10240
    ds_read_b128 v[236:239], v101 offset:11264
    s_cmp_eq_u32 s4, s7
    s_cbranch_scc1 L_own0e
    s_waitcnt lgkmcnt(10)
    v_add_f32 v144, v144, v168
    v_add_f32 v145, v145, v169
    v_add_f32 v146, v146, v170
    v_add_f32 v147, v147, v171
    v_add_f32 v148, v148, v172
    v_add_f32 v149, v149, v173
    v_add_f32 v150, v150, v174
    v_add_f32_e64 v151, v151, v175
    v_cvt_pk_bf16_f32 v144, v144, v145
    v_cvt_pk_bf16_f32 v145, v146, v147
    v_cvt_pk_bf16_f32 v146, v148, v149
    v_cvt_pk_bf16_f32 v147, v150, v151
    buffer_store_dwordx4 v[144:147], v141, s[24:27], s67 offen offset:0 sc1
    s_waitcnt lgkmcnt(8)
    v_add_f32 v152, v152, v176
    v_add_f32 v153, v153, v177
    v_add_f32 v154, v154, v178
    v_add_f32 v155, v155, v179
    v_add_f32 v156, v156, v180
    v_add_f32 v157, v157, v181
    v_add_f32 v158, v158, v182
    v_add_f32_e64 v159, v159, v183
    v_cvt_pk_bf16_f32 v152, v152, v153
    v_cvt_pk_bf16_f32 v153, v154, v155
    v_cvt_pk_bf16_f32 v154, v156, v157
    v_cvt_pk_bf16_f32 v155, v158, v159
    buffer_store_dwordx4 v[152:155], v141, s[24:27], s67 offen offset:1024 sc1
    s_waitcnt lgkmcnt(6)
    v_add_f32 v160, v160, v184
    v_add_f32 v161, v161, v185
    v_add_f32 v162, v162, v186
    v_add_f32 v163, v163, v187
    v_add_f32 v164, v164, v188
    v_add_f32 v165, v165, v189
    v_add_f32 v166, v166, v190
    v_add_f32_e64 v167, v167, v191
    v_cvt_pk_bf16_f32 v160, v160, v161
    v_cvt_pk_bf16_f32 v161, v162, v163
    v_cvt_pk_bf16_f32 v162, v164, v165
    v_cvt_pk_bf16_f32 v163, v166, v167
    buffer_store_dwordx4 v[160:163], v141, s[24:27], s67 offen offset:2048 sc1
    s_waitcnt lgkmcnt(4)
    v_add_f32 v192, v192, v216
    v_add_f32 v193, v193, v217
    v_add_f32 v194, v194, v218
    v_add_f32 v195, v195, v219
    v_add_f32 v196, v196, v220
    v_add_f32 v197, v197, v221
    v_add_f32 v198, v198, v222
    v_add_f32_e64 v199, v199, v223
    v_cvt_pk_bf16_f32 v192, v192, v193
    v_cvt_pk_bf16_f32 v193, v194, v195
    v_cvt_pk_bf16_f32 v194, v196, v197
    v_cvt_pk_bf16_f32 v195, v198, v199
    buffer_store_dwordx4 v[192:195], v141, s[24:27], s87 offen offset:0 sc1
    s_waitcnt lgkmcnt(2)
    v_add_f32 v200, v200, v224
    v_add_f32 v201, v201, v225
    v_add_f32 v202, v202, v226
    v_add_f32 v203, v203, v227
    v_add_f32 v204, v204, v228
    v_add_f32 v205, v205, v229
    v_add_f32 v206, v206, v230
    v_add_f32_e64 v207, v207, v231
    v_cvt_pk_bf16_f32 v200, v200, v201
    v_cvt_pk_bf16_f32 v201, v202, v203
    v_cvt_pk_bf16_f32 v202, v204, v205
    v_cvt_pk_bf16_f32 v203, v206, v207
    buffer_store_dwordx4 v[200:203], v141, s[24:27], s87 offen offset:1024 sc1
    s_waitcnt lgkmcnt(0)
    v_add_f32 v208, v208, v232
    v_add_f32 v209, v209, v233
    v_add_f32 v210, v210, v234
    v_add_f32 v211, v211, v235
    v_add_f32 v212, v212, v236
    v_add_f32 v213, v213, v237
    v_add_f32 v214, v214, v238
    v_add_f32_e64 v215, v215, v239
    v_cvt_pk_bf16_f32 v208, v208, v209
    v_cvt_pk_bf16_f32 v209, v210, v211
    v_cvt_pk_bf16_f32 v210, v212, v213
    v_cvt_pk_bf16_f32 v211, v214, v215
    buffer_store_dwordx4 v[208:211], v141, s[24:27], s87 offen offset:2048 sc1
    s_branch L_red
L_own0e:
    s_waitcnt lgkmcnt(10)
    v_add_f32 v144, v144, v168
    v_add_f32 v145, v145, v169
    v_add_f32 v146, v146, v170
    v_add_f32 v147, v147, v171
    v_add_f32 v148, v148, v172
    v_add_f32 v149, v149, v173
    v_add_f32 v150, v150, v174
    v_add_f32 v151, v151, v175
    ds_write_b128 v102, v[144:147] offset:0
    ds_write_b128 v102, v[148:151] offset:64
    s_waitcnt lgkmcnt(10)
    v_add_f32 v152, v152, v176
    v_add_f32 v153, v153, v177
    v_add_f32 v154, v154, v178
    v_add_f32 v155, v155, v179
    v_add_f32 v156, v156, v180
    v_add_f32 v157, v157, v181
    v_add_f32 v158, v158, v182
    v_add_f32_e64 v159, v159, v183
    ds_write_b128 v102, v[152:155] offset:128
    ds_write_b128 v102, v[156:159] offset:192
    s_waitcnt lgkmcnt(10)
    v_add_f32 v160, v160, v184
    v_add_f32 v161, v161, v185
    v_add_f32 v162, v162, v186
    v_add_f32 v163, v163, v187
    v_add_f32 v164, v164, v188
    v_add_f32 v165, v165, v189
    v_add_f32 v166, v166, v190
    v_add_f32_e64 v167, v167, v191
    ds_write_b128 v102, v[160:163] offset:256
    ds_write_b128 v102, v[164:167] offset:320
    s_waitcnt lgkmcnt(10)
    v_add_f32 v192, v192, v216
    v_add_f32 v193, v193, v217
    v_add_f32 v194, v194, v218
    v_add_f32 v195, v195, v219
    v_add_f32 v196, v196, v220
    v_add_f32 v197, v197, v221
    v_add_f32 v198, v198, v222
    v_add_f32_e64 v199, v199, v223
    ds_write_b128 v102, v[192:195] offset:3136
    ds_write_b128 v102, v[196:199] offset:3200
    s_waitcnt lgkmcnt(10)
    v_add_f32 v200, v200, v224
    v_add_f32 v201, v201, v225
    v_add_f32 v202, v202, v226
    v_add_f32 v203, v203, v227
    v_add_f32 v204, v204, v228
    v_add_f32 v205, v205, v229
    v_add_f32 v206, v206, v230
    v_add_f32_e64 v207, v207, v231
    ds_write_b128 v102, v[200:203] offset:3264
    ds_write_b128 v102, v[204:207] offset:3328
    s_waitcnt lgkmcnt(10)
    v_add_f32 v208, v208, v232
    v_add_f32 v209, v209, v233
    v_add_f32 v210, v210, v234
    v_add_f32 v211, v211, v235
    v_add_f32 v212, v212, v236
    v_add_f32 v213, v213, v237
    v_add_f32 v214, v214, v238
    v_add_f32_e64 v215, v215, v239
    ds_write_b128 v102, v[208:211] offset:3392
    ds_write_b128 v102, v[212:215] offset:3456
    s_branch L_red
LB_e1:
    ds_write_b128 v100, v[144:147] offset:0
    ds_write_b128 v100, v[148:151] offset:1024
    ds_write_b128 v100, v[152:155] offset:2048
    ds_write_b128 v100, v[156:159] offset:3072
    ds_write_b128 v100, v[160:163] offset:4096
    ds_write_b128 v100, v[164:167] offset:5120
    ds_write_b128 v100, v[192:195] offset:6144
    ds_write_b128 v100, v[196:199] offset:7168
    ds_write_b128 v100, v[200:203] offset:8192
    ds_write_b128 v100, v[204:207] offset:9216
    ds_write_b128 v100, v[208:211] offset:10240
    ds_write_b128 v100, v[212:215] offset:11264
    s_lshl_b32 s67, s7, 4
    s_add_u32 s67, s67, s6
    s_mul_i32 s67, s67, 3
    s_add_u32 s67, s67, s89
    s_lshl_b32 s67, s67, 2
    s_add_u32 s67, s67, s4
    s_mul_i32 s67, s67, 12288
    s_add_u32 s67, s67, 24120320
    s_add_u32 s87, s67, 6144
    v_add_u32 v102, 100736, v140
    s_waitcnt lgkmcnt(0)
    s_barrier
    ds_read_b128 v[144:147], v101 offset:0
    ds_read_b128 v[148:151], v101 offset:1024
    ds_read_b128 v[152:155], v101 offset:2048
    ds_read_b128 v[156:159], v101 offset:3072
    ds_read_b128 v[160:163], v101 offset:4096
    ds_read_b128 v[164:167], v101 offset:5120
    ds_read_b128 v[192:195], v101 offset:6144
    ds_read_b128 v[196:199], v101 offset:7168
    ds_read_b128 v[200:203], v101 offset:8192
    ds_read_b128 v[204:207], v101 offset:9216
    ds_read_b128 v[208:211], v101 offset:10240
    ds_read_b128 v[212:215], v101 offset:11264
    s_cmp_eq_u32 s4, s7
    s_cbranch_scc1 L_own1e
    s_waitcnt lgkmcnt(10)
    v_add_f32 v168, v168, v144
    v_add_f32 v169, v169, v145
    v_add_f32 v170, v170, v146
    v_add_f32 v171, v171, v147
    v_add_f32 v172, v172, v148
    v_add_f32 v173, v173, v149
    v_add_f32 v174, v174, v150
    v_add_f32 v175, v175, v151
    v_cvt_pk_bf16_f32 v168, v168, v169
    v_cvt_pk_bf16_f32 v169, v170, v171
    v_cvt_pk_bf16_f32 v170, v172, v173
    v_cvt_pk_bf16_f32 v171, v174, v175
    buffer_store_dwordx4 v[168:171], v141, s[24:27], s67 offen offset:0 sc1
    s_waitcnt lgkmcnt(8)
    v_add_f32 v176, v176, v152
    v_add_f32 v177, v177, v153
    v_add_f32 v178, v178, v154
    v_add_f32 v179, v179, v155
    v_add_f32 v180, v180, v156
    v_add_f32 v181, v181, v157
    v_add_f32 v182, v182, v158
    v_add_f32_e64 v183, v183, v159
    v_cvt_pk_bf16_f32 v176, v176, v177
    v_cvt_pk_bf16_f32 v177, v178, v179
    v_cvt_pk_bf16_f32 v178, v180, v181
    v_cvt_pk_bf16_f32 v179, v182, v183
    buffer_store_dwordx4 v[176:179], v141, s[24:27], s67 offen offset:1024 sc1
    s_waitcnt lgkmcnt(6)
    v_add_f32 v184, v184, v160
    v_add_f32 v185, v185, v161
    v_add_f32 v186, v186, v162
    v_add_f32 v187, v187, v163
    v_add_f32 v188, v188, v164
    v_add_f32 v189, v189, v165
    v_add_f32 v190, v190, v166
    v_add_f32_e64 v191, v191, v167
    v_cvt_pk_bf16_f32 v184, v184, v185
    v_cvt_pk_bf16_f32 v185, v186, v187
    v_cvt_pk_bf16_f32 v186, v188, v189
    v_cvt_pk_bf16_f32 v187, v190, v191
    buffer_store_dwordx4 v[184:187], v141, s[24:27], s67 offen offset:2048 sc1
    s_waitcnt lgkmcnt(4)
    v_add_f32 v216, v216, v192
    v_add_f32 v217, v217, v193
    v_add_f32 v218, v218, v194
    v_add_f32 v219, v219, v195
    v_add_f32 v220, v220, v196
    v_add_f32 v221, v221, v197
    v_add_f32 v222, v222, v198
    v_add_f32_e64 v223, v223, v199
    v_cvt_pk_bf16_f32 v216, v216, v217
    v_cvt_pk_bf16_f32 v217, v218, v219
    v_cvt_pk_bf16_f32 v218, v220, v221
    v_cvt_pk_bf16_f32 v219, v222, v223
    buffer_store_dwordx4 v[216:219], v141, s[24:27], s87 offen offset:0 sc1
    s_waitcnt lgkmcnt(2)
    v_add_f32 v224, v224, v200
    v_add_f32 v225, v225, v201
    v_add_f32 v226, v226, v202
    v_add_f32 v227, v227, v203
    v_add_f32 v228, v228, v204
    v_add_f32 v229, v229, v205
    v_add_f32 v230, v230, v206
    v_add_f32_e64 v231, v231, v207
    v_cvt_pk_bf16_f32 v224, v224, v225
    v_cvt_pk_bf16_f32 v225, v226, v227
    v_cvt_pk_bf16_f32 v226, v228, v229
    v_cvt_pk_bf16_f32 v227, v230, v231
    buffer_store_dwordx4 v[224:227], v141, s[24:27], s87 offen offset:1024 sc1
    s_waitcnt lgkmcnt(0)
    v_add_f32 v232, v232, v208
    v_add_f32 v233, v233, v209
    v_add_f32 v234, v234, v210
    v_add_f32 v235, v235, v211
    v_add_f32 v236, v236, v212
    v_add_f32 v237, v237, v213
    v_add_f32 v238, v238, v214
    v_add_f32_e64 v239, v239, v215
    v_cvt_pk_bf16_f32 v232, v232, v233
    v_cvt_pk_bf16_f32 v233, v234, v235
    v_cvt_pk_bf16_f32 v234, v236, v237
    v_cvt_pk_bf16_f32 v235, v238, v239
    buffer_store_dwordx4 v[232:235], v141, s[24:27], s87 offen offset:2048 sc1
    s_branch L_red
L_own1e:
    s_waitcnt lgkmcnt(10)
    v_add_f32 v168, v168, v144
    v_add_f32 v169, v169, v145
    v_add_f32 v170, v170, v146
    v_add_f32 v171, v171, v147
    v_add_f32 v172, v172, v148
    v_add_f32 v173, v173, v149
    v_add_f32 v174, v174, v150
    v_add_f32 v175, v175, v151
    ds_write_b128 v102, v[168:171] offset:0
    ds_write_b128 v102, v[172:175] offset:64
    s_waitcnt lgkmcnt(10)
    v_add_f32 v176, v176, v152
    v_add_f32 v177, v177, v153
    v_add_f32 v178, v178, v154
    v_add_f32 v179, v179, v155
    v_add_f32 v180, v180, v156
    v_add_f32 v181, v181, v157
    v_add_f32 v182, v182, v158
    v_add_f32_e64 v183, v183, v159
    ds_write_b128 v102, v[176:179] offset:128
    ds_write_b128 v102, v[180:183] offset:192
    s_waitcnt lgkmcnt(10)
    v_add_f32 v184, v184, v160
    v_add_f32 v185, v185, v161
    v_add_f32 v186, v186, v162
    v_add_f32 v187, v187, v163
    v_add_f32 v188, v188, v164
    v_add_f32 v189, v189, v165
    v_add_f32 v190, v190, v166
    v_add_f32_e64 v191, v191, v167
    ds_write_b128 v102, v[184:187] offset:256
    ds_write_b128 v102, v[188:191] offset:320
    s_waitcnt lgkmcnt(10)
    v_add_f32 v216, v216, v192
    v_add_f32 v217, v217, v193
    v_add_f32 v218, v218, v194
    v_add_f32 v219, v219, v195
    v_add_f32 v220, v220, v196
    v_add_f32 v221, v221, v197
    v_add_f32 v222, v222, v198
    v_add_f32_e64 v223, v223, v199
    ds_write_b128 v102, v[216:219] offset:3136
    ds_write_b128 v102, v[220:223] offset:3200
    s_waitcnt lgkmcnt(10)
    v_add_f32 v224, v224, v200
    v_add_f32 v225, v225, v201
    v_add_f32 v226, v226, v202
    v_add_f32 v227, v227, v203
    v_add_f32 v228, v228, v204
    v_add_f32 v229, v229, v205
    v_add_f32 v230, v230, v206
    v_add_f32_e64 v231, v231, v207
    ds_write_b128 v102, v[224:227] offset:3264
    ds_write_b128 v102, v[228:231] offset:3328
    s_waitcnt lgkmcnt(10)
    v_add_f32 v232, v232, v208
    v_add_f32 v233, v233, v209
    v_add_f32 v234, v234, v210
    v_add_f32 v235, v235, v211
    v_add_f32 v236, v236, v212
    v_add_f32 v237, v237, v213
    v_add_f32 v238, v238, v214
    v_add_f32_e64 v239, v239, v215
    ds_write_b128 v102, v[232:235] offset:3392
    ds_write_b128 v102, v[236:239] offset:3456
L_red:
    s_mul_i32 s44, s6, 3
    s_add_u32 s44, s44, s89
    s_lshl_b32 s44, s44, 2
    s_add_u32 s44, s44, s7
    s_mul_i32 s44, s44, 12
    s_add_u32 s44, s44, s3
    s_lshl_b32 s44, s44, 10
    s_add_u32 s44, s44, 24117248
    s_lshl_b32 s45, s6, 2
    s_add_u32 s45, s45, s7
    s_mul_i32 s45, s45, 36
    s_mul_i32 s42, s89, 12
    s_add_u32 s45, s45, s42
    s_add_u32 s45, s45, s3
    s_lshl_b32 s45, s45, 10
    s_add_u32 s45, s45, 33816576
    s_cmp_ge_u32 s3, 4
    s_cselect_b32 s46, 1073741824, 0
    s_add_u32 s46, s46, 8192
    s_waitcnt vmcnt(0)
    s_barrier
    s_cmp_lg_u32 s3, 0
    s_cbranch_scc1 L_fs8
    s_add_u32 s38, s97, 65536
    v_mov_b32 v128, s96
    s_mov_b64 exec, 1
    buffer_store_dword v128, off, s[24:27], s38 sc1
    s_mov_b64 exec, -1
L_fs8:
    v_and_b32 v127, 3, v125
    v_lshlrev_b32 v127, 9, v127
    v_cmp_lt_u32 vcc, 3, v125
    s_sub_u32 s42, 3, s89
    s_lshl_b32 s42, s42, 7
    v_mov_b32 v99, s42
    v_cndmask_b32 v99, 0, v99, vcc
    v_add_u32_e64 v127, v127, v99
    s_lshl_b32 s42, s7, 9
    s_sub_u32 s71, s97, s42
    s_add_u32 s71, s71, 65536
    v_mov_b32_e64 v226, 0
    s_lshl_b32 s42, s3, 7
    s_cmp_ge_u32 s3, 6
    s_cselect_b32 s40, 2368, 0
    s_add_u32 s40, s40, s42
    v_add_u32 v100, s40, v140
    s_add_u32 s42, s42, 3392
    v_add_u32 v101, s42, v140
    s_lshl_b32 s42, s3, 6
    s_add_u32 s42, s42, 25088
    v_add_u32 v102, s42, v140
    v_cmp_lt_u32 vcc, 7, v125
    v_mov_b32 v99, 32768
    v_mov_b32 v228, 0
    v_cndmask_b32 v99, 0, v99, vcc
    v_add_u32_e64 v99, v127, v99
    v_mov_b32 v103, 126976
    s_cmp_lg_u32 s3, 0
    s_cbranch_scc1 L_e2
    s_mov_b32 s93, 0
    buffer_load_dword v226, v99, s[24:27], s71 offen sc1
L_e0:
    s_sleep 6
    buffer_load_dword v227, v99, s[24:27], s71 offen sc1
    s_waitcnt vmcnt(1)
    v_cmp_ne_u32 vcc, s96, v226
    s_nop 1
    s_and_b32 s42, vcc_lo, 0xf00
    s_cbranch_scc0 L_e1
    s_sleep 6
    buffer_load_dword v226, v99, s[24:27], s71 offen sc1
    s_waitcnt vmcnt(1)
    v_cmp_ne_u32 vcc, s96, v227
    s_nop 1
    s_and_b32 s42, vcc_lo, 0xf00
    s_cbranch_scc0 L_e1
    s_add_u32 s93, s93, 1
    s_cmp_gt_u32 s93, 60000
    s_cbranch_scc0 L_e0
L_e1:
    s_and_b32 s42, vcc_lo, 0xff
    v_mov_b32 v229, s42
    ds_write_b32 v103, v229
    s_waitcnt lgkmcnt(0)
L_e2:
    s_barrier
    ds_read_b32 v229, v103
    s_add_u32 s42, s45, 0
    buffer_load_dwordx4 v[32:35], v141, s[24:27], s42 offen sc1
    s_add_u32 s42, s45, 2359296
    buffer_load_dwordx4 v[36:39], v141, s[24:27], s42 offen sc1
    s_add_u32 s42, s45, 4718592
    buffer_load_dwordx4 v[40:43], v141, s[24:27], s42 offen sc1
    s_add_u32 s42, s45, 7077888
    buffer_load_dwordx4 v[44:47], v141, s[24:27], s42 offen sc1
    s_waitcnt lgkmcnt(0)
    v_readfirstlane_b32 s42, v229
    s_nop 3
    s_cmp_eq_u32 s42, 0
    s_cbranch_scc1 L_e3
    s_cmp_lg_u32 s3, 0
    s_cbranch_scc1 L_fc9
    v_cmp_ne_u32 vcc, s96, v228
    s_cbranch_vccz L_fc9
    s_mov_b32 s93, 0
    buffer_load_dword v228, v127, s[24:27], s71 offen sc1
L_fl9:
    s_sleep 6
    buffer_load_dword v229, v127, s[24:27], s71 offen sc1
    s_waitcnt vmcnt(1)
    v_cmp_ne_u32 vcc, s96, v228
    s_cbranch_vccz L_fd9
    s_sleep 6
    buffer_load_dword v228, v127, s[24:27], s71 offen sc1
    s_waitcnt vmcnt(1)
    v_cmp_ne_u32 vcc, s96, v229
    s_cbranch_vccz L_fd9
    s_add_u32 s93, s93, 1
    s_cmp_gt_u32 s93, 60000
    s_cbranch_scc0 L_fl9
L_fd9:
L_fc9:
    s_barrier
L_e3:
    s_add_u32 s42, s7, 1
    s_and_b32 s42, s42, 3
    s_mul_i32 s42, s42, 2359296
    s_add_u32 s42, s42, s44
    buffer_load_dwordx4 v[0:3], v141, s[24:27], s42 offen sc1
    s_add_u32 s42, s7, 2
    s_and_b32 s42, s42, 3
    s_mul_i32 s42, s42, 2359296
    s_add_u32 s42, s42, s44
    buffer_load_dwordx4 v[4:7], v141, s[24:27], s42 offen sc1
    s_add_u32 s42, s7, 3
    s_and_b32 s42, s42, 3
    s_mul_i32 s42, s42, 2359296
    s_add_u32 s42, s42, s44
    buffer_load_dwordx4 v[8:11], v141, s[24:27], s42 offen sc1
    s_add_u32 s42, s7, 1
    s_and_b32 s42, s42, 3
    s_mul_i32 s42, s42, 2359296
    s_add_u32 s42, s42, s44
    s_add_u32 s42, s42, s46
    buffer_load_dwordx4 v[16:19], v141, s[24:27], s42 offen sc1
    s_add_u32 s42, s7, 2
    s_and_b32 s42, s42, 3
    s_mul_i32 s42, s42, 2359296
    s_add_u32 s42, s42, s44
    s_add_u32 s42, s42, s46
    buffer_load_dwordx4 v[20:23], v141, s[24:27], s42 offen sc1
    s_add_u32 s42, s7, 3
    s_and_b32 s42, s42, 3
    s_mul_i32 s42, s42, 2359296
    s_add_u32 s42, s42, s44
    s_add_u32 s42, s42, s46
    buffer_load_dwordx4 v[24:27], v141, s[24:27], s42 offen sc1
    s_add_u32 s42, s45, 0
    s_add_u32 s42, s42, s46
    buffer_load_dwordx4 v[48:51], v141, s[24:27], s42 offen sc1
    s_add_u32 s42, s45, 2359296
    s_add_u32 s42, s42, s46
    buffer_load_dwordx4 v[52:55], v141, s[24:27], s42 offen sc1
    s_add_u32 s42, s45, 4718592
    s_add_u32 s42, s42, s46
    buffer_load_dwordx4 v[56:59], v141, s[24:27], s42 offen sc1
    s_add_u32 s42, s45, 7077888
    s_add_u32 s42, s42, s46
    buffer_load_dwordx4 v[60:63], v141, s[24:27], s42 offen sc1
    s_waitcnt vmcnt(13)
    v_dot2_f32_bf16 v152, v32, s90, 0
    v_dot2_f32_bf16 v153, v32, s91, 0
    v_dot2_f32_bf16 v154, v33, s90, 0
    v_dot2_f32_bf16 v155, v33, s91, 0
    v_dot2_f32_bf16 v156, v34, s90, 0
    v_dot2_f32_bf16 v157, v34, s91, 0
    v_dot2_f32_bf16 v158, v35, s90, 0
    v_dot2_f32_bf16 v159, v35, s91, 0
    s_waitcnt vmcnt(12)
    v_dot2_f32_bf16 v152, v36, s90, v152
    v_dot2_f32_bf16 v153, v36, s91, v153
    v_dot2_f32_bf16 v154, v37, s90, v154
    v_dot2_f32_bf16 v155, v37, s91, v155
    v_dot2_f32_bf16 v156, v38, s90, v156
    v_dot2_f32_bf16 v157, v38, s91, v157
    v_dot2_f32_bf16 v158, v39, s90, v158
    v_dot2_f32_bf16 v159, v39, s91, v159
    s_waitcnt vmcnt(11)
    v_dot2_f32_bf16 v152, v40, s90, v152
    v_dot2_f32_bf16 v153, v40, s91, v153
    v_dot2_f32_bf16 v154, v41, s90, v154
    v_dot2_f32_bf16 v155, v41, s91, v155
    v_dot2_f32_bf16 v156, v42, s90, v156
    v_dot2_f32_bf16 v157, v42, s91, v157
    v_dot2_f32_bf16 v158, v43, s90, v158
    v_dot2_f32_bf16 v159, v43, s91, v159
    s_waitcnt vmcnt(10)
    v_dot2_f32_bf16 v152, v44, s90, v152
    v_dot2_f32_bf16 v153, v44, s91, v153
    v_dot2_f32_bf16 v154, v45, s90, v154
    v_dot2_f32_bf16 v155, v45, s91, v155
    v_dot2_f32_bf16 v156, v46, s90, v156
    v_dot2_f32_bf16 v157, v46, s91, v157
    v_dot2_f32_bf16 v158, v47, s90, v158
    v_dot2_f32_bf16 v159, v47, s91, v159
    s_nop 2
    ds_write_b128 v102, v[152:155] offset:0
    ds_write_b128 v102, v[156:159] offset:3136
    s_waitcnt vmcnt(9)
    v_dot2_f32_bf16 v144, v0, s90, 0
    v_dot2_f32_bf16 v145, v0, s91, 0
    v_dot2_f32_bf16 v146, v1, s90, 0
    v_dot2_f32_bf16 v147, v1, s91, 0
    v_dot2_f32_bf16 v148, v2, s90, 0
    v_dot2_f32_bf16 v149, v2, s91, 0
    v_dot2_f32_bf16 v150, v3, s90, 0
    v_dot2_f32_bf16 v151, v3, s91, 0
    s_waitcnt vmcnt(8)
    v_dot2_f32_bf16 v144, v4, s90, v144
    v_dot2_f32_bf16 v145, v4, s91, v145
    v_dot2_f32_bf16 v146, v5, s90, v146
    v_dot2_f32_bf16 v147, v5, s91, v147
    v_dot2_f32_bf16 v148, v6, s90, v148
    v_dot2_f32_bf16 v149, v6, s91, v149
    v_dot2_f32_bf16 v150, v7, s90, v150
    v_dot2_f32_bf16 v151, v7, s91, v151
    s_waitcnt vmcnt(7)
    v_dot2_f32_bf16 v144, v8, s90, v144
    v_dot2_f32_bf16 v145, v8, s91, v145
    v_dot2_f32_bf16 v146, v9, s90, v146
    v_dot2_f32_bf16 v147, v9, s91, v147
    v_dot2_f32_bf16 v148, v10, s90, v148
    v_dot2_f32_bf16 v149, v10, s91, v149
    v_dot2_f32_bf16 v150, v11, s90, v150
    v_dot2_f32_bf16 v151, v11, s91, v151
    s_nop 2
    ds_write_b128 v100, v[144:147]
    ds_write_b128 v100, v[148:151] offset:64
    s_cmp_ge_u32 s3, 4
    s_cbranch_scc1 L_rs
    s_waitcnt vmcnt(6)
    v_dot2_f32_bf16 v144, v16, s90, 0
    v_dot2_f32_bf16 v145, v16, s91, 0
    v_dot2_f32_bf16 v146, v17, s90, 0
    v_dot2_f32_bf16 v147, v17, s91, 0
    v_dot2_f32_bf16 v148, v18, s90, 0
    v_dot2_f32_bf16 v149, v18, s91, 0
    v_dot2_f32_bf16 v150, v19, s90, 0
    v_dot2_f32_bf16 v151, v19, s91, 0
    s_waitcnt vmcnt(5)
    v_dot2_f32_bf16 v144, v20, s90, v144
    v_dot2_f32_bf16 v145, v20, s91, v145
    v_dot2_f32_bf16 v146, v21, s90, v146
    v_dot2_f32_bf16 v147, v21, s91, v147
    v_dot2_f32_bf16 v148, v22, s90, v148
    v_dot2_f32_bf16 v149, v22, s91, v149
    v_dot2_f32_bf16 v150, v23, s90, v150
    v_dot2_f32_bf16 v151, v23, s91, v151
    s_waitcnt vmcnt(4)
    v_dot2_f32_bf16 v144, v24, s90, v144
    v_dot2_f32_bf16 v145, v24, s91, v145
    v_dot2_f32_bf16 v146, v25, s90, v146
    v_dot2_f32_bf16 v147, v25, s91, v147
    v_dot2_f32_bf16 v148, v26, s90, v148
    v_dot2_f32_bf16 v149, v26, s91, v149
    v_dot2_f32_bf16 v150, v27, s90, v150
    v_dot2_f32_bf16 v151, v27, s91, v151
    s_nop 2
    ds_write_b128 v101, v[144:147]
    ds_write_b128 v101, v[148:151] offset:64
    s_waitcnt vmcnt(3)
    v_dot2_f32_bf16 v152, v48, s90, 0
    v_dot2_f32_bf16 v153, v48, s91, 0
    v_dot2_f32_bf16 v154, v49, s90, 0
    v_dot2_f32_bf16 v155, v49, s91, 0
    v_dot2_f32_bf16 v156, v50, s90, 0
    v_dot2_f32_bf16 v157, v50, s91, 0
    v_dot2_f32_bf16 v158, v51, s90, 0
    v_dot2_f32_bf16 v159, v51, s91, 0
    s_waitcnt vmcnt(2)
    v_dot2_f32_bf16 v152, v52, s90, v152
    v_dot2_f32_bf16 v153, v52, s91, v153
    v_dot2_f32_bf16 v154, v53, s90, v154
    v_dot2_f32_bf16 v155, v53, s91, v155
    v_dot2_f32_bf16 v156, v54, s90, v156
    v_dot2_f32_bf16 v157, v54, s91, v157
    v_dot2_f32_bf16 v158, v55, s90, v158
    v_dot2_f32_bf16 v159, v55, s91, v159
    s_waitcnt vmcnt(1)
    v_dot2_f32_bf16 v152, v56, s90, v152
    v_dot2_f32_bf16 v153, v56, s91, v153
    v_dot2_f32_bf16 v154, v57, s90, v154
    v_dot2_f32_bf16 v155, v57, s91, v155
    v_dot2_f32_bf16 v156, v58, s90, v156
    v_dot2_f32_bf16 v157, v58, s91, v157
    v_dot2_f32_bf16 v158, v59, s90, v158
    v_dot2_f32_bf16 v159, v59, s91, v159
    s_waitcnt vmcnt(0)
    v_dot2_f32_bf16 v152, v60, s90, v152
    v_dot2_f32_bf16 v153, v60, s91, v153
    v_dot2_f32_bf16 v154, v61, s90, v154
    v_dot2_f32_bf16 v155, v61, s91, v155
    v_dot2_f32_bf16 v156, v62, s90, v156
    v_dot2_f32_bf16 v157, v62, s91, v157
    v_dot2_f32_bf16 v158, v63, s90, v158
    v_dot2_f32_bf16 v159, v63, s91, v159
    s_nop 2
    ds_write_b128 v102, v[152:155] offset:512
    ds_write_b128 v102, v[156:159] offset:3648
L_rs:
    s_waitcnt lgkmcnt(0)
    s_barrier
    ds_read_b128 v[0:3], v104
    ds_read_b128 v[4:7], v104 offset:25088
    v_add_u32 v104, 100352, v104
    ds_read_b128 v[8:11], v104
    ds_read_b128 v[12:15], v105
    ds_read_b128 v[16:19], v105 offset:25088
    v_add_u32 v105, 100352, v105
    ds_read_b128 v[20:23], v105
    ds_read_b128 v[24:27], v106
    ds_read_b128 v[28:31], v106 offset:25088
    v_add_u32 v106, 100352, v106
    ds_read_b128 v[32:35], v106
    s_waitcnt lgkmcnt(6)
    v_add_f32 v72, v72, v4
    v_add_f32 v73, v73, v5
    v_add_f32 v74, v74, v6
    v_add_f32 v75, v75, v7
    v_add_f32 v72, v72, v0
    v_add_f32 v73, v73, v1
    v_add_f32 v74, v74, v2
    v_add_f32 v75, v75, v3
    v_add_f32 v72, v72, v8
    v_add_f32 v73, v73, v9
    v_add_f32 v74, v74, v10
    v_add_f32_e64 v75, v75, v11
    buffer_store_dwordx4 v[72:75], v96, s[20:23], s43 offen sc1
    s_waitcnt lgkmcnt(3)
    v_add_f32 v76, v76, v16
    v_add_f32 v77, v77, v17
    v_add_f32 v78, v78, v18
    v_add_f32 v79, v79, v19
    v_add_f32 v76, v76, v12
    v_add_f32 v77, v77, v13
    v_add_f32 v78, v78, v14
    v_add_f32 v79, v79, v15
    v_add_f32 v76, v76, v20
    v_add_f32 v77, v77, v21
    v_add_f32 v78, v78, v22
    v_add_f32_e64 v79, v79, v23
    buffer_store_dwordx4 v[76:79], v97, s[20:23], s43 offen sc1
    s_waitcnt lgkmcnt(0)
    v_add_f32 v80, v80, v28
    v_add_f32 v81, v81, v29
    v_add_f32 v82, v82, v30
    v_add_f32 v83, v83, v31
    v_add_f32 v80, v80, v24
    v_add_f32 v81, v81, v25
    v_add_f32 v82, v82, v26
    v_add_f32 v83, v83, v27
    v_add_f32 v80, v80, v32
    v_add_f32 v81, v81, v33
    v_add_f32 v82, v82, v34
    v_add_f32_e64 v83, v83, v35
    buffer_store_dwordx4 v[80:83], v98, s[20:23], s43 offen sc1
    s_endpgm
LA_M:
    s_mul_i32 s66, s7, 165888
    s_and_b32 s99, s6, 1
    s_mul_i32 s87, s99, 73728
    s_add_u32 s65, s66, s87
    s_movk_i32 s87, 144
    v_cmp_gt_u32 s[44:45], s87, v195
    v_mul_u32_u24_e64 v195, 56, v195
    v_add_u32 v195, 147456, v195
    v_add_u32 v254, 7168, v254
    s_lshl_b32 s67, s68, 6
    s_add_u32 s67, s67, s95
    s_add_u32 m0, s67, 89856
    s_add_u32 s67, s68, 4608
    buffer_load_dwordx4 v239, s[8:11], s67 offen offset:256 lds
    s_lshl_b32 s67, s69, 6
    s_add_u32 s67, s67, s95
    s_add_u32 m0, s67, 73728
    s_add_u32 s67, s69, 4608
    buffer_load_dwordx4 v239, s[8:11], s67 offen offset:0 lds
    s_cmp_eq_u32 s5, 0
    s_cbranch_scc1 L_noctc
    s_waitcnt vmcnt(13)
    v_lshlrev_b32 v190, 16, v190
    v_lshlrev_b32 v191, 16, v191
    v_lshlrev_b32 v192, 16, v192
    v_mul_f32 v192, 0x3fb8aa3b, v192
    v_exp_f32 v192, v192
    s_nop 0
    v_cvt_pk_bf16_f32 v192, v192, v192
    v_lshlrev_b32 v192, 16, v192
    v_mul_f32 v193, v192, v190
    v_mul_f32_e64 v194, v192, v191
    v_mul_f32 v193, 0x3fb8aa3b, v193
    v_mul_f32_e64 v194, 0x3e22f983, v194
    v_mul_f32 v196, 0x42000000, v193
    v_mul_f32 v197, 0x42000000, v194
    v_exp_f32 v196, v196
    v_fract_f32 v197, v197
    v_cos_f32 v180, v197
    v_sin_f32 v181, v197
    s_nop 0
    v_mul_f32 v180, v180, v196
    v_mul_f32_e64 v181, -v181, v196
    v_mul_f32 v196, 0x41000000, v193
    v_mul_f32 v197, 0x41000000, v194
    v_exp_f32 v196, v196
    v_fract_f32 v197, v197
    v_cos_f32 v184, v197
    v_sin_f32 v185, v197
    s_nop 0
    v_mul_f32 v184, v184, v196
    v_mul_f32_e64 v185, -v185, v196
    v_mul_f32 v196, 0x41800000, v193
    v_mul_f32 v197, 0x41800000, v194
    v_exp_f32 v196, v196
    v_fract_f32 v197, v197
    v_cos_f32 v186, v197
    v_sin_f32 v187, v197
    s_nop 0
    v_mul_f32 v186, v186, v196
    v_mul_f32_e64 v187, -v187, v196
    v_mul_f32 v196, 0x41c00000, v193
    v_mul_f32 v197, 0x41c00000, v194
    v_exp_f32 v196, v196
    v_fract_f32 v197, v197
    v_cos_f32 v188, v197
    v_sin_f32 v189, v197
    s_nop 0
    v_mul_f32 v188, v188, v196
    v_mul_f32_e64 v189, -v189, v196
    v_mul_f32 v196, 0x3f800000, v193
    v_mul_f32 v197, 0x3f800000, v194
    v_exp_f32 v196, v196
    v_fract_f32 v197, v197
    v_cos_f32 v178, v197
    v_sin_f32 v179, v197
    s_nop 0
    v_mul_f32 v178, v178, v196
    v_mul_f32_e64 v179, -v179, v196
    v_mov_b32 v182, 1.0
    v_mov_b32 v183, 0
    v_cos_f32 v198, v197
    v_mul_f32 v199, 0.5, v194
    v_fract_f32 v199, v199
    v_sin_f32 v199, v199
    v_add_f32 v196, -1.0, v196
    v_mul_f32 v196, v196, v198
    v_mul_f32_e64 v199, v199, v199
    v_fma_f32 v196, -2.0, v199, v196
    v_mul_f32 v197, v190, v190
    v_fmac_f32 v197, v191, v191
    v_rcp_f32 v197, v197
    v_mul_f32 v176, v196, v190
    v_fma_f32 v176, -v179, v191, v176
    v_mul_f32 v177, v196, v191
    v_fmac_f32 v177, v179, v190
    v_add_f32 v197, v197, v197
    v_mul_f32 v176, v176, v197
    v_mul_f32 v177, v177, v197
L_noctc:
    s_waitcnt vmcnt(4)
    s_barrier
    ds_read_b128 v[0:3], v252 offset:0
    ds_read_b128 v[8:11], v253 offset:0
    ds_read_b128 v[16:19], v252 offset:8192
    ds_read_b128 v[24:27], v253 offset:8192
    ds_read_b128 v[32:35], v252 offset:16384
    ds_read_b128 v[40:43], v253 offset:16384
    ds_read_b128 v[48:51], v252 offset:24576
    ds_read_b128 v[56:59], v253 offset:24576
    s_waitcnt lgkmcnt(7)
    v_mfma_f32_16x16x32_bf16 v[200:203], v[232:235], v[0:3], 0
    ds_read_b128 v[64:67], v252 offset:32768
    s_waitcnt lgkmcnt(7)
    v_mfma_f32_16x16x32_bf16 v[200:203], v[232:235], v[8:11], v[200:203]
    ds_read_b128 v[72:75], v253 offset:32768
    s_waitcnt lgkmcnt(7)
    v_mfma_f32_16x16x32_bf16 v[200:203], v[232:235], v[16:19], v[200:203]
    ds_read_b128 v[80:83], v252 offset:40960
    s_waitcnt lgkmcnt(7)
    v_mfma_f32_16x16x32_bf16 v[200:203], v[232:235], v[24:27], v[200:203]
    ds_read_b128 v[88:91], v253 offset:40960
    s_lshl_b32 s67, s69, 6
    s_add_u32 s67, s67, s95
    s_add_u32 m0, s67, 81792
    s_add_u32 s67, s69, 4608
    buffer_load_dwordx4 v239, s[8:11], s67 offen offset:128 lds
    s_waitcnt lgkmcnt(7)
    v_mfma_f32_16x16x32_bf16 v[200:203], v[232:235], v[32:35], v[200:203]
    v_add_u32 v252, 49152, v252
    v_add_u32 v253, 49152, v253
    ds_read_b128 v[96:99], v252 offset:0
    s_waitcnt lgkmcnt(7)
    v_mfma_f32_16x16x32_bf16 v[200:203], v[232:235], v[40:43], v[200:203]
    ds_read_b128 v[104:107], v253 offset:0
    s_waitcnt lgkmcnt(7)
    v_mfma_f32_16x16x32_bf16 v[200:203], v[232:235], v[48:51], v[200:203]
    ds_read_b128 v[112:115], v252 offset:8192
    s_waitcnt lgkmcnt(7)
    v_mfma_f32_16x16x32_bf16 v[200:203], v[232:235], v[56:59], v[200:203]
    ds_read_b128 v[120:123], v253 offset:8192
    s_waitcnt lgkmcnt(7)
    v_mfma_f32_16x16x32_bf16 v[200:203], v[232:235], v[64:67], v[200:203]
    ds_read_b128 v[128:131], v252 offset:16384
    s_waitcnt lgkmcnt(7)
    v_mfma_f32_16x16x32_bf16 v[200:203], v[232:235], v[72:75], v[200:203]
    ds_read_b128 v[136:139], v253 offset:16384
    s_lshl_b32 s67, s69, 6
    s_add_u32 s67, s67, s95
    s_add_u32 m0, s67, 89856
    s_add_u32 s67, s69, 4608
    buffer_load_dwordx4 v239, s[8:11], s67 offen offset:256 lds
    s_waitcnt lgkmcnt(7)
    v_mfma_f32_16x16x32_bf16 v[200:203], v[232:235], v[80:83], v[200:203]
    s_waitcnt lgkmcnt(6)
    v_mfma_f32_16x16x32_bf16 v[200:203], v[232:235], v[88:91], v[200:203]
    s_waitcnt lgkmcnt(5)
    v_mfma_f32_16x16x32_bf16 v[200:203], v[232:235], v[96:99], v[200:203]
    s_waitcnt lgkmcnt(4)
    v_mfma_f32_16x16x32_bf16 v[200:203], v[232:235], v[104:107], v[200:203]
    s_waitcnt lgkmcnt(3)
    v_mfma_f32_16x16x32_bf16 v[200:203], v[232:235], v[112:115], v[200:203]
    s_waitcnt lgkmcnt(2)
    v_mfma_f32_16x16x32_bf16 v[200:203], v[232:235], v[120:123], v[200:203]
    s_lshl_b32 s67, s70, 6
    s_add_u32 s67, s67, s95
    s_add_u32 m0, s67, 73728
    s_add_u32 s67, s70, 4608
    buffer_load_dwordx4 v239, s[8:11], s67 offen offset:0 lds
    s_waitcnt lgkmcnt(1)
    v_mfma_f32_16x16x32_bf16 v[200:203], v[232:235], v[128:131], v[200:203]
    s_waitcnt lgkmcnt(0)
    v_mfma_f32_16x16x32_bf16 v[200:203], v[232:235], v[136:139], v[200:203]
    s_barrier
    v_add_u32 v252, 24576, v252
    v_add_u32 v253, 24576, v253
    s_cmp_lg_u32 s5, 0
    s_cbranch_scc1 L_ngM0
    v_mfma_f32_16x16x32_bf16 v[204:207], v[0:3], v[0:3], 0
    v_mfma_f32_16x16x32_bf16 v[204:207], v[8:11], v[8:11], v[204:207]
    v_mfma_f32_16x16x32_bf16 v[204:207], v[16:19], v[16:19], v[204:207]
    v_mfma_f32_16x16x32_bf16 v[204:207], v[24:27], v[24:27], v[204:207]
    v_mfma_f32_16x16x32_bf16 v[204:207], v[32:35], v[32:35], v[204:207]
    v_mfma_f32_16x16x32_bf16 v[204:207], v[40:43], v[40:43], v[204:207]
    v_mfma_f32_16x16x32_bf16 v[204:207], v[48:51], v[48:51], v[204:207]
    v_mfma_f32_16x16x32_bf16 v[204:207], v[56:59], v[56:59], v[204:207]
    v_mfma_f32_16x16x32_bf16 v[204:207], v[64:67], v[64:67], v[204:207]
    v_mfma_f32_16x16x32_bf16 v[204:207], v[72:75], v[72:75], v[204:207]
    v_mfma_f32_16x16x32_bf16 v[204:207], v[80:83], v[80:83], v[204:207]
    v_mfma_f32_16x16x32_bf16 v[204:207], v[88:91], v[88:91], v[204:207]
    v_mfma_f32_16x16x32_bf16 v[204:207], v[96:99], v[96:99], v[204:207]
    v_mfma_f32_16x16x32_bf16 v[204:207], v[104:107], v[104:107], v[204:207]
    v_mfma_f32_16x16x32_bf16 v[204:207], v[112:115], v[112:115], v[204:207]
    v_mfma_f32_16x16x32_bf16 v[204:207], v[120:123], v[120:123], v[204:207]
    v_mfma_f32_16x16x32_bf16 v[204:207], v[128:131], v[128:131], v[204:207]
    v_mfma_f32_16x16x32_bf16 v[204:207], v[136:139], v[136:139], v[204:207]
L_ngM0:
    s_nop 4
    v_mul_f32 v200, 0x3ae38e39, v200
    v_cvt_pk_bf16_f32 v251, v200, v200
    v_lshlrev_b32 v251, 16, v251
    v_xor_b32 v251, 0x80000000, v251
    v_dot2_f32_bf16 v144, v0, s90, v251
    v_dot2_f32_bf16 v145, v0, s91, v251
    v_dot2_f32_bf16 v146, v1, s90, v251
    v_dot2_f32_bf16 v147, v1, s91, v251
    v_dot2_f32_bf16 v148, v2, s90, v251
    v_dot2_f32_bf16 v149, v2, s91, v251
    v_dot2_f32_bf16 v150, v3, s90, v251
    v_dot2_f32_bf16 v151, v3, s91, v251
    v_cvt_pk_bf16_f32 v0, v144, v145
    v_cvt_pk_bf16_f32 v1, v146, v147
    v_cvt_pk_bf16_f32 v2, v148, v149
    v_cvt_pk_bf16_f32 v3, v150, v151
    v_dot2_f32_bf16 v152, v8, s90, v251
    v_dot2_f32_bf16 v153, v8, s91, v251
    v_dot2_f32_bf16 v154, v9, s90, v251
    v_dot2_f32_bf16 v155, v9, s91, v251
    v_dot2_f32_bf16 v156, v10, s90, v251
    v_dot2_f32_bf16 v157, v10, s91, v251
    v_dot2_f32_bf16 v158, v11, s90, v251
    v_dot2_f32_bf16 v159, v11, s91, v251
    s_lshl_b32 s67, s70, 6
    s_add_u32 s67, s67, s95
    s_add_u32 m0, s67, 81792
    s_add_u32 s67, s70, 4608
    buffer_load_dwordx4 v239, s[8:11], s67 offen offset:128 lds
    v_cvt_pk_bf16_f32 v8, v152, v153
    v_cvt_pk_bf16_f32 v9, v154, v155
    v_cvt_pk_bf16_f32 v10, v156, v157
    v_cvt_pk_bf16_f32 v11, v158, v159
    v_dot2_f32_bf16 v144, v16, s90, v251
    v_dot2_f32_bf16 v145, v16, s91, v251
    v_dot2_f32_bf16 v146, v17, s90, v251
    v_dot2_f32_bf16 v147, v17, s91, v251
    v_dot2_f32_bf16 v148, v18, s90, v251
    v_dot2_f32_bf16 v149, v18, s91, v251
    v_dot2_f32_bf16 v150, v19, s90, v251
    v_dot2_f32_bf16 v151, v19, s91, v251
    v_cvt_pk_bf16_f32 v16, v144, v145
    v_cvt_pk_bf16_f32 v17, v146, v147
    v_cvt_pk_bf16_f32 v18, v148, v149
    v_cvt_pk_bf16_f32 v19, v150, v151
    v_dot2_f32_bf16 v152, v24, s90, v251
    v_dot2_f32_bf16 v153, v24, s91, v251
    v_dot2_f32_bf16 v154, v25, s90, v251
    v_dot2_f32_bf16 v155, v25, s91, v251
    v_dot2_f32_bf16 v156, v26, s90, v251
    v_dot2_f32_bf16 v157, v26, s91, v251
    v_dot2_f32_bf16 v158, v27, s90, v251
    v_dot2_f32_bf16 v159, v27, s91, v251
    s_lshl_b32 s67, s70, 6
    s_add_u32 s67, s67, s95
    s_add_u32 m0, s67, 89856
    s_add_u32 s67, s70, 4608
    buffer_load_dwordx4 v239, s[8:11], s67 offen offset:256 lds
    v_cvt_pk_bf16_f32 v24, v152, v153
    v_cvt_pk_bf16_f32 v25, v154, v155
    v_cvt_pk_bf16_f32 v26, v156, v157
    v_cvt_pk_bf16_f32 v27, v158, v159
    v_dot2_f32_bf16 v144, v32, s90, v251
    v_dot2_f32_bf16 v145, v32, s91, v251
    v_dot2_f32_bf16 v146, v33, s90, v251
    v_dot2_f32_bf16 v147, v33, s91, v251
    v_dot2_f32_bf16 v148, v34, s90, v251
    v_dot2_f32_bf16 v149, v34, s91, v251
    v_dot2_f32_bf16 v150, v35, s90, v251
    v_dot2_f32_bf16 v151, v35, s91, v251
    v_bfe_u32 v255, v246, 4, 6
    v_min_u32 v255, 4, v255
    v_lshlrev_b32_e64 v255, 7, v255
    s_and_b32 s38, s6, 7
    s_lshl_b32 s38, s38, 2
    s_add_u32 s38, s38, s4
    s_mul_i32 s38, s38, 576
    s_add_u32 s38, s38, s66
    s_add_u32 s38, s38, 147456
    buffer_load_dword v255, v255, s[40:43], s38 offen
    v_cvt_pk_bf16_f32 v32, v144, v145
    v_cvt_pk_bf16_f32 v33, v146, v147
    v_cvt_pk_bf16_f32 v34, v148, v149
    v_cvt_pk_bf16_f32 v35, v150, v151
    v_dot2_f32_bf16 v152, v40, s90, v251
    v_dot2_f32_bf16 v153, v40, s91, v251
    v_dot2_f32_bf16 v154, v41, s90, v251
    v_dot2_f32_bf16 v155, v41, s91, v251
    v_dot2_f32_bf16 v156, v42, s90, v251
    v_dot2_f32_bf16 v157, v42, s91, v251
    v_dot2_f32_bf16 v158, v43, s90, v251
    v_dot2_f32_bf16 v159, v43, s91, v251
    v_cvt_pk_bf16_f32 v40, v152, v153
    v_cvt_pk_bf16_f32 v41, v154, v155
    v_cvt_pk_bf16_f32 v42, v156, v157
    v_cvt_pk_bf16_f32 v43, v158, v159
    v_dot2_f32_bf16 v144, v48, s90, v251
    v_dot2_f32_bf16 v145, v48, s91, v251
    v_dot2_f32_bf16 v146, v49, s90, v251
    v_dot2_f32_bf16 v147, v49, s91, v251
    v_dot2_f32_bf16 v148, v50, s90, v251
    v_dot2_f32_bf16 v149, v50, s91, v251
    v_dot2_f32_bf16 v150, v51, s90, v251
    v_dot2_f32_bf16 v151, v51, s91, v251
    v_cvt_pk_bf16_f32 v48, v144, v145
    v_cvt_pk_bf16_f32 v49, v146, v147
    v_cvt_pk_bf16_f32 v50, v148, v149
    v_cvt_pk_bf16_f32 v51, v150, v151
    v_dot2_f32_bf16 v152, v56, s90, v251
    v_dot2_f32_bf16 v153, v56, s91, v251
    v_dot2_f32_bf16 v154, v57, s90, v251
    v_dot2_f32_bf16 v155, v57, s91, v251
    v_dot2_f32_bf16 v156, v58, s90, v251
    v_dot2_f32_bf16 v157, v58, s91, v251
    v_dot2_f32_bf16 v158, v59, s90, v251
    v_dot2_f32_bf16 v159, v59, s91, v251
    v_cvt_pk_bf16_f32 v56, v152, v153
    v_cvt_pk_bf16_f32 v57, v154, v155
    v_cvt_pk_bf16_f32 v58, v156, v157
    v_cvt_pk_bf16_f32 v59, v158, v159
    v_dot2_f32_bf16 v144, v64, s90, v251
    v_dot2_f32_bf16 v145, v64, s91, v251
    v_dot2_f32_bf16 v146, v65, s90, v251
    v_dot2_f32_bf16 v147, v65, s91, v251
    v_dot2_f32_bf16 v148, v66, s90, v251
    v_dot2_f32_bf16 v149, v66, s91, v251
    v_dot2_f32_bf16 v150, v67, s90, v251
    v_dot2_f32_bf16 v151, v67, s91, v251
    v_cvt_pk_bf16_f32 v64, v144, v145
    v_cvt_pk_bf16_f32 v65, v146, v147
    v_cvt_pk_bf16_f32 v66, v148, v149
    v_cvt_pk_bf16_f32 v67, v150, v151
    v_dot2_f32_bf16 v152, v72, s90, v251
    v_dot2_f32_bf16 v153, v72, s91, v251
    v_dot2_f32_bf16 v154, v73, s90, v251
    v_dot2_f32_bf16 v155, v73, s91, v251
    v_dot2_f32_bf16 v156, v74, s90, v251
    v_dot2_f32_bf16 v157, v74, s91, v251
    v_dot2_f32_bf16 v158, v75, s90, v251
    v_dot2_f32_bf16 v159, v75, s91, v251
    v_cvt_pk_bf16_f32 v72, v152, v153
    v_cvt_pk_bf16_f32 v73, v154, v155
    v_cvt_pk_bf16_f32 v74, v156, v157
    v_cvt_pk_bf16_f32 v75, v158, v159
    v_dot2_f32_bf16 v144, v80, s90, v251
    v_dot2_f32_bf16 v145, v80, s91, v251
    v_dot2_f32_bf16 v146, v81, s90, v251
    v_dot2_f32_bf16 v147, v81, s91, v251
    v_dot2_f32_bf16 v148, v82, s90, v251
    v_dot2_f32_bf16 v149, v82, s91, v251
    v_dot2_f32_bf16 v150, v83, s90, v251
    v_dot2_f32_bf16 v151, v83, s91, v251
    s_add_u32 m0, s64, 0
    s_add_u32 s67, s65, 0
    buffer_load_dwordx4 v245, s[16:19], s67 offen lds
    v_cvt_pk_bf16_f32 v80, v144, v145
    v_cvt_pk_bf16_f32 v81, v146, v147
    v_cvt_pk_bf16_f32 v82, v148, v149
    v_cvt_pk_bf16_f32 v83, v150, v151
    v_dot2_f32_bf16 v152, v88, s90, v251
    v_dot2_f32_bf16 v153, v88, s91, v251
    v_dot2_f32_bf16 v154, v89, s90, v251
    v_dot2_f32_bf16 v155, v89, s91, v251
    v_dot2_f32_bf16 v156, v90, s90, v251
    v_dot2_f32_bf16 v157, v90, s91, v251
    v_dot2_f32_bf16 v158, v91, s90, v251
    v_dot2_f32_bf16 v159, v91, s91, v251
    v_cvt_pk_bf16_f32 v88, v152, v153
    v_cvt_pk_bf16_f32 v89, v154, v155
    v_cvt_pk_bf16_f32 v90, v156, v157
    v_cvt_pk_bf16_f32 v91, v158, v159
    v_dot2_f32_bf16 v144, v96, s90, v251
    v_dot2_f32_bf16 v145, v96, s91, v251
    v_dot2_f32_bf16 v146, v97, s90, v251
    v_dot2_f32_bf16 v147, v97, s91, v251
    v_dot2_f32_bf16 v148, v98, s90, v251
    v_dot2_f32_bf16 v149, v98, s91, v251
    v_dot2_f32_bf16 v150, v99, s90, v251
    v_dot2_f32_bf16 v151, v99, s91, v251
    s_add_u32 m0, s64, 8192
    s_add_u32 s67, s65, 0
    buffer_load_dwordx4 v245, s[20:23], s67 offen lds
    v_cvt_pk_bf16_f32 v96, v144, v145
    v_cvt_pk_bf16_f32 v97, v146, v147
    v_cvt_pk_bf16_f32 v98, v148, v149
    v_cvt_pk_bf16_f32 v99, v150, v151
    v_dot2_f32_bf16 v152, v104, s90, v251
    v_dot2_f32_bf16 v153, v104, s91, v251
    v_dot2_f32_bf16 v154, v105, s90, v251
    v_dot2_f32_bf16 v155, v105, s91, v251
    v_dot2_f32_bf16 v156, v106, s90, v251
    v_dot2_f32_bf16 v157, v106, s91, v251
    v_dot2_f32_bf16 v158, v107, s90, v251
    v_dot2_f32_bf16 v159, v107, s91, v251
    v_cvt_pk_bf16_f32 v104, v152, v153
    v_cvt_pk_bf16_f32 v105, v154, v155
    v_cvt_pk_bf16_f32 v106, v156, v157
    v_cvt_pk_bf16_f32 v107, v158, v159
    v_dot2_f32_bf16 v144, v112, s90, v251
    v_dot2_f32_bf16 v145, v112, s91, v251
    v_dot2_f32_bf16 v146, v113, s90, v251
    v_dot2_f32_bf16 v147, v113, s91, v251
    v_dot2_f32_bf16 v148, v114, s90, v251
    v_dot2_f32_bf16 v149, v114, s91, v251
    v_dot2_f32_bf16 v150, v115, s90, v251
    v_dot2_f32_bf16 v151, v115, s91, v251
    s_add_u32 m0, s64, 16384
    s_add_u32 s67, s65, 128
    buffer_load_dwordx4 v245, s[16:19], s67 offen lds
    v_cvt_pk_bf16_f32 v112, v144, v145
    v_cvt_pk_bf16_f32 v113, v146, v147
    v_cvt_pk_bf16_f32 v114, v148, v149
    v_cvt_pk_bf16_f32 v115, v150, v151
    v_dot2_f32_bf16 v152, v120, s90, v251
    v_dot2_f32_bf16 v153, v120, s91, v251
    v_dot2_f32_bf16 v154, v121, s90, v251
    v_dot2_f32_bf16 v155, v121, s91, v251
    v_dot2_f32_bf16 v156, v122, s90, v251
    v_dot2_f32_bf16 v157, v122, s91, v251
    v_dot2_f32_bf16 v158, v123, s90, v251
    v_dot2_f32_bf16 v159, v123, s91, v251
    v_cvt_pk_bf16_f32 v120, v152, v153
    v_cvt_pk_bf16_f32 v121, v154, v155
    v_cvt_pk_bf16_f32 v122, v156, v157
    v_cvt_pk_bf16_f32 v123, v158, v159
    v_dot2_f32_bf16 v144, v128, s90, v251
    v_dot2_f32_bf16 v145, v128, s91, v251
    v_dot2_f32_bf16 v146, v129, s90, v251
    v_dot2_f32_bf16 v147, v129, s91, v251
    v_dot2_f32_bf16 v148, v130, s90, v251
    v_dot2_f32_bf16 v149, v130, s91, v251
    v_dot2_f32_bf16 v150, v131, s90, v251
    v_dot2_f32_bf16 v151, v131, s91, v251
    s_add_u32 m0, s64, 24576
    s_add_u32 s67, s65, 128
    buffer_load_dwordx4 v245, s[20:23], s67 offen lds
    v_cvt_pk_bf16_f32 v128, v144, v145
    v_cvt_pk_bf16_f32 v129, v146, v147
    v_cvt_pk_bf16_f32 v130, v148, v149
    v_cvt_pk_bf16_f32 v131, v150, v151
    v_dot2_f32_bf16 v152, v136, s90, v251
    v_dot2_f32_bf16 v153, v136, s91, v251
    v_dot2_f32_bf16 v154, v137, s90, v251
    v_dot2_f32_bf16 v155, v137, s91, v251
    v_dot2_f32_bf16 v156, v138, s90, v251
    v_dot2_f32_bf16 v157, v138, s91, v251
    v_dot2_f32_bf16 v158, v139, s90, v251
    v_dot2_f32_bf16 v159, v139, s91, v251
    v_cvt_pk_bf16_f32 v136, v152, v153
    v_cvt_pk_bf16_f32 v137, v154, v155
    v_cvt_pk_bf16_f32 v138, v156, v157
    v_cvt_pk_bf16_f32 v139, v158, v159
    s_waitcnt vmcnt(4)
    s_barrier
    ds_read_b128 v[4:7], v252 offset:0
    ds_read_b128 v[12:15], v253 offset:0
    ds_read_b128 v[20:23], v252 offset:8192
    ds_read_b128 v[28:31], v253 offset:8192
    ds_read_b128 v[36:39], v252 offset:16384
    ds_read_b128 v[44:47], v253 offset:16384
    ds_read_b128 v[52:55], v252 offset:24576
    ds_read_b128 v[60:63], v253 offset:24576
    s_waitcnt lgkmcnt(7)
    v_mfma_f32_16x16x32_bf16 v[196:199], v[232:235], v[4:7], 0
    ds_read_b128 v[68:71], v252 offset:32768
    s_waitcnt lgkmcnt(7)
    v_mfma_f32_16x16x32_bf16 v[196:199], v[232:235], v[12:15], v[196:199]
    ds_read_b128 v[76:79], v253 offset:32768
    s_waitcnt lgkmcnt(7)
    v_mfma_f32_16x16x32_bf16 v[196:199], v[232:235], v[20:23], v[196:199]
    ds_read_b128 v[84:87], v252 offset:40960
    s_waitcnt lgkmcnt(7)
    v_mfma_f32_16x16x32_bf16 v[196:199], v[232:235], v[28:31], v[196:199]
    ds_read_b128 v[92:95], v253 offset:40960
    s_waitcnt lgkmcnt(7)
    v_mfma_f32_16x16x32_bf16 v[196:199], v[232:235], v[36:39], v[196:199]
    v_add_u32 v252, 49152, v252
    v_add_u32 v253, 49152, v253
    ds_read_b128 v[100:103], v252 offset:0
    s_add_u32 m0, s64, 32768
    s_add_u32 s67, s65, 256
    buffer_load_dwordx4 v245, s[16:19], s67 offen lds
    s_waitcnt lgkmcnt(7)
    v_mfma_f32_16x16x32_bf16 v[196:199], v[232:235], v[44:47], v[196:199]
    ds_read_b128 v[108:111], v253 offset:0
    s_waitcnt lgkmcnt(7)
    v_mfma_f32_16x16x32_bf16 v[196:199], v[232:235], v[52:55], v[196:199]
    ds_read_b128 v[116:119], v252 offset:8192
    s_waitcnt lgkmcnt(7)
    v_mfma_f32_16x16x32_bf16 v[196:199], v[232:235], v[60:63], v[196:199]
    ds_read_b128 v[124:127], v253 offset:8192
    s_waitcnt lgkmcnt(7)
    v_mfma_f32_16x16x32_bf16 v[196:199], v[232:235], v[68:71], v[196:199]
    ds_read_b128 v[132:135], v252 offset:16384
    s_waitcnt lgkmcnt(7)
    v_mfma_f32_16x16x32_bf16 v[196:199], v[232:235], v[76:79], v[196:199]
    ds_read_b128 v[140:143], v253 offset:16384
    s_waitcnt lgkmcnt(7)
    v_mfma_f32_16x16x32_bf16 v[196:199], v[232:235], v[84:87], v[196:199]
    s_add_u32 m0, s64, 40960
    s_add_u32 s67, s65, 256
    buffer_load_dwordx4 v245, s[20:23], s67 offen lds
    s_waitcnt lgkmcnt(6)
    v_mfma_f32_16x16x32_bf16 v[196:199], v[232:235], v[92:95], v[196:199]
    s_waitcnt lgkmcnt(5)
    v_mfma_f32_16x16x32_bf16 v[196:199], v[232:235], v[100:103], v[196:199]
    s_waitcnt lgkmcnt(4)
    v_mfma_f32_16x16x32_bf16 v[196:199], v[232:235], v[108:111], v[196:199]
    s_waitcnt lgkmcnt(3)
    v_mfma_f32_16x16x32_bf16 v[196:199], v[232:235], v[116:119], v[196:199]
    s_waitcnt lgkmcnt(2)
    v_mfma_f32_16x16x32_bf16 v[196:199], v[232:235], v[124:127], v[196:199]
    s_waitcnt lgkmcnt(1)
    v_mfma_f32_16x16x32_bf16 v[196:199], v[232:235], v[132:135], v[196:199]
    s_add_u32 m0, s64, 49152
    s_add_u32 s67, s65, 384
    buffer_load_dwordx4 v245, s[16:19], s67 offen lds
    s_waitcnt lgkmcnt(0)
    v_mfma_f32_16x16x32_bf16 v[196:199], v[232:235], v[140:143], v[196:199]
    s_barrier
    s_lshr_b32 s87, s3, 2
    s_lshl_b32 s69, s87, 12
    s_and_b32 s88, s3, 3
    s_lshl_b32 s88, s88, 10
    s_add_u32 s69, s69, s88
    s_add_u32 s69, s69, 98304
    s_lshl_b32 s70, s87, 7
    s_add_u32 s70, s70, s66
    s_add_u32 s70, s70, 147456
    s_and_b32 s88, s3, 6
    s_mul_i32 s88, s88, 9216
    s_sub_u32 s70, s70, s88
    s_bitcmp1_b32 s3, 1
    s_cselect_b32 s32, s20, s16
    s_cselect_b32 s33, s21, s17
    s_mov_b32 s34, 663552
    s_mov_b32 s35, 0x20000
    s_add_u32 m0, s69, 0
    s_add_u32 s67, s70, 0
    buffer_load_dwordx4 v245, s[32:35], s67 offen lds
    s_add_u32 m0, s69, 8192
    s_add_u32 s67, s70, 256
    buffer_load_dwordx4 v245, s[32:35], s67 offen lds
    s_add_u32 m0, s69, 16384
    s_add_u32 s67, s70, 512
    buffer_load_dwordx4 v245, s[32:35], s67 offen lds
    s_add_u32 m0, s69, 24576
    s_add_u32 s67, s70, 768
    buffer_load_dwordx4 v245, s[32:35], s67 offen lds
    s_add_u32 m0, s69, 32768
    s_add_u32 s67, s70, 1024
    buffer_load_dwordx4 v245, s[32:35], s67 offen lds
    s_cmp_lg_u32 s5, 1
    s_cbranch_scc1 L_ngM1
    v_mfma_f32_16x16x32_bf16 v[204:207], v[4:7], v[4:7], 0
    v_mfma_f32_16x16x32_bf16 v[204:207], v[12:15], v[12:15], v[204:207]
    v_mfma_f32_16x16x32_bf16 v[204:207], v[20:23], v[20:23], v[204:207]
    v_mfma_f32_16x16x32_bf16 v[204:207], v[28:31], v[28:31], v[204:207]
    v_mfma_f32_16x16x32_bf16 v[204:207], v[36:39], v[36:39], v[204:207]
    v_mfma_f32_16x16x32_bf16 v[204:207], v[44:47], v[44:47], v[204:207]
    v_mfma_f32_16x16x32_bf16 v[204:207], v[52:55], v[52:55], v[204:207]
    v_mfma_f32_16x16x32_bf16 v[204:207], v[60:63], v[60:63], v[204:207]
    v_mfma_f32_16x16x32_bf16 v[204:207], v[68:71], v[68:71], v[204:207]
    v_mfma_f32_16x16x32_bf16 v[204:207], v[76:79], v[76:79], v[204:207]
    v_mfma_f32_16x16x32_bf16 v[204:207], v[84:87], v[84:87], v[204:207]
    v_mfma_f32_16x16x32_bf16 v[204:207], v[92:95], v[92:95], v[204:207]
    v_mfma_f32_16x16x32_bf16 v[204:207], v[100:103], v[100:103], v[204:207]
    v_mfma_f32_16x16x32_bf16 v[204:207], v[108:111], v[108:111], v[204:207]
    v_mfma_f32_16x16x32_bf16 v[204:207], v[116:119], v[116:119], v[204:207]
    v_mfma_f32_16x16x32_bf16 v[204:207], v[124:127], v[124:127], v[204:207]
    v_mfma_f32_16x16x32_bf16 v[204:207], v[132:135], v[132:135], v[204:207]
    v_mfma_f32_16x16x32_bf16 v[204:207], v[140:143], v[140:143], v[204:207]
L_ngM1:
    s_nop 4
    v_mul_f32 v196, 0x3ae38e39, v196
    v_cvt_pk_bf16_f32 v247, v196, v196
    v_lshlrev_b32_e64 v247, 16, v247
    v_xor_b32 v247, 0x80000000, v247
    v_dot2_f32_bf16 v144, v4, s90, v247
    v_dot2_f32_bf16 v145, v4, s91, v247
    v_dot2_f32_bf16 v146, v5, s90, v247
    v_dot2_f32_bf16 v147, v5, s91, v247
    v_dot2_f32_bf16 v148, v6, s90, v247
    v_dot2_f32_bf16 v149, v6, s91, v247
    v_dot2_f32_bf16 v150, v7, s90, v247
    v_dot2_f32_bf16 v151, v7, s91, v247
    s_add_u32 m0, s64, 57344
    s_add_u32 s67, s65, 384
    buffer_load_dwordx4 v245, s[20:23], s67 offen lds
    v_cvt_pk_bf16_f32 v4, v144, v145
    v_cvt_pk_bf16_f32 v5, v146, v147
    v_cvt_pk_bf16_f32 v6, v148, v149
    v_cvt_pk_bf16_f32 v7, v150, v151
    v_dot2_f32_bf16 v152, v12, s90, v247
    v_dot2_f32_bf16 v153, v12, s91, v247
    v_dot2_f32_bf16 v154, v13, s90, v247
    v_dot2_f32_bf16 v155, v13, s91, v247
    v_dot2_f32_bf16 v156, v14, s90, v247
    v_dot2_f32_bf16 v157, v14, s91, v247
    v_dot2_f32_bf16 v158, v15, s90, v247
    v_dot2_f32_bf16 v159, v15, s91, v247
    v_cvt_pk_bf16_f32 v12, v152, v153
    v_cvt_pk_bf16_f32 v13, v154, v155
    v_cvt_pk_bf16_f32 v14, v156, v157
    v_cvt_pk_bf16_f32 v15, v158, v159
    v_dot2_f32_bf16 v144, v20, s90, v247
    v_dot2_f32_bf16 v145, v20, s91, v247
    v_dot2_f32_bf16 v146, v21, s90, v247
    v_dot2_f32_bf16 v147, v21, s91, v247
    v_dot2_f32_bf16 v148, v22, s90, v247
    v_dot2_f32_bf16 v149, v22, s91, v247
    v_dot2_f32_bf16 v150, v23, s90, v247
    v_dot2_f32_bf16 v151, v23, s91, v247
    s_add_u32 m0, s64, 65536
    s_add_u32 s67, s65, 512
    buffer_load_dwordx4 v245, s[16:19], s67 offen lds
    v_cvt_pk_bf16_f32 v20, v144, v145
    v_cvt_pk_bf16_f32 v21, v146, v147
    v_cvt_pk_bf16_f32 v22, v148, v149
    v_cvt_pk_bf16_f32 v23, v150, v151
    v_dot2_f32_bf16 v152, v28, s90, v247
    v_dot2_f32_bf16 v153, v28, s91, v247
    v_dot2_f32_bf16 v154, v29, s90, v247
    v_dot2_f32_bf16 v155, v29, s91, v247
    v_dot2_f32_bf16 v156, v30, s90, v247
    v_dot2_f32_bf16 v157, v30, s91, v247
    v_dot2_f32_bf16 v158, v31, s90, v247
    v_dot2_f32_bf16 v159, v31, s91, v247
    v_cvt_pk_bf16_f32 v28, v152, v153
    v_cvt_pk_bf16_f32 v29, v154, v155
    v_cvt_pk_bf16_f32 v30, v156, v157
    v_cvt_pk_bf16_f32 v31, v158, v159
    v_dot2_f32_bf16 v144, v36, s90, v247
    v_dot2_f32_bf16 v145, v36, s91, v247
    v_dot2_f32_bf16 v146, v37, s90, v247
    v_dot2_f32_bf16 v147, v37, s91, v247
    v_dot2_f32_bf16 v148, v38, s90, v247
    v_dot2_f32_bf16 v149, v38, s91, v247
    v_dot2_f32_bf16 v150, v39, s90, v247
    v_dot2_f32_bf16 v151, v39, s91, v247
    s_add_u32 m0, s64, 73728
    s_add_u32 s67, s65, 512
    buffer_load_dwordx4 v245, s[20:23], s67 offen lds
    v_cvt_pk_bf16_f32 v36, v144, v145
    v_cvt_pk_bf16_f32 v37, v146, v147
    v_cvt_pk_bf16_f32 v38, v148, v149
    v_cvt_pk_bf16_f32 v39, v150, v151
    v_dot2_f32_bf16 v152, v44, s90, v247
    v_dot2_f32_bf16 v153, v44, s91, v247
    v_dot2_f32_bf16 v154, v45, s90, v247
    v_dot2_f32_bf16 v155, v45, s91, v247
    v_dot2_f32_bf16 v156, v46, s90, v247
    v_dot2_f32_bf16 v157, v46, s91, v247
    v_dot2_f32_bf16 v158, v47, s90, v247
    v_dot2_f32_bf16 v159, v47, s91, v247
    v_cvt_pk_bf16_f32 v44, v152, v153
    v_cvt_pk_bf16_f32 v45, v154, v155
    v_cvt_pk_bf16_f32 v46, v156, v157
    v_cvt_pk_bf16_f32 v47, v158, v159
    v_dot2_f32_bf16 v144, v52, s90, v247
    v_dot2_f32_bf16 v145, v52, s91, v247
    v_dot2_f32_bf16 v146, v53, s90, v247
    v_dot2_f32_bf16 v147, v53, s91, v247
    v_dot2_f32_bf16 v148, v54, s90, v247
    v_dot2_f32_bf16 v149, v54, s91, v247
    v_dot2_f32_bf16 v150, v55, s90, v247
    v_dot2_f32_bf16 v151, v55, s91, v247
    s_add_u32 m0, s64, 81920
    s_add_u32 s67, s65, 640
    buffer_load_dwordx4 v245, s[16:19], s67 offen lds
    v_cvt_pk_bf16_f32 v52, v144, v145
    v_cvt_pk_bf16_f32 v53, v146, v147
    v_cvt_pk_bf16_f32 v54, v148, v149
    v_cvt_pk_bf16_f32 v55, v150, v151
    v_dot2_f32_bf16 v152, v60, s90, v247
    v_dot2_f32_bf16 v153, v60, s91, v247
    v_dot2_f32_bf16 v154, v61, s90, v247
    v_dot2_f32_bf16 v155, v61, s91, v247
    v_dot2_f32_bf16 v156, v62, s90, v247
    v_dot2_f32_bf16 v157, v62, s91, v247
    v_dot2_f32_bf16 v158, v63, s90, v247
    v_dot2_f32_bf16 v159, v63, s91, v247
    v_cvt_pk_bf16_f32 v60, v152, v153
    v_cvt_pk_bf16_f32 v61, v154, v155
    v_cvt_pk_bf16_f32 v62, v156, v157
    v_cvt_pk_bf16_f32 v63, v158, v159
    v_dot2_f32_bf16 v144, v68, s90, v247
    v_dot2_f32_bf16 v145, v68, s91, v247
    v_dot2_f32_bf16 v146, v69, s90, v247
    v_dot2_f32_bf16 v147, v69, s91, v247
    v_dot2_f32_bf16 v148, v70, s90, v247
    v_dot2_f32_bf16 v149, v70, s91, v247
    v_dot2_f32_bf16 v150, v71, s90, v247
    v_dot2_f32_bf16 v151, v71, s91, v247
    s_add_u32 m0, s64, 90112
    s_add_u32 s67, s65, 640
    buffer_load_dwordx4 v245, s[20:23], s67 offen lds
    v_cvt_pk_bf16_f32 v68, v144, v145
    v_cvt_pk_bf16_f32 v69, v146, v147
    v_cvt_pk_bf16_f32 v70, v148, v149
    v_cvt_pk_bf16_f32 v71, v150, v151
    v_dot2_f32_bf16 v152, v76, s90, v247
    v_dot2_f32_bf16 v153, v76, s91, v247
    v_dot2_f32_bf16 v154, v77, s90, v247
    v_dot2_f32_bf16 v155, v77, s91, v247
    v_dot2_f32_bf16 v156, v78, s90, v247
    v_dot2_f32_bf16 v157, v78, s91, v247
    v_dot2_f32_bf16 v158, v79, s90, v247
    v_dot2_f32_bf16 v159, v79, s91, v247
    v_cvt_pk_bf16_f32 v76, v152, v153
    v_cvt_pk_bf16_f32 v77, v154, v155
    v_cvt_pk_bf16_f32 v78, v156, v157
    v_cvt_pk_bf16_f32 v79, v158, v159
    v_dot2_f32_bf16 v144, v84, s90, v247
    v_dot2_f32_bf16 v145, v84, s91, v247
    v_dot2_f32_bf16 v146, v85, s90, v247
    v_dot2_f32_bf16 v147, v85, s91, v247
    v_dot2_f32_bf16 v148, v86, s90, v247
    v_dot2_f32_bf16 v149, v86, s91, v247
    v_dot2_f32_bf16 v150, v87, s90, v247
    v_dot2_f32_bf16 v151, v87, s91, v247
    v_cvt_pk_bf16_f32 v84, v144, v145
    v_cvt_pk_bf16_f32 v85, v146, v147
    v_cvt_pk_bf16_f32 v86, v148, v149
    v_cvt_pk_bf16_f32 v87, v150, v151
    v_dot2_f32_bf16 v152, v92, s90, v247
    v_dot2_f32_bf16 v153, v92, s91, v247
    v_dot2_f32_bf16 v154, v93, s90, v247
    v_dot2_f32_bf16 v155, v93, s91, v247
    v_dot2_f32_bf16 v156, v94, s90, v247
    v_dot2_f32_bf16 v157, v94, s91, v247
    v_dot2_f32_bf16 v158, v95, s90, v247
    v_dot2_f32_bf16 v159, v95, s91, v247
    v_cvt_pk_bf16_f32 v92, v152, v153
    v_cvt_pk_bf16_f32 v93, v154, v155
    v_cvt_pk_bf16_f32 v94, v156, v157
    v_cvt_pk_bf16_f32 v95, v158, v159
    v_dot2_f32_bf16 v144, v100, s90, v247
    v_dot2_f32_bf16 v145, v100, s91, v247
    v_dot2_f32_bf16 v146, v101, s90, v247
    v_dot2_f32_bf16 v147, v101, s91, v247
    v_dot2_f32_bf16 v148, v102, s90, v247
    v_dot2_f32_bf16 v149, v102, s91, v247
    v_dot2_f32_bf16 v150, v103, s90, v247
    v_dot2_f32_bf16 v151, v103, s91, v247
    v_cvt_pk_bf16_f32 v100, v144, v145
    v_cvt_pk_bf16_f32 v101, v146, v147
    v_cvt_pk_bf16_f32 v102, v148, v149
    v_cvt_pk_bf16_f32 v103, v150, v151
    v_dot2_f32_bf16 v152, v108, s90, v247
    v_dot2_f32_bf16 v153, v108, s91, v247
    v_dot2_f32_bf16 v154, v109, s90, v247
    v_dot2_f32_bf16 v155, v109, s91, v247
    v_dot2_f32_bf16 v156, v110, s90, v247
    v_dot2_f32_bf16 v157, v110, s91, v247
    v_dot2_f32_bf16 v158, v111, s90, v247
    v_dot2_f32_bf16 v159, v111, s91, v247
    v_cvt_pk_bf16_f32 v108, v152, v153
    v_cvt_pk_bf16_f32 v109, v154, v155
    v_cvt_pk_bf16_f32 v110, v156, v157
    v_cvt_pk_bf16_f32 v111, v158, v159
    v_dot2_f32_bf16 v144, v116, s90, v247
    v_dot2_f32_bf16 v145, v116, s91, v247
    v_dot2_f32_bf16 v146, v117, s90, v247
    v_dot2_f32_bf16 v147, v117, s91, v247
    v_dot2_f32_bf16 v148, v118, s90, v247
    v_dot2_f32_bf16 v149, v118, s91, v247
    v_dot2_f32_bf16 v150, v119, s90, v247
    v_dot2_f32_bf16 v151, v119, s91, v247
    v_cvt_pk_bf16_f32 v116, v144, v145
    v_cvt_pk_bf16_f32 v117, v146, v147
    v_cvt_pk_bf16_f32 v118, v148, v149
    v_cvt_pk_bf16_f32 v119, v150, v151
    v_dot2_f32_bf16 v152, v124, s90, v247
    v_dot2_f32_bf16 v153, v124, s91, v247
    v_dot2_f32_bf16 v154, v125, s90, v247
    v_dot2_f32_bf16 v155, v125, s91, v247
    v_dot2_f32_bf16 v156, v126, s90, v247
    v_dot2_f32_bf16 v157, v126, s91, v247
    v_dot2_f32_bf16 v158, v127, s90, v247
    v_dot2_f32_bf16 v159, v127, s91, v247
    v_cvt_pk_bf16_f32 v124, v152, v153
    v_cvt_pk_bf16_f32 v125, v154, v155
    v_cvt_pk_bf16_f32 v126, v156, v157
    v_cvt_pk_bf16_f32 v127, v158, v159
    v_dot2_f32_bf16 v144, v132, s90, v247
    v_dot2_f32_bf16 v145, v132, s91, v247
    v_dot2_f32_bf16 v146, v133, s90, v247
    v_dot2_f32_bf16 v147, v133, s91, v247
    v_dot2_f32_bf16 v148, v134, s90, v247
    v_dot2_f32_bf16 v149, v134, s91, v247
    v_dot2_f32_bf16 v150, v135, s90, v247
    v_dot2_f32_bf16 v151, v135, s91, v247
    v_cvt_pk_bf16_f32 v132, v144, v145
    v_cvt_pk_bf16_f32 v133, v146, v147
    v_cvt_pk_bf16_f32 v134, v148, v149
    v_cvt_pk_bf16_f32 v135, v150, v151
    v_dot2_f32_bf16 v152, v140, s90, v247
    v_dot2_f32_bf16 v153, v140, s91, v247
    v_dot2_f32_bf16 v154, v141, s90, v247
    v_dot2_f32_bf16 v155, v141, s91, v247
    v_dot2_f32_bf16 v156, v142, s90, v247
    v_dot2_f32_bf16 v157, v142, s91, v247
    v_dot2_f32_bf16 v158, v143, s90, v247
    v_dot2_f32_bf16 v159, v143, s91, v247
    v_cvt_pk_bf16_f32 v140, v152, v153
    v_cvt_pk_bf16_f32 v141, v154, v155
    v_cvt_pk_bf16_f32 v142, v156, v157
    v_cvt_pk_bf16_f32 v143, v158, v159
    s_cmp_eq_u32 s5, 0
    s_cbranch_scc1 L_ownM
    v_mov_b32 v200, v196
    v_mov_b32 v251, v247
L_ownM:
    s_waitcnt vmcnt(5)
    s_barrier
    s_mul_i32 s95, s6, 36
    s_mul_i32 s87, s7, 9
    s_add_u32 s95, s95, s87
    s_lshl_b32 s95, s95, 13
    s_add_u32 s95, s95, 18874368
    s_mul_i32 s86, s6, 4608
    s_mul_i32 s87, s7, 1152
    s_add_u32 s86, s86, s87
    s_mul_i32 s87, s5, 3968
    s_sub_u32 s86, s86, s87
    s_add_u32 s86, s86, 23592960
    s_cmp_lg_u32 s5, 0
    s_cbranch_scc1 LA_Q1
    v_add_u32 v242, 98304, v242
    v_add_u32 v243, 98304, v243
    ds_read_b128 v[208:211], v242 offset:0
    ds_read_b128 v[212:215], v242 offset:2048
    ds_read_b128 v[216:219], v243 offset:0
    ds_read_b128 v[220:223], v243 offset:2048
    ds_read_b128 v[224:227], v242 offset:4096
    s_waitcnt lgkmcnt(4)
    v_mfma_f32_16x16x32_bf16 v[144:147], v[0:3], v[208:211], 0
    v_bfe_u32 v238, v246, 4, 2
    v_mfma_f32_16x16x32_bf16 v[148:151], v[4:7], v[208:211], 0
    ds_read_b128 v[228:231], v242 offset:6144
    s_waitcnt lgkmcnt(4)
    v_mfma_f32_16x16x32_bf16 v[152:155], v[0:3], v[212:215], 0
    v_cmp_eq_u32 s[32:33], 1, v238
    v_mfma_f32_16x16x32_bf16 v[156:159], v[4:7], v[212:215], 0
    ds_read_b128 v[208:211], v243 offset:4096
    v_cmp_eq_u32 s[34:35], 2, v238
    s_waitcnt lgkmcnt(4)
    v_mfma_f32_16x16x32_bf16 v[144:147], v[8:11], v[216:219], v[144:147]
    v_mfma_f32_16x16x32_bf16 v[148:151], v[12:15], v[216:219], v[148:151]
    ds_read_b128 v[212:215], v243 offset:6144
    v_cmp_eq_u32 vcc, 3, v238
    s_waitcnt lgkmcnt(4)
    v_mfma_f32_16x16x32_bf16 v[152:155], v[8:11], v[220:223], v[152:155]
    v_mfma_f32_16x16x32_bf16 v[156:159], v[12:15], v[220:223], v[156:159]
    ds_read_b128 v[216:219], v242 offset:8192
    v_bfe_u32 v238, v246, 4, 4
    s_waitcnt lgkmcnt(4)
    v_mfma_f32_16x16x32_bf16 v[144:147], v[16:19], v[224:227], v[144:147]
    v_bfe_u32 v239, v246, 6, 2
    v_mfma_f32_16x16x32_bf16 v[148:151], v[20:23], v[224:227], v[148:151]
    ds_read_b128 v[220:223], v242 offset:10240
    s_waitcnt lgkmcnt(4)
    v_mfma_f32_16x16x32_bf16 v[152:155], v[16:19], v[228:231], v[152:155]
    v_lshlrev_b32 v238, 2, v238
    v_mfma_f32_16x16x32_bf16 v[156:159], v[20:23], v[228:231], v[156:159]
    ds_read_b128 v[224:227], v243 offset:8192
    v_lshl_add_u32 v238, v239, 6, v238
    s_waitcnt lgkmcnt(4)
    v_mfma_f32_16x16x32_bf16 v[144:147], v[24:27], v[208:211], v[144:147]
    v_mfma_f32_16x16x32_bf16 v[148:151], v[28:31], v[208:211], v[148:151]
    ds_read_b128 v[228:231], v243 offset:10240
    v_cndmask_b32_e64 v204, v204, v205, s[32:33]
    s_waitcnt lgkmcnt(4)
    v_mfma_f32_16x16x32_bf16 v[152:155], v[24:27], v[212:215], v[152:155]
    v_cndmask_b32_e64 v204, v204, v206, s[34:35]
    v_mfma_f32_16x16x32_bf16 v[156:159], v[28:31], v[212:215], v[156:159]
    ds_read_b128 v[208:211], v242 offset:12288
    s_waitcnt lgkmcnt(4)
    v_mfma_f32_16x16x32_bf16 v[144:147], v[32:35], v[216:219], v[144:147]
    v_cndmask_b32 v204, v204, v207, vcc
    v_mfma_f32_16x16x32_bf16 v[148:151], v[36:39], v[216:219], v[148:151]
    ds_read_b128 v[212:215], v242 offset:14336
    s_waitcnt lgkmcnt(4)
    v_mfma_f32_16x16x32_bf16 v[152:155], v[32:35], v[220:223], v[152:155]
    v_mfma_f32_16x16x32_bf16 v[156:159], v[36:39], v[220:223], v[156:159]
    ds_read_b128 v[216:219], v243 offset:12288
    s_waitcnt lgkmcnt(4)
    v_mfma_f32_16x16x32_bf16 v[144:147], v[40:43], v[224:227], v[144:147]
    v_mfma_f32_16x16x32_bf16 v[148:151], v[44:47], v[224:227], v[148:151]
    ds_read_b128 v[220:223], v243 offset:14336
    ds_bpermute_b32 v205, v238, v204
    s_waitcnt lgkmcnt(5)
    v_mfma_f32_16x16x32_bf16 v[152:155], v[40:43], v[228:231], v[152:155]
    v_mfma_f32_16x16x32_bf16 v[156:159], v[44:47], v[228:231], v[156:159]
    ds_read_b128 v[224:227], v242 offset:16384
    s_waitcnt lgkmcnt(5)
    v_mfma_f32_16x16x32_bf16 v[144:147], v[48:51], v[208:211], v[144:147]
    v_mfma_f32_16x16x32_bf16 v[148:151], v[52:55], v[208:211], v[148:151]
    ds_read_b128 v[228:231], v242 offset:18432
    s_waitcnt lgkmcnt(5)
    v_mfma_f32_16x16x32_bf16 v[152:155], v[48:51], v[212:215], v[152:155]
    v_mfma_f32_16x16x32_bf16 v[156:159], v[52:55], v[212:215], v[156:159]
    ds_read_b128 v[208:211], v243 offset:16384
    v_mul_f32_e64 v200, v200, v200
    s_waitcnt lgkmcnt(5)
    v_mfma_f32_16x16x32_bf16 v[144:147], v[56:59], v[216:219], v[144:147]
    s_mov_b32 s88, 0x3ae38e39
    s_waitcnt lgkmcnt(3)
    v_mfma_f32_16x16x32_bf16 v[148:151], v[60:63], v[216:219], v[148:151]
    ds_read_b128 v[212:215], v243 offset:18432
    v_fma_f32 v205, v205, s88, -v200
    v_mfma_f32_16x16x32_bf16 v[152:155], v[56:59], v[220:223], v[152:155]
    v_mfma_f32_16x16x32_bf16 v[156:159], v[60:63], v[220:223], v[156:159]
    ds_read_b128 v[216:219], v242 offset:20480
    v_max_f32_e64 v205, 0, v205
    s_waitcnt lgkmcnt(4)
    v_mfma_f32_16x16x32_bf16 v[144:147], v[64:67], v[224:227], v[144:147]
    v_cvt_pk_bf16_f32 v205, v205, v205
    v_mfma_f32_16x16x32_bf16 v[148:151], v[68:71], v[224:227], v[148:151]
    ds_read_b128 v[220:223], v242 offset:22528
    s_waitcnt lgkmcnt(4)
    v_mfma_f32_16x16x32_bf16 v[152:155], v[64:67], v[228:231], v[152:155]
    v_lshlrev_b32 v205, 16, v205
    v_mfma_f32_16x16x32_bf16 v[156:159], v[68:71], v[228:231], v[156:159]
    ds_read_b128 v[224:227], v243 offset:20480
    v_add_f32 v205, 0x3727c5ac, v205
    s_waitcnt lgkmcnt(4)
    v_mfma_f32_16x16x32_bf16 v[144:147], v[72:75], v[208:211], v[144:147]
    v_mfma_f32_16x16x32_bf16 v[148:151], v[76:79], v[208:211], v[148:151]
    ds_read_b128 v[228:231], v243 offset:22528
    v_cvt_pk_bf16_f32 v205, v205, v205
    s_waitcnt lgkmcnt(4)
    v_mfma_f32_16x16x32_bf16 v[152:155], v[72:75], v[212:215], v[152:155]
    v_lshlrev_b32_e64 v205, 16, v205
    v_mfma_f32_16x16x32_bf16 v[156:159], v[76:79], v[212:215], v[156:159]
    ds_read_b128 v[208:211], v242 offset:24576
    s_waitcnt lgkmcnt(4)
    v_mfma_f32_16x16x32_bf16 v[144:147], v[80:83], v[216:219], v[144:147]
    v_mfma_f32_16x16x32_bf16 v[148:151], v[84:87], v[216:219], v[148:151]
    ds_read_b128 v[212:215], v242 offset:26624
    v_sqrt_f32_e64 v205, v205
    s_waitcnt lgkmcnt(4)
    v_mfma_f32_16x16x32_bf16 v[152:155], v[80:83], v[220:223], v[152:155]
    v_mfma_f32_16x16x32_bf16 v[156:159], v[84:87], v[220:223], v[156:159]
    ds_read_b128 v[216:219], v243 offset:24576
    v_xor_b32 v204, 0x80000000, v251
    s_waitcnt lgkmcnt(4)
    v_mfma_f32_16x16x32_bf16 v[144:147], v[88:91], v[224:227], v[144:147]
    v_mfma_f32_16x16x32_bf16 v[148:151], v[92:95], v[224:227], v[148:151]
    ds_read_b128 v[220:223], v243 offset:26624
    v_cvt_pk_bf16_f32 v205, v205, v205
    s_waitcnt lgkmcnt(4)
    v_mfma_f32_16x16x32_bf16 v[152:155], v[88:91], v[228:231], v[152:155]
    v_lshlrev_b32_e64 v205, 16, v205
    v_mfma_f32_16x16x32_bf16 v[156:159], v[92:95], v[228:231], v[156:159]
    ds_read_b128 v[224:227], v242 offset:28672
    s_waitcnt lgkmcnt(4)
    v_mfma_f32_16x16x32_bf16 v[144:147], v[96:99], v[208:211], v[144:147]
    v_mfma_f32_16x16x32_bf16 v[148:151], v[100:103], v[208:211], v[148:151]
    ds_read_b128 v[228:231], v242 offset:30720
    v_rcp_f32_e64 v205, v205
    s_waitcnt lgkmcnt(4)
    v_mfma_f32_16x16x32_bf16 v[152:155], v[96:99], v[212:215], v[152:155]
    v_mfma_f32_16x16x32_bf16 v[156:159], v[100:103], v[212:215], v[156:159]
    ds_read_b128 v[208:211], v243 offset:28672
    v_bfe_u32 v236, v246, 6, 2
    s_waitcnt lgkmcnt(4)
    v_mfma_f32_16x16x32_bf16 v[144:147], v[104:107], v[216:219], v[144:147]
    v_bfe_u32 v237, v246, 4, 2
    v_mfma_f32_16x16x32_bf16 v[148:151], v[108:111], v[216:219], v[148:151]
    ds_read_b128 v[212:215], v243 offset:30720
    s_lshl_b32 s87, s4, 7
    s_waitcnt lgkmcnt(4)
    v_mfma_f32_16x16x32_bf16 v[152:155], v[104:107], v[220:223], v[152:155]
    s_add_u32 s87, s87, 162816
    v_mfma_f32_16x16x32_bf16 v[156:159], v[108:111], v[220:223], v[156:159]
    ds_read_b128 v[216:219], v242 offset:32768
    v_lshl_add_u32 v236, v236, 5, s87
    s_waitcnt lgkmcnt(4)
    v_mfma_f32_16x16x32_bf16 v[144:147], v[112:115], v[224:227], v[144:147]
    v_lshl_add_u32 v236, v237, 2, v236
    v_mfma_f32_16x16x32_bf16 v[148:151], v[116:119], v[224:227], v[148:151]
    ds_read_b128 v[220:223], v242 offset:34816
    s_waitcnt lgkmcnt(4)
    v_mfma_f32_16x16x32_bf16 v[152:155], v[112:115], v[228:231], v[152:155]
    v_lshl_add_u32 v236, s5, 4, v236
    v_mfma_f32_16x16x32_bf16 v[156:159], v[116:119], v[228:231], v[156:159]
    ds_read_b128 v[224:227], v243 offset:32768
    ds_write_b32 v236, v204 offset:512
    ds_write_b32 v236, v205
    s_waitcnt lgkmcnt(6)
    v_mfma_f32_16x16x32_bf16 v[144:147], v[120:123], v[208:211], v[144:147]
    v_mfma_f32_16x16x32_bf16 v[148:151], v[124:127], v[208:211], v[148:151]
    ds_read_b128 v[228:231], v243 offset:34816
    s_waitcnt lgkmcnt(6)
    v_mfma_f32_16x16x32_bf16 v[152:155], v[120:123], v[212:215], v[152:155]
    v_mfma_f32_16x16x32_bf16 v[156:159], v[124:127], v[212:215], v[156:159]
    s_waitcnt lgkmcnt(5)
    v_mfma_f32_16x16x32_bf16 v[144:147], v[128:131], v[216:219], v[144:147]
    v_mfma_f32_16x16x32_bf16 v[148:151], v[132:135], v[216:219], v[148:151]
    s_waitcnt lgkmcnt(4)
    v_mfma_f32_16x16x32_bf16 v[152:155], v[128:131], v[220:223], v[152:155]
    v_mfma_f32_16x16x32_bf16 v[156:159], v[132:135], v[220:223], v[156:159]
    s_waitcnt lgkmcnt(3)
    v_mfma_f32_16x16x32_bf16 v[144:147], v[136:139], v[224:227], v[144:147]
    v_mfma_f32_16x16x32_bf16 v[148:151], v[140:143], v[224:227], v[148:151]
    s_waitcnt lgkmcnt(0)
    v_mfma_f32_16x16x32_bf16 v[152:155], v[136:139], v[228:231], v[152:155]
    v_mfma_f32_16x16x32_bf16 v[156:159], v[140:143], v[228:231], v[156:159]
    v_subrev_u32 v242, 98304, v242
    v_subrev_u32 v243, 98304, v243
    ds_read_b128 v[208:211], v242 offset:0
    ds_read_b128 v[212:215], v242 offset:8192
    ds_read_b128 v[216:219], v242 offset:4096
    ds_read_b128 v[220:223], v242 offset:12288
    s_branch LA_M5
LA_Q1:
    s_and_saveexec_b64 s[46:47], s[44:45]
    s_cbranch_execz L_noct1
    ds_write_b64 v195, v[176:177] offset:0
    ds_write_b64 v195, v[178:179] offset:8
    ds_write_b64 v195, v[180:181] offset:16
    ds_write_b64 v195, v[182:183] offset:24
    ds_write_b64 v195, v[184:185] offset:32
    ds_write_b64 v195, v[186:187] offset:40
    ds_write_b64 v195, v[188:189] offset:48
    s_waitcnt lgkmcnt(0)
L_noct1:
    s_mov_b64 exec, -1
    v_bfe_u32 v238, v246, 4, 2
    v_cmp_eq_u32 s[32:33], 1, v238
    v_cmp_eq_u32 s[34:35], 2, v238
    v_cmp_eq_u32 vcc, 3, v238
    v_bfe_u32 v238, v246, 4, 4
    v_bfe_u32 v239, v246, 6, 2
    v_lshlrev_b32 v238, 2, v238
    v_lshl_add_u32 v238, v239, 6, v238
    v_cndmask_b32_e64 v204, v204, v205, s[32:33]
    v_cndmask_b32_e64 v204, v204, v206, s[34:35]
    v_cndmask_b32 v204, v204, v207, vcc
    ds_bpermute_b32 v205, v238, v204
    v_mul_f32 v200, v200, v200
    s_mov_b32 s88, 0x3ae38e39
    s_waitcnt lgkmcnt(0)
    v_fma_f32 v205, v205, s88, -v200
    v_max_f32 v205, 0, v205
    v_cvt_pk_bf16_f32 v205, v205, v205
    v_lshlrev_b32_e64 v205, 16, v205
    v_add_f32 v205, 0x3727c5ac, v205
    v_cvt_pk_bf16_f32 v205, v205, v205
    v_lshlrev_b32 v205, 16, v205
    v_sqrt_f32 v205, v205
    v_xor_b32 v204, 0x80000000, v251
    v_cvt_pk_bf16_f32 v205, v205, v205
    v_lshlrev_b32 v205, 16, v205
    v_rcp_f32 v205, v205
    v_bfe_u32 v236, v246, 6, 2
    v_bfe_u32 v237, v246, 4, 2
    s_lshl_b32 s87, s4, 7
    s_add_u32 s87, s87, 162816
    v_lshl_add_u32 v236, v236, 5, s87
    v_lshl_add_u32 v236, v237, 2, v236
    v_lshl_add_u32 v236, s5, 4, v236
    ds_write_b32 v236, v204 offset:512
    ds_write_b32 v236, v205
    ds_read_b128 v[208:211], v242 offset:0
    ds_read_b128 v[212:215], v242 offset:8192
    ds_read_b128 v[216:219], v242 offset:4096
    ds_read_b128 v[220:223], v242 offset:12288
LA_M5:
    s_lshl_b32 s87, s5, 30
    s_add_u32 s68, s95, s87
    s_add_u32 s68, s68, 65536
    s_add_u32 s73, s86, s87
    s_add_u32 s73, s73, 1024
    s_xor_b32 s87, s99, 1
    s_mul_i32 s87, s87, 73728
    s_add_u32 s66, s66, s87
    s_waitcnt vmcnt(4) lgkmcnt(4)
    s_barrier
    s_waitcnt lgkmcnt(2)
    v_mfma_f32_16x16x32_bf16 v[176:179], v[0:3], v[208:211], 0
    ds_read_b128 v[224:227], v243 offset:0
    v_bfe_u32 v247, v246, 8, 2
    v_mfma_f32_16x16x32_bf16 v[180:183], v[4:7], v[208:211], 0
    ds_read_b128 v[228:231], v243 offset:8192
    s_lshl_b32 s87, s4, 7
    s_add_u32 s87, s87, 162816
    v_mfma_f32_16x16x32_bf16 v[188:191], v[4:7], v[212:215], 0
    ds_read_b128 v[208:211], v243 offset:4096
    v_lshl_add_u32 v247, v247, 5, s87
    ds_read_b64 v[252:253], v254 offset:8
    v_mfma_f32_16x16x32_bf16 v[184:187], v[0:3], v[212:215], 0
    ds_read_b128 v[232:235], v247
    s_waitcnt lgkmcnt(5)
    v_mfma_f32_16x16x32_bf16 v[192:195], v[0:3], v[216:219], 0
    ds_read_b128 v[212:215], v243 offset:12288
    v_mfma_f32_16x16x32_bf16 v[196:199], v[4:7], v[216:219], 0
    s_add_u32 m0, s64, 98304
    s_add_u32 s67, s65, 768
    buffer_load_dwordx4 v245, s[16:19], s67 offen lds
    v_mfma_f32_16x16x32_bf16 v[204:207], v[4:7], v[220:223], 0
    ds_read_b128 v[216:219], v242 offset:16384
    ds_read_b128 v[236:239], v247 offset:16
    v_mfma_f32_16x16x32_bf16 v[200:203], v[0:3], v[220:223], 0
    s_waitcnt lgkmcnt(6)
    v_mfma_f32_16x16x32_bf16 v[176:179], v[8:11], v[224:227], v[176:179]
    ds_read_b128 v[220:223], v242 offset:24576
    v_mfma_f32_16x16x32_bf16 v[180:183], v[12:15], v[224:227], v[180:183]
    v_mfma_f32_16x16x32_bf16 v[188:191], v[12:15], v[228:231], v[188:191]
    ds_read_b128 v[224:227], v242 offset:20480
    s_waitcnt lgkmcnt(2)
    v_mul_f32 v144, v144, v232
    v_mfma_f32_16x16x32_bf16 v[184:187], v[8:11], v[228:231], v[184:187]
    v_mul_f32_e64 v152, -v152, v232
    v_mfma_f32_16x16x32_bf16 v[192:195], v[8:11], v[208:211], v[192:195]
    ds_read_b128 v[228:231], v242 offset:28672
    v_mul_f32_e64 v145, v145, v233
    v_mfma_f32_16x16x32_bf16 v[196:199], v[12:15], v[208:211], v[196:199]
    s_add_u32 m0, s64, 106496
    s_add_u32 s67, s65, 768
    buffer_load_dwordx4 v245, s[20:23], s67 offen lds
    v_mfma_f32_16x16x32_bf16 v[204:207], v[12:15], v[212:215], v[204:207]
    ds_read_b128 v[208:211], v243 offset:16384
    v_mul_f32_e64 v153, -v153, v233
    v_mfma_f32_16x16x32_bf16 v[200:203], v[8:11], v[212:215], v[200:203]
    v_mul_f32 v146, v146, v234
    s_waitcnt lgkmcnt(3)
    v_mfma_f32_16x16x32_bf16 v[176:179], v[16:19], v[216:219], v[176:179]
    ds_read_b128 v[212:215], v243 offset:24576
    v_mul_f32_e64 v154, -v154, v234
    v_mfma_f32_16x16x32_bf16 v[180:183], v[20:23], v[216:219], v[180:183]
    v_mul_f32_e64 v147, v147, v235
    v_mfma_f32_16x16x32_bf16 v[188:191], v[20:23], v[220:223], v[188:191]
    ds_read_b128 v[216:219], v243 offset:20480
    v_mul_f32_e64 v155, -v155, v235
    v_mfma_f32_16x16x32_bf16 v[184:187], v[16:19], v[220:223], v[184:187]
    v_mul_f32 v148, v148, v236
    s_waitcnt lgkmcnt(3)
    v_mfma_f32_16x16x32_bf16 v[192:195], v[16:19], v[224:227], v[192:195]
    ds_read_b128 v[220:223], v243 offset:28672
    v_mul_f32_e64 v156, -v156, v236
    v_mfma_f32_16x16x32_bf16 v[196:199], v[20:23], v[224:227], v[196:199]
    v_mul_f32_e64 v149, v149, v237
    s_add_u32 m0, s64, 114688
    s_add_u32 s67, s65, 896
    buffer_load_dwordx4 v245, s[16:19], s67 offen lds
    v_mfma_f32_16x16x32_bf16 v[204:207], v[20:23], v[228:231], v[204:207]
    ds_read_b128 v[224:227], v242 offset:32768
    v_mul_f32_e64 v157, -v157, v237
    v_mfma_f32_16x16x32_bf16 v[200:203], v[16:19], v[228:231], v[200:203]
    s_waitcnt lgkmcnt(3)
    v_mfma_f32_16x16x32_bf16 v[176:179], v[24:27], v[208:211], v[176:179]
    ds_read_b128 v[228:231], v242 offset:40960
    v_mul_f32 v150, v150, v238
    v_mfma_f32_16x16x32_bf16 v[180:183], v[28:31], v[208:211], v[180:183]
    v_mul_f32_e64 v158, -v158, v238
    v_mfma_f32_16x16x32_bf16 v[188:191], v[28:31], v[212:215], v[188:191]
    ds_read_b128 v[208:211], v242 offset:36864
    v_mul_f32_e64 v151, v151, v239
    v_mfma_f32_16x16x32_bf16 v[184:187], v[24:27], v[212:215], v[184:187]
    v_mul_f32_e64 v159, -v159, v239
    s_waitcnt lgkmcnt(3)
    v_mfma_f32_16x16x32_bf16 v[192:195], v[24:27], v[216:219], v[192:195]
    ds_read_b128 v[212:215], v242 offset:45056
    v_fma_f32 v232, v252, v144, v145
    v_mfma_f32_16x16x32_bf16 v[196:199], v[28:31], v[216:219], v[196:199]
    v_fma_f32 v233, v252, v152, v153
    s_add_u32 m0, s64, 122880
    s_add_u32 s67, s65, 896
    buffer_load_dwordx4 v245, s[20:23], s67 offen lds
    v_mfma_f32_16x16x32_bf16 v[204:207], v[28:31], v[220:223], v[204:207]
    ds_read_b128 v[216:219], v243 offset:32768
    v_fma_f32 v232, -v253, v152, v232
    v_mfma_f32_16x16x32_bf16 v[200:203], v[24:27], v[220:223], v[200:203]
    v_fmac_f32_e64 v233, v253, v144
    s_waitcnt lgkmcnt(3)
    v_mfma_f32_16x16x32_bf16 v[176:179], v[32:35], v[224:227], v[176:179]
    ds_read_b128 v[220:223], v243 offset:40960
    v_fma_f32 v234, v252, v232, v146
    v_mfma_f32_16x16x32_bf16 v[180:183], v[36:39], v[224:227], v[180:183]
    v_fma_f32 v235, v252, v233, v154
    v_mfma_f32_16x16x32_bf16 v[188:191], v[36:39], v[228:231], v[188:191]
    ds_read_b128 v[224:227], v243 offset:36864
    v_mfma_f32_16x16x32_bf16 v[184:187], v[32:35], v[228:231], v[184:187]
    v_fma_f32 v234, -v253, v233, v234
    s_waitcnt lgkmcnt(3)
    v_mfma_f32_16x16x32_bf16 v[192:195], v[32:35], v[208:211], v[192:195]
    ds_read_b128 v[228:231], v243 offset:45056
    v_fmac_f32 v235, v253, v232
    v_mfma_f32_16x16x32_bf16 v[196:199], v[36:39], v[208:211], v[196:199]
    v_fma_f32 v232, v252, v234, v147
    s_add_u32 m0, s64, 131072
    s_add_u32 s67, s65, 1024
    buffer_load_dwordx4 v245, s[16:19], s67 offen lds
    v_mfma_f32_16x16x32_bf16 v[204:207], v[36:39], v[212:215], v[204:207]
    v_add_u32 v242, 49152, v242
    v_add_u32 v243, 49152, v243
    ds_read_b128 v[208:211], v242 offset:0
    v_fma_f32 v233, v252, v235, v155
    v_mfma_f32_16x16x32_bf16 v[200:203], v[32:35], v[212:215], v[200:203]
    v_fma_f32 v232, -v253, v235, v232
    s_waitcnt lgkmcnt(3)
    v_mfma_f32_16x16x32_bf16 v[176:179], v[40:43], v[216:219], v[176:179]
    ds_read_b128 v[212:215], v242 offset:8192
    v_fmac_f32 v233, v253, v234
    v_mfma_f32_16x16x32_bf16 v[180:183], v[44:47], v[216:219], v[180:183]
    v_fma_f32 v234, v252, v232, v148
    v_mfma_f32_16x16x32_bf16 v[188:191], v[44:47], v[220:223], v[188:191]
    ds_read_b128 v[216:219], v242 offset:4096
    v_fma_f32 v235, v252, v233, v156
    v_mfma_f32_16x16x32_bf16 v[184:187], v[40:43], v[220:223], v[184:187]
    v_fma_f32 v234, -v253, v233, v234
    s_waitcnt lgkmcnt(3)
    v_mfma_f32_16x16x32_bf16 v[192:195], v[40:43], v[224:227], v[192:195]
    ds_read_b128 v[220:223], v242 offset:12288
    v_fmac_f32 v235, v253, v232
    v_mfma_f32_16x16x32_bf16 v[196:199], v[44:47], v[224:227], v[196:199]
    s_add_u32 m0, s64, 139264
    s_add_u32 s67, s65, 1024
    buffer_load_dwordx4 v245, s[20:23], s67 offen lds
    s_lshr_b32 s38, s6, 2
    s_lshl_b32 s38, s38, 4
    s_add_u32 s38, s38, s6
    s_and_b32 s38, s38, 0x33
    s_lshl_b32 s38, s38, 2
    s_add_u32 s38, s38, 16
    s_cmp_eq_u32 s3, 0
    s_cselect_b32 s38, s38, 1073741824
    buffer_load_dword v160, off, s[60:63], s38 sc1
    v_mfma_f32_16x16x32_bf16 v[204:207], v[44:47], v[228:231], v[204:207]
    v_fma_f32 v232, v252, v234, v149
    v_mfma_f32_16x16x32_bf16 v[200:203], v[40:43], v[228:231], v[200:203]
    v_fma_f32 v233, v252, v235, v157
    s_waitcnt vmcnt(4)
    s_barrier
    s_waitcnt lgkmcnt(2)
    v_mfma_f32_16x16x32_bf16 v[176:179], v[48:51], v[208:211], v[176:179]
    ds_read_b128 v[224:227], v243 offset:0
    v_fma_f32 v232, -v253, v235, v232
    v_mfma_f32_16x16x32_bf16 v[180:183], v[52:55], v[208:211], v[180:183]
    ds_read_b128 v[228:231], v243 offset:8192
    v_fmac_f32 v233, v253, v234
    v_mfma_f32_16x16x32_bf16 v[188:191], v[52:55], v[212:215], v[188:191]
    ds_read_b128 v[208:211], v243 offset:4096
    v_fma_f32 v234, v252, v232, v150
    v_mfma_f32_16x16x32_bf16 v[184:187], v[48:51], v[212:215], v[184:187]
    v_fma_f32 v235, v252, v233, v158
    s_waitcnt lgkmcnt(3)
    v_mfma_f32_16x16x32_bf16 v[192:195], v[48:51], v[216:219], v[192:195]
    ds_read_b128 v[212:215], v243 offset:12288
    v_fma_f32 v234, -v253, v233, v234
    v_mfma_f32_16x16x32_bf16 v[196:199], v[52:55], v[216:219], v[196:199]
    v_fmac_f32 v235, v253, v232
    s_add_u32 m0, s64, 0
    s_add_u32 s67, s66, 0
    buffer_load_dwordx4 v245, s[16:19], s67 offen lds
    v_mfma_f32_16x16x32_bf16 v[204:207], v[52:55], v[220:223], v[204:207]
    ds_read_b128 v[216:219], v242 offset:16384
    v_fma_f32 v232, v252, v234, v151
    v_mfma_f32_16x16x32_bf16 v[200:203], v[48:51], v[220:223], v[200:203]
    s_waitcnt lgkmcnt(3)
    v_mfma_f32_16x16x32_bf16 v[176:179], v[56:59], v[224:227], v[176:179]
    ds_read_b128 v[220:223], v242 offset:24576
    v_fma_f32 v233, v252, v235, v159
    v_mfma_f32_16x16x32_bf16 v[180:183], v[60:63], v[224:227], v[180:183]
    v_fma_f32 v232, -v253, v235, v232
    v_mfma_f32_16x16x32_bf16 v[188:191], v[60:63], v[228:231], v[188:191]
    ds_read_b128 v[224:227], v242 offset:20480
    v_fmac_f32 v233, v253, v234
    ds_read_b64 v[252:253], v254 offset:32
    v_mfma_f32_16x16x32_bf16 v[184:187], v[56:59], v[228:231], v[184:187]
    s_lshl_b32 s87, s5, 10
    s_lshl_b32 s88, s4, 3
    s_add_u32 s87, s87, s88
    s_waitcnt lgkmcnt(4)
    v_mfma_f32_16x16x32_bf16 v[192:195], v[56:59], v[208:211], v[192:195]
    ds_read_b128 v[228:231], v242 offset:28672
    s_add_u32 s87, s87, 155520
    v_mov_b32_e64 v234, v232
    v_mfma_f32_16x16x32_bf16 v[196:199], v[60:63], v[208:211], v[196:199]
    v_mov_b32_e64 v235, v233
    s_add_u32 m0, s64, 8192
    s_add_u32 s67, s66, 0
    buffer_load_dwordx4 v245, s[20:23], s67 offen lds
    v_mfma_f32_16x16x32_bf16 v[204:207], v[60:63], v[212:215], v[204:207]
    ds_read_b128 v[208:211], v243 offset:16384
    v_bfe_u32 v247, v246, 4, 4
    v_mfma_f32_16x16x32_bf16 v[200:203], v[56:59], v[212:215], v[200:203]
    s_waitcnt lgkmcnt(4)
    v_mfma_f32_16x16x32_bf16 v[176:179], v[64:67], v[216:219], v[176:179]
    ds_read_b128 v[212:215], v243 offset:24576
    v_permlane16_swap_b32 v232, v234
    v_mfma_f32_16x16x32_bf16 v[180:183], v[68:71], v[216:219], v[180:183]
    v_permlane16_swap_b32 v233, v235
    v_mfma_f32_16x16x32_bf16 v[188:191], v[68:71], v[220:223], v[188:191]
    ds_read_b128 v[216:219], v243 offset:20480
    v_mov_b32_e64 v248, v232
    v_mfma_f32_16x16x32_bf16 v[184:187], v[64:67], v[220:223], v[184:187]
    v_mov_b32 v238, v234
    s_waitcnt lgkmcnt(3)
    v_mfma_f32_16x16x32_bf16 v[192:195], v[64:67], v[224:227], v[192:195]
    ds_read_b128 v[220:223], v243 offset:28672
    v_mov_b32_e64 v249, v233
    v_mfma_f32_16x16x32_bf16 v[196:199], v[68:71], v[224:227], v[196:199]
    v_mov_b32_e64 v239, v235
    s_add_u32 m0, s64, 16384
    s_add_u32 s67, s66, 128
    buffer_load_dwordx4 v245, s[16:19], s67 offen lds
    v_mfma_f32_16x16x32_bf16 v[204:207], v[68:71], v[228:231], v[204:207]
    ds_read_b128 v[224:227], v242 offset:32768
    v_lshl_add_u32 v247, v247, 5, s87
    v_mfma_f32_16x16x32_bf16 v[200:203], v[64:67], v[228:231], v[200:203]
    v_permlane32_swap_b32 v232, v248
    s_waitcnt lgkmcnt(3)
    v_mfma_f32_16x16x32_bf16 v[176:179], v[72:75], v[208:211], v[176:179]
    ds_read_b128 v[228:231], v242 offset:40960
    v_permlane32_swap_b32 v234, v238
    v_mfma_f32_16x16x32_bf16 v[180:183], v[76:79], v[208:211], v[180:183]
    v_permlane32_swap_b32 v233, v249
    v_mfma_f32_16x16x32_bf16 v[188:191], v[76:79], v[212:215], v[188:191]
    ds_read_b128 v[208:211], v242 offset:36864
    v_mfma_f32_16x16x32_bf16 v[184:187], v[72:75], v[212:215], v[184:187]
    v_permlane32_swap_b32 v235, v239
    s_waitcnt lgkmcnt(3)
    v_mfma_f32_16x16x32_bf16 v[192:195], v[72:75], v[216:219], v[192:195]
    ds_read_b128 v[212:215], v242 offset:45056
    v_fmac_f32_e64 v234, v252, v232
    v_mfma_f32_16x16x32_bf16 v[196:199], v[76:79], v[216:219], v[196:199]
    v_fmac_f32_e64 v235, v252, v233
    s_add_u32 m0, s64, 24576
    s_add_u32 s67, s66, 128
    buffer_load_dwordx4 v245, s[20:23], s67 offen lds
    v_mfma_f32_16x16x32_bf16 v[204:207], v[76:79], v[220:223], v[204:207]
    ds_read_b128 v[216:219], v243 offset:32768
    v_fma_f32 v234, -v253, v233, v234
    v_mfma_f32_16x16x32_bf16 v[200:203], v[72:75], v[220:223], v[200:203]
    v_fmac_f32 v235, v253, v232
    s_waitcnt lgkmcnt(3)
    v_mfma_f32_16x16x32_bf16 v[176:179], v[80:83], v[224:227], v[176:179]
    ds_read_b128 v[220:223], v243 offset:40960
    v_fmac_f32_e64 v248, v252, v234
    v_mfma_f32_16x16x32_bf16 v[180:183], v[84:87], v[224:227], v[180:183]
    v_fmac_f32_e64 v249, v252, v235
    v_mfma_f32_16x16x32_bf16 v[188:191], v[84:87], v[228:231], v[188:191]
    ds_read_b128 v[224:227], v243 offset:36864
    v_mfma_f32_16x16x32_bf16 v[184:187], v[80:83], v[228:231], v[184:187]
    v_fma_f32 v248, -v253, v235, v248
    s_waitcnt lgkmcnt(3)
    v_mfma_f32_16x16x32_bf16 v[192:195], v[80:83], v[208:211], v[192:195]
    ds_read_b128 v[228:231], v243 offset:45056
    v_fmac_f32 v249, v253, v234
    v_mfma_f32_16x16x32_bf16 v[196:199], v[84:87], v[208:211], v[196:199]
    v_fmac_f32_e64 v238, v252, v248
    s_add_u32 m0, s64, 32768
    s_add_u32 s67, s66, 256
    buffer_load_dwordx4 v245, s[16:19], s67 offen lds
    v_mfma_f32_16x16x32_bf16 v[204:207], v[84:87], v[212:215], v[204:207]
    v_add_u32 v242, 49152, v242
    v_add_u32 v243, 49152, v243
    ds_read_b128 v[208:211], v242 offset:0
    v_fmac_f32_e64 v239, v252, v249
    v_mfma_f32_16x16x32_bf16 v[200:203], v[80:83], v[212:215], v[200:203]
    v_fma_f32 v238, -v253, v249, v238
    s_waitcnt lgkmcnt(3)
    v_mfma_f32_16x16x32_bf16 v[176:179], v[88:91], v[216:219], v[176:179]
    ds_read_b128 v[212:215], v242 offset:8192
    v_fmac_f32 v239, v253, v248
    v_mfma_f32_16x16x32_bf16 v[180:183], v[92:95], v[216:219], v[180:183]
    ds_write_b64 v247, v[238:239]
    v_cndmask_b32_e64 v248, 0, v248, s[78:79]
    v_mfma_f32_16x16x32_bf16 v[188:191], v[92:95], v[220:223], v[188:191]
    ds_read_b128 v[216:219], v242 offset:4096
    v_mfma_f32_16x16x32_bf16 v[184:187], v[88:91], v[220:223], v[184:187]
    v_cndmask_b32_e64 v248, v248, v232, s[74:75]
    s_waitcnt lgkmcnt(4)
    v_mfma_f32_16x16x32_bf16 v[192:195], v[88:91], v[224:227], v[192:195]
    ds_read_b128 v[220:223], v242 offset:12288
    v_cndmask_b32_e64 v248, v248, v234, s[76:77]
    v_mfma_f32_16x16x32_bf16 v[196:199], v[92:95], v[224:227], v[196:199]
    v_cndmask_b32_e64 v249, 0, v249, s[78:79]
    s_add_u32 m0, s64, 40960
    s_add_u32 s67, s66, 256
    buffer_load_dwordx4 v245, s[20:23], s67 offen lds
    v_mfma_f32_16x16x32_bf16 v[204:207], v[92:95], v[228:231], v[204:207]
    v_cndmask_b32_e64 v249, v249, v233, s[74:75]
    v_mfma_f32_16x16x32_bf16 v[200:203], v[88:91], v[228:231], v[200:203]
    v_cndmask_b32_e64 v249, v249, v235, s[76:77]
    s_waitcnt vmcnt(4) lgkmcnt(2)
    s_barrier
    v_mfma_f32_16x16x32_bf16 v[176:179], v[96:99], v[208:211], v[176:179]
    ds_read_b128 v[224:227], v243 offset:0
    s_lshl_b32 s88, s4, 3
    v_subrev_u32_e64 v247, s88, v247
    ds_read_b64 v[252:253], v254 offset:16
    v_mfma_f32_16x16x32_bf16 v[180:183], v[100:103], v[208:211], v[180:183]
    ds_read_b128 v[228:231], v243 offset:8192
    ds_read_b128 v[232:235], v247
    v_mfma_f32_16x16x32_bf16 v[188:191], v[100:103], v[212:215], v[188:191]
    ds_read_b128 v[208:211], v243 offset:4096
    v_mfma_f32_16x16x32_bf16 v[184:187], v[96:99], v[212:215], v[184:187]
    ds_read_b128 v[236:239], v247 offset:16
    s_waitcnt lgkmcnt(6)
    v_mfma_f32_16x16x32_bf16 v[192:195], v[96:99], v[216:219], v[192:195]
    ds_read_b128 v[212:215], v243 offset:12288
    v_mfma_f32_16x16x32_bf16 v[196:199], v[100:103], v[216:219], v[196:199]
    s_waitcnt lgkmcnt(1)
    v_fmac_f32_e64 v234, v252, v232
    s_add_u32 m0, s64, 49152
    s_add_u32 s67, s66, 384
    buffer_load_dwordx4 v245, s[16:19], s67 offen lds
    v_mfma_f32_16x16x32_bf16 v[204:207], v[100:103], v[220:223], v[204:207]
    ds_read_b128 v[216:219], v242 offset:16384
    v_fmac_f32_e64 v235, v252, v233
    v_fma_f32 v234, -v253, v233, v234
    v_mfma_f32_16x16x32_bf16 v[200:203], v[96:99], v[220:223], v[200:203]
    v_fmac_f32_e64 v235, v253, v232
    v_mfma_f32_16x16x32_bf16 v[176:179], v[104:107], v[224:227], v[176:179]
    ds_read_b128 v[220:223], v242 offset:24576
    v_fmac_f32 v236, v252, v234
    v_fmac_f32 v237, v252, v235
    v_mfma_f32_16x16x32_bf16 v[180:183], v[108:111], v[224:227], v[180:183]
    v_fma_f32 v236, -v253, v235, v236
    v_mfma_f32_16x16x32_bf16 v[188:191], v[108:111], v[228:231], v[188:191]
    ds_read_b128 v[224:227], v242 offset:20480
    v_fmac_f32 v237, v253, v234
    v_fmac_f32 v238, v252, v236
    v_mfma_f32_16x16x32_bf16 v[184:187], v[104:107], v[228:231], v[184:187]
    v_fmac_f32 v239, v252, v237
    s_waitcnt lgkmcnt(3)
    v_mfma_f32_16x16x32_bf16 v[192:195], v[104:107], v[208:211], v[192:195]
    ds_read_b128 v[228:231], v242 offset:28672
    v_fma_f32 v238, -v253, v237, v238
    v_fmac_f32_e64 v239, v253, v236
    v_mfma_f32_16x16x32_bf16 v[196:199], v[108:111], v[208:211], v[196:199]
    s_cmp_lg_u32 s4, 0
    s_cbranch_scc1 L_agg10
    v_lshrrev_b32_e64 v252, 1, v246
    s_mov_b64 exec, 0xffff
    buffer_store_dwordx2 v[238:239], v252, s[24:27], s73 offen offset:0 sc1
    s_mov_b64 exec, -1
L_agg10:
    v_bfe_u32 v238, v246, 8, 2
    s_add_u32 m0, s64, 57344
    s_add_u32 s67, s66, 384
    buffer_load_dwordx4 v245, s[20:23], s67 offen lds
    v_mfma_f32_16x16x32_bf16 v[204:207], v[108:111], v[212:215], v[204:207]
    ds_read_b128 v[208:211], v243 offset:16384
    v_lshl_add_u32 v238, v238, 3, v254
    v_mfma_f32_16x16x32_bf16 v[200:203], v[104:107], v[212:215], v[200:203]
    ds_read_b64 v[238:239], v238 offset:24
    ds_read_b64 v[252:253], v254 offset:8
    v_cndmask_b32_e64 v232, 0, v232, s[80:81]
    s_waitcnt lgkmcnt(5)
    v_mfma_f32_16x16x32_bf16 v[176:179], v[112:115], v[216:219], v[176:179]
    ds_read_b128 v[212:215], v243 offset:24576
    v_cndmask_b32_e64 v232, v232, v234, s[82:83]
    v_cndmask_b32_e64 v232, v232, v236, s[84:85]
    v_mfma_f32_16x16x32_bf16 v[180:183], v[116:119], v[216:219], v[180:183]
    v_cndmask_b32_e64 v233, 0, v233, s[80:81]
    v_mfma_f32_16x16x32_bf16 v[188:191], v[116:119], v[220:223], v[188:191]
    ds_read_b128 v[216:219], v243 offset:20480
    v_cndmask_b32_e64 v233, v233, v235, s[82:83]
    v_cndmask_b32_e64 v233, v233, v237, s[84:85]
    v_mfma_f32_16x16x32_bf16 v[184:187], v[112:115], v[220:223], v[184:187]
    s_waitcnt lgkmcnt(2)
    v_fmac_f32 v248, v238, v232
    v_mfma_f32_16x16x32_bf16 v[192:195], v[112:115], v[224:227], v[192:195]
    ds_read_b128 v[220:223], v243 offset:28672
    v_fmac_f32_e64 v249, v238, v233
    v_fma_f32 v248, -v239, v233, v248
    v_mfma_f32_16x16x32_bf16 v[196:199], v[116:119], v[224:227], v[196:199]
    v_fmac_f32_e64 v249, v239, v232
    s_add_u32 m0, s64, 65536
    s_add_u32 s67, s66, 512
    buffer_load_dwordx4 v245, s[16:19], s67 offen lds
    v_mfma_f32_16x16x32_bf16 v[204:207], v[116:119], v[228:231], v[204:207]
    ds_read_b128 v[224:227], v242 offset:32768
    v_fmac_f32 v144, v252, v248
    v_fmac_f32 v152, v252, v249
    v_mfma_f32_16x16x32_bf16 v[200:203], v[112:115], v[228:231], v[200:203]
    v_fma_f32 v144, -v253, v249, v144
    s_waitcnt lgkmcnt(3)
    v_mfma_f32_16x16x32_bf16 v[176:179], v[120:123], v[208:211], v[176:179]
    ds_read_b128 v[228:231], v242 offset:40960
    v_fmac_f32 v152, v253, v248
    v_fmac_f32_e64 v145, v252, v144
    v_mfma_f32_16x16x32_bf16 v[180:183], v[124:127], v[208:211], v[180:183]
    v_fmac_f32_e64 v153, v252, v152
    v_mfma_f32_16x16x32_bf16 v[188:191], v[124:127], v[212:215], v[188:191]
    ds_read_b128 v[208:211], v242 offset:36864
    v_fma_f32 v145, -v253, v152, v145
    v_fmac_f32_e64 v153, v253, v144
    v_mfma_f32_16x16x32_bf16 v[184:187], v[120:123], v[212:215], v[184:187]
    v_fmac_f32 v146, v252, v145
    s_waitcnt lgkmcnt(3)
    v_mfma_f32_16x16x32_bf16 v[192:195], v[120:123], v[216:219], v[192:195]
    ds_read_b128 v[212:215], v242 offset:45056
    v_fmac_f32_e64 v154, v252, v153
    v_fma_f32 v146, -v253, v153, v146
    v_mfma_f32_16x16x32_bf16 v[196:199], v[124:127], v[216:219], v[196:199]
    v_fmac_f32_e64 v154, v253, v145
    s_add_u32 m0, s64, 73728
    s_add_u32 s67, s66, 512
    buffer_load_dwordx4 v245, s[20:23], s67 offen lds
    v_mfma_f32_16x16x32_bf16 v[204:207], v[124:127], v[220:223], v[204:207]
    ds_read_b128 v[216:219], v243 offset:32768
    v_fmac_f32 v147, v252, v146
    v_fmac_f32 v155, v252, v154
    v_mfma_f32_16x16x32_bf16 v[200:203], v[120:123], v[220:223], v[200:203]
    v_fma_f32 v147, -v253, v154, v147
    v_fmac_f32 v155, v253, v146
    s_waitcnt lgkmcnt(3)
    v_mfma_f32_16x16x32_bf16 v[176:179], v[128:131], v[224:227], v[176:179]
    ds_read_b128 v[220:223], v243 offset:40960
    v_fmac_f32_e64 v148, v252, v147
    v_mfma_f32_16x16x32_bf16 v[180:183], v[132:135], v[224:227], v[180:183]
    v_fmac_f32_e64 v156, v252, v155
    v_fma_f32 v148, -v253, v155, v148
    v_mfma_f32_16x16x32_bf16 v[188:191], v[132:135], v[228:231], v[188:191]
    ds_read_b128 v[224:227], v243 offset:36864
    v_fmac_f32_e64 v156, v253, v147
    v_mfma_f32_16x16x32_bf16 v[184:187], v[128:131], v[228:231], v[184:187]
    v_fmac_f32 v149, v252, v148
    v_fmac_f32_e64 v157, v252, v156
    s_waitcnt lgkmcnt(3)
    v_mfma_f32_16x16x32_bf16 v[192:195], v[128:131], v[208:211], v[192:195]
    ds_read_b128 v[228:231], v243 offset:45056
    v_fma_f32 v149, -v253, v156, v149
    v_mfma_f32_16x16x32_bf16 v[196:199], v[132:135], v[208:211], v[196:199]
    v_fmac_f32 v157, v253, v148
    v_fmac_f32 v150, v252, v149
    s_add_u32 m0, s64, 81920
    s_add_u32 s67, s66, 640
    buffer_load_dwordx4 v245, s[16:19], s67 offen lds
    v_mfma_f32_16x16x32_bf16 v[204:207], v[132:135], v[212:215], v[204:207]
    v_subrev_u32 v242, 98304, v242
    v_subrev_u32 v243, 98304, v243
    ds_read_b128 v[208:211], v242 offset:0
    v_fmac_f32_e64 v158, v252, v157
    v_mfma_f32_16x16x32_bf16 v[200:203], v[128:131], v[212:215], v[200:203]
    v_fma_f32 v150, -v253, v157, v150
    v_fmac_f32 v158, v253, v149
    s_waitcnt lgkmcnt(3)
    v_mfma_f32_16x16x32_bf16 v[176:179], v[136:139], v[216:219], v[176:179]
    ds_read_b128 v[212:215], v242 offset:8192
    v_fmac_f32_e64 v151, v252, v150
    v_mfma_f32_16x16x32_bf16 v[180:183], v[140:143], v[216:219], v[180:183]
    v_fmac_f32_e64 v159, v252, v158
    v_fma_f32 v151, -v253, v158, v151
    v_mfma_f32_16x16x32_bf16 v[188:191], v[140:143], v[220:223], v[188:191]
    ds_read_b128 v[216:219], v242 offset:4096
    v_fmac_f32_e64 v159, v253, v150
    v_cvt_pk_bf16_f32 v144, v144, v145
    v_mfma_f32_16x16x32_bf16 v[184:187], v[136:139], v[220:223], v[184:187]
    v_cvt_pk_bf16_f32 v145, v146, v147
    s_waitcnt lgkmcnt(3)
    v_mfma_f32_16x16x32_bf16 v[192:195], v[136:139], v[224:227], v[192:195]
    ds_read_b128 v[220:223], v242 offset:12288
    v_cvt_pk_bf16_f32 v146, v148, v149
    v_cvt_pk_bf16_f32 v147, v150, v151
    v_mfma_f32_16x16x32_bf16 v[196:199], v[140:143], v[224:227], v[196:199]
    v_cvt_pk_bf16_f32 v152, v152, v153
    s_add_u32 m0, s64, 90112
    s_add_u32 s67, s66, 640
    buffer_load_dwordx4 v245, s[20:23], s67 offen lds
    v_mfma_f32_16x16x32_bf16 v[204:207], v[140:143], v[228:231], v[204:207]
    v_cvt_pk_bf16_f32 v153, v154, v155
    v_cvt_pk_bf16_f32 v154, v156, v157
    v_mfma_f32_16x16x32_bf16 v[200:203], v[136:139], v[228:231], v[200:203]
    v_cvt_pk_bf16_f32 v155, v158, v159
    s_add_u32 s87, s68, 0
    buffer_store_dwordx4 v[144:147], v246, s[24:27], s87 offen sc1
    buffer_store_dwordx4 v[152:155], v246, s[24:27], s87 offen offset:1024 sc1
    s_cmp_lg_u32 s3, 0
    s_cbranch_scc1 L_ntM
    s_mov_b32 s93, 0
L_ntlM:
    v_readfirstlane_b32 s96, v160
    s_nop 3
    s_cmp_lg_u32 s96, 0
    s_cbranch_scc1 L_ntM
    s_add_u32 s93, s93, 1
    s_cmp_gt_u32 s93, 60000
    s_cbranch_scc1 L_ntM
    s_sleep 8
    s_lshr_b32 s38, s6, 2
    s_lshl_b32 s38, s38, 4
    s_add_u32 s38, s38, s6
    s_and_b32 s38, s38, 0x33
    s_lshl_b32 s38, s38, 2
    s_add_u32 s38, s38, 16
    buffer_load_dword v160, off, s[60:63], s38 sc1
    s_waitcnt vmcnt(0)
    s_branch L_ntlM
L_ntM:
    s_lshl_b32 s97, s6, 2
    s_add_u32 s97, s97, s7
    s_lshl_b32 s97, s97, 2
    s_add_u32 s97, s97, s89
    s_lshl_b32 s97, s97, 7
    s_add_u32 s97, s97, 23789568
    s_mul_i32 s87, s99, 3584
    s_sub_u32 s87, s87, 7168
    v_add_u32_e64 v254, s87, v254
    s_mov_b32 s65, s66
    s_and_b32 s87, s6, 7
    s_mul_i32 s88, s87, 43
    s_lshr_b32 s88, s88, 7
    s_mul_i32 s88, s88, 3
    s_sub_u32 s87, s87, s88
    s_add_u32 s66, s71, s87
    s_lshl_b32 s66, s66, 7
    s_add_u32 s98, s71, 3
    s_lshl_b32 s98, s98, 7
    s_lshl_b32 s87, s99, 15
    s_add_u32 s68, s95, s87
    s_lshl_b32 s87, s99, 9
    s_add_u32 s73, s86, s87
    s_waitcnt vmcnt(4)
    s_barrier
    s_waitcnt lgkmcnt(2)
    v_mfma_f32_16x16x32_bf16 v[144:147], v[0:3], v[208:211], 0
    ds_read_b128 v[224:227], v243 offset:0
    v_bfe_u32 v247, v246, 8, 2
    s_lshl_b32 s87, s4, 7
    s_add_u32 s87, s87, 162816
    v_lshl_add_u32 v247, v247, 5, s87
    v_mfma_f32_16x16x32_bf16 v[148:151], v[4:7], v[208:211], 0
    ds_read_b128 v[228:231], v243 offset:8192
    ds_read_b64 v[252:253], v254 offset:8
    ds_read_b64 v[250:251], v254 offset:1800
    ds_read_b128 v[232:235], v247
    v_mfma_f32_16x16x32_bf16 v[156:159], v[4:7], v[212:215], 0
    ds_read_b128 v[208:211], v243 offset:4096
    ds_read_b128 v[236:239], v247 offset:16
    v_mfma_f32_16x16x32_bf16 v[152:155], v[0:3], v[212:215], 0
    s_waitcnt lgkmcnt(7)
    v_mfma_f32_16x16x32_bf16 v[160:163], v[0:3], v[216:219], 0
    ds_read_b128 v[212:215], v243 offset:12288
    s_waitcnt lgkmcnt(1)
    v_mul_f32 v176, v176, v232
    v_mul_f32_e64 v184, -v184, v232
    v_mfma_f32_16x16x32_bf16 v[164:167], v[4:7], v[216:219], 0
    v_mul_f32_e64 v177, v177, v233
    v_mul_f32_e64 v185, -v185, v233
    s_add_u32 m0, s64, 98304
    s_add_u32 s67, s65, 768
    buffer_load_dwordx4 v245, s[16:19], s67 offen lds
    v_mfma_f32_16x16x32_bf16 v[172:175], v[4:7], v[220:223], 0
    ds_read_b128 v[216:219], v242 offset:16384
    v_mul_f32_e64 v178, v178, v234
    v_mul_f32_e64 v186, -v186, v234
    v_mfma_f32_16x16x32_bf16 v[168:171], v[0:3], v[220:223], 0
    v_mul_f32_e64 v179, v179, v235
    v_mul_f32_e64 v187, -v187, v235
    v_mul_f32_e64 v180, v180, v236
    v_mfma_f32_16x16x32_bf16 v[144:147], v[8:11], v[224:227], v[144:147]
    ds_read_b128 v[220:223], v242 offset:24576
    v_mul_f32_e64 v188, -v188, v236
    v_mul_f32_e64 v181, v181, v237
    v_mfma_f32_16x16x32_bf16 v[148:151], v[12:15], v[224:227], v[148:151]
    v_mul_f32_e64 v189, -v189, v237
    v_mul_f32_e64 v182, v182, v238
    v_mfma_f32_16x16x32_bf16 v[156:159], v[12:15], v[228:231], v[156:159]
    ds_read_b128 v[224:227], v242 offset:20480
    v_mul_f32_e64 v190, -v190, v238
    v_mul_f32_e64 v183, v183, v239
    v_mfma_f32_16x16x32_bf16 v[152:155], v[8:11], v[228:231], v[152:155]
    v_mul_f32_e64 v191, -v191, v239
    v_mul_f32_e64 v192, v192, v232
    v_mul_f32_e64 v200, -v200, v232
    s_waitcnt lgkmcnt(3)
    v_mfma_f32_16x16x32_bf16 v[160:163], v[8:11], v[208:211], v[160:163]
    ds_read_b128 v[228:231], v242 offset:28672
    v_mul_f32 v193, v193, v233
    v_mul_f32_e64 v201, -v201, v233
    v_mfma_f32_16x16x32_bf16 v[164:167], v[12:15], v[208:211], v[164:167]
    v_mul_f32_e64 v194, v194, v234
    v_mul_f32_e64 v202, -v202, v234
    s_add_u32 m0, s64, 106496
    s_add_u32 s67, s65, 768
    buffer_load_dwordx4 v245, s[20:23], s67 offen lds
    v_mfma_f32_16x16x32_bf16 v[172:175], v[12:15], v[212:215], v[172:175]
    ds_read_b128 v[208:211], v243 offset:16384
    v_mul_f32_e64 v195, v195, v235
    v_mul_f32_e64 v203, -v203, v235
    v_mfma_f32_16x16x32_bf16 v[168:171], v[8:11], v[212:215], v[168:171]
    v_mul_f32_e64 v196, v196, v236
    v_mul_f32_e64 v204, -v204, v236
    v_mul_f32 v197, v197, v237
    s_waitcnt lgkmcnt(3)
    v_mfma_f32_16x16x32_bf16 v[144:147], v[16:19], v[216:219], v[144:147]
    ds_read_b128 v[212:215], v243 offset:24576
    v_mul_f32_e64 v205, -v205, v237
    v_mul_f32_e64 v198, v198, v238
    v_mfma_f32_16x16x32_bf16 v[148:151], v[20:23], v[216:219], v[148:151]
    v_mul_f32_e64 v206, -v206, v238
    v_mul_f32_e64 v199, v199, v239
    v_mfma_f32_16x16x32_bf16 v[156:159], v[20:23], v[220:223], v[156:159]
    ds_read_b128 v[216:219], v243 offset:20480
    v_mul_f32_e64 v207, -v207, v239
    v_fma_f32 v232, v252, v176, v177
    v_mfma_f32_16x16x32_bf16 v[152:155], v[16:19], v[220:223], v[152:155]
    v_fma_f32 v233, v252, v184, v185
    v_fma_f32 v232, -v253, v184, v232
    v_fmac_f32 v233, v253, v176
    s_waitcnt lgkmcnt(3)
    v_mfma_f32_16x16x32_bf16 v[160:163], v[16:19], v[224:227], v[160:163]
    ds_read_b128 v[220:223], v243 offset:28672
    v_fma_f32 v234, v252, v232, v178
    v_fma_f32 v235, v252, v233, v186
    v_mfma_f32_16x16x32_bf16 v[164:167], v[20:23], v[224:227], v[164:167]
    v_fma_f32 v234, -v253, v233, v234
    v_fmac_f32_e64 v235, v253, v232
    s_add_u32 m0, s64, 114688
    s_add_u32 s67, s65, 896
    buffer_load_dwordx4 v245, s[16:19], s67 offen lds
    v_mfma_f32_16x16x32_bf16 v[172:175], v[20:23], v[228:231], v[172:175]
    ds_read_b128 v[224:227], v242 offset:32768
    v_fma_f32 v232, v252, v234, v179
    v_fma_f32 v233, v252, v235, v187
    v_mfma_f32_16x16x32_bf16 v[168:171], v[16:19], v[228:231], v[168:171]
    v_fma_f32 v232, -v253, v235, v232
    v_fmac_f32_e64 v233, v253, v234
    v_fma_f32 v234, v252, v232, v180
    s_waitcnt lgkmcnt(3)
    v_mfma_f32_16x16x32_bf16 v[144:147], v[24:27], v[208:211], v[144:147]
    ds_read_b128 v[228:231], v242 offset:40960
    v_fma_f32 v235, v252, v233, v188
    v_fma_f32 v234, -v253, v233, v234
    v_mfma_f32_16x16x32_bf16 v[148:151], v[28:31], v[208:211], v[148:151]
    v_fmac_f32 v235, v253, v232
    v_fma_f32 v232, v252, v234, v181
    v_mfma_f32_16x16x32_bf16 v[156:159], v[28:31], v[212:215], v[156:159]
    ds_read_b128 v[208:211], v242 offset:36864
    v_fma_f32 v233, v252, v235, v189
    v_fma_f32 v232, -v253, v235, v232
    v_mfma_f32_16x16x32_bf16 v[152:155], v[24:27], v[212:215], v[152:155]
    v_fmac_f32_e64 v233, v253, v234
    v_fma_f32 v234, v252, v232, v182
    v_fma_f32 v235, v252, v233, v190
    s_waitcnt lgkmcnt(3)
    v_mfma_f32_16x16x32_bf16 v[160:163], v[24:27], v[216:219], v[160:163]
    ds_read_b128 v[212:215], v242 offset:45056
    v_fma_f32 v234, -v253, v233, v234
    v_fmac_f32 v235, v253, v232
    v_mfma_f32_16x16x32_bf16 v[164:167], v[28:31], v[216:219], v[164:167]
    v_fma_f32 v232, v252, v234, v183
    v_fma_f32 v233, v252, v235, v191
    s_add_u32 m0, s64, 122880
    s_add_u32 s67, s65, 896
    buffer_load_dwordx4 v245, s[20:23], s67 offen lds
    v_mfma_f32_16x16x32_bf16 v[172:175], v[28:31], v[220:223], v[172:175]
    ds_read_b128 v[216:219], v243 offset:32768
    v_fma_f32 v232, -v253, v235, v232
    v_fmac_f32_e64 v233, v253, v234
    ds_read_b64 v[252:253], v254 offset:32
    v_mfma_f32_16x16x32_bf16 v[168:171], v[24:27], v[220:223], v[168:171]
    v_fma_f32 v236, v250, v192, v193
    v_fma_f32 v237, v250, v200, v201
    s_waitcnt lgkmcnt(4)
    v_mfma_f32_16x16x32_bf16 v[144:147], v[32:35], v[224:227], v[144:147]
    ds_read_b128 v[220:223], v243 offset:40960
    v_fma_f32 v236, -v251, v200, v236
    v_fmac_f32 v237, v251, v192
    v_fma_f32 v238, v250, v236, v194
    v_mfma_f32_16x16x32_bf16 v[148:151], v[36:39], v[224:227], v[148:151]
    v_fma_f32 v239, v250, v237, v202
    v_fma_f32 v238, -v251, v237, v238
    v_mfma_f32_16x16x32_bf16 v[156:159], v[36:39], v[228:231], v[156:159]
    ds_read_b128 v[224:227], v243 offset:36864
    v_fmac_f32_e64 v239, v251, v236
    v_fma_f32 v236, v250, v238, v195
    v_mfma_f32_16x16x32_bf16 v[152:155], v[32:35], v[228:231], v[152:155]
    v_fma_f32 v237, v250, v239, v203
    v_fma_f32 v236, -v251, v239, v236
    s_waitcnt lgkmcnt(4)
    v_mfma_f32_16x16x32_bf16 v[160:163], v[32:35], v[208:211], v[160:163]
    ds_read_b128 v[228:231], v243 offset:45056
    v_fmac_f32 v237, v251, v238
    v_fma_f32 v238, v250, v236, v196
    v_fma_f32 v239, v250, v237, v204
    v_mfma_f32_16x16x32_bf16 v[164:167], v[36:39], v[208:211], v[164:167]
    v_fma_f32 v238, -v251, v237, v238
    v_fmac_f32_e64 v239, v251, v236
    s_add_u32 m0, s64, 131072
    s_add_u32 s67, s65, 1024
    buffer_load_dwordx4 v245, s[16:19], s67 offen lds
    v_mfma_f32_16x16x32_bf16 v[172:175], v[36:39], v[212:215], v[172:175]
    v_add_u32 v242, 49152, v242
    v_add_u32 v243, 49152, v243
    ds_read_b128 v[208:211], v242 offset:0
    v_fma_f32 v236, v250, v238, v197
    v_fma_f32 v237, v250, v239, v205
    v_mfma_f32_16x16x32_bf16 v[168:171], v[32:35], v[212:215], v[168:171]
    v_fma_f32 v236, -v251, v239, v236
    v_fmac_f32_e64 v237, v251, v238
    v_fma_f32 v238, v250, v236, v198
    s_waitcnt lgkmcnt(3)
    v_mfma_f32_16x16x32_bf16 v[144:147], v[40:43], v[216:219], v[144:147]
    ds_read_b128 v[212:215], v242 offset:8192
    v_fma_f32 v239, v250, v237, v206
    v_fma_f32 v238, -v251, v237, v238
    v_mfma_f32_16x16x32_bf16 v[148:151], v[44:47], v[216:219], v[148:151]
    v_fmac_f32 v239, v251, v236
    v_fma_f32 v236, v250, v238, v199
    v_mfma_f32_16x16x32_bf16 v[156:159], v[44:47], v[220:223], v[156:159]
    ds_read_b128 v[216:219], v242 offset:4096
    v_fma_f32 v237, v250, v239, v207
    v_fma_f32 v236, -v251, v239, v236
    v_mfma_f32_16x16x32_bf16 v[152:155], v[40:43], v[220:223], v[152:155]
    v_fmac_f32_e64 v237, v251, v238
    ds_read_b64 v[250:251], v254 offset:1824
    s_lshl_b32 s87, s5, 10
    s_lshl_b32 s88, s4, 3
    s_add_u32 s87, s87, s88
    s_add_u32 s87, s87, 155520
    s_waitcnt lgkmcnt(4)
    v_mfma_f32_16x16x32_bf16 v[160:163], v[40:43], v[224:227], v[160:163]
    ds_read_b128 v[220:223], v242 offset:12288
    v_mov_b32 v234, v232
    v_mov_b32 v235, v233
    v_bfe_u32 v247, v246, 4, 4
    v_mfma_f32_16x16x32_bf16 v[164:167], v[44:47], v[224:227], v[164:167]
    v_permlane16_swap_b32 v232, v234
    v_permlane16_swap_b32 v233, v235
    s_add_u32 m0, s64, 139264
    s_add_u32 s67, s65, 1024
    buffer_load_dwordx4 v245, s[20:23], s67 offen lds
    v_mfma_f32_16x16x32_bf16 v[172:175], v[44:47], v[228:231], v[172:175]
    v_mov_b32 v248, v232
    v_mov_b32 v238, v234
    v_mfma_f32_16x16x32_bf16 v[168:171], v[40:43], v[228:231], v[168:171]
    v_mov_b32 v249, v233
    v_mov_b32_e64 v239, v235
    s_waitcnt vmcnt(4)
    s_barrier
    s_waitcnt lgkmcnt(3)
    v_mfma_f32_16x16x32_bf16 v[144:147], v[48:51], v[208:211], v[144:147]
    ds_read_b128 v[224:227], v243 offset:0
    v_lshl_add_u32 v247, v247, 5, s87
    v_permlane32_swap_b32 v232, v248
    v_permlane32_swap_b32 v234, v238
    v_mfma_f32_16x16x32_bf16 v[148:151], v[52:55], v[208:211], v[148:151]
    ds_read_b128 v[228:231], v243 offset:8192
    v_permlane32_swap_b32 v233, v249
    v_permlane32_swap_b32 v235, v239
    v_mfma_f32_16x16x32_bf16 v[156:159], v[52:55], v[212:215], v[156:159]
    ds_read_b128 v[208:211], v243 offset:4096
    v_fmac_f32 v234, v252, v232
    v_fmac_f32 v235, v252, v233
    v_mfma_f32_16x16x32_bf16 v[152:155], v[48:51], v[212:215], v[152:155]
    v_fma_f32 v234, -v253, v233, v234
    v_fmac_f32 v235, v253, v232
    s_waitcnt lgkmcnt(3)
    v_mfma_f32_16x16x32_bf16 v[160:163], v[48:51], v[216:219], v[160:163]
    ds_read_b128 v[212:215], v243 offset:12288
    v_fmac_f32 v248, v252, v234
    v_fmac_f32 v249, v252, v235
    v_mfma_f32_16x16x32_bf16 v[164:167], v[52:55], v[216:219], v[164:167]
    v_fma_f32 v248, -v253, v235, v248
    v_fmac_f32 v249, v253, v234
    v_fmac_f32 v238, v252, v248
    s_add_u32 m0, s64, 0
    s_add_u32 s67, s66, 0
    buffer_load_dwordx4 v244, s[12:15], s67 offen lds
    v_mfma_f32_16x16x32_bf16 v[172:175], v[52:55], v[220:223], v[172:175]
    ds_read_b128 v[216:219], v242 offset:16384
    v_fmac_f32_e64 v239, v252, v249
    v_fma_f32 v238, -v253, v249, v238
    v_mfma_f32_16x16x32_bf16 v[168:171], v[48:51], v[220:223], v[168:171]
    v_fmac_f32_e64 v239, v253, v248
    ds_write_b64 v247, v[238:239]
    v_cndmask_b32_e64 v248, 0, v248, s[78:79]
    s_waitcnt lgkmcnt(4)
    v_mfma_f32_16x16x32_bf16 v[144:147], v[56:59], v[224:227], v[144:147]
    ds_read_b128 v[220:223], v242 offset:24576
    v_cndmask_b32_e64 v248, v248, v232, s[74:75]
    v_cndmask_b32_e64 v248, v248, v234, s[76:77]
    v_mfma_f32_16x16x32_bf16 v[148:151], v[60:63], v[224:227], v[148:151]
    v_cndmask_b32_e64 v249, 0, v249, s[78:79]
    v_cndmask_b32_e64 v249, v249, v233, s[74:75]
    v_mfma_f32_16x16x32_bf16 v[156:159], v[60:63], v[228:231], v[156:159]
    ds_read_b128 v[224:227], v242 offset:20480
    v_cndmask_b32_e64 v249, v249, v235, s[76:77]
    v_mov_b32 v232, v236
    v_mov_b32_e64 v233, v237
    v_mfma_f32_16x16x32_bf16 v[152:155], v[56:59], v[228:231], v[152:155]
    s_nop 0
    v_permlane16_swap_b32 v236, v232
    v_permlane16_swap_b32 v237, v233
    s_waitcnt lgkmcnt(4)
    v_mfma_f32_16x16x32_bf16 v[160:163], v[56:59], v[208:211], v[160:163]
    ds_read_b128 v[228:231], v242 offset:28672
    v_mov_b32 v234, v236
    v_mov_b32 v238, v232
    v_mfma_f32_16x16x32_bf16 v[164:167], v[60:63], v[208:211], v[164:167]
    v_mov_b32 v235, v237
    v_mov_b32_e64 v239, v233
    s_nop 0
    s_add_u32 m0, s64, 8192
    s_add_u32 s67, s66, 294912
    buffer_load_dwordx4 v244, s[12:15], s67 offen lds
    v_mfma_f32_16x16x32_bf16 v[172:175], v[60:63], v[212:215], v[172:175]
    ds_read_b128 v[208:211], v243 offset:16384
    v_permlane32_swap_b32 v236, v234
    v_permlane32_swap_b32 v232, v238
    v_mfma_f32_16x16x32_bf16 v[168:171], v[56:59], v[212:215], v[168:171]
    v_permlane32_swap_b32 v237, v235
    v_permlane32_swap_b32 v233, v239
    s_waitcnt lgkmcnt(3)
    v_mfma_f32_16x16x32_bf16 v[144:147], v[64:67], v[216:219], v[144:147]
    ds_read_b128 v[212:215], v243 offset:24576
    v_fmac_f32 v232, v250, v236
    v_fmac_f32_e64 v233, v250, v237
    v_mfma_f32_16x16x32_bf16 v[148:151], v[68:71], v[216:219], v[148:151]
    v_fma_f32 v232, -v251, v237, v232
    v_fmac_f32 v233, v251, v236
    v_fmac_f32 v234, v250, v232
    v_mfma_f32_16x16x32_bf16 v[156:159], v[68:71], v[220:223], v[156:159]
    ds_read_b128 v[216:219], v243 offset:20480
    v_fmac_f32_e64 v235, v250, v233
    v_fma_f32 v234, -v251, v233, v234
    v_mfma_f32_16x16x32_bf16 v[152:155], v[64:67], v[220:223], v[152:155]
    v_fmac_f32 v235, v251, v232
    v_fmac_f32_e64 v238, v250, v234
    s_waitcnt lgkmcnt(3)
    v_mfma_f32_16x16x32_bf16 v[160:163], v[64:67], v[224:227], v[160:163]
    ds_read_b128 v[220:223], v243 offset:28672
    v_fmac_f32_e64 v239, v250, v235
    v_fma_f32 v238, -v251, v235, v238
    v_mfma_f32_16x16x32_bf16 v[164:167], v[68:71], v[224:227], v[164:167]
    v_fmac_f32_e64 v239, v251, v234
    ds_write_b64 v247, v[238:239] offset:512
    v_cndmask_b32_e64 v250, 0, v236, s[74:75]
    s_add_u32 m0, s64, 16384
    s_add_u32 s67, s66, 589824
    buffer_load_dwordx4 v244, s[12:15], s67 offen lds
    v_mfma_f32_16x16x32_bf16 v[172:175], v[68:71], v[228:231], v[172:175]
    ds_read_b128 v[224:227], v242 offset:32768
    v_cndmask_b32_e64 v250, v250, v232, s[76:77]
    v_cndmask_b32_e64 v250, v250, v234, s[78:79]
    v_cndmask_b32_e64 v251, 0, v237, s[74:75]
    v_mfma_f32_16x16x32_bf16 v[168:171], v[64:67], v[228:231], v[168:171]
    v_cndmask_b32_e64 v251, v251, v233, s[76:77]
    v_cndmask_b32_e64 v251, v251, v235, s[78:79]
    s_waitcnt lgkmcnt(1)
    s_barrier
    v_mfma_f32_16x16x32_bf16 v[144:147], v[72:75], v[208:211], v[144:147]
    ds_read_b128 v[228:231], v242 offset:40960
    s_lshl_b32 s88, s4, 3
    v_subrev_u32 v247, s88, v247
    ds_read_b64 v[252:253], v254 offset:16
    ds_read_b128 v[232:235], v247
    v_mfma_f32_16x16x32_bf16 v[148:151], v[76:79], v[208:211], v[148:151]
    v_mfma_f32_16x16x32_bf16 v[156:159], v[76:79], v[212:215], v[156:159]
    ds_read_b128 v[208:211], v242 offset:36864
    ds_read_b128 v[236:239], v247 offset:16
    v_mfma_f32_16x16x32_bf16 v[152:155], v[72:75], v[212:215], v[152:155]
    v_mfma_f32_16x16x32_bf16 v[160:163], v[72:75], v[216:219], v[160:163]
    ds_read_b128 v[212:215], v242 offset:45056
    s_waitcnt lgkmcnt(1)
    v_fmac_f32 v234, v252, v232
    v_fmac_f32_e64 v235, v252, v233
    v_mfma_f32_16x16x32_bf16 v[164:167], v[76:79], v[216:219], v[164:167]
    v_fma_f32 v234, -v253, v233, v234
    v_fmac_f32_e64 v235, v253, v232
    s_add_u32 m0, s64, 24576
    s_add_u32 s67, s66, 884736
    buffer_load_dwordx4 v244, s[12:15], s67 offen lds
    v_mfma_f32_16x16x32_bf16 v[172:175], v[76:79], v[220:223], v[172:175]
    ds_read_b128 v[216:219], v243 offset:32768
    v_fmac_f32 v236, v252, v234
    v_fmac_f32 v237, v252, v235
    v_mfma_f32_16x16x32_bf16 v[168:171], v[72:75], v[220:223], v[168:171]
    v_fma_f32 v236, -v253, v235, v236
    v_fmac_f32_e64 v237, v253, v234
    v_mfma_f32_16x16x32_bf16 v[144:147], v[80:83], v[224:227], v[144:147]
    ds_read_b128 v[220:223], v243 offset:40960
    v_fmac_f32 v238, v252, v236
    v_fmac_f32 v239, v252, v237
    v_mfma_f32_16x16x32_bf16 v[148:151], v[84:87], v[224:227], v[148:151]
    v_fma_f32 v238, -v253, v237, v238
    v_fmac_f32_e64 v239, v253, v236
    v_mfma_f32_16x16x32_bf16 v[156:159], v[84:87], v[228:231], v[156:159]
    ds_read_b128 v[224:227], v243 offset:36864
    s_cmp_lg_u32 s4, 0
    s_cbranch_scc1 L_agg11
    v_lshrrev_b32_e64 v252, 1, v246
    s_mov_b64 exec, 0xffff
    buffer_store_dwordx2 v[238:239], v252, s[24:27], s73 offen offset:0 sc1
    s_mov_b64 exec, -1
L_agg11:
    v_bfe_u32 v238, v246, 8, 2
    v_mfma_f32_16x16x32_bf16 v[152:155], v[80:83], v[228:231], v[152:155]
    v_lshl_add_u32 v238, v238, 3, v254
    ds_read_b64 v[238:239], v238 offset:24
    ds_read_b64 v[252:253], v254 offset:8
    s_waitcnt lgkmcnt(5)
    v_mfma_f32_16x16x32_bf16 v[160:163], v[80:83], v[208:211], v[160:163]
    ds_read_b128 v[228:231], v243 offset:45056
    v_cndmask_b32_e64 v232, 0, v232, s[80:81]
    v_cndmask_b32_e64 v232, v232, v234, s[82:83]
    v_mfma_f32_16x16x32_bf16 v[164:167], v[84:87], v[208:211], v[164:167]
    v_cndmask_b32_e64 v232, v232, v236, s[84:85]
    v_cndmask_b32_e64 v233, 0, v233, s[80:81]
    s_add_u32 m0, s64, 32768
    s_add_u32 s67, s66, 1179648
    buffer_load_dwordx4 v244, s[12:15], s67 offen lds
    v_mfma_f32_16x16x32_bf16 v[172:175], v[84:87], v[212:215], v[172:175]
    v_add_u32 v242, 49152, v242
    v_add_u32 v243, 49152, v243
    ds_read_b128 v[208:211], v242 offset:0
    v_cndmask_b32_e64 v233, v233, v235, s[82:83]
    v_cndmask_b32_e64 v233, v233, v237, s[84:85]
    v_mfma_f32_16x16x32_bf16 v[168:171], v[80:83], v[212:215], v[168:171]
    s_waitcnt lgkmcnt(2)
    v_fmac_f32 v248, v238, v232
    v_fmac_f32_e64 v249, v238, v233
    v_mfma_f32_16x16x32_bf16 v[144:147], v[88:91], v[216:219], v[144:147]
    ds_read_b128 v[212:215], v242 offset:8192
    v_fma_f32 v248, -v239, v233, v248
    v_fmac_f32_e64 v249, v239, v232
    v_mfma_f32_16x16x32_bf16 v[148:151], v[92:95], v[216:219], v[148:151]
    ds_read_b128 v[232:235], v247 offset:512
    ds_read_b128 v[236:239], v247 offset:528
    v_fmac_f32_e64 v176, v252, v248
    v_mfma_f32_16x16x32_bf16 v[156:159], v[92:95], v[220:223], v[156:159]
    ds_read_b128 v[216:219], v242 offset:4096
    v_fmac_f32_e64 v184, v252, v249
    v_fma_f32 v176, -v253, v249, v176
    v_mfma_f32_16x16x32_bf16 v[152:155], v[88:91], v[220:223], v[152:155]
    v_fmac_f32_e64 v184, v253, v248
    ds_read_b64 v[248:249], v254 offset:1808
    v_fmac_f32 v177, v252, v176
    s_waitcnt lgkmcnt(6)
    v_mfma_f32_16x16x32_bf16 v[160:163], v[88:91], v[224:227], v[160:163]
    ds_read_b128 v[220:223], v242 offset:12288
    v_fmac_f32_e64 v185, v252, v184
    v_fma_f32 v177, -v253, v184, v177
    v_mfma_f32_16x16x32_bf16 v[164:167], v[92:95], v[224:227], v[164:167]
    v_fmac_f32 v185, v253, v176
    v_fmac_f32 v178, v252, v177
    s_add_u32 m0, s64, 40960
    s_add_u32 s67, s66, 1474560
    buffer_load_dwordx4 v244, s[12:15], s67 offen lds
    v_mfma_f32_16x16x32_bf16 v[172:175], v[92:95], v[228:231], v[172:175]
    v_fmac_f32_e64 v186, v252, v185
    v_fma_f32 v178, -v253, v185, v178
    v_mfma_f32_16x16x32_bf16 v[168:171], v[88:91], v[228:231], v[168:171]
    v_fmac_f32 v186, v253, v177
    s_waitcnt vmcnt(5)
    s_barrier
    s_waitcnt lgkmcnt(5)
    v_mfma_f32_16x16x32_bf16 v[144:147], v[96:99], v[208:211], v[144:147]
    ds_read_b128 v[224:227], v243 offset:0
    v_fmac_f32 v179, v252, v178
    v_fmac_f32 v187, v252, v186
    v_mfma_f32_16x16x32_bf16 v[148:151], v[100:103], v[208:211], v[148:151]
    ds_read_b128 v[228:231], v243 offset:8192
    v_fma_f32 v179, -v253, v186, v179
    v_fmac_f32_e64 v187, v253, v178
    v_mfma_f32_16x16x32_bf16 v[156:159], v[100:103], v[212:215], v[156:159]
    ds_read_b128 v[208:211], v243 offset:4096
    v_fmac_f32 v180, v252, v179
    v_fmac_f32 v188, v252, v187
    v_mfma_f32_16x16x32_bf16 v[152:155], v[96:99], v[212:215], v[152:155]
    v_fma_f32 v180, -v253, v187, v180
    v_fmac_f32 v188, v253, v179
    s_waitcnt lgkmcnt(3)
    v_mfma_f32_16x16x32_bf16 v[160:163], v[96:99], v[216:219], v[160:163]
    ds_read_b128 v[212:215], v243 offset:12288
    v_fmac_f32 v181, v252, v180
    v_fmac_f32 v189, v252, v188
    v_mfma_f32_16x16x32_bf16 v[164:167], v[100:103], v[216:219], v[164:167]
    v_fma_f32 v181, -v253, v188, v181
    v_fmac_f32_e64 v189, v253, v180
    s_add_u32 m0, s64, 49152
    s_add_u32 s67, s66, 1769472
    buffer_load_dwordx4 v244, s[12:15], s67 offen lds
    v_mfma_f32_16x16x32_bf16 v[172:175], v[100:103], v[220:223], v[172:175]
    ds_read_b128 v[216:219], v242 offset:16384
    v_fmac_f32 v182, v252, v181
    v_fmac_f32 v190, v252, v189
    v_mfma_f32_16x16x32_bf16 v[168:171], v[96:99], v[220:223], v[168:171]
    v_fma_f32 v182, -v253, v189, v182
    v_fmac_f32 v190, v253, v181
    s_waitcnt lgkmcnt(3)
    v_mfma_f32_16x16x32_bf16 v[144:147], v[104:107], v[224:227], v[144:147]
    ds_read_b128 v[220:223], v242 offset:24576
    v_fmac_f32 v183, v252, v182
    v_fmac_f32 v191, v252, v190
    v_mfma_f32_16x16x32_bf16 v[148:151], v[108:111], v[224:227], v[148:151]
    v_fma_f32 v183, -v253, v190, v183
    v_fmac_f32_e64 v191, v253, v182
    v_mfma_f32_16x16x32_bf16 v[156:159], v[108:111], v[228:231], v[156:159]
    ds_read_b128 v[224:227], v242 offset:20480
    v_cvt_pk_bf16_f32 v176, v176, v177
    v_cvt_pk_bf16_f32 v177, v178, v179
    v_mfma_f32_16x16x32_bf16 v[152:155], v[104:107], v[228:231], v[152:155]
    v_cvt_pk_bf16_f32 v178, v180, v181
    v_cvt_pk_bf16_f32 v179, v182, v183
    s_waitcnt lgkmcnt(3)
    v_mfma_f32_16x16x32_bf16 v[160:163], v[104:107], v[208:211], v[160:163]
    ds_read_b128 v[228:231], v242 offset:28672
    v_cvt_pk_bf16_f32 v184, v184, v185
    v_cvt_pk_bf16_f32 v185, v186, v187
    v_mfma_f32_16x16x32_bf16 v[164:167], v[108:111], v[208:211], v[164:167]
    v_cvt_pk_bf16_f32 v186, v188, v189
    v_cvt_pk_bf16_f32 v187, v190, v191
    s_add_u32 m0, s64, 57344
    s_add_u32 s67, s66, 2064384
    buffer_load_dwordx4 v244, s[12:15], s67 offen lds
    v_mfma_f32_16x16x32_bf16 v[172:175], v[108:111], v[212:215], v[172:175]
    ds_read_b128 v[208:211], v243 offset:16384
    s_add_u32 s87, s68, 0
    buffer_store_dwordx4 v[176:179], v246, s[24:27], s87 offen sc1
    buffer_store_dwordx4 v[184:187], v246, s[24:27], s87 offen offset:1024 sc1
    v_fmac_f32_e64 v234, v248, v232
    v_mfma_f32_16x16x32_bf16 v[168:171], v[104:107], v[212:215], v[168:171]
    v_fmac_f32_e64 v235, v248, v233
    v_fma_f32 v234, -v249, v233, v234
    s_waitcnt lgkmcnt(3)
    v_mfma_f32_16x16x32_bf16 v[144:147], v[112:115], v[216:219], v[144:147]
    ds_read_b128 v[212:215], v243 offset:24576
    v_fmac_f32 v235, v249, v232
    v_fmac_f32_e64 v236, v248, v234
    v_mfma_f32_16x16x32_bf16 v[148:151], v[116:119], v[216:219], v[148:151]
    v_fmac_f32_e64 v237, v248, v235
    v_fma_f32 v236, -v249, v235, v236
    v_mfma_f32_16x16x32_bf16 v[156:159], v[116:119], v[220:223], v[156:159]
    ds_read_b128 v[216:219], v243 offset:20480
    v_fmac_f32 v237, v249, v234
    v_fmac_f32 v238, v248, v236
    v_mfma_f32_16x16x32_bf16 v[152:155], v[112:115], v[220:223], v[152:155]
    v_fmac_f32_e64 v239, v248, v237
    v_fma_f32 v238, -v249, v237, v238
    s_waitcnt lgkmcnt(3)
    v_mfma_f32_16x16x32_bf16 v[160:163], v[112:115], v[224:227], v[160:163]
    ds_read_b128 v[220:223], v243 offset:28672
    v_fmac_f32 v239, v249, v236
    s_cmp_lg_u32 s4, 0
    s_cbranch_scc1 L_agg12
    v_lshrrev_b32_e64 v252, 1, v246
    s_mov_b64 exec, 0xffff
    buffer_store_dwordx2 v[238:239], v252, s[24:27], s73 offen offset:256 sc1
    s_mov_b64 exec, -1
L_agg12:
    v_mfma_f32_16x16x32_bf16 v[164:167], v[116:119], v[224:227], v[164:167]
    v_bfe_u32 v238, v246, 8, 2
    v_lshl_add_u32 v238, v238, 3, v254
    s_add_u32 m0, s64, 65536
    s_add_u32 s67, s66, 2359296
    buffer_load_dwordx4 v244, s[12:15], s67 offen lds
    v_mfma_f32_16x16x32_bf16 v[172:175], v[116:119], v[228:231], v[172:175]
    ds_read_b128 v[224:227], v242 offset:32768
    ds_read_b64 v[238:239], v238 offset:1816
    ds_read_b64 v[252:253], v254 offset:1800
    v_cndmask_b32_e64 v232, 0, v232, s[80:81]
    v_cndmask_b32_e64 v232, v232, v234, s[82:83]
    v_mfma_f32_16x16x32_bf16 v[168:171], v[112:115], v[228:231], v[168:171]
    v_cndmask_b32_e64 v232, v232, v236, s[84:85]
    s_waitcnt lgkmcnt(5)
    v_mfma_f32_16x16x32_bf16 v[144:147], v[120:123], v[208:211], v[144:147]
    ds_read_b128 v[228:231], v242 offset:40960
    v_cndmask_b32_e64 v233, 0, v233, s[80:81]
    v_cndmask_b32_e64 v233, v233, v235, s[82:83]
    v_mfma_f32_16x16x32_bf16 v[148:151], v[124:127], v[208:211], v[148:151]
    v_cndmask_b32_e64 v233, v233, v237, s[84:85]
    s_waitcnt lgkmcnt(1)
    v_fmac_f32 v250, v238, v232
    v_mfma_f32_16x16x32_bf16 v[156:159], v[124:127], v[212:215], v[156:159]
    ds_read_b128 v[208:211], v242 offset:36864
    v_fmac_f32_e64 v251, v238, v233
    v_fma_f32 v250, -v239, v233, v250
    v_mfma_f32_16x16x32_bf16 v[152:155], v[120:123], v[212:215], v[152:155]
    v_fmac_f32 v251, v239, v232
    v_fmac_f32 v192, v252, v250
    v_mfma_f32_16x16x32_bf16 v[160:163], v[120:123], v[216:219], v[160:163]
    ds_read_b128 v[212:215], v242 offset:45056
    v_fmac_f32_e64 v200, v252, v251
    v_fma_f32 v192, -v253, v251, v192
    v_mfma_f32_16x16x32_bf16 v[164:167], v[124:127], v[216:219], v[164:167]
    v_fmac_f32 v200, v253, v250
    v_fmac_f32 v193, v252, v192
    s_add_u32 m0, s64, 73728
    s_add_u32 s67, s66, 2654208
    buffer_load_dwordx4 v244, s[12:15], s67 offen lds
    v_mfma_f32_16x16x32_bf16 v[172:175], v[124:127], v[220:223], v[172:175]
    ds_read_b128 v[216:219], v243 offset:32768
    v_fmac_f32_e64 v201, v252, v200
    v_fma_f32 v193, -v253, v200, v193
    v_mfma_f32_16x16x32_bf16 v[168:171], v[120:123], v[220:223], v[168:171]
    v_fmac_f32 v201, v253, v192
    v_fmac_f32_e64 v194, v252, v193
    s_waitcnt lgkmcnt(3)
    v_mfma_f32_16x16x32_bf16 v[144:147], v[128:131], v[224:227], v[144:147]
    ds_read_b128 v[220:223], v243 offset:40960
    v_fmac_f32_e64 v202, v252, v201
    v_fma_f32 v194, -v253, v201, v194
    v_mfma_f32_16x16x32_bf16 v[148:151], v[132:135], v[224:227], v[148:151]
    v_fmac_f32 v202, v253, v193
    v_fmac_f32 v195, v252, v194
    v_mfma_f32_16x16x32_bf16 v[156:159], v[132:135], v[228:231], v[156:159]
    ds_read_b128 v[224:227], v243 offset:36864
    v_fmac_f32_e64 v203, v252, v202
    v_fma_f32 v195, -v253, v202, v195
    v_mfma_f32_16x16x32_bf16 v[152:155], v[128:131], v[228:231], v[152:155]
    v_fmac_f32 v203, v253, v194
    v_fmac_f32_e64 v196, v252, v195
    s_waitcnt lgkmcnt(3)
    v_mfma_f32_16x16x32_bf16 v[160:163], v[128:131], v[208:211], v[160:163]
    ds_read_b128 v[228:231], v243 offset:45056
    v_fmac_f32_e64 v204, v252, v203
    v_fma_f32 v196, -v253, v203, v196
    v_mfma_f32_16x16x32_bf16 v[164:167], v[132:135], v[208:211], v[164:167]
    v_fmac_f32 v204, v253, v195
    v_fmac_f32 v197, v252, v196
    s_add_u32 m0, s64, 81920
    s_add_u32 s67, s66, 2949120
    buffer_load_dwordx4 v244, s[12:15], s67 offen lds
    v_mfma_f32_16x16x32_bf16 v[172:175], v[132:135], v[212:215], v[172:175]
    v_subrev_u32 v242, 98304, v242
    v_subrev_u32 v243, 98304, v243
    ds_read_b64_tr_b16 v[208:209], v240 offset:0
    v_fmac_f32_e64 v205, v252, v204
    v_fma_f32 v197, -v253, v204, v197
    v_mfma_f32_16x16x32_bf16 v[168:171], v[128:131], v[212:215], v[168:171]
    ds_read_b64_tr_b16 v[210:211], v240 offset:512
    v_fmac_f32 v205, v253, v196
    v_fmac_f32_e64 v198, v252, v197
    s_waitcnt lgkmcnt(4)
    v_mfma_f32_16x16x32_bf16 v[144:147], v[136:139], v[216:219], v[144:147]
    ds_read_b64_tr_b16 v[212:213], v240 offset:4096
    v_fmac_f32_e64 v206, v252, v205
    v_fma_f32 v198, -v253, v205, v198
    v_mfma_f32_16x16x32_bf16 v[148:151], v[140:143], v[216:219], v[148:151]
    ds_read_b64_tr_b16 v[214:215], v240 offset:4608
    v_fmac_f32_e64 v206, v253, v197
    v_mfma_f32_16x16x32_bf16 v[156:159], v[140:143], v[220:223], v[156:159]
    ds_read_b64_tr_b16 v[216:217], v241 offset:0
    v_fmac_f32 v199, v252, v198
    v_fmac_f32 v207, v252, v206
    v_mfma_f32_16x16x32_bf16 v[152:155], v[136:139], v[220:223], v[152:155]
    ds_read_b64_tr_b16 v[218:219], v241 offset:512
    v_fma_f32 v199, -v253, v206, v199
    v_fmac_f32 v207, v253, v198
    s_waitcnt lgkmcnt(6)
    v_mfma_f32_16x16x32_bf16 v[160:163], v[136:139], v[224:227], v[160:163]
    ds_read_b64_tr_b16 v[220:221], v241 offset:4096
    v_cvt_pk_bf16_f32 v192, v192, v193
    v_cvt_pk_bf16_f32 v193, v194, v195
    v_mfma_f32_16x16x32_bf16 v[164:167], v[140:143], v[224:227], v[164:167]
    ds_read_b64_tr_b16 v[222:223], v241 offset:4608
    v_cvt_pk_bf16_f32 v194, v196, v197
    v_cvt_pk_bf16_f32 v195, v198, v199
    s_add_u32 m0, s64, 90112
    s_add_u32 s67, s66, 3244032
    buffer_load_dwordx4 v244, s[12:15], s67 offen lds
    v_mfma_f32_16x16x32_bf16 v[172:175], v[140:143], v[228:231], v[172:175]
    v_cvt_pk_bf16_f32 v200, v200, v201
    v_cvt_pk_bf16_f32 v201, v202, v203
    v_mfma_f32_16x16x32_bf16 v[168:171], v[136:139], v[228:231], v[168:171]
    v_cvt_pk_bf16_f32 v202, v204, v205
    v_cvt_pk_bf16_f32 v203, v206, v207
    s_add_u32 s87, s68, 16384
    buffer_store_dwordx4 v[192:195], v246, s[24:27], s87 offen sc1
    buffer_store_dwordx4 v[200:203], v246, s[24:27], s87 offen offset:1024 sc1
    s_mul_i32 s87, s99, -7168
    s_add_u32 s87, s87, 3584
    v_add_u32_e64 v254, s87, v254
    s_xor_b32 s99, s99, 1
    s_mov_b32 s65, s66
    s_add_u32 s66, s65, 128
    s_cmp_eq_u32 s66, s98
    s_cselect_b32 s87, 384, 0
    s_sub_u32 s66, s66, s87
    s_lshl_b32 s87, s99, 15
    s_add_u32 s68, s95, s87
    s_lshl_b32 s87, s99, 9
    s_add_u32 s73, s86, s87
    s_waitcnt vmcnt(5)
    s_barrier
    s_waitcnt lgkmcnt(4)
    v_mfma_f32_16x16x32_bf16 v[176:179], v[208:211], v[0:3], 0
    ds_read_b64_tr_b16 v[224:225], v240 offset:8192
    v_bfe_u32 v247, v246, 8, 2
    s_lshl_b32 s87, s4, 7
    s_add_u32 s87, s87, 162816
    v_lshl_add_u32 v247, v247, 5, s87
    v_mfma_f32_16x16x32_bf16 v[180:183], v[208:211], v[4:7], 0
    ds_read_b64_tr_b16 v[226:227], v240 offset:8704
    ds_read_b64 v[252:253], v254 offset:8
    ds_read_b64 v[250:251], v254 offset:1800
    ds_read_b128 v[232:235], v247
    v_mfma_f32_16x16x32_bf16 v[188:191], v[212:215], v[4:7], 0
    ds_read_b64_tr_b16 v[228:229], v240 offset:12288
    ds_read_b128 v[236:239], v247 offset:16
    v_mfma_f32_16x16x32_bf16 v[184:187], v[212:215], v[0:3], 0
    ds_read_b64_tr_b16 v[230:231], v240 offset:12800
    s_waitcnt lgkmcnt(8)
    v_mfma_f32_16x16x32_bf16 v[192:195], v[216:219], v[0:3], 0
    ds_read_b64_tr_b16 v[208:209], v241 offset:8192
    s_waitcnt lgkmcnt(2)
    v_mul_f32_e64 v144, v144, v232
    v_mul_f32_e64 v152, -v152, v232
    v_mfma_f32_16x16x32_bf16 v[196:199], v[216:219], v[4:7], 0
    ds_read_b64_tr_b16 v[210:211], v241 offset:8704
    v_mul_f32_e64 v145, v145, v233
    v_mul_f32_e64 v153, -v153, v233
    s_add_u32 m0, s64, 98304
    s_add_u32 s67, s65, 3538944
    buffer_load_dwordx4 v244, s[12:15], s67 offen lds
    v_mfma_f32_16x16x32_bf16 v[204:207], v[220:223], v[4:7], 0
    ds_read_b64_tr_b16 v[212:213], v241 offset:12288
    v_mul_f32_e64 v146, v146, v234
    v_mul_f32_e64 v154, -v154, v234
    v_mfma_f32_16x16x32_bf16 v[200:203], v[220:223], v[0:3], 0
    ds_read_b64_tr_b16 v[214:215], v241 offset:12800
    v_mul_f32_e64 v147, v147, v235
    v_mul_f32_e64 v155, -v155, v235
    v_mul_f32 v148, v148, v236
    s_waitcnt lgkmcnt(4)
    v_mfma_f32_16x16x32_bf16 v[176:179], v[224:227], v[8:11], v[176:179]
    ds_read_b64_tr_b16 v[216:217], v240 offset:16384
    v_mul_f32_e64 v156, -v156, v236
    v_mul_f32_e64 v149, v149, v237
    v_mfma_f32_16x16x32_bf16 v[180:183], v[224:227], v[12:15], v[180:183]
    ds_read_b64_tr_b16 v[218:219], v240 offset:16896
    v_mul_f32_e64 v157, -v157, v237
    v_mul_f32_e64 v150, v150, v238
    v_mfma_f32_16x16x32_bf16 v[188:191], v[228:231], v[12:15], v[188:191]
    ds_read_b64_tr_b16 v[220:221], v240 offset:20480
    v_mul_f32_e64 v158, -v158, v238
    v_mul_f32_e64 v151, v151, v239
    v_mfma_f32_16x16x32_bf16 v[184:187], v[228:231], v[8:11], v[184:187]
    ds_read_b64_tr_b16 v[222:223], v240 offset:20992
    v_mul_f32_e64 v159, -v159, v239
    v_mul_f32_e64 v160, v160, v232
    v_mul_f32_e64 v168, -v168, v232
    s_waitcnt lgkmcnt(4)
    v_mfma_f32_16x16x32_bf16 v[192:195], v[208:211], v[8:11], v[192:195]
    ds_read_b64_tr_b16 v[224:225], v241 offset:16384
    v_mul_f32 v161, v161, v233
    v_mul_f32_e64 v169, -v169, v233
    v_mfma_f32_16x16x32_bf16 v[196:199], v[208:211], v[12:15], v[196:199]
    ds_read_b64_tr_b16 v[226:227], v241 offset:16896
    v_mul_f32_e64 v162, v162, v234
    v_mul_f32_e64 v170, -v170, v234
    s_add_u32 m0, s64, 106496
    s_add_u32 s67, s65, 3833856
    buffer_load_dwordx4 v244, s[12:15], s67 offen lds
    v_mfma_f32_16x16x32_bf16 v[204:207], v[212:215], v[12:15], v[204:207]
    ds_read_b64_tr_b16 v[228:229], v241 offset:20480
    v_mul_f32_e64 v163, v163, v235
    v_mul_f32_e64 v171, -v171, v235
    v_mfma_f32_16x16x32_bf16 v[200:203], v[212:215], v[8:11], v[200:203]
    ds_read_b64_tr_b16 v[230:231], v241 offset:20992
    v_mul_f32_e64 v164, v164, v236
    v_mul_f32_e64 v172, -v172, v236
    v_mul_f32 v165, v165, v237
    s_waitcnt lgkmcnt(4)
    v_mfma_f32_16x16x32_bf16 v[176:179], v[216:219], v[16:19], v[176:179]
    ds_read_b64_tr_b16 v[208:209], v240 offset:24576
    v_mul_f32_e64 v173, -v173, v237
    v_mul_f32_e64 v166, v166, v238
    v_mfma_f32_16x16x32_bf16 v[180:183], v[216:219], v[20:23], v[180:183]
    ds_read_b64_tr_b16 v[210:211], v240 offset:25088
    v_mul_f32_e64 v174, -v174, v238
    v_mul_f32_e64 v167, v167, v239
    v_mfma_f32_16x16x32_bf16 v[188:191], v[220:223], v[20:23], v[188:191]
    ds_read_b64_tr_b16 v[212:213], v240 offset:28672
    v_mul_f32_e64 v175, -v175, v239
    v_fma_f32 v232, v252, v144, v145
    v_mfma_f32_16x16x32_bf16 v[184:187], v[220:223], v[16:19], v[184:187]
    ds_read_b64_tr_b16 v[214:215], v240 offset:29184
    v_fma_f32 v233, v252, v152, v153
    v_fma_f32 v232, -v253, v152, v232
    v_fmac_f32 v233, v253, v144
    s_waitcnt lgkmcnt(4)
    v_mfma_f32_16x16x32_bf16 v[192:195], v[224:227], v[16:19], v[192:195]
    ds_read_b64_tr_b16 v[216:217], v241 offset:24576
    v_fma_f32 v234, v252, v232, v146
    v_fma_f32 v235, v252, v233, v154
    v_mfma_f32_16x16x32_bf16 v[196:199], v[224:227], v[20:23], v[196:199]
    ds_read_b64_tr_b16 v[218:219], v241 offset:25088
    v_fma_f32 v234, -v253, v233, v234
    v_fmac_f32_e64 v235, v253, v232
    s_add_u32 m0, s64, 114688
    s_add_u32 s67, s65, 4128768
    buffer_load_dwordx4 v244, s[12:15], s67 offen lds
    v_mfma_f32_16x16x32_bf16 v[204:207], v[228:231], v[20:23], v[204:207]
    ds_read_b64_tr_b16 v[220:221], v241 offset:28672
    v_fma_f32 v232, v252, v234, v147
    v_fma_f32 v233, v252, v235, v155
    v_mfma_f32_16x16x32_bf16 v[200:203], v[228:231], v[16:19], v[200:203]
    ds_read_b64_tr_b16 v[222:223], v241 offset:29184
    v_fma_f32 v232, -v253, v235, v232
    v_fmac_f32_e64 v233, v253, v234
    v_fma_f32 v234, v252, v232, v148
    s_waitcnt lgkmcnt(4)
    v_mfma_f32_16x16x32_bf16 v[176:179], v[208:211], v[24:27], v[176:179]
    ds_read_b64_tr_b16 v[224:225], v240 offset:32768
    v_fma_f32 v235, v252, v233, v156
    v_fma_f32 v234, -v253, v233, v234
    v_mfma_f32_16x16x32_bf16 v[180:183], v[208:211], v[28:31], v[180:183]
    ds_read_b64_tr_b16 v[226:227], v240 offset:33280
    v_fmac_f32 v235, v253, v232
    v_fma_f32 v232, v252, v234, v149
    v_mfma_f32_16x16x32_bf16 v[188:191], v[212:215], v[28:31], v[188:191]
    ds_read_b64_tr_b16 v[228:229], v240 offset:36864
    v_fma_f32 v233, v252, v235, v157
    v_fma_f32 v232, -v253, v235, v232
    v_mfma_f32_16x16x32_bf16 v[184:187], v[212:215], v[24:27], v[184:187]
    ds_read_b64_tr_b16 v[230:231], v240 offset:37376
    v_fmac_f32_e64 v233, v253, v234
    v_fma_f32 v234, v252, v232, v150
    v_fma_f32 v235, v252, v233, v158
    s_waitcnt lgkmcnt(4)
    v_mfma_f32_16x16x32_bf16 v[192:195], v[216:219], v[24:27], v[192:195]
    ds_read_b64_tr_b16 v[208:209], v241 offset:32768
    v_fma_f32 v234, -v253, v233, v234
    v_fmac_f32 v235, v253, v232
    v_mfma_f32_16x16x32_bf16 v[196:199], v[216:219], v[28:31], v[196:199]
    ds_read_b64_tr_b16 v[210:211], v241 offset:33280
    v_fma_f32 v232, v252, v234, v151
    v_fma_f32 v233, v252, v235, v159
    s_add_u32 m0, s64, 122880
    s_add_u32 s67, s65, 4423680
    buffer_load_dwordx4 v244, s[12:15], s67 offen lds
    v_mfma_f32_16x16x32_bf16 v[204:207], v[220:223], v[28:31], v[204:207]
    ds_read_b64_tr_b16 v[212:213], v241 offset:36864
    v_fma_f32 v232, -v253, v235, v232
    v_fmac_f32_e64 v233, v253, v234
    ds_read_b64 v[252:253], v254 offset:32
    v_mfma_f32_16x16x32_bf16 v[200:203], v[220:223], v[24:27], v[200:203]
    ds_read_b64_tr_b16 v[214:215], v241 offset:37376
    v_fma_f32 v236, v250, v160, v161
    v_fma_f32 v237, v250, v168, v169
    s_waitcnt lgkmcnt(5)
    v_mfma_f32_16x16x32_bf16 v[176:179], v[224:227], v[32:35], v[176:179]
    ds_read_b64_tr_b16 v[216:217], v240 offset:40960
    v_fma_f32 v236, -v251, v168, v236
    v_fmac_f32 v237, v251, v160
    v_fma_f32 v238, v250, v236, v162
    v_mfma_f32_16x16x32_bf16 v[180:183], v[224:227], v[36:39], v[180:183]
    ds_read_b64_tr_b16 v[218:219], v240 offset:41472
    v_fma_f32 v239, v250, v237, v170
    v_fma_f32 v238, -v251, v237, v238
    v_mfma_f32_16x16x32_bf16 v[188:191], v[228:231], v[36:39], v[188:191]
    ds_read_b64_tr_b16 v[220:221], v240 offset:45056
    v_fmac_f32_e64 v239, v251, v236
    v_fma_f32 v236, v250, v238, v163
    v_mfma_f32_16x16x32_bf16 v[184:187], v[228:231], v[32:35], v[184:187]
    ds_read_b64_tr_b16 v[222:223], v240 offset:45568
    v_fma_f32 v237, v250, v239, v171
    v_fma_f32 v236, -v251, v239, v236
    s_waitcnt lgkmcnt(4)
    v_mfma_f32_16x16x32_bf16 v[192:195], v[208:211], v[32:35], v[192:195]
    ds_read_b64_tr_b16 v[224:225], v241 offset:40960
    v_fmac_f32 v237, v251, v238
    v_fma_f32 v238, v250, v236, v164
    v_fma_f32 v239, v250, v237, v172
    v_mfma_f32_16x16x32_bf16 v[196:199], v[208:211], v[36:39], v[196:199]
    ds_read_b64_tr_b16 v[226:227], v241 offset:41472
    v_fma_f32 v238, -v251, v237, v238
    v_fmac_f32_e64 v239, v251, v236
    s_add_u32 m0, s64, 131072
    s_add_u32 s67, s65, 4718592
    buffer_load_dwordx4 v244, s[12:15], s67 offen lds
    v_mfma_f32_16x16x32_bf16 v[204:207], v[212:215], v[36:39], v[204:207]
    ds_read_b64_tr_b16 v[228:229], v241 offset:45056
    v_fma_f32 v236, v250, v238, v165
    v_fma_f32 v237, v250, v239, v173
    v_mfma_f32_16x16x32_bf16 v[200:203], v[212:215], v[32:35], v[200:203]
    ds_read_b64_tr_b16 v[230:231], v241 offset:45568
    v_fma_f32 v236, -v251, v239, v236
    v_fmac_f32_e64 v237, v251, v238
    v_fma_f32 v238, v250, v236, v166
    s_waitcnt lgkmcnt(4)
    v_mfma_f32_16x16x32_bf16 v[176:179], v[216:219], v[40:43], v[176:179]
    v_add_u32 v240, 49152, v240
    v_add_u32 v241, 49152, v241
    ds_read_b64_tr_b16 v[208:209], v240 offset:0
    v_fma_f32 v239, v250, v237, v174
    v_fma_f32 v238, -v251, v237, v238
    v_mfma_f32_16x16x32_bf16 v[180:183], v[216:219], v[44:47], v[180:183]
    ds_read_b64_tr_b16 v[210:211], v240 offset:512
    v_fmac_f32 v239, v251, v236
    v_fma_f32 v236, v250, v238, v167
    v_mfma_f32_16x16x32_bf16 v[188:191], v[220:223], v[44:47], v[188:191]
    ds_read_b64_tr_b16 v[212:213], v240 offset:4096
    v_fma_f32 v237, v250, v239, v175
    v_fma_f32 v236, -v251, v239, v236
    v_mfma_f32_16x16x32_bf16 v[184:187], v[220:223], v[40:43], v[184:187]
    ds_read_b64_tr_b16 v[214:215], v240 offset:4608
    v_fmac_f32_e64 v237, v251, v238
    ds_read_b64 v[250:251], v254 offset:1824
    s_lshl_b32 s87, s5, 10
    s_lshl_b32 s88, s4, 3
    s_add_u32 s87, s87, s88
    s_add_u32 s87, s87, 155520
    s_waitcnt lgkmcnt(5)
    v_mfma_f32_16x16x32_bf16 v[192:195], v[224:227], v[40:43], v[192:195]
    ds_read_b64_tr_b16 v[216:217], v241 offset:0
    v_mov_b32 v234, v232
    v_mov_b32 v235, v233
    v_bfe_u32 v247, v246, 4, 4
    v_mfma_f32_16x16x32_bf16 v[196:199], v[224:227], v[44:47], v[196:199]
    ds_read_b64_tr_b16 v[218:219], v241 offset:512
    v_permlane16_swap_b32 v232, v234
    v_permlane16_swap_b32 v233, v235
    s_add_u32 m0, s64, 139264
    s_add_u32 s67, s65, 5013504
    buffer_load_dwordx4 v244, s[12:15], s67 offen lds
    v_mfma_f32_16x16x32_bf16 v[204:207], v[228:231], v[44:47], v[204:207]
    ds_read_b64_tr_b16 v[220:221], v241 offset:4096
    v_mov_b32 v248, v232
    v_mov_b32 v238, v234
    v_mfma_f32_16x16x32_bf16 v[200:203], v[228:231], v[40:43], v[200:203]
    ds_read_b64_tr_b16 v[222:223], v241 offset:4608
    v_mov_b32 v249, v233
    v_mov_b32_e64 v239, v235
    s_waitcnt vmcnt(5)
    s_barrier
    s_waitcnt lgkmcnt(5)
    v_mfma_f32_16x16x32_bf16 v[176:179], v[208:211], v[48:51], v[176:179]
    ds_read_b64_tr_b16 v[224:225], v240 offset:8192
    v_lshl_add_u32 v247, v247, 5, s87
    v_permlane32_swap_b32 v232, v248
    v_permlane32_swap_b32 v234, v238
    v_mfma_f32_16x16x32_bf16 v[180:183], v[208:211], v[52:55], v[180:183]
    ds_read_b64_tr_b16 v[226:227], v240 offset:8704
    v_permlane32_swap_b32 v233, v249
    v_permlane32_swap_b32 v235, v239
    v_mfma_f32_16x16x32_bf16 v[188:191], v[212:215], v[52:55], v[188:191]
    ds_read_b64_tr_b16 v[228:229], v240 offset:12288
    v_fmac_f32 v234, v252, v232
    v_fmac_f32 v235, v252, v233
    v_mfma_f32_16x16x32_bf16 v[184:187], v[212:215], v[48:51], v[184:187]
    ds_read_b64_tr_b16 v[230:231], v240 offset:12800
    v_fma_f32 v234, -v253, v233, v234
    v_fmac_f32 v235, v253, v232
    s_waitcnt lgkmcnt(4)
    v_mfma_f32_16x16x32_bf16 v[192:195], v[216:219], v[48:51], v[192:195]
    ds_read_b64_tr_b16 v[208:209], v241 offset:8192
    v_fmac_f32 v248, v252, v234
    v_fmac_f32 v249, v252, v235
    v_mfma_f32_16x16x32_bf16 v[196:199], v[216:219], v[52:55], v[196:199]
    ds_read_b64_tr_b16 v[210:211], v241 offset:8704
    v_fma_f32 v248, -v253, v235, v248
    v_fmac_f32 v249, v253, v234
    v_fmac_f32 v238, v252, v248
    s_add_u32 m0, s64, 0
    s_add_u32 s67, s66, 0
    buffer_load_dwordx4 v244, s[12:15], s67 offen lds
    v_mfma_f32_16x16x32_bf16 v[204:207], v[220:223], v[52:55], v[204:207]
    ds_read_b64_tr_b16 v[212:213], v241 offset:12288
    v_fmac_f32_e64 v239, v252, v249
    v_fma_f32 v238, -v253, v249, v238
    v_mfma_f32_16x16x32_bf16 v[200:203], v[220:223], v[48:51], v[200:203]
    ds_read_b64_tr_b16 v[214:215], v241 offset:12800
    v_fmac_f32_e64 v239, v253, v248
    ds_write_b64 v247, v[238:239]
    v_cndmask_b32_e64 v248, 0, v248, s[78:79]
    s_waitcnt lgkmcnt(5)
    v_mfma_f32_16x16x32_bf16 v[176:179], v[224:227], v[56:59], v[176:179]
    ds_read_b64_tr_b16 v[216:217], v240 offset:16384
    v_cndmask_b32_e64 v248, v248, v232, s[74:75]
    v_cndmask_b32_e64 v248, v248, v234, s[76:77]
    v_mfma_f32_16x16x32_bf16 v[180:183], v[224:227], v[60:63], v[180:183]
    ds_read_b64_tr_b16 v[218:219], v240 offset:16896
    v_cndmask_b32_e64 v249, 0, v249, s[78:79]
    v_cndmask_b32_e64 v249, v249, v233, s[74:75]
    v_mfma_f32_16x16x32_bf16 v[188:191], v[228:231], v[60:63], v[188:191]
    ds_read_b64_tr_b16 v[220:221], v240 offset:20480
    v_cndmask_b32_e64 v249, v249, v235, s[76:77]
    v_mov_b32 v232, v236
    v_mov_b32_e64 v233, v237
    v_mfma_f32_16x16x32_bf16 v[184:187], v[228:231], v[56:59], v[184:187]
    ds_read_b64_tr_b16 v[222:223], v240 offset:20992
    s_nop 0
    v_permlane16_swap_b32 v236, v232
    v_permlane16_swap_b32 v237, v233
    s_waitcnt lgkmcnt(5)
    v_mfma_f32_16x16x32_bf16 v[192:195], v[208:211], v[56:59], v[192:195]
    ds_read_b64_tr_b16 v[224:225], v241 offset:16384
    v_mov_b32 v234, v236
    v_mov_b32 v238, v232
    v_mfma_f32_16x16x32_bf16 v[196:199], v[208:211], v[60:63], v[196:199]
    ds_read_b64_tr_b16 v[226:227], v241 offset:16896
    v_mov_b32 v235, v237
    v_mov_b32_e64 v239, v233
    s_nop 0
    s_add_u32 m0, s64, 8192
    s_add_u32 s67, s66, 294912
    buffer_load_dwordx4 v244, s[12:15], s67 offen lds
    v_mfma_f32_16x16x32_bf16 v[204:207], v[212:215], v[60:63], v[204:207]
    ds_read_b64_tr_b16 v[228:229], v241 offset:20480
    v_permlane32_swap_b32 v236, v234
    v_permlane32_swap_b32 v232, v238
    v_mfma_f32_16x16x32_bf16 v[200:203], v[212:215], v[56:59], v[200:203]
    ds_read_b64_tr_b16 v[230:231], v241 offset:20992
    v_permlane32_swap_b32 v237, v235
    v_permlane32_swap_b32 v233, v239
    s_waitcnt lgkmcnt(4)
    v_mfma_f32_16x16x32_bf16 v[176:179], v[216:219], v[64:67], v[176:179]
    ds_read_b64_tr_b16 v[208:209], v240 offset:24576
    v_fmac_f32 v232, v250, v236
    v_fmac_f32_e64 v233, v250, v237
    v_mfma_f32_16x16x32_bf16 v[180:183], v[216:219], v[68:71], v[180:183]
    ds_read_b64_tr_b16 v[210:211], v240 offset:25088
    v_fma_f32 v232, -v251, v237, v232
    v_fmac_f32 v233, v251, v236
    v_fmac_f32 v234, v250, v232
    v_mfma_f32_16x16x32_bf16 v[188:191], v[220:223], v[68:71], v[188:191]
    ds_read_b64_tr_b16 v[212:213], v240 offset:28672
    v_fmac_f32_e64 v235, v250, v233
    v_fma_f32 v234, -v251, v233, v234
    v_mfma_f32_16x16x32_bf16 v[184:187], v[220:223], v[64:67], v[184:187]
    ds_read_b64_tr_b16 v[214:215], v240 offset:29184
    v_fmac_f32 v235, v251, v232
    v_fmac_f32_e64 v238, v250, v234
    s_waitcnt lgkmcnt(4)
    v_mfma_f32_16x16x32_bf16 v[192:195], v[224:227], v[64:67], v[192:195]
    ds_read_b64_tr_b16 v[216:217], v241 offset:24576
    v_fmac_f32_e64 v239, v250, v235
    v_fma_f32 v238, -v251, v235, v238
    v_mfma_f32_16x16x32_bf16 v[196:199], v[224:227], v[68:71], v[196:199]
    ds_read_b64_tr_b16 v[218:219], v241 offset:25088
    v_fmac_f32_e64 v239, v251, v234
    ds_write_b64 v247, v[238:239] offset:512
    v_cndmask_b32_e64 v250, 0, v236, s[74:75]
    s_add_u32 m0, s64, 16384
    s_add_u32 s67, s66, 589824
    buffer_load_dwordx4 v244, s[12:15], s67 offen lds
    v_mfma_f32_16x16x32_bf16 v[204:207], v[228:231], v[68:71], v[204:207]
    ds_read_b64_tr_b16 v[220:221], v241 offset:28672
    v_cndmask_b32_e64 v250, v250, v232, s[76:77]
    v_cndmask_b32_e64 v250, v250, v234, s[78:79]
    v_cndmask_b32_e64 v251, 0, v237, s[74:75]
    v_mfma_f32_16x16x32_bf16 v[200:203], v[228:231], v[64:67], v[200:203]
    ds_read_b64_tr_b16 v[222:223], v241 offset:29184
    v_cndmask_b32_e64 v251, v251, v233, s[76:77]
    v_cndmask_b32_e64 v251, v251, v235, s[78:79]
    s_waitcnt lgkmcnt(2)
    s_barrier
    v_mfma_f32_16x16x32_bf16 v[176:179], v[208:211], v[72:75], v[176:179]
    ds_read_b64_tr_b16 v[224:225], v240 offset:32768
    s_lshl_b32 s88, s4, 3
    v_subrev_u32 v247, s88, v247
    ds_read_b64 v[252:253], v254 offset:16
    ds_read_b128 v[232:235], v247
    v_mfma_f32_16x16x32_bf16 v[180:183], v[208:211], v[76:79], v[180:183]
    ds_read_b64_tr_b16 v[226:227], v240 offset:33280
    v_mfma_f32_16x16x32_bf16 v[188:191], v[212:215], v[76:79], v[188:191]
    ds_read_b64_tr_b16 v[228:229], v240 offset:36864
    ds_read_b128 v[236:239], v247 offset:16
    v_mfma_f32_16x16x32_bf16 v[184:187], v[212:215], v[72:75], v[184:187]
    ds_read_b64_tr_b16 v[230:231], v240 offset:37376
    s_waitcnt lgkmcnt(7)
    v_mfma_f32_16x16x32_bf16 v[192:195], v[216:219], v[72:75], v[192:195]
    ds_read_b64_tr_b16 v[208:209], v241 offset:32768
    s_waitcnt lgkmcnt(2)
    v_fmac_f32 v234, v252, v232
    v_fmac_f32 v235, v252, v233
    v_mfma_f32_16x16x32_bf16 v[196:199], v[216:219], v[76:79], v[196:199]
    ds_read_b64_tr_b16 v[210:211], v241 offset:33280
    v_fma_f32 v234, -v253, v233, v234
    v_fmac_f32_e64 v235, v253, v232
    s_add_u32 m0, s64, 24576
    s_add_u32 s67, s66, 884736
    buffer_load_dwordx4 v244, s[12:15], s67 offen lds
    v_mfma_f32_16x16x32_bf16 v[204:207], v[220:223], v[76:79], v[204:207]
    ds_read_b64_tr_b16 v[212:213], v241 offset:36864
    v_fmac_f32 v236, v252, v234
    v_fmac_f32 v237, v252, v235
    v_mfma_f32_16x16x32_bf16 v[200:203], v[220:223], v[72:75], v[200:203]
    ds_read_b64_tr_b16 v[214:215], v241 offset:37376
    v_fma_f32 v236, -v253, v235, v236
    v_fmac_f32 v237, v253, v234
    s_waitcnt lgkmcnt(4)
    v_mfma_f32_16x16x32_bf16 v[176:179], v[224:227], v[80:83], v[176:179]
    ds_read_b64_tr_b16 v[216:217], v240 offset:40960
    v_fmac_f32 v238, v252, v236
    v_fmac_f32 v239, v252, v237
    v_mfma_f32_16x16x32_bf16 v[180:183], v[224:227], v[84:87], v[180:183]
    ds_read_b64_tr_b16 v[218:219], v240 offset:41472
    v_fma_f32 v238, -v253, v237, v238
    v_fmac_f32_e64 v239, v253, v236
    v_mfma_f32_16x16x32_bf16 v[188:191], v[228:231], v[84:87], v[188:191]
    ds_read_b64_tr_b16 v[220:221], v240 offset:45056
    s_cmp_lg_u32 s4, 0
    s_cbranch_scc1 L_agg13
    v_lshrrev_b32_e64 v252, 1, v246
    s_mov_b64 exec, 0xffff
    buffer_store_dwordx2 v[238:239], v252, s[24:27], s73 offen offset:0 sc1
    s_mov_b64 exec, -1
L_agg13:
    v_bfe_u32 v238, v246, 8, 2
    v_mfma_f32_16x16x32_bf16 v[184:187], v[228:231], v[80:83], v[184:187]
    ds_read_b64_tr_b16 v[222:223], v240 offset:45568
    v_lshl_add_u32 v238, v238, 3, v254
    ds_read_b64 v[238:239], v238 offset:24
    ds_read_b64 v[252:253], v254 offset:8
    s_waitcnt lgkmcnt(6)
    v_mfma_f32_16x16x32_bf16 v[192:195], v[208:211], v[80:83], v[192:195]
    ds_read_b64_tr_b16 v[224:225], v241 offset:40960
    v_cndmask_b32_e64 v232, 0, v232, s[80:81]
    v_cndmask_b32_e64 v232, v232, v234, s[82:83]
    v_mfma_f32_16x16x32_bf16 v[196:199], v[208:211], v[84:87], v[196:199]
    ds_read_b64_tr_b16 v[226:227], v241 offset:41472
    v_cndmask_b32_e64 v232, v232, v236, s[84:85]
    v_cndmask_b32_e64 v233, 0, v233, s[80:81]
    s_add_u32 m0, s64, 32768
    s_add_u32 s67, s66, 1179648
    buffer_load_dwordx4 v244, s[12:15], s67 offen lds
    v_mfma_f32_16x16x32_bf16 v[204:207], v[212:215], v[84:87], v[204:207]
    ds_read_b64_tr_b16 v[228:229], v241 offset:45056
    v_cndmask_b32_e64 v233, v233, v235, s[82:83]
    v_cndmask_b32_e64 v233, v233, v237, s[84:85]
    v_mfma_f32_16x16x32_bf16 v[200:203], v[212:215], v[80:83], v[200:203]
    ds_read_b64_tr_b16 v[230:231], v241 offset:45568
    s_waitcnt lgkmcnt(4)
    v_fmac_f32 v248, v238, v232
    v_fmac_f32_e64 v249, v238, v233
    v_mfma_f32_16x16x32_bf16 v[176:179], v[216:219], v[88:91], v[176:179]
    v_add_u32 v240, 49152, v240
    v_add_u32 v241, 49152, v241
    ds_read_b64_tr_b16 v[208:209], v240 offset:0
    v_fma_f32 v248, -v239, v233, v248
    v_fmac_f32_e64 v249, v239, v232
    v_mfma_f32_16x16x32_bf16 v[180:183], v[216:219], v[92:95], v[180:183]
    ds_read_b64_tr_b16 v[210:211], v240 offset:512
    ds_read_b128 v[232:235], v247 offset:512
    ds_read_b128 v[236:239], v247 offset:528
    v_fmac_f32_e64 v144, v252, v248
    v_mfma_f32_16x16x32_bf16 v[188:191], v[220:223], v[92:95], v[188:191]
    ds_read_b64_tr_b16 v[212:213], v240 offset:4096
    v_fmac_f32_e64 v152, v252, v249
    v_fma_f32 v144, -v253, v249, v144
    v_mfma_f32_16x16x32_bf16 v[184:187], v[220:223], v[88:91], v[184:187]
    ds_read_b64_tr_b16 v[214:215], v240 offset:4608
    v_fmac_f32_e64 v152, v253, v248
    ds_read_b64 v[248:249], v254 offset:1808
    v_fmac_f32 v145, v252, v144
    s_waitcnt lgkmcnt(7)
    v_mfma_f32_16x16x32_bf16 v[192:195], v[224:227], v[88:91], v[192:195]
    ds_read_b64_tr_b16 v[216:217], v241 offset:0
    v_fmac_f32_e64 v153, v252, v152
    v_fma_f32 v145, -v253, v152, v145
    v_mfma_f32_16x16x32_bf16 v[196:199], v[224:227], v[92:95], v[196:199]
    ds_read_b64_tr_b16 v[218:219], v241 offset:512
    v_fmac_f32 v153, v253, v144
    v_fmac_f32 v146, v252, v145
    s_add_u32 m0, s64, 40960
    s_add_u32 s67, s66, 1474560
    buffer_load_dwordx4 v244, s[12:15], s67 offen lds
    v_mfma_f32_16x16x32_bf16 v[204:207], v[228:231], v[92:95], v[204:207]
    ds_read_b64_tr_b16 v[220:221], v241 offset:4096
    v_fmac_f32_e64 v154, v252, v153
    v_fma_f32 v146, -v253, v153, v146
    v_mfma_f32_16x16x32_bf16 v[200:203], v[228:231], v[88:91], v[200:203]
    ds_read_b64_tr_b16 v[222:223], v241 offset:4608
    v_fmac_f32 v154, v253, v145
    s_waitcnt vmcnt(5)
    s_barrier
    s_waitcnt lgkmcnt(5)
    v_mfma_f32_16x16x32_bf16 v[176:179], v[208:211], v[96:99], v[176:179]
    ds_read_b64_tr_b16 v[224:225], v240 offset:8192
    v_fmac_f32 v147, v252, v146
    v_fmac_f32 v155, v252, v154
    v_mfma_f32_16x16x32_bf16 v[180:183], v[208:211], v[100:103], v[180:183]
    ds_read_b64_tr_b16 v[226:227], v240 offset:8704
    v_fma_f32 v147, -v253, v154, v147
    v_fmac_f32_e64 v155, v253, v146
    v_mfma_f32_16x16x32_bf16 v[188:191], v[212:215], v[100:103], v[188:191]
    ds_read_b64_tr_b16 v[228:229], v240 offset:12288
    v_fmac_f32 v148, v252, v147
    v_fmac_f32 v156, v252, v155
    v_mfma_f32_16x16x32_bf16 v[184:187], v[212:215], v[96:99], v[184:187]
    ds_read_b64_tr_b16 v[230:231], v240 offset:12800
    v_fma_f32 v148, -v253, v155, v148
    v_fmac_f32 v156, v253, v147
    s_waitcnt lgkmcnt(4)
    v_mfma_f32_16x16x32_bf16 v[192:195], v[216:219], v[96:99], v[192:195]
    ds_read_b64_tr_b16 v[208:209], v241 offset:8192
    v_fmac_f32 v149, v252, v148
    v_fmac_f32 v157, v252, v156
    v_mfma_f32_16x16x32_bf16 v[196:199], v[216:219], v[100:103], v[196:199]
    ds_read_b64_tr_b16 v[210:211], v241 offset:8704
    v_fma_f32 v149, -v253, v156, v149
    v_fmac_f32_e64 v157, v253, v148
    s_add_u32 m0, s64, 49152
    s_add_u32 s67, s66, 1769472
    buffer_load_dwordx4 v244, s[12:15], s67 offen lds
    v_mfma_f32_16x16x32_bf16 v[204:207], v[220:223], v[100:103], v[204:207]
    ds_read_b64_tr_b16 v[212:213], v241 offset:12288
    v_fmac_f32 v150, v252, v149
    v_fmac_f32 v158, v252, v157
    v_mfma_f32_16x16x32_bf16 v[200:203], v[220:223], v[96:99], v[200:203]
    ds_read_b64_tr_b16 v[214:215], v241 offset:12800
    v_fma_f32 v150, -v253, v157, v150
    v_fmac_f32 v158, v253, v149
    s_waitcnt lgkmcnt(4)
    v_mfma_f32_16x16x32_bf16 v[176:179], v[224:227], v[104:107], v[176:179]
    ds_read_b64_tr_b16 v[216:217], v240 offset:16384
    v_fmac_f32 v151, v252, v150
    v_fmac_f32 v159, v252, v158
    v_mfma_f32_16x16x32_bf16 v[180:183], v[224:227], v[108:111], v[180:183]
    ds_read_b64_tr_b16 v[218:219], v240 offset:16896
    v_fma_f32 v151, -v253, v158, v151
    v_fmac_f32_e64 v159, v253, v150
    v_mfma_f32_16x16x32_bf16 v[188:191], v[228:231], v[108:111], v[188:191]
    ds_read_b64_tr_b16 v[220:221], v240 offset:20480
    v_cvt_pk_bf16_f32 v144, v144, v145
    v_cvt_pk_bf16_f32 v145, v146, v147
    v_mfma_f32_16x16x32_bf16 v[184:187], v[228:231], v[104:107], v[184:187]
    ds_read_b64_tr_b16 v[222:223], v240 offset:20992
    v_cvt_pk_bf16_f32 v146, v148, v149
    v_cvt_pk_bf16_f32 v147, v150, v151
    s_waitcnt lgkmcnt(4)
    v_mfma_f32_16x16x32_bf16 v[192:195], v[208:211], v[104:107], v[192:195]
    ds_read_b64_tr_b16 v[224:225], v241 offset:16384
    v_cvt_pk_bf16_f32 v152, v152, v153
    v_cvt_pk_bf16_f32 v153, v154, v155
    v_mfma_f32_16x16x32_bf16 v[196:199], v[208:211], v[108:111], v[196:199]
    ds_read_b64_tr_b16 v[226:227], v241 offset:16896
    v_cvt_pk_bf16_f32 v154, v156, v157
    v_cvt_pk_bf16_f32 v155, v158, v159
    s_add_u32 m0, s64, 57344
    s_add_u32 s67, s66, 2064384
    buffer_load_dwordx4 v244, s[12:15], s67 offen lds
    v_mfma_f32_16x16x32_bf16 v[204:207], v[212:215], v[108:111], v[204:207]
    ds_read_b64_tr_b16 v[228:229], v241 offset:20480
    s_add_u32 s87, s68, 0
    buffer_store_dwordx4 v[144:147], v246, s[24:27], s87 offen sc1
    buffer_store_dwordx4 v[152:155], v246, s[24:27], s87 offen offset:1024 sc1
    v_fmac_f32_e64 v234, v248, v232
    v_mfma_f32_16x16x32_bf16 v[200:203], v[212:215], v[104:107], v[200:203]
    ds_read_b64_tr_b16 v[230:231], v241 offset:20992
    v_fmac_f32_e64 v235, v248, v233
    v_fma_f32 v234, -v249, v233, v234
    s_waitcnt lgkmcnt(4)
    v_mfma_f32_16x16x32_bf16 v[176:179], v[216:219], v[112:115], v[176:179]
    ds_read_b64_tr_b16 v[208:209], v240 offset:24576
    v_fmac_f32 v235, v249, v232
    v_fmac_f32_e64 v236, v248, v234
    v_mfma_f32_16x16x32_bf16 v[180:183], v[216:219], v[116:119], v[180:183]
    ds_read_b64_tr_b16 v[210:211], v240 offset:25088
    v_fmac_f32_e64 v237, v248, v235
    v_fma_f32 v236, -v249, v235, v236
    v_mfma_f32_16x16x32_bf16 v[188:191], v[220:223], v[116:119], v[188:191]
    ds_read_b64_tr_b16 v[212:213], v240 offset:28672
    v_fmac_f32 v237, v249, v234
    v_fmac_f32 v238, v248, v236
    v_mfma_f32_16x16x32_bf16 v[184:187], v[220:223], v[112:115], v[184:187]
    ds_read_b64_tr_b16 v[214:215], v240 offset:29184
    v_fmac_f32_e64 v239, v248, v237
    v_fma_f32 v238, -v249, v237, v238
    s_waitcnt lgkmcnt(4)
    v_mfma_f32_16x16x32_bf16 v[192:195], v[224:227], v[112:115], v[192:195]
    ds_read_b64_tr_b16 v[216:217], v241 offset:24576
    v_fmac_f32 v239, v249, v236
    s_cmp_lg_u32 s4, 0
    s_cbranch_scc1 L_agg14
    v_lshrrev_b32_e64 v252, 1, v246
    s_mov_b64 exec, 0xffff
    buffer_store_dwordx2 v[238:239], v252, s[24:27], s73 offen offset:256 sc1
    s_mov_b64 exec, -1
L_agg14:
    v_mfma_f32_16x16x32_bf16 v[196:199], v[224:227], v[116:119], v[196:199]
    ds_read_b64_tr_b16 v[218:219], v241 offset:25088
    v_bfe_u32 v238, v246, 8, 2
    v_lshl_add_u32 v238, v238, 3, v254
    s_add_u32 m0, s64, 65536
    s_add_u32 s67, s66, 2359296
    buffer_load_dwordx4 v244, s[12:15], s67 offen lds
    v_mfma_f32_16x16x32_bf16 v[204:207], v[228:231], v[116:119], v[204:207]
    ds_read_b64_tr_b16 v[220:221], v241 offset:28672
    ds_read_b64 v[238:239], v238 offset:1816
    ds_read_b64 v[252:253], v254 offset:1800
    v_cndmask_b32_e64 v232, 0, v232, s[80:81]
    v_cndmask_b32_e64 v232, v232, v234, s[82:83]
    v_mfma_f32_16x16x32_bf16 v[200:203], v[228:231], v[112:115], v[200:203]
    ds_read_b64_tr_b16 v[222:223], v241 offset:29184
    v_cndmask_b32_e64 v232, v232, v236, s[84:85]
    s_waitcnt lgkmcnt(6)
    v_mfma_f32_16x16x32_bf16 v[176:179], v[208:211], v[120:123], v[176:179]
    ds_read_b64_tr_b16 v[224:225], v240 offset:32768
    v_cndmask_b32_e64 v233, 0, v233, s[80:81]
    v_cndmask_b32_e64 v233, v233, v235, s[82:83]
    v_mfma_f32_16x16x32_bf16 v[180:183], v[208:211], v[124:127], v[180:183]
    ds_read_b64_tr_b16 v[226:227], v240 offset:33280
    v_cndmask_b32_e64 v233, v233, v237, s[84:85]
    s_waitcnt lgkmcnt(3)
    v_fmac_f32 v250, v238, v232
    v_mfma_f32_16x16x32_bf16 v[188:191], v[212:215], v[124:127], v[188:191]
    ds_read_b64_tr_b16 v[228:229], v240 offset:36864
    v_fmac_f32_e64 v251, v238, v233
    v_fma_f32 v250, -v239, v233, v250
    v_mfma_f32_16x16x32_bf16 v[184:187], v[212:215], v[120:123], v[184:187]
    ds_read_b64_tr_b16 v[230:231], v240 offset:37376
    v_fmac_f32 v251, v239, v232
    v_fmac_f32_e64 v160, v252, v250
    s_waitcnt lgkmcnt(4)
    v_mfma_f32_16x16x32_bf16 v[192:195], v[216:219], v[120:123], v[192:195]
    ds_read_b64_tr_b16 v[208:209], v241 offset:32768
    v_fmac_f32_e64 v168, v252, v251
    v_fma_f32 v160, -v253, v251, v160
    v_mfma_f32_16x16x32_bf16 v[196:199], v[216:219], v[124:127], v[196:199]
    ds_read_b64_tr_b16 v[210:211], v241 offset:33280
    v_fmac_f32 v168, v253, v250
    v_fmac_f32 v161, v252, v160
    s_add_u32 m0, s64, 73728
    s_add_u32 s67, s66, 2654208
    buffer_load_dwordx4 v244, s[12:15], s67 offen lds
    v_mfma_f32_16x16x32_bf16 v[204:207], v[220:223], v[124:127], v[204:207]
    ds_read_b64_tr_b16 v[212:213], v241 offset:36864
    v_fmac_f32_e64 v169, v252, v168
    v_fma_f32 v161, -v253, v168, v161
    v_mfma_f32_16x16x32_bf16 v[200:203], v[220:223], v[120:123], v[200:203]
    ds_read_b64_tr_b16 v[214:215], v241 offset:37376
    v_fmac_f32 v169, v253, v160
    v_fmac_f32_e64 v162, v252, v161
    s_waitcnt lgkmcnt(4)
    v_mfma_f32_16x16x32_bf16 v[176:179], v[224:227], v[128:131], v[176:179]
    ds_read_b64_tr_b16 v[216:217], v240 offset:40960
    v_fmac_f32_e64 v170, v252, v169
    v_fma_f32 v162, -v253, v169, v162
    v_mfma_f32_16x16x32_bf16 v[180:183], v[224:227], v[132:135], v[180:183]
    ds_read_b64_tr_b16 v[218:219], v240 offset:41472
    v_fmac_f32 v170, v253, v161
    v_fmac_f32 v163, v252, v162
    v_mfma_f32_16x16x32_bf16 v[188:191], v[228:231], v[132:135], v[188:191]
    ds_read_b64_tr_b16 v[220:221], v240 offset:45056
    v_fmac_f32_e64 v171, v252, v170
    v_fma_f32 v163, -v253, v170, v163
    v_mfma_f32_16x16x32_bf16 v[184:187], v[228:231], v[128:131], v[184:187]
    ds_read_b64_tr_b16 v[222:223], v240 offset:45568
    v_fmac_f32 v171, v253, v162
    v_fmac_f32_e64 v164, v252, v163
    s_waitcnt lgkmcnt(4)
    v_mfma_f32_16x16x32_bf16 v[192:195], v[208:211], v[128:131], v[192:195]
    ds_read_b64_tr_b16 v[224:225], v241 offset:40960
    v_fmac_f32_e64 v172, v252, v171
    v_fma_f32 v164, -v253, v171, v164
    v_mfma_f32_16x16x32_bf16 v[196:199], v[208:211], v[132:135], v[196:199]
    ds_read_b64_tr_b16 v[226:227], v241 offset:41472
    v_fmac_f32 v172, v253, v163
    v_fmac_f32 v165, v252, v164
    s_add_u32 m0, s64, 81920
    s_add_u32 s67, s66, 2949120
    buffer_load_dwordx4 v244, s[12:15], s67 offen lds
    v_mfma_f32_16x16x32_bf16 v[204:207], v[212:215], v[132:135], v[204:207]
    ds_read_b64_tr_b16 v[228:229], v241 offset:45056
    v_fmac_f32_e64 v173, v252, v172
    v_fma_f32 v165, -v253, v172, v165
    v_mfma_f32_16x16x32_bf16 v[200:203], v[212:215], v[128:131], v[200:203]
    ds_read_b64_tr_b16 v[230:231], v241 offset:45568
    v_fmac_f32 v173, v253, v164
    v_fmac_f32_e64 v166, v252, v165
    s_waitcnt lgkmcnt(4)
    v_mfma_f32_16x16x32_bf16 v[176:179], v[216:219], v[136:139], v[176:179]
    v_subrev_u32 v240, 98304, v240
    v_subrev_u32 v241, 98304, v241
    ds_read_b64_tr_b16 v[208:209], v240 offset:0
    v_fmac_f32_e64 v174, v252, v173
    v_fma_f32 v166, -v253, v173, v166
    v_mfma_f32_16x16x32_bf16 v[180:183], v[216:219], v[140:143], v[180:183]
    ds_read_b64_tr_b16 v[210:211], v240 offset:512
    v_fmac_f32_e64 v174, v253, v165
    v_mfma_f32_16x16x32_bf16 v[188:191], v[220:223], v[140:143], v[188:191]
    ds_read_b64_tr_b16 v[212:213], v240 offset:4096
    v_fmac_f32 v167, v252, v166
    v_fmac_f32 v175, v252, v174
    v_mfma_f32_16x16x32_bf16 v[184:187], v[220:223], v[136:139], v[184:187]
    ds_read_b64_tr_b16 v[214:215], v240 offset:4608
    v_fma_f32 v167, -v253, v174, v167
    v_fmac_f32 v175, v253, v166
    s_waitcnt lgkmcnt(4)
    v_mfma_f32_16x16x32_bf16 v[192:195], v[224:227], v[136:139], v[192:195]
    ds_read_b64_tr_b16 v[216:217], v241 offset:0
    v_cvt_pk_bf16_f32 v160, v160, v161
    v_cvt_pk_bf16_f32 v161, v162, v163
    v_mfma_f32_16x16x32_bf16 v[196:199], v[224:227], v[140:143], v[196:199]
    ds_read_b64_tr_b16 v[218:219], v241 offset:512
    v_cvt_pk_bf16_f32 v162, v164, v165
    v_cvt_pk_bf16_f32 v163, v166, v167
    s_add_u32 m0, s64, 90112
    s_add_u32 s67, s66, 3244032
    buffer_load_dwordx4 v244, s[12:15], s67 offen lds
    v_mfma_f32_16x16x32_bf16 v[204:207], v[228:231], v[140:143], v[204:207]
    ds_read_b64_tr_b16 v[220:221], v241 offset:4096
    v_cvt_pk_bf16_f32 v168, v168, v169
    v_cvt_pk_bf16_f32 v169, v170, v171
    v_mfma_f32_16x16x32_bf16 v[200:203], v[228:231], v[136:139], v[200:203]
    ds_read_b64_tr_b16 v[222:223], v241 offset:4608
    v_cvt_pk_bf16_f32 v170, v172, v173
    v_cvt_pk_bf16_f32 v171, v174, v175
    s_add_u32 s87, s68, 16384
    buffer_store_dwordx4 v[160:163], v246, s[24:27], s87 offen sc1
    buffer_store_dwordx4 v[168:171], v246, s[24:27], s87 offen offset:1024 sc1
    s_load_dwordx4 s[44:47], s[0:1], 40
    s_and_b32 s87, s6, 7
    s_mul_i32 s87, s87, 72
    s_mul_i32 s88, s4, 18
    s_add_u32 s87, s87, s88
    s_mul_i32 s39, s87, 1152
    s_lshl_b32 s87, s7, 8
    s_add_u32 s39, s39, s87
    s_waitcnt lgkmcnt(0)
    s_cmp_eq_u32 s5, 0
    s_cselect_b32 s40, s44, s46
    s_cselect_b32 s41, s45, s47
    s_mov_b32 s42, 663552
    s_mov_b32 s43, 0x20000
    s_mul_i32 s68, s6, 1179648
    s_lshl_b32 s87, s65, 7
    s_add_u32 s68, s68, s87
    s_mov_b32 s65, s66
    s_add_u32 s66, s65, 128
    s_cmp_eq_u32 s66, s98
    s_cselect_b32 s87, 384, 0
    s_sub_u32 s66, s66, s87
    s_mov_b32 s70, 1
    s_waitcnt vmcnt(5)
    s_barrier
    s_waitcnt lgkmcnt(4)
    v_mfma_f32_16x16x32_bf16 v[144:147], v[208:211], v[0:3], 0
    ds_read_b64_tr_b16 v[224:225], v240 offset:8192
    v_bfe_u32 v236, v246, 6, 2
    v_mfma_f32_16x16x32_bf16 v[148:151], v[208:211], v[4:7], 0
    ds_read_b64_tr_b16 v[226:227], v240 offset:8704
    v_bfe_u32 v237, v246, 4, 2
    s_lshl_b32 s87, s4, 7
    s_add_u32 s87, s87, 162816
    v_mfma_f32_16x16x32_bf16 v[156:159], v[212:215], v[4:7], 0
    ds_read_b64_tr_b16 v[228:229], v240 offset:12288
    v_lshl_add_u32 v236, v236, 5, s87
    v_mfma_f32_16x16x32_bf16 v[152:155], v[212:215], v[0:3], 0
    ds_read_b64_tr_b16 v[230:231], v240 offset:12800
    v_lshl_add_u32 v236, v237, 2, v236
    ds_read_b32 v249, v236
    s_waitcnt lgkmcnt(5)
    v_mfma_f32_16x16x32_bf16 v[160:163], v[216:219], v[0:3], 0
    ds_read_b64_tr_b16 v[208:209], v241 offset:8192
    v_mfma_f32_16x16x32_bf16 v[164:167], v[216:219], v[4:7], 0
    ds_read_b64_tr_b16 v[210:211], v241 offset:8704
    ds_read_b32 v250, v236 offset:16
    s_add_u32 m0, s64, 98304
    s_add_u32 s67, s65, 3538944
    buffer_load_dwordx4 v244, s[12:15], s67 offen lds
    v_mfma_f32_16x16x32_bf16 v[172:175], v[220:223], v[4:7], 0
    ds_read_b64_tr_b16 v[212:213], v241 offset:12288
    v_mfma_f32_16x16x32_bf16 v[168:171], v[220:223], v[0:3], 0
    ds_read_b64_tr_b16 v[214:215], v241 offset:12800
    s_waitcnt lgkmcnt(6)
    v_mfma_f32_16x16x32_bf16 v[144:147], v[224:227], v[8:11], v[144:147]
    ds_read_b64_tr_b16 v[216:217], v240 offset:16384
    s_waitcnt lgkmcnt(3)
    v_mul_f32 v247, 0xbfb8aa3b, v249
    v_mfma_f32_16x16x32_bf16 v[148:151], v[224:227], v[12:15], v[148:151]
    ds_read_b64_tr_b16 v[218:219], v240 offset:16896
    v_mul_f32_e64 v249, v249, v249
    v_mfma_f32_16x16x32_bf16 v[156:159], v[228:231], v[12:15], v[156:159]
    ds_read_b64_tr_b16 v[220:221], v240 offset:20480
    v_mul_f32 v248, 0xbfb8aa3b, v250
    v_mfma_f32_16x16x32_bf16 v[152:155], v[228:231], v[8:11], v[152:155]
    ds_read_b64_tr_b16 v[222:223], v240 offset:20992
    v_mul_f32 v250, v250, v250
    v_mul_f32_e64 v232, v176, v247
    s_waitcnt lgkmcnt(4)
    v_mfma_f32_16x16x32_bf16 v[160:163], v[208:211], v[8:11], v[160:163]
    ds_read_b64_tr_b16 v[224:225], v241 offset:16384
    v_mul_f32_e64 v233, v177, v247
    v_mfma_f32_16x16x32_bf16 v[164:167], v[208:211], v[12:15], v[164:167]
    ds_read_b64_tr_b16 v[226:227], v241 offset:16896
    v_mul_f32_e64 v234, v178, v247
    s_add_u32 m0, s64, 106496
    s_add_u32 s67, s65, 3833856
    buffer_load_dwordx4 v244, s[12:15], s67 offen lds
    v_mfma_f32_16x16x32_bf16 v[172:175], v[212:215], v[12:15], v[172:175]
    ds_read_b64_tr_b16 v[228:229], v241 offset:20480
    v_mul_f32_e64 v235, v179, v247
    v_mfma_f32_16x16x32_bf16 v[168:171], v[212:215], v[8:11], v[168:171]
    ds_read_b64_tr_b16 v[230:231], v241 offset:20992
    v_exp_f32 v232, v232
    s_waitcnt lgkmcnt(4)
    v_mfma_f32_16x16x32_bf16 v[144:147], v[216:219], v[16:19], v[144:147]
    ds_read_b64_tr_b16 v[208:209], v240 offset:24576
    v_mfma_f32_16x16x32_bf16 v[148:151], v[216:219], v[20:23], v[148:151]
    ds_read_b64_tr_b16 v[210:211], v240 offset:25088
    v_exp_f32_e64 v233, v233
    v_mfma_f32_16x16x32_bf16 v[156:159], v[220:223], v[20:23], v[156:159]
    ds_read_b64_tr_b16 v[212:213], v240 offset:28672
    v_exp_f32_e64 v234, v234
    v_mfma_f32_16x16x32_bf16 v[152:155], v[220:223], v[16:19], v[152:155]
    ds_read_b64_tr_b16 v[214:215], v240 offset:29184
    s_waitcnt lgkmcnt(4)
    v_mfma_f32_16x16x32_bf16 v[160:163], v[224:227], v[16:19], v[160:163]
    ds_read_b64_tr_b16 v[216:217], v241 offset:24576
    v_exp_f32 v235, v235
    v_mfma_f32_16x16x32_bf16 v[164:167], v[224:227], v[20:23], v[164:167]
    ds_read_b64_tr_b16 v[218:219], v241 offset:25088
    v_mul_f32_e64 v184, v184, v249
    s_add_u32 m0, s64, 114688
    s_add_u32 s67, s65, 4128768
    buffer_load_dwordx4 v244, s[12:15], s67 offen lds
    v_mfma_f32_16x16x32_bf16 v[172:175], v[228:231], v[20:23], v[172:175]
    ds_read_b64_tr_b16 v[220:221], v241 offset:28672
    v_mul_f32_e64 v185, v185, v249
    v_mfma_f32_16x16x32_bf16 v[168:171], v[228:231], v[16:19], v[168:171]
    ds_read_b64_tr_b16 v[222:223], v241 offset:29184
    v_mul_f32 v186, v186, v249
    s_waitcnt lgkmcnt(4)
    v_mfma_f32_16x16x32_bf16 v[144:147], v[208:211], v[24:27], v[144:147]
    ds_read_b64_tr_b16 v[224:225], v240 offset:32768
    v_mul_f32 v187, v187, v249
    v_add_f32 v232, 1.0, v232
    v_mfma_f32_16x16x32_bf16 v[148:151], v[208:211], v[28:31], v[148:151]
    ds_read_b64_tr_b16 v[226:227], v240 offset:33280
    v_add_f32_e64 v233, 1.0, v233
    v_mfma_f32_16x16x32_bf16 v[156:159], v[212:215], v[28:31], v[156:159]
    ds_read_b64_tr_b16 v[228:229], v240 offset:36864
    v_add_f32_e64 v234, 1.0, v234
    v_mfma_f32_16x16x32_bf16 v[152:155], v[212:215], v[24:27], v[152:155]
    ds_read_b64_tr_b16 v[230:231], v240 offset:37376
    v_add_f32 v235, 1.0, v235
    s_waitcnt lgkmcnt(4)
    v_mfma_f32_16x16x32_bf16 v[160:163], v[216:219], v[24:27], v[160:163]
    ds_read_b64_tr_b16 v[208:209], v241 offset:32768
    v_rcp_f32_e64 v232, v232
    v_mfma_f32_16x16x32_bf16 v[164:167], v[216:219], v[28:31], v[164:167]
    ds_read_b64_tr_b16 v[210:211], v241 offset:33280
    s_add_u32 m0, s64, 122880
    s_add_u32 s67, s65, 4423680
    buffer_load_dwordx4 v244, s[12:15], s67 offen lds
    v_mfma_f32_16x16x32_bf16 v[172:175], v[220:223], v[28:31], v[172:175]
    ds_read_b64_tr_b16 v[212:213], v241 offset:36864
    v_rcp_f32_e64 v233, v233
    v_mfma_f32_16x16x32_bf16 v[168:171], v[220:223], v[24:27], v[168:171]
    ds_read_b64_tr_b16 v[214:215], v241 offset:37376
    v_rcp_f32 v234, v234
    s_waitcnt lgkmcnt(4)
    v_mfma_f32_16x16x32_bf16 v[144:147], v[224:227], v[32:35], v[144:147]
    ds_read_b64_tr_b16 v[216:217], v240 offset:40960
    v_mfma_f32_16x16x32_bf16 v[148:151], v[224:227], v[36:39], v[148:151]
    ds_read_b64_tr_b16 v[218:219], v240 offset:41472
    v_rcp_f32_e64 v235, v235
    v_mfma_f32_16x16x32_bf16 v[156:159], v[228:231], v[36:39], v[156:159]
    ds_read_b64_tr_b16 v[220:221], v240 offset:45056
    v_mul_f32_e64 v176, v176, v232
    v_mfma_f32_16x16x32_bf16 v[152:155], v[228:231], v[32:35], v[152:155]
    ds_read_b64_tr_b16 v[222:223], v240 offset:45568
    v_mul_f32 v177, v177, v233
    s_waitcnt lgkmcnt(4)
    v_mfma_f32_16x16x32_bf16 v[160:163], v[208:211], v[32:35], v[160:163]
    ds_read_b64_tr_b16 v[224:225], v241 offset:40960
    v_mul_f32_e64 v178, v178, v234
    v_mfma_f32_16x16x32_bf16 v[164:167], v[208:211], v[36:39], v[164:167]
    ds_read_b64_tr_b16 v[226:227], v241 offset:41472
    v_mul_f32 v179, v179, v235
    v_mul_f32 v184, v184, v176
    s_add_u32 m0, s64, 131072
    s_add_u32 s67, s65, 4718592
    buffer_load_dwordx4 v244, s[12:15], s67 offen lds
    v_mfma_f32_16x16x32_bf16 v[172:175], v[212:215], v[36:39], v[172:175]
    ds_read_b64_tr_b16 v[228:229], v241 offset:45056
    v_mul_f32_e64 v185, v185, v177
    v_mfma_f32_16x16x32_bf16 v[168:171], v[212:215], v[32:35], v[168:171]
    ds_read_b64_tr_b16 v[230:231], v241 offset:45568
    v_mul_f32 v186, v186, v178
    s_waitcnt lgkmcnt(4)
    v_mfma_f32_16x16x32_bf16 v[144:147], v[216:219], v[40:43], v[144:147]
    v_add_u32 v240, 49152, v240
    v_add_u32 v241, 49152, v241
    ds_read_b64_tr_b16 v[208:209], v240 offset:0
    v_mul_f32_e64 v187, v187, v179
    v_mfma_f32_16x16x32_bf16 v[148:151], v[216:219], v[44:47], v[148:151]
    ds_read_b64_tr_b16 v[210:211], v240 offset:512
    v_mul_f32_e64 v232, v192, v247
    v_mfma_f32_16x16x32_bf16 v[156:159], v[220:223], v[44:47], v[156:159]
    ds_read_b64_tr_b16 v[212:213], v240 offset:4096
    v_mul_f32 v233, v193, v247
    v_mul_f32 v234, v194, v247
    v_mfma_f32_16x16x32_bf16 v[152:155], v[220:223], v[40:43], v[152:155]
    ds_read_b64_tr_b16 v[214:215], v240 offset:4608
    v_mul_f32 v235, v195, v247
    s_waitcnt lgkmcnt(4)
    v_mfma_f32_16x16x32_bf16 v[160:163], v[224:227], v[40:43], v[160:163]
    ds_read_b64_tr_b16 v[216:217], v241 offset:0
    v_exp_f32_e64 v232, v232
    v_mfma_f32_16x16x32_bf16 v[164:167], v[224:227], v[44:47], v[164:167]
    ds_read_b64_tr_b16 v[218:219], v241 offset:512
    s_add_u32 m0, s64, 139264
    s_add_u32 s67, s65, 5013504
    buffer_load_dwordx4 v244, s[12:15], s67 offen lds
    v_mfma_f32_16x16x32_bf16 v[172:175], v[228:231], v[44:47], v[172:175]
    ds_read_b64_tr_b16 v[220:221], v241 offset:4096
    v_exp_f32_e64 v233, v233
    v_mfma_f32_16x16x32_bf16 v[168:171], v[228:231], v[40:43], v[168:171]
    ds_read_b64_tr_b16 v[222:223], v241 offset:4608
    s_waitcnt vmcnt(5)
    s_barrier
    s_waitcnt lgkmcnt(4)
    v_mfma_f32_16x16x32_bf16 v[144:147], v[208:211], v[48:51], v[144:147]
    ds_read_b64_tr_b16 v[224:225], v240 offset:8192
    v_exp_f32 v234, v234
    v_mfma_f32_16x16x32_bf16 v[148:151], v[208:211], v[52:55], v[148:151]
    ds_read_b64_tr_b16 v[226:227], v240 offset:8704
    v_exp_f32_e64 v235, v235
    v_mfma_f32_16x16x32_bf16 v[156:159], v[212:215], v[52:55], v[156:159]
    ds_read_b64_tr_b16 v[228:229], v240 offset:12288
    v_mfma_f32_16x16x32_bf16 v[152:155], v[212:215], v[48:51], v[152:155]
    ds_read_b64_tr_b16 v[230:231], v240 offset:12800
    v_mul_f32 v200, v200, v249
    v_mul_f32_e64 v201, v201, v249
    s_waitcnt lgkmcnt(4)
    v_mfma_f32_16x16x32_bf16 v[160:163], v[216:219], v[48:51], v[160:163]
    ds_read_b64_tr_b16 v[208:209], v241 offset:8192
    v_mul_f32_e64 v202, v202, v249
    v_mfma_f32_16x16x32_bf16 v[164:167], v[216:219], v[52:55], v[164:167]
    ds_read_b64_tr_b16 v[210:211], v241 offset:8704
    v_mul_f32_e64 v203, v203, v249
    s_add_u32 m0, s64, 0
    s_add_u32 s67, s66, 0
    buffer_load_dwordx4 v244, s[12:15], s67 offen lds
    s_cmp_lg_u32 s3, 0
    s_cbranch_scc1 L_noflag
    s_lshl_b32 s38, 1, s6
    v_mov_b32 v239, s38
    s_lshl_b32 s38, s7, 6
    s_mov_b64 exec, 1
    buffer_atomic_or v239, off, s[60:63], s38 sc1
    s_mov_b64 exec, -1
L_noflag:
    v_mfma_f32_16x16x32_bf16 v[172:175], v[220:223], v[52:55], v[172:175]
    ds_read_b64_tr_b16 v[212:213], v241 offset:12288
    v_add_f32 v232, 1.0, v232
    v_mfma_f32_16x16x32_bf16 v[168:171], v[220:223], v[48:51], v[168:171]
    ds_read_b64_tr_b16 v[214:215], v241 offset:12800
    v_add_f32 v233, 1.0, v233
    v_add_f32_e64 v234, 1.0, v234
    s_waitcnt lgkmcnt(4)
    v_mfma_f32_16x16x32_bf16 v[144:147], v[224:227], v[56:59], v[144:147]
    ds_read_b64_tr_b16 v[216:217], v240 offset:16384
    v_add_f32_e64 v235, 1.0, v235
    v_mfma_f32_16x16x32_bf16 v[148:151], v[224:227], v[60:63], v[148:151]
    ds_read_b64_tr_b16 v[218:219], v240 offset:16896
    v_rcp_f32_e64 v232, v232
    v_mfma_f32_16x16x32_bf16 v[156:159], v[228:231], v[60:63], v[156:159]
    ds_read_b64_tr_b16 v[220:221], v240 offset:20480
    v_mfma_f32_16x16x32_bf16 v[152:155], v[228:231], v[56:59], v[152:155]
    ds_read_b64_tr_b16 v[222:223], v240 offset:20992
    v_rcp_f32 v233, v233
    s_waitcnt lgkmcnt(4)
    v_mfma_f32_16x16x32_bf16 v[160:163], v[208:211], v[56:59], v[160:163]
    ds_read_b64_tr_b16 v[224:225], v241 offset:16384
    v_mfma_f32_16x16x32_bf16 v[164:167], v[208:211], v[60:63], v[164:167]
    ds_read_b64_tr_b16 v[226:227], v241 offset:16896
    v_rcp_f32_e64 v234, v234
    s_add_u32 m0, s64, 8192
    s_add_u32 s67, s66, 294912
    buffer_load_dwordx4 v244, s[12:15], s67 offen lds
    v_mfma_f32_16x16x32_bf16 v[172:175], v[212:215], v[60:63], v[172:175]
    ds_read_b64_tr_b16 v[228:229], v241 offset:20480
    v_rcp_f32_e64 v235, v235
    v_mfma_f32_16x16x32_bf16 v[168:171], v[212:215], v[56:59], v[168:171]
    ds_read_b64_tr_b16 v[230:231], v241 offset:20992
    s_waitcnt lgkmcnt(4)
    v_mfma_f32_16x16x32_bf16 v[144:147], v[216:219], v[64:67], v[144:147]
    ds_read_b64_tr_b16 v[208:209], v240 offset:24576
    v_mul_f32 v192, v192, v232
    v_mul_f32_e64 v193, v193, v233
    v_mfma_f32_16x16x32_bf16 v[148:151], v[216:219], v[68:71], v[148:151]
    ds_read_b64_tr_b16 v[210:211], v240 offset:25088
    v_mul_f32_e64 v194, v194, v234
    v_mfma_f32_16x16x32_bf16 v[156:159], v[220:223], v[68:71], v[156:159]
    ds_read_b64_tr_b16 v[212:213], v240 offset:28672
    v_mul_f32_e64 v195, v195, v235
    v_mfma_f32_16x16x32_bf16 v[152:155], v[220:223], v[64:67], v[152:155]
    ds_read_b64_tr_b16 v[214:215], v240 offset:29184
    v_mul_f32 v200, v200, v192
    s_waitcnt lgkmcnt(4)
    v_mfma_f32_16x16x32_bf16 v[160:163], v[224:227], v[64:67], v[160:163]
    ds_read_b64_tr_b16 v[216:217], v241 offset:24576
    v_mul_f32_e64 v201, v201, v193
    v_mfma_f32_16x16x32_bf16 v[164:167], v[224:227], v[68:71], v[164:167]
    ds_read_b64_tr_b16 v[218:219], v241 offset:25088
    v_mul_f32 v202, v202, v194
    v_mul_f32 v203, v203, v195
    s_add_u32 m0, s64, 16384
    s_add_u32 s67, s66, 589824
    buffer_load_dwordx4 v244, s[12:15], s67 offen lds
    v_mfma_f32_16x16x32_bf16 v[172:175], v[228:231], v[68:71], v[172:175]
    ds_read_b64_tr_b16 v[220:221], v241 offset:28672
    v_cvt_pk_bf16_f32 v176, v184, v185
    v_mfma_f32_16x16x32_bf16 v[168:171], v[228:231], v[64:67], v[168:171]
    ds_read_b64_tr_b16 v[222:223], v241 offset:29184
    v_cvt_pk_bf16_f32 v177, v186, v187
    s_waitcnt lgkmcnt(4)
    v_mfma_f32_16x16x32_bf16 v[144:147], v[208:211], v[72:75], v[144:147]
    ds_read_b64_tr_b16 v[224:225], v240 offset:32768
    v_cvt_pk_bf16_f32 v178, v200, v201
    v_mfma_f32_16x16x32_bf16 v[148:151], v[208:211], v[76:79], v[148:151]
    ds_read_b64_tr_b16 v[226:227], v240 offset:33280
    v_cvt_pk_bf16_f32 v179, v202, v203
    buffer_store_dwordx4 v[176:179], v246, s[24:27], s68 offen offset:0 sc1
    v_mfma_f32_16x16x32_bf16 v[156:159], v[212:215], v[76:79], v[156:159]
    ds_read_b64_tr_b16 v[228:229], v240 offset:36864
    v_mul_f32 v232, v180, v248
    v_mul_f32_e64 v233, v181, v248
    v_mfma_f32_16x16x32_bf16 v[152:155], v[212:215], v[72:75], v[152:155]
    ds_read_b64_tr_b16 v[230:231], v240 offset:37376
    v_mul_f32 v234, v182, v248
    s_waitcnt lgkmcnt(4)
    v_mfma_f32_16x16x32_bf16 v[160:163], v[216:219], v[72:75], v[160:163]
    ds_read_b64_tr_b16 v[208:209], v241 offset:32768
    v_mul_f32_e64 v235, v183, v248
    v_mfma_f32_16x16x32_bf16 v[164:167], v[216:219], v[76:79], v[164:167]
    ds_read_b64_tr_b16 v[210:211], v241 offset:33280
    v_exp_f32_e64 v232, v232
    s_add_u32 m0, s64, 24576
    s_add_u32 s67, s66, 884736
    buffer_load_dwordx4 v244, s[12:15], s67 offen lds
    v_mfma_f32_16x16x32_bf16 v[172:175], v[220:223], v[76:79], v[172:175]
    ds_read_b64_tr_b16 v[212:213], v241 offset:36864
    v_mfma_f32_16x16x32_bf16 v[168:171], v[220:223], v[72:75], v[168:171]
    ds_read_b64_tr_b16 v[214:215], v241 offset:37376
    v_exp_f32 v233, v233
    s_waitcnt lgkmcnt(4)
    v_mfma_f32_16x16x32_bf16 v[144:147], v[224:227], v[80:83], v[144:147]
    ds_read_b64_tr_b16 v[216:217], v240 offset:40960
    v_mfma_f32_16x16x32_bf16 v[148:151], v[224:227], v[84:87], v[148:151]
    ds_read_b64_tr_b16 v[218:219], v240 offset:41472
    v_exp_f32_e64 v234, v234
    v_mfma_f32_16x16x32_bf16 v[156:159], v[228:231], v[84:87], v[156:159]
    ds_read_b64_tr_b16 v[220:221], v240 offset:45056
    v_exp_f32_e64 v235, v235
    v_mfma_f32_16x16x32_bf16 v[152:155], v[228:231], v[80:83], v[152:155]
    ds_read_b64_tr_b16 v[222:223], v240 offset:45568
    v_mul_f32 v188, v188, v250
    s_waitcnt lgkmcnt(4)
    v_mfma_f32_16x16x32_bf16 v[160:163], v[208:211], v[80:83], v[160:163]
    ds_read_b64_tr_b16 v[224:225], v241 offset:40960
    v_mul_f32_e64 v189, v189, v250
    v_mfma_f32_16x16x32_bf16 v[164:167], v[208:211], v[84:87], v[164:167]
    ds_read_b64_tr_b16 v[226:227], v241 offset:41472
    v_mul_f32_e64 v190, v190, v250
    s_add_u32 m0, s64, 32768
    s_add_u32 s67, s66, 1179648
    buffer_load_dwordx4 v244, s[12:15], s67 offen lds
    v_mfma_f32_16x16x32_bf16 v[172:175], v[212:215], v[84:87], v[172:175]
    ds_read_b64_tr_b16 v[228:229], v241 offset:45056
    v_mul_f32_e64 v191, v191, v250
    v_mfma_f32_16x16x32_bf16 v[168:171], v[212:215], v[80:83], v[168:171]
    ds_read_b64_tr_b16 v[230:231], v241 offset:45568
    v_add_f32 v232, 1.0, v232
    s_waitcnt lgkmcnt(4)
    v_mfma_f32_16x16x32_bf16 v[144:147], v[216:219], v[88:91], v[144:147]
    v_add_u32 v240, 49152, v240
    v_add_u32 v241, 49152, v241
    ds_read_b64_tr_b16 v[208:209], v240 offset:0
    v_add_f32 v233, 1.0, v233
    v_add_f32 v234, 1.0, v234
    v_mfma_f32_16x16x32_bf16 v[148:151], v[216:219], v[92:95], v[148:151]
    ds_read_b64_tr_b16 v[210:211], v240 offset:512
    v_add_f32_e64 v235, 1.0, v235
    v_mfma_f32_16x16x32_bf16 v[156:159], v[220:223], v[92:95], v[156:159]
    ds_read_b64_tr_b16 v[212:213], v240 offset:4096
    v_rcp_f32_e64 v232, v232
    v_mfma_f32_16x16x32_bf16 v[152:155], v[220:223], v[88:91], v[152:155]
    ds_read_b64_tr_b16 v[214:215], v240 offset:4608
    s_waitcnt lgkmcnt(4)
    v_mfma_f32_16x16x32_bf16 v[160:163], v[224:227], v[88:91], v[160:163]
    ds_read_b64_tr_b16 v[216:217], v241 offset:0
    v_rcp_f32 v233, v233
    v_mfma_f32_16x16x32_bf16 v[164:167], v[224:227], v[92:95], v[164:167]
    ds_read_b64_tr_b16 v[218:219], v241 offset:512
    s_add_u32 m0, s64, 40960
    s_add_u32 s67, s66, 1474560
    buffer_load_dwordx4 v244, s[12:15], s67 offen lds
    v_mfma_f32_16x16x32_bf16 v[172:175], v[228:231], v[92:95], v[172:175]
    ds_read_b64_tr_b16 v[220:221], v241 offset:4096
    v_rcp_f32_e64 v234, v234
    v_mfma_f32_16x16x32_bf16 v[168:171], v[228:231], v[88:91], v[168:171]
    ds_read_b64_tr_b16 v[222:223], v241 offset:4608
    v_rcp_f32 v235, v235
    s_waitcnt vmcnt(5)
    s_barrier
    s_waitcnt lgkmcnt(4)
    v_mfma_f32_16x16x32_bf16 v[144:147], v[208:211], v[96:99], v[144:147]
    ds_read_b64_tr_b16 v[224:225], v240 offset:8192
    v_mul_f32_e64 v180, v180, v232
    v_mfma_f32_16x16x32_bf16 v[148:151], v[208:211], v[100:103], v[148:151]
    ds_read_b64_tr_b16 v[226:227], v240 offset:8704
    v_mul_f32_e64 v181, v181, v233
    v_mfma_f32_16x16x32_bf16 v[156:159], v[212:215], v[100:103], v[156:159]
    ds_read_b64_tr_b16 v[228:229], v240 offset:12288
    v_mul_f32_e64 v182, v182, v234
    v_mfma_f32_16x16x32_bf16 v[152:155], v[212:215], v[96:99], v[152:155]
    ds_read_b64_tr_b16 v[230:231], v240 offset:12800
    v_mul_f32 v183, v183, v235
    s_waitcnt lgkmcnt(4)
    v_mfma_f32_16x16x32_bf16 v[160:163], v[216:219], v[96:99], v[160:163]
    ds_read_b64_tr_b16 v[208:209], v241 offset:8192
    v_mul_f32_e64 v188, v188, v180
    v_mfma_f32_16x16x32_bf16 v[164:167], v[216:219], v[100:103], v[164:167]
    ds_read_b64_tr_b16 v[210:211], v241 offset:8704
    v_mul_f32 v189, v189, v181
    v_mul_f32 v190, v190, v182
    s_add_u32 m0, s64, 49152
    s_add_u32 s67, s66, 1769472
    buffer_load_dwordx4 v244, s[12:15], s67 offen lds
    v_mfma_f32_16x16x32_bf16 v[172:175], v[220:223], v[100:103], v[172:175]
    ds_read_b64_tr_b16 v[212:213], v241 offset:12288
    v_mul_f32_e64 v191, v191, v183
    v_mfma_f32_16x16x32_bf16 v[168:171], v[220:223], v[96:99], v[168:171]
    ds_read_b64_tr_b16 v[214:215], v241 offset:12800
    v_mul_f32 v232, v196, v248
    s_waitcnt lgkmcnt(4)
    v_mfma_f32_16x16x32_bf16 v[144:147], v[224:227], v[104:107], v[144:147]
    ds_read_b64_tr_b16 v[216:217], v240 offset:16384
    v_mul_f32_e64 v233, v197, v248
    v_mfma_f32_16x16x32_bf16 v[148:151], v[224:227], v[108:111], v[148:151]
    ds_read_b64_tr_b16 v[218:219], v240 offset:16896
    v_mul_f32 v234, v198, v248
    v_mul_f32 v235, v199, v248
    v_mfma_f32_16x16x32_bf16 v[156:159], v[228:231], v[108:111], v[156:159]
    ds_read_b64_tr_b16 v[220:221], v240 offset:20480
    v_mfma_f32_16x16x32_bf16 v[152:155], v[228:231], v[104:107], v[152:155]
    ds_read_b64_tr_b16 v[222:223], v240 offset:20992
    v_exp_f32 v232, v232
    s_waitcnt lgkmcnt(4)
    v_mfma_f32_16x16x32_bf16 v[160:163], v[208:211], v[104:107], v[160:163]
    ds_read_b64_tr_b16 v[224:225], v241 offset:16384
    v_exp_f32_e64 v233, v233
    v_mfma_f32_16x16x32_bf16 v[164:167], v[208:211], v[108:111], v[164:167]
    ds_read_b64_tr_b16 v[226:227], v241 offset:16896
    s_add_u32 m0, s64, 57344
    s_add_u32 s67, s66, 2064384
    buffer_load_dwordx4 v244, s[12:15], s67 offen lds
    v_mfma_f32_16x16x32_bf16 v[172:175], v[212:215], v[108:111], v[172:175]
    ds_read_b64_tr_b16 v[228:229], v241 offset:20480
    v_exp_f32_e64 v234, v234
    v_mfma_f32_16x16x32_bf16 v[168:171], v[212:215], v[104:107], v[168:171]
    ds_read_b64_tr_b16 v[230:231], v241 offset:20992
    s_waitcnt lgkmcnt(4)
    v_mfma_f32_16x16x32_bf16 v[144:147], v[216:219], v[112:115], v[144:147]
    ds_read_b64_tr_b16 v[208:209], v240 offset:24576
    v_exp_f32 v235, v235
    v_mfma_f32_16x16x32_bf16 v[148:151], v[216:219], v[116:119], v[148:151]
    ds_read_b64_tr_b16 v[210:211], v240 offset:25088
    v_mul_f32_e64 v204, v204, v250
    v_mfma_f32_16x16x32_bf16 v[156:159], v[220:223], v[116:119], v[156:159]
    ds_read_b64_tr_b16 v[212:213], v240 offset:28672
    v_mul_f32 v205, v205, v250
    v_mul_f32 v206, v206, v250
    v_mfma_f32_16x16x32_bf16 v[152:155], v[220:223], v[112:115], v[152:155]
    ds_read_b64_tr_b16 v[214:215], v240 offset:29184
    v_mul_f32 v207, v207, v250
    s_waitcnt lgkmcnt(4)
    v_mfma_f32_16x16x32_bf16 v[160:163], v[224:227], v[112:115], v[160:163]
    ds_read_b64_tr_b16 v[216:217], v241 offset:24576
    v_add_f32_e64 v232, 1.0, v232
    v_mfma_f32_16x16x32_bf16 v[164:167], v[224:227], v[116:119], v[164:167]
    ds_read_b64_tr_b16 v[218:219], v241 offset:25088
    v_add_f32_e64 v233, 1.0, v233
    s_add_u32 m0, s64, 65536
    s_add_u32 s67, s66, 2359296
    buffer_load_dwordx4 v244, s[12:15], s67 offen lds
    v_mfma_f32_16x16x32_bf16 v[172:175], v[228:231], v[116:119], v[172:175]
    ds_read_b64_tr_b16 v[220:221], v241 offset:28672
    v_add_f32_e64 v234, 1.0, v234
    v_mfma_f32_16x16x32_bf16 v[168:171], v[228:231], v[112:115], v[168:171]
    ds_read_b64_tr_b16 v[222:223], v241 offset:29184
    v_add_f32 v235, 1.0, v235
    s_waitcnt lgkmcnt(4)
    v_mfma_f32_16x16x32_bf16 v[144:147], v[208:211], v[120:123], v[144:147]
    ds_read_b64_tr_b16 v[224:225], v240 offset:32768
    v_rcp_f32_e64 v232, v232
    v_mfma_f32_16x16x32_bf16 v[148:151], v[208:211], v[124:127], v[148:151]
    ds_read_b64_tr_b16 v[226:227], v240 offset:33280
    v_rcp_f32_e64 v233, v233
    v_mfma_f32_16x16x32_bf16 v[156:159], v[212:215], v[124:127], v[156:159]
    ds_read_b64_tr_b16 v[228:229], v240 offset:36864
    v_mfma_f32_16x16x32_bf16 v[152:155], v[212:215], v[120:123], v[152:155]
    ds_read_b64_tr_b16 v[230:231], v240 offset:37376
    v_rcp_f32 v234, v234
    s_waitcnt lgkmcnt(4)
    v_mfma_f32_16x16x32_bf16 v[160:163], v[216:219], v[120:123], v[160:163]
    ds_read_b64_tr_b16 v[208:209], v241 offset:32768
    v_mfma_f32_16x16x32_bf16 v[164:167], v[216:219], v[124:127], v[164:167]
    ds_read_b64_tr_b16 v[210:211], v241 offset:33280
    v_rcp_f32_e64 v235, v235
    s_add_u32 m0, s64, 73728
    s_add_u32 s67, s66, 2654208
    buffer_load_dwordx4 v244, s[12:15], s67 offen lds
    v_mfma_f32_16x16x32_bf16 v[172:175], v[220:223], v[124:127], v[172:175]
    ds_read_b64_tr_b16 v[212:213], v241 offset:36864
    v_mul_f32_e64 v196, v196, v232
    v_mfma_f32_16x16x32_bf16 v[168:171], v[220:223], v[120:123], v[168:171]
    ds_read_b64_tr_b16 v[214:215], v241 offset:37376
    v_mul_f32 v197, v197, v233
    s_waitcnt lgkmcnt(4)
    v_mfma_f32_16x16x32_bf16 v[144:147], v[224:227], v[128:131], v[144:147]
    ds_read_b64_tr_b16 v[216:217], v240 offset:40960
    v_mul_f32 v198, v198, v234
    v_mul_f32 v199, v199, v235
    v_mfma_f32_16x16x32_bf16 v[148:151], v[224:227], v[132:135], v[148:151]
    ds_read_b64_tr_b16 v[218:219], v240 offset:41472
    v_mul_f32_e64 v204, v204, v196
    v_mfma_f32_16x16x32_bf16 v[156:159], v[228:231], v[132:135], v[156:159]
    ds_read_b64_tr_b16 v[220:221], v240 offset:45056
    v_mul_f32_e64 v205, v205, v197
    v_mfma_f32_16x16x32_bf16 v[152:155], v[228:231], v[128:131], v[152:155]
    ds_read_b64_tr_b16 v[222:223], v240 offset:45568
    v_mul_f32 v206, v206, v198
    s_waitcnt lgkmcnt(4)
    v_mfma_f32_16x16x32_bf16 v[160:163], v[208:211], v[128:131], v[160:163]
    ds_read_b64_tr_b16 v[224:225], v241 offset:40960
    v_mul_f32_e64 v207, v207, v199
    v_cvt_pk_bf16_f32 v180, v188, v189
    s_lshl_b32 s38, s7, 6
    s_cmp_eq_u32 s3, 0
    s_cselect_b32 s38, s38, 1073741824
    s_cmp_eq_u32 s70, 0
    s_cselect_b32 s38, 1073741824, s38
    buffer_load_dword v239, off, s[60:63], s38 sc1
    v_mfma_f32_16x16x32_bf16 v[164:167], v[208:211], v[132:135], v[164:167]
    ds_read_b64_tr_b16 v[226:227], v241 offset:41472
    v_cvt_pk_bf16_f32 v181, v190, v191
    s_add_u32 m0, s64, 81920
    s_add_u32 s67, s66, 2949120
    buffer_load_dwordx4 v244, s[12:15], s67 offen lds
    v_mfma_f32_16x16x32_bf16 v[172:175], v[212:215], v[132:135], v[172:175]
    ds_read_b64_tr_b16 v[228:229], v241 offset:45056
    v_cvt_pk_bf16_f32 v182, v204, v205
    v_mfma_f32_16x16x32_bf16 v[168:171], v[212:215], v[128:131], v[168:171]
    ds_read_b64_tr_b16 v[230:231], v241 offset:45568
    v_cvt_pk_bf16_f32 v183, v206, v207
    buffer_store_dwordx4 v[180:183], v246, s[24:27], s68 offen offset:1024 sc1
    s_waitcnt lgkmcnt(4)
    v_mfma_f32_16x16x32_bf16 v[144:147], v[216:219], v[136:139], v[144:147]
    v_subrev_u32 v240, 98304, v240
    v_subrev_u32 v241, 98304, v241
    ds_read_b64_tr_b16 v[208:209], v240 offset:0
    v_mfma_f32_16x16x32_bf16 v[148:151], v[216:219], v[140:143], v[148:151]
    ds_read_b64_tr_b16 v[210:211], v240 offset:512
    v_mfma_f32_16x16x32_bf16 v[156:159], v[220:223], v[140:143], v[156:159]
    ds_read_b64_tr_b16 v[212:213], v240 offset:4096
    v_mfma_f32_16x16x32_bf16 v[152:155], v[220:223], v[136:139], v[152:155]
    ds_read_b64_tr_b16 v[214:215], v240 offset:4608
    s_waitcnt lgkmcnt(4)
    v_mfma_f32_16x16x32_bf16 v[160:163], v[224:227], v[136:139], v[160:163]
    ds_read_b64_tr_b16 v[216:217], v241 offset:0
    v_mfma_f32_16x16x32_bf16 v[164:167], v[224:227], v[140:143], v[164:167]
    ds_read_b64_tr_b16 v[218:219], v241 offset:512
    s_add_u32 m0, s64, 90112
    s_add_u32 s67, s66, 3244032
    buffer_load_dwordx4 v244, s[12:15], s67 offen lds
    v_mfma_f32_16x16x32_bf16 v[172:175], v[228:231], v[140:143], v[172:175]
    ds_read_b64_tr_b16 v[220:221], v241 offset:4096
    v_mfma_f32_16x16x32_bf16 v[168:171], v[228:231], v[136:139], v[168:171]
    ds_read_b64_tr_b16 v[222:223], v241 offset:4608
    s_waitcnt vmcnt(2)
    s_cmp_lg_u32 s3, 0
    s_cbranch_scc1 L_pollok
    s_lshl_b32 s40, 1, s6
    s_sub_u32 s40, s40, 1
    s_lshl_b32 s38, s7, 6
    s_mov_b32 s93, 0
L_poll:
    v_readfirstlane_b32 s41, v239
    s_nop 3
    s_and_b32 s41, s41, s40
    s_cmp_eq_u32 s41, s40
    s_cbranch_scc1 L_pollok
    s_add_u32 s93, s93, 1
    s_cmp_gt_u32 s93, 60000
    s_cbranch_scc1 L_pollok
    s_sleep 8
    buffer_load_dword v239, off, s[60:63], s38 sc1
    s_waitcnt vmcnt(0)
    s_branch L_poll
L_pollok:
    s_mul_i32 s68, s6, 1179648
    s_lshl_b32 s87, s65, 7
    s_add_u32 s68, s68, s87
    s_mov_b32 s65, s66
    s_barrier
    s_waitcnt lgkmcnt(4)
    v_mfma_f32_16x16x32_bf16 v[176:179], v[208:211], v[0:3], 0
    ds_read_b64_tr_b16 v[224:225], v240 offset:8192
    v_mul_f32 v232, v144, v247
    v_mfma_f32_16x16x32_bf16 v[180:183], v[208:211], v[4:7], 0
    ds_read_b64_tr_b16 v[226:227], v240 offset:8704
    v_mul_f32_e64 v233, v145, v247
    v_mfma_f32_16x16x32_bf16 v[188:191], v[212:215], v[4:7], 0
    ds_read_b64_tr_b16 v[228:229], v240 offset:12288
    v_mul_f32_e64 v234, v146, v247
    v_mfma_f32_16x16x32_bf16 v[184:187], v[212:215], v[0:3], 0
    ds_read_b64_tr_b16 v[230:231], v240 offset:12800
    v_mul_f32 v235, v147, v247
    s_waitcnt lgkmcnt(4)
    v_mfma_f32_16x16x32_bf16 v[192:195], v[216:219], v[0:3], 0
    ds_read_b64_tr_b16 v[208:209], v241 offset:8192
    v_exp_f32_e64 v232, v232
    v_mfma_f32_16x16x32_bf16 v[196:199], v[216:219], v[4:7], 0
    ds_read_b64_tr_b16 v[210:211], v241 offset:8704
    s_add_u32 m0, s64, 98304
    s_add_u32 s67, s65, 3538944
    buffer_load_dwordx4 v244, s[12:15], s67 offen lds
    v_mfma_f32_16x16x32_bf16 v[204:207], v[220:223], v[4:7], 0
    ds_read_b64_tr_b16 v[212:213], v241 offset:12288
    v_exp_f32_e64 v233, v233
    v_mfma_f32_16x16x32_bf16 v[200:203], v[220:223], v[0:3], 0
    ds_read_b64_tr_b16 v[214:215], v241 offset:12800
    s_waitcnt lgkmcnt(4)
    v_mfma_f32_16x16x32_bf16 v[176:179], v[224:227], v[8:11], v[176:179]
    ds_read_b64_tr_b16 v[216:217], v240 offset:16384
    v_exp_f32 v234, v234
    v_mfma_f32_16x16x32_bf16 v[180:183], v[224:227], v[12:15], v[180:183]
    ds_read_b64_tr_b16 v[218:219], v240 offset:16896
    v_exp_f32_e64 v235, v235
    v_mfma_f32_16x16x32_bf16 v[188:191], v[228:231], v[12:15], v[188:191]
    ds_read_b64_tr_b16 v[220:221], v240 offset:20480
    v_mfma_f32_16x16x32_bf16 v[184:187], v[228:231], v[8:11], v[184:187]
    ds_read_b64_tr_b16 v[222:223], v240 offset:20992
    v_mul_f32 v152, v152, v249
    s_waitcnt lgkmcnt(4)
    v_mfma_f32_16x16x32_bf16 v[192:195], v[208:211], v[8:11], v[192:195]
    ds_read_b64_tr_b16 v[224:225], v241 offset:16384
    v_mul_f32 v153, v153, v249
    v_mul_f32 v154, v154, v249
    v_mfma_f32_16x16x32_bf16 v[196:199], v[208:211], v[12:15], v[196:199]
    ds_read_b64_tr_b16 v[226:227], v241 offset:16896
    v_mul_f32_e64 v155, v155, v249
    s_add_u32 m0, s64, 106496
    s_add_u32 s67, s65, 3833856
    buffer_load_dwordx4 v244, s[12:15], s67 offen lds
    v_mfma_f32_16x16x32_bf16 v[204:207], v[212:215], v[12:15], v[204:207]
    ds_read_b64_tr_b16 v[228:229], v241 offset:20480
    v_add_f32_e64 v232, 1.0, v232
    v_mfma_f32_16x16x32_bf16 v[200:203], v[212:215], v[8:11], v[200:203]
    ds_read_b64_tr_b16 v[230:231], v241 offset:20992
    v_add_f32 v233, 1.0, v233
    s_waitcnt lgkmcnt(4)
    v_mfma_f32_16x16x32_bf16 v[176:179], v[216:219], v[16:19], v[176:179]
    ds_read_b64_tr_b16 v[208:209], v240 offset:24576
    v_add_f32_e64 v234, 1.0, v234
    v_mfma_f32_16x16x32_bf16 v[180:183], v[216:219], v[20:23], v[180:183]
    ds_read_b64_tr_b16 v[210:211], v240 offset:25088
    v_add_f32_e64 v235, 1.0, v235
    v_mfma_f32_16x16x32_bf16 v[188:191], v[220:223], v[20:23], v[188:191]
    ds_read_b64_tr_b16 v[212:213], v240 offset:28672
    v_rcp_f32_e64 v232, v232
    v_mfma_f32_16x16x32_bf16 v[184:187], v[220:223], v[16:19], v[184:187]
    ds_read_b64_tr_b16 v[214:215], v240 offset:29184
    s_waitcnt lgkmcnt(4)
    v_mfma_f32_16x16x32_bf16 v[192:195], v[224:227], v[16:19], v[192:195]
    ds_read_b64_tr_b16 v[216:217], v241 offset:24576
    v_rcp_f32 v233, v233
    v_mfma_f32_16x16x32_bf16 v[196:199], v[224:227], v[20:23], v[196:199]
    ds_read_b64_tr_b16 v[218:219], v241 offset:25088
    s_add_u32 m0, s64, 114688
    s_add_u32 s67, s65, 4128768
    buffer_load_dwordx4 v244, s[12:15], s67 offen lds
    v_mfma_f32_16x16x32_bf16 v[204:207], v[228:231], v[20:23], v[204:207]
    ds_read_b64_tr_b16 v[220:221], v241 offset:28672
    v_rcp_f32_e64 v234, v234
    v_mfma_f32_16x16x32_bf16 v[200:203], v[228:231], v[16:19], v[200:203]
    ds_read_b64_tr_b16 v[222:223], v241 offset:29184
    s_waitcnt lgkmcnt(4)
    v_mfma_f32_16x16x32_bf16 v[176:179], v[208:211], v[24:27], v[176:179]
    ds_read_b64_tr_b16 v[224:225], v240 offset:32768
    v_rcp_f32 v235, v235
    v_mfma_f32_16x16x32_bf16 v[180:183], v[208:211], v[28:31], v[180:183]
    ds_read_b64_tr_b16 v[226:227], v240 offset:33280
    v_mul_f32_e64 v144, v144, v232
    v_mfma_f32_16x16x32_bf16 v[188:191], v[212:215], v[28:31], v[188:191]
    ds_read_b64_tr_b16 v[228:229], v240 offset:36864
    v_mul_f32_e64 v145, v145, v233
    v_mfma_f32_16x16x32_bf16 v[184:187], v[212:215], v[24:27], v[184:187]
    ds_read_b64_tr_b16 v[230:231], v240 offset:37376
    v_mul_f32 v146, v146, v234
    s_waitcnt lgkmcnt(4)
    v_mfma_f32_16x16x32_bf16 v[192:195], v[216:219], v[24:27], v[192:195]
    ds_read_b64_tr_b16 v[208:209], v241 offset:32768
    v_mul_f32 v147, v147, v235
    v_mul_f32 v152, v152, v144
    v_mfma_f32_16x16x32_bf16 v[196:199], v[216:219], v[28:31], v[196:199]
    ds_read_b64_tr_b16 v[210:211], v241 offset:33280
    v_mul_f32_e64 v153, v153, v145
    s_add_u32 m0, s64, 122880
    s_add_u32 s67, s65, 4423680
    buffer_load_dwordx4 v244, s[12:15], s67 offen lds
    v_mfma_f32_16x16x32_bf16 v[204:207], v[220:223], v[28:31], v[204:207]
    ds_read_b64_tr_b16 v[212:213], v241 offset:36864
    v_mul_f32_e64 v154, v154, v146
    v_mfma_f32_16x16x32_bf16 v[200:203], v[220:223], v[24:27], v[200:203]
    ds_read_b64_tr_b16 v[214:215], v241 offset:37376
    v_mul_f32 v155, v155, v147
    s_waitcnt lgkmcnt(4)
    v_mfma_f32_16x16x32_bf16 v[176:179], v[224:227], v[32:35], v[176:179]
    ds_read_b64_tr_b16 v[216:217], v240 offset:40960
    v_mul_f32_e64 v232, v160, v247
    v_mfma_f32_16x16x32_bf16 v[180:183], v[224:227], v[36:39], v[180:183]
    ds_read_b64_tr_b16 v[218:219], v240 offset:41472
    v_mul_f32_e64 v233, v161, v247
    v_mfma_f32_16x16x32_bf16 v[188:191], v[228:231], v[36:39], v[188:191]
    ds_read_b64_tr_b16 v[220:221], v240 offset:45056
    v_mul_f32_e64 v234, v162, v247
    v_mfma_f32_16x16x32_bf16 v[184:187], v[228:231], v[32:35], v[184:187]
    ds_read_b64_tr_b16 v[222:223], v240 offset:45568
    v_mul_f32 v235, v163, v247
    s_waitcnt lgkmcnt(4)
    v_mfma_f32_16x16x32_bf16 v[192:195], v[208:211], v[32:35], v[192:195]
    ds_read_b64_tr_b16 v[224:225], v241 offset:40960
    v_exp_f32_e64 v232, v232
    v_mfma_f32_16x16x32_bf16 v[196:199], v[208:211], v[36:39], v[196:199]
    ds_read_b64_tr_b16 v[226:227], v241 offset:41472
    s_add_u32 m0, s64, 131072
    s_add_u32 s67, s65, 4718592
    buffer_load_dwordx4 v244, s[12:15], s67 offen lds
    v_mfma_f32_16x16x32_bf16 v[204:207], v[212:215], v[36:39], v[204:207]
    ds_read_b64_tr_b16 v[228:229], v241 offset:45056
    v_exp_f32_e64 v233, v233
    v_mfma_f32_16x16x32_bf16 v[200:203], v[212:215], v[32:35], v[200:203]
    ds_read_b64_tr_b16 v[230:231], v241 offset:45568
    s_waitcnt lgkmcnt(4)
    v_mfma_f32_16x16x32_bf16 v[176:179], v[216:219], v[40:43], v[176:179]
    v_add_u32 v240, 49152, v240
    v_add_u32 v241, 49152, v241
    ds_read_b64_tr_b16 v[208:209], v240 offset:0
    v_exp_f32 v234, v234
    v_bfe_u32 v0, v246, 4, 6
    v_mfma_f32_16x16x32_bf16 v[180:183], v[216:219], v[44:47], v[180:183]
    ds_read_b64_tr_b16 v[210:211], v240 offset:512
    v_exp_f32_e64 v235, v235
    v_lshl_add_u32 v0, s3, 6, v0
    v_mfma_f32_16x16x32_bf16 v[188:191], v[220:223], v[44:47], v[188:191]
    ds_read_b64_tr_b16 v[212:213], v240 offset:4096
    s_movk_i32 s38, 144
    v_mfma_f32_16x16x32_bf16 v[184:187], v[220:223], v[40:43], v[184:187]
    ds_read_b64_tr_b16 v[214:215], v240 offset:4608
    v_mul_f32 v168, v168, v249
    v_cmp_gt_u32 s[84:85], s38, v0
    s_add_u32 s76, s24, 23592960
    s_waitcnt lgkmcnt(4)
    v_mfma_f32_16x16x32_bf16 v[192:195], v[224:227], v[40:43], v[192:195]
    ds_read_b64_tr_b16 v[216:217], v241 offset:0
    v_mul_f32_e64 v169, v169, v249
    s_addc_u32 s77, s25, 0
    s_mov_b32 s78, 73728
    s_mov_b32 s79, 0x20000
    s_sub_u32 s82, s6, 1
    v_mfma_f32_16x16x32_bf16 v[196:199], v[224:227], v[44:47], v[196:199]
    ds_read_b64_tr_b16 v[218:219], v241 offset:512
    v_mul_f32 v170, v170, v249
    v_mul_f32_e64 v171, v171, v249
    s_mul_i32 s82, s82, 4608
    s_mul_i32 s38, s7, 1152
    s_add_u32 s82, s82, s38
    s_add_u32 m0, s64, 139264
    s_add_u32 s67, s65, 5013504
    buffer_load_dwordx4 v244, s[12:15], s67 offen lds
    v_mfma_f32_16x16x32_bf16 v[204:207], v[228:231], v[44:47], v[204:207]
    ds_read_b64_tr_b16 v[220:221], v241 offset:4096
    v_add_f32 v232, 1.0, v232
    v_lshl_add_u32 v1, v0, 3, s82
    v_mfma_f32_16x16x32_bf16 v[200:203], v[228:231], v[40:43], v[200:203]
    ds_read_b64_tr_b16 v[222:223], v241 offset:4608
    v_add_f32_e64 v233, 1.0, v233
    s_cmp_ge_u32 s3, 3
    s_cbranch_scc1 L_nosg
    buffer_load_dwordx2 v[32:33], v1, s[76:79], 0 offen sc1
    v_subrev_u32 v1, 4608, v1
    buffer_load_dwordx2 v[30:31], v1, s[76:79], 0 offen sc1
    v_subrev_u32 v1, 4608, v1
    buffer_load_dwordx2 v[28:29], v1, s[76:79], 0 offen sc1
    v_subrev_u32 v1, 4608, v1
    buffer_load_dwordx2 v[26:27], v1, s[76:79], 0 offen sc1
    v_subrev_u32 v1, 4608, v1
    buffer_load_dwordx2 v[24:25], v1, s[76:79], 0 offen sc1
    v_subrev_u32 v1, 4608, v1
    buffer_load_dwordx2 v[22:23], v1, s[76:79], 0 offen sc1
    v_subrev_u32 v1, 4608, v1
    buffer_load_dwordx2 v[20:21], v1, s[76:79], 0 offen sc1
    v_subrev_u32 v1, 4608, v1
    buffer_load_dwordx2 v[18:19], v1, s[76:79], 0 offen sc1
    v_subrev_u32 v1, 4608, v1
    buffer_load_dwordx2 v[16:17], v1, s[76:79], 0 offen sc1
    v_subrev_u32 v1, 4608, v1
    buffer_load_dwordx2 v[14:15], v1, s[76:79], 0 offen sc1
    v_subrev_u32 v1, 4608, v1
    buffer_load_dwordx2 v[12:13], v1, s[76:79], 0 offen sc1
    v_subrev_u32 v1, 4608, v1
    buffer_load_dwordx2 v[10:11], v1, s[76:79], 0 offen sc1
    v_subrev_u32 v1, 4608, v1
    buffer_load_dwordx2 v[8:9], v1, s[76:79], 0 offen sc1
    v_subrev_u32 v1, 4608, v1
    buffer_load_dwordx2 v[6:7], v1, s[76:79], 0 offen sc1
    v_subrev_u32 v1, 4608, v1
    buffer_load_dwordx2 v[4:5], v1, s[76:79], 0 offen sc1
L_nosg:
    s_waitcnt vmcnt(6)
    s_barrier
    s_waitcnt lgkmcnt(4)
    v_mfma_f32_16x16x32_bf16 v[176:179], v[208:211], v[48:51], v[176:179]
    ds_read_b64_tr_b16 v[224:225], v240 offset:8192
    v_add_f32 v234, 1.0, v234
    v_mfma_f32_16x16x32_bf16 v[180:183], v[208:211], v[52:55], v[180:183]
    ds_read_b64_tr_b16 v[226:227], v240 offset:8704
    v_add_f32_e64 v235, 1.0, v235
    v_mfma_f32_16x16x32_bf16 v[188:191], v[212:215], v[52:55], v[188:191]
    ds_read_b64_tr_b16 v[228:229], v240 offset:12288
    v_rcp_f32_e64 v232, v232
    v_mfma_f32_16x16x32_bf16 v[184:187], v[212:215], v[48:51], v[184:187]
    ds_read_b64_tr_b16 v[230:231], v240 offset:12800
    s_waitcnt lgkmcnt(4)
    v_mfma_f32_16x16x32_bf16 v[192:195], v[216:219], v[48:51], v[192:195]
    ds_read_b64_tr_b16 v[208:209], v241 offset:8192
    v_rcp_f32 v233, v233
    v_mfma_f32_16x16x32_bf16 v[196:199], v[216:219], v[52:55], v[196:199]
    ds_read_b64_tr_b16 v[210:211], v241 offset:8704
    v_mfma_f32_16x16x32_bf16 v[204:207], v[220:223], v[52:55], v[204:207]
    ds_read_b64_tr_b16 v[212:213], v241 offset:12288
    v_rcp_f32_e64 v234, v234
    v_mfma_f32_16x16x32_bf16 v[200:203], v[220:223], v[48:51], v[200:203]
    ds_read_b64_tr_b16 v[214:215], v241 offset:12800
    s_waitcnt lgkmcnt(4)
    v_mfma_f32_16x16x32_bf16 v[176:179], v[224:227], v[56:59], v[176:179]
    ds_read_b64_tr_b16 v[216:217], v240 offset:16384
    v_rcp_f32 v235, v235
    v_mfma_f32_16x16x32_bf16 v[180:183], v[224:227], v[60:63], v[180:183]
    ds_read_b64_tr_b16 v[218:219], v240 offset:16896
    v_mul_f32_e64 v160, v160, v232
    v_mfma_f32_16x16x32_bf16 v[188:191], v[228:231], v[60:63], v[188:191]
    ds_read_b64_tr_b16 v[220:221], v240 offset:20480
    v_mul_f32_e64 v161, v161, v233
    v_mfma_f32_16x16x32_bf16 v[184:187], v[228:231], v[56:59], v[184:187]
    ds_read_b64_tr_b16 v[222:223], v240 offset:20992
    v_mul_f32 v162, v162, v234
    s_waitcnt lgkmcnt(4)
    v_mfma_f32_16x16x32_bf16 v[192:195], v[208:211], v[56:59], v[192:195]
    ds_read_b64_tr_b16 v[224:225], v241 offset:16384
    v_mul_f32_e64 v163, v163, v235
    v_mfma_f32_16x16x32_bf16 v[196:199], v[208:211], v[60:63], v[196:199]
    ds_read_b64_tr_b16 v[226:227], v241 offset:16896
    v_mul_f32 v168, v168, v160
    v_mul_f32 v169, v169, v161
    v_mfma_f32_16x16x32_bf16 v[204:207], v[212:215], v[60:63], v[204:207]
    ds_read_b64_tr_b16 v[228:229], v241 offset:20480
    v_mul_f32_e64 v170, v170, v162
    v_mfma_f32_16x16x32_bf16 v[200:203], v[212:215], v[56:59], v[200:203]
    ds_read_b64_tr_b16 v[230:231], v241 offset:20992
    v_mul_f32 v171, v171, v163
    s_waitcnt lgkmcnt(4)
    v_mfma_f32_16x16x32_bf16 v[176:179], v[216:219], v[64:67], v[176:179]
    ds_read_b64_tr_b16 v[208:209], v240 offset:24576
    v_cvt_pk_bf16_f32 v144, v152, v153
    s_cmp_eq_u32 s5, 0
    s_cselect_b32 s8, s44, s46
    s_cselect_b32 s9, s45, s47
    s_mov_b32 s10, 663552
    v_mfma_f32_16x16x32_bf16 v[180:183], v[216:219], v[68:71], v[180:183]
    ds_read_b64_tr_b16 v[210:211], v240 offset:25088
    v_cvt_pk_bf16_f32 v145, v154, v155
    s_mov_b32 s11, 0x20000
    v_mfma_f32_16x16x32_bf16 v[188:191], v[220:223], v[68:71], v[188:191]
    ds_read_b64_tr_b16 v[212:213], v240 offset:28672
    v_cvt_pk_bf16_f32 v146, v168, v169
    v_bfe_u32 v53, v246, 7, 3
    v_mfma_f32_16x16x32_bf16 v[184:187], v[220:223], v[64:67], v[184:187]
    ds_read_b64_tr_b16 v[214:215], v240 offset:29184
    v_cvt_pk_bf16_f32 v147, v170, v171
    buffer_store_dwordx4 v[144:147], v246, s[24:27], s68 offen offset:0 sc1
    v_lshl_add_u32 v53, s4, 3, v53
    s_waitcnt lgkmcnt(4)
    v_mfma_f32_16x16x32_bf16 v[192:195], v[224:227], v[64:67], v[192:195]
    ds_read_b64_tr_b16 v[216:217], v241 offset:24576
    v_mul_f32_e64 v232, v148, v248
    v_mfma_f32_16x16x32_bf16 v[196:199], v[224:227], v[68:71], v[196:199]
    ds_read_b64_tr_b16 v[218:219], v241 offset:25088
    v_mul_f32_e64 v233, v149, v248
    v_mul_u32_u24 v53, 1152, v53
    v_mfma_f32_16x16x32_bf16 v[204:207], v[228:231], v[68:71], v[204:207]
    ds_read_b64_tr_b16 v[220:221], v241 offset:28672
    v_mul_f32_e64 v234, v150, v248
    v_bfe_u32 v54, v246, 8, 2
    v_mfma_f32_16x16x32_bf16 v[200:203], v[228:231], v[64:67], v[200:203]
    ds_read_b64_tr_b16 v[222:223], v241 offset:29184
    v_mul_f32 v235, v151, v248
    s_waitcnt lgkmcnt(4)
    v_mfma_f32_16x16x32_bf16 v[176:179], v[208:211], v[72:75], v[176:179]
    ds_read_b64_tr_b16 v[224:225], v240 offset:32768
    v_exp_f32_e64 v232, v232
    s_and_b32 s73, s4, 1
    s_lshl_b32 s73, s73, 2
    v_mfma_f32_16x16x32_bf16 v[180:183], v[208:211], v[76:79], v[180:183]
    ds_read_b64_tr_b16 v[226:227], v240 offset:33280
    v_or_b32_e64 v54, s73, v54
    v_mfma_f32_16x16x32_bf16 v[188:191], v[212:215], v[76:79], v[188:191]
    ds_read_b64_tr_b16 v[228:229], v240 offset:36864
    v_exp_f32 v233, v233
    s_cmp_ge_u32 s3, 3
    s_cbranch_scc1 L_hg15
    v_mul_u32_u24 v2, 56, v0
    v_add_u32 v2, 147456, v2
    v_lshlrev_b32_e64 v3, 5, v0
    v_add_u32 v3, 157696, v3
    ds_read_b64 v[36:37], v2 offset:8
    ds_read_b64 v[38:39], v2 offset:16
    s_waitcnt lgkmcnt(0)
L_hg15:
    v_mfma_f32_16x16x32_bf16 v[184:187], v[212:215], v[72:75], v[184:187]
    ds_read_b64_tr_b16 v[230:231], v240 offset:37376
    v_bfe_u32 v55, v246, 4, 3
    s_waitcnt lgkmcnt(4)
    v_mfma_f32_16x16x32_bf16 v[192:195], v[216:219], v[72:75], v[192:195]
    ds_read_b64_tr_b16 v[208:209], v241 offset:32768
    v_exp_f32 v234, v234
    v_xor_b32 v54, v54, v55
    v_mfma_f32_16x16x32_bf16 v[196:199], v[216:219], v[76:79], v[196:199]
    ds_read_b64_tr_b16 v[210:211], v241 offset:33280
    v_exp_f32_e64 v235, v235
    v_mfma_f32_16x16x32_bf16 v[204:207], v[220:223], v[76:79], v[204:207]
    ds_read_b64_tr_b16 v[212:213], v241 offset:36864
    s_cmp_ge_u32 s3, 3
    s_cbranch_scc1 L_hg16
    v_mul_f32 v42, v38, v38
    v_mul_f32 v43, v38, v39
    v_fma_f32 v42, -v39, v39, v42
    v_fmac_f32 v43, v39, v38
    v_mul_f32 v40, v42, v42
    v_mul_f32_e64 v41, v42, v43
    v_fma_f32 v40, -v43, v43, v40
    v_fmac_f32 v41, v43, v42
L_hg16:
    v_lshl_add_u32 v52, v54, 4, v53
    v_mfma_f32_16x16x32_bf16 v[200:203], v[220:223], v[72:75], v[200:203]
    ds_read_b64_tr_b16 v[214:215], v241 offset:37376
    v_mul_f32_e64 v156, v156, v250
    s_lshl_b32 s73, s7, 8
    s_lshl_b32 s72, s3, 10
    s_waitcnt lgkmcnt(4)
    v_mfma_f32_16x16x32_bf16 v[176:179], v[224:227], v[80:83], v[176:179]
    ds_read_b64_tr_b16 v[216:217], v240 offset:40960
    v_mul_f32 v157, v157, v250
    v_mul_f32 v158, v158, v250
    v_mfma_f32_16x16x32_bf16 v[180:183], v[224:227], v[84:87], v[180:183]
    ds_read_b64_tr_b16 v[218:219], v240 offset:41472
    v_mul_f32_e64 v159, v159, v250
    v_mfma_f32_16x16x32_bf16 v[188:191], v[228:231], v[84:87], v[188:191]
    ds_read_b64_tr_b16 v[220:221], v240 offset:45056
    v_add_f32_e64 v232, 1.0, v232
    v_mfma_f32_16x16x32_bf16 v[184:187], v[228:231], v[80:83], v[184:187]
    ds_read_b64_tr_b16 v[222:223], v240 offset:45568
    v_add_f32 v233, 1.0, v233
    s_cmp_ge_u32 s3, 3
    s_cbranch_scc1 L_hg17
    s_waitcnt vmcnt(0)
    v_fmac_f32 v6, v40, v4
    v_fmac_f32 v7, v40, v5
    v_fma_f32 v6, -v41, v5, v6
    v_fmac_f32 v7, v41, v4
    v_fmac_f32 v8, v40, v6
    v_fmac_f32_e64 v9, v40, v7
    v_fma_f32 v8, -v41, v7, v8
L_hg17:
    s_waitcnt lgkmcnt(4)
    v_mfma_f32_16x16x32_bf16 v[192:195], v[208:211], v[80:83], v[192:195]
    ds_read_b64_tr_b16 v[224:225], v241 offset:40960
    v_add_f32 v234, 1.0, v234
    v_mfma_f32_16x16x32_bf16 v[196:199], v[208:211], v[84:87], v[196:199]
    ds_read_b64_tr_b16 v[226:227], v241 offset:41472
    v_add_f32_e64 v235, 1.0, v235
    v_mfma_f32_16x16x32_bf16 v[204:207], v[212:215], v[84:87], v[204:207]
    ds_read_b64_tr_b16 v[228:229], v241 offset:45056
    v_rcp_f32_e64 v232, v232
    v_mfma_f32_16x16x32_bf16 v[200:203], v[212:215], v[80:83], v[200:203]
    ds_read_b64_tr_b16 v[230:231], v241 offset:45568
    s_cmp_ge_u32 s3, 3
    s_cbranch_scc1 L_hg18
    v_fmac_f32 v9, v41, v6
    v_fmac_f32 v10, v40, v8
    v_fmac_f32_e64 v11, v40, v9
    v_fma_f32 v10, -v41, v9, v10
    v_fmac_f32 v11, v41, v8
    v_fmac_f32 v12, v40, v10
    v_fmac_f32_e64 v13, v40, v11
    v_fma_f32 v12, -v41, v11, v12
L_hg18:
    s_waitcnt lgkmcnt(4)
    v_mfma_f32_16x16x32_bf16 v[176:179], v[216:219], v[88:91], v[176:179]
    v_add_u32 v240, 49152, v240
    v_add_u32 v241, 49152, v241
    ds_read_b64_tr_b16 v[208:209], v240 offset:0
    v_rcp_f32 v233, v233
    v_mfma_f32_16x16x32_bf16 v[180:183], v[216:219], v[92:95], v[180:183]
    ds_read_b64_tr_b16 v[210:211], v240 offset:512
    v_mfma_f32_16x16x32_bf16 v[188:191], v[220:223], v[92:95], v[188:191]
    ds_read_b64_tr_b16 v[212:213], v240 offset:4096
    v_rcp_f32_e64 v234, v234
    v_mfma_f32_16x16x32_bf16 v[184:187], v[220:223], v[88:91], v[184:187]
    ds_read_b64_tr_b16 v[214:215], v240 offset:4608
    s_waitcnt lgkmcnt(4)
    v_mfma_f32_16x16x32_bf16 v[192:195], v[224:227], v[88:91], v[192:195]
    ds_read_b64_tr_b16 v[216:217], v241 offset:0
    v_rcp_f32 v235, v235
    s_cmp_ge_u32 s3, 3
    s_cbranch_scc1 L_hg19
    v_fmac_f32 v13, v41, v10
    v_fmac_f32 v14, v40, v12
    v_fmac_f32_e64 v15, v40, v13
    v_fma_f32 v14, -v41, v13, v14
    v_fmac_f32 v15, v41, v12
    v_fmac_f32 v16, v40, v14
    v_fmac_f32_e64 v17, v40, v15
    v_fma_f32 v16, -v41, v15, v16
L_hg19:
    v_mfma_f32_16x16x32_bf16 v[196:199], v[224:227], v[92:95], v[196:199]
    ds_read_b64_tr_b16 v[218:219], v241 offset:512
    v_mul_f32_e64 v148, v148, v232
    v_mfma_f32_16x16x32_bf16 v[204:207], v[228:231], v[92:95], v[204:207]
    ds_read_b64_tr_b16 v[220:221], v241 offset:4096
    v_mul_f32_e64 v149, v149, v233
    v_mfma_f32_16x16x32_bf16 v[200:203], v[228:231], v[88:91], v[200:203]
    ds_read_b64_tr_b16 v[222:223], v241 offset:4608
    v_mul_f32 v150, v150, v234
    s_waitcnt vmcnt(1)
    s_barrier
    s_waitcnt lgkmcnt(4)
    v_mfma_f32_16x16x32_bf16 v[176:179], v[208:211], v[96:99], v[176:179]
    ds_read_b64_tr_b16 v[224:225], v240 offset:8192
    v_mul_f32 v151, v151, v235
    v_mul_f32 v156, v156, v148
    s_cmp_ge_u32 s3, 3
    s_cbranch_scc1 L_hg20
    v_fmac_f32 v17, v41, v14
    v_fmac_f32 v18, v40, v16
    v_fmac_f32_e64 v19, v40, v17
    v_fma_f32 v18, -v41, v17, v18
    v_fmac_f32 v19, v41, v16
    v_fmac_f32 v20, v40, v18
    v_fmac_f32_e64 v21, v40, v19
    v_fma_f32 v20, -v41, v19, v20
L_hg20:
    v_mfma_f32_16x16x32_bf16 v[180:183], v[208:211], v[100:103], v[180:183]
    ds_read_b64_tr_b16 v[226:227], v240 offset:8704
    v_mul_f32_e64 v157, v157, v149
    v_mfma_f32_16x16x32_bf16 v[188:191], v[212:215], v[100:103], v[188:191]
    ds_read_b64_tr_b16 v[228:229], v240 offset:12288
    v_mul_f32_e64 v158, v158, v150
    v_mfma_f32_16x16x32_bf16 v[184:187], v[212:215], v[96:99], v[184:187]
    ds_read_b64_tr_b16 v[230:231], v240 offset:12800
    v_mul_f32 v159, v159, v151
    s_waitcnt lgkmcnt(4)
    v_mfma_f32_16x16x32_bf16 v[192:195], v[216:219], v[96:99], v[192:195]
    ds_read_b64_tr_b16 v[208:209], v241 offset:8192
    v_mul_f32_e64 v232, v164, v248
    v_mfma_f32_16x16x32_bf16 v[196:199], v[216:219], v[100:103], v[196:199]
    ds_read_b64_tr_b16 v[210:211], v241 offset:8704
    v_mul_f32 v233, v165, v248
    s_cmp_ge_u32 s3, 3
    s_cbranch_scc1 L_hg21
    v_fmac_f32 v21, v41, v18
    v_fmac_f32 v22, v40, v20
    v_fmac_f32 v23, v40, v21
    v_fma_f32 v22, -v41, v21, v22
    v_fmac_f32 v23, v41, v20
    v_fmac_f32 v24, v40, v22
    v_fmac_f32_e64 v25, v40, v23
    v_fma_f32 v24, -v41, v23, v24
L_hg21:
    s_add_u32 s38, s95, 0
    buffer_load_dwordx4 v[56:59], v246, s[24:27], s38 offen sc1
    buffer_load_dwordx4 v[60:63], v246, s[24:27], s38 offen offset:1024 sc1
    s_add_u32 s38, s95, 16384
    buffer_load_dwordx4 v[64:67], v246, s[24:27], s38 offen sc1
    buffer_load_dwordx4 v[68:71], v246, s[24:27], s38 offen offset:1024 sc1
    s_add_u32 s38, s95, 32768
    buffer_load_dwordx4 v[72:75], v246, s[24:27], s38 offen sc1
    buffer_load_dwordx4 v[76:79], v246, s[24:27], s38 offen offset:1024 sc1
    s_add_u32 s38, s95, 49152
    buffer_load_dwordx4 v[80:83], v246, s[24:27], s38 offen sc1
    buffer_load_dwordx4 v[84:87], v246, s[24:27], s38 offen offset:1024 sc1
    s_add_u32 s38, s95, 65536
    s_lshl_b32 s43, s5, 30
    s_add_u32 s38, s38, s43
    buffer_load_dwordx4 v[88:91], v246, s[24:27], s38 offen sc1
    buffer_load_dwordx4 v[92:95], v246, s[24:27], s38 offen offset:1024 sc1
    v_mfma_f32_16x16x32_bf16 v[204:207], v[220:223], v[100:103], v[204:207]
    ds_read_b64_tr_b16 v[212:213], v241 offset:12288
    v_mul_f32 v234, v166, v248
    v_mfma_f32_16x16x32_bf16 v[200:203], v[220:223], v[96:99], v[200:203]
    ds_read_b64_tr_b16 v[214:215], v241 offset:12800
    v_mul_f32 v235, v167, v248
    s_waitcnt lgkmcnt(4)
    v_mfma_f32_16x16x32_bf16 v[176:179], v[224:227], v[104:107], v[176:179]
    ds_read_b64_tr_b16 v[216:217], v240 offset:16384
    v_exp_f32_e64 v232, v232
    v_mfma_f32_16x16x32_bf16 v[180:183], v[224:227], v[108:111], v[180:183]
    ds_read_b64_tr_b16 v[218:219], v240 offset:16896
    v_mfma_f32_16x16x32_bf16 v[188:191], v[228:231], v[108:111], v[188:191]
    ds_read_b64_tr_b16 v[220:221], v240 offset:20480
    v_exp_f32 v233, v233
    s_cmp_ge_u32 s3, 3
    s_cbranch_scc1 L_hg22
    v_fmac_f32 v25, v41, v22
    v_fmac_f32 v26, v40, v24
    v_fmac_f32 v27, v40, v25
    v_fma_f32 v26, -v41, v25, v26
    v_fmac_f32 v27, v41, v24
    v_fmac_f32 v28, v40, v26
    v_fmac_f32_e64 v29, v40, v27
    v_fma_f32 v28, -v41, v27, v28
L_hg22:
    v_mfma_f32_16x16x32_bf16 v[184:187], v[228:231], v[104:107], v[184:187]
    ds_read_b64_tr_b16 v[222:223], v240 offset:20992
    s_waitcnt lgkmcnt(4)
    v_mfma_f32_16x16x32_bf16 v[192:195], v[208:211], v[104:107], v[192:195]
    ds_read_b64_tr_b16 v[224:225], v241 offset:16384
    v_exp_f32 v234, v234
    v_mfma_f32_16x16x32_bf16 v[196:199], v[208:211], v[108:111], v[196:199]
    ds_read_b64_tr_b16 v[226:227], v241 offset:16896
    v_exp_f32_e64 v235, v235
    s_add_u32 m0, s72, 0
    s_add_u32 s67, s73, 0
    buffer_load_dwordx4 v52, s[8:11], s67 offen offset:0 lds
    s_add_u32 m0, s72, 8064
    s_add_u32 s67, s73, 0
    buffer_load_dwordx4 v52, s[8:11], s67 offen offset:128 lds
    s_add_u32 m0, s72, 16128
    s_add_u32 s67, s73, 0
    buffer_load_dwordx4 v52, s[8:11], s67 offen offset:256 lds
    v_mfma_f32_16x16x32_bf16 v[204:207], v[212:215], v[108:111], v[204:207]
    ds_read_b64_tr_b16 v[228:229], v241 offset:20480
    s_cmp_ge_u32 s3, 3
    s_cbranch_scc1 L_hg23
    v_fmac_f32 v29, v41, v26
    v_fmac_f32 v30, v40, v28
    v_fmac_f32_e64 v31, v40, v29
    v_fma_f32 v30, -v41, v29, v30
    v_fmac_f32 v31, v41, v28
    v_fmac_f32 v32, v40, v30
    v_fmac_f32_e64 v33, v40, v31
    v_fma_f32 v32, -v41, v31, v32
L_hg23:
    v_mfma_f32_16x16x32_bf16 v[200:203], v[212:215], v[104:107], v[200:203]
    ds_read_b64_tr_b16 v[230:231], v241 offset:20992
    v_mul_f32 v172, v172, v250
    s_waitcnt lgkmcnt(4)
    v_mfma_f32_16x16x32_bf16 v[176:179], v[216:219], v[112:115], v[176:179]
    ds_read_b64_tr_b16 v[208:209], v240 offset:24576
    v_mul_f32_e64 v173, v173, v250
    v_mfma_f32_16x16x32_bf16 v[180:183], v[216:219], v[116:119], v[180:183]
    ds_read_b64_tr_b16 v[210:211], v240 offset:25088
    v_mul_f32 v174, v174, v250
    v_mul_f32 v175, v175, v250
    v_mfma_f32_16x16x32_bf16 v[188:191], v[220:223], v[116:119], v[188:191]
    ds_read_b64_tr_b16 v[212:213], v240 offset:28672
    v_add_f32_e64 v232, 1.0, v232
    v_mfma_f32_16x16x32_bf16 v[184:187], v[220:223], v[112:115], v[184:187]
    ds_read_b64_tr_b16 v[214:215], v240 offset:29184
    v_add_f32 v233, 1.0, v233
    s_cmp_ge_u32 s3, 3
    s_cbranch_scc1 L_hg24
    v_fmac_f32 v33, v41, v30
    v_mul_f32 v44, v36, v32
    v_mul_f32 v45, v36, v33
    v_fma_f32 v44, -v37, v33, v44
    v_fmac_f32 v45, v37, v32
    v_mul_f32 v46, v38, v44
    v_mul_f32_e64 v47, v38, v45
    v_fma_f32 v46, -v39, v45, v46
L_hg24:
    s_waitcnt lgkmcnt(4)
    v_mfma_f32_16x16x32_bf16 v[192:195], v[224:227], v[112:115], v[192:195]
    ds_read_b64_tr_b16 v[216:217], v241 offset:24576
    v_add_f32 v234, 1.0, v234
    v_mfma_f32_16x16x32_bf16 v[196:199], v[224:227], v[116:119], v[196:199]
    ds_read_b64_tr_b16 v[218:219], v241 offset:25088
    v_add_f32_e64 v235, 1.0, v235
    v_mfma_f32_16x16x32_bf16 v[204:207], v[228:231], v[116:119], v[204:207]
    ds_read_b64_tr_b16 v[220:221], v241 offset:28672
    v_rcp_f32_e64 v232, v232
    v_mfma_f32_16x16x32_bf16 v[200:203], v[228:231], v[112:115], v[200:203]
    ds_read_b64_tr_b16 v[222:223], v241 offset:29184
    s_cmp_ge_u32 s3, 3
    s_cbranch_scc1 L_hg25
    v_fmac_f32 v47, v39, v44
    v_mul_f32 v48, v38, v46
    v_mul_f32_e64 v49, v38, v47
    v_fma_f32 v48, -v39, v47, v48
    v_fmac_f32 v49, v39, v46
    v_mul_f32 v50, v38, v48
    v_mul_f32_e64 v51, v38, v49
    v_fma_f32 v50, -v39, v49, v50
L_hg25:
    s_waitcnt lgkmcnt(4)
    v_mfma_f32_16x16x32_bf16 v[176:179], v[208:211], v[120:123], v[176:179]
    ds_read_b64_tr_b16 v[224:225], v240 offset:32768
    v_rcp_f32 v233, v233
    v_mfma_f32_16x16x32_bf16 v[180:183], v[208:211], v[124:127], v[180:183]
    ds_read_b64_tr_b16 v[226:227], v240 offset:33280
    v_mfma_f32_16x16x32_bf16 v[188:191], v[212:215], v[124:127], v[188:191]
    ds_read_b64_tr_b16 v[228:229], v240 offset:36864
    v_rcp_f32_e64 v234, v234
    v_mfma_f32_16x16x32_bf16 v[184:187], v[212:215], v[120:123], v[184:187]
    ds_read_b64_tr_b16 v[230:231], v240 offset:37376
    s_waitcnt lgkmcnt(4)
    v_mfma_f32_16x16x32_bf16 v[192:195], v[216:219], v[120:123], v[192:195]
    ds_read_b64_tr_b16 v[208:209], v241 offset:32768
    v_rcp_f32 v235, v235
    s_cmp_ge_u32 s3, 3
    s_cbranch_scc1 L_hg26
    v_fmac_f32 v51, v39, v48
L_hg26:
    v_mfma_f32_16x16x32_bf16 v[196:199], v[216:219], v[124:127], v[196:199]
    ds_read_b64_tr_b16 v[210:211], v241 offset:33280
    v_mul_f32 v164, v164, v232
    s_add_u32 m0, s72, 24576
    s_add_u32 s67, s73, 36864
    buffer_load_dwordx4 v52, s[8:11], s67 offen offset:0 lds
    s_add_u32 m0, s72, 32640
    s_add_u32 s67, s73, 36864
    buffer_load_dwordx4 v52, s[8:11], s67 offen offset:128 lds
    s_add_u32 m0, s72, 40704
    s_add_u32 s67, s73, 36864
    buffer_load_dwordx4 v52, s[8:11], s67 offen offset:256 lds
    v_mfma_f32_16x16x32_bf16 v[204:207], v[220:223], v[124:127], v[204:207]
    ds_read_b64_tr_b16 v[212:213], v241 offset:36864
    v_mul_f32_e64 v165, v165, v233
    v_mfma_f32_16x16x32_bf16 v[200:203], v[220:223], v[120:123], v[200:203]
    ds_read_b64_tr_b16 v[214:215], v241 offset:37376
    v_mul_f32_e64 v166, v166, v234
    s_and_saveexec_b64 s[82:83], s[84:85]
    s_cbranch_execz L_nohin
    ds_write_b128 v3, v[44:47]
    ds_write_b128 v3, v[48:51] offset:16
    s_waitcnt lgkmcnt(0)
L_nohin:
    s_mov_b64 exec, -1
    s_waitcnt lgkmcnt(4)
    v_mfma_f32_16x16x32_bf16 v[176:179], v[224:227], v[128:131], v[176:179]
    ds_read_b64_tr_b16 v[216:217], v240 offset:40960
    v_mul_f32 v167, v167, v235
    v_mfma_f32_16x16x32_bf16 v[180:183], v[224:227], v[132:135], v[180:183]
    ds_read_b64_tr_b16 v[218:219], v240 offset:41472
    v_mul_f32 v172, v172, v164
    v_mul_f32 v173, v173, v165
    v_mfma_f32_16x16x32_bf16 v[188:191], v[228:231], v[132:135], v[188:191]
    ds_read_b64_tr_b16 v[220:221], v240 offset:45056
    v_mul_f32_e64 v174, v174, v166
    v_mfma_f32_16x16x32_bf16 v[184:187], v[228:231], v[128:131], v[184:187]
    ds_read_b64_tr_b16 v[222:223], v240 offset:45568
    v_mul_f32 v175, v175, v167
    s_waitcnt lgkmcnt(4)
    v_mfma_f32_16x16x32_bf16 v[192:195], v[208:211], v[128:131], v[192:195]
    ds_read_b64_tr_b16 v[224:225], v241 offset:40960
    v_cvt_pk_bf16_f32 v148, v156, v157
    v_mfma_f32_16x16x32_bf16 v[196:199], v[208:211], v[132:135], v[196:199]
    ds_read_b64_tr_b16 v[226:227], v241 offset:41472
    v_cvt_pk_bf16_f32 v149, v158, v159
    v_mfma_f32_16x16x32_bf16 v[204:207], v[212:215], v[132:135], v[204:207]
    ds_read_b64_tr_b16 v[228:229], v241 offset:45056
    v_cvt_pk_bf16_f32 v150, v172, v173
    v_mfma_f32_16x16x32_bf16 v[200:203], v[212:215], v[128:131], v[200:203]
    ds_read_b64_tr_b16 v[230:231], v241 offset:45568
    v_cvt_pk_bf16_f32 v151, v174, v175
    buffer_store_dwordx4 v[148:151], v246, s[24:27], s68 offen offset:1024 sc1
    s_waitcnt lgkmcnt(4)
    v_mfma_f32_16x16x32_bf16 v[176:179], v[216:219], v[136:139], v[176:179]
    v_mfma_f32_16x16x32_bf16 v[180:183], v[216:219], v[140:143], v[180:183]
    v_mfma_f32_16x16x32_bf16 v[188:191], v[220:223], v[140:143], v[188:191]
    v_mfma_f32_16x16x32_bf16 v[184:187], v[220:223], v[136:139], v[184:187]
    s_waitcnt lgkmcnt(0)
    v_mfma_f32_16x16x32_bf16 v[192:195], v[224:227], v[136:139], v[192:195]
    v_mfma_f32_16x16x32_bf16 v[196:199], v[224:227], v[140:143], v[196:199]
    s_add_u32 m0, s72, 49152
    s_add_u32 s67, s73, 73728
    buffer_load_dwordx4 v52, s[8:11], s67 offen offset:0 lds
    s_add_u32 m0, s72, 57216
    s_add_u32 s67, s73, 73728
    buffer_load_dwordx4 v52, s[8:11], s67 offen offset:128 lds
    s_add_u32 m0, s72, 65280
    s_add_u32 s67, s73, 73728
    buffer_load_dwordx4 v52, s[8:11], s67 offen offset:256 lds
    v_mfma_f32_16x16x32_bf16 v[204:207], v[228:231], v[140:143], v[204:207]
    v_mfma_f32_16x16x32_bf16 v[200:203], v[228:231], v[136:139], v[200:203]
    v_subrev_u32 v240, 98304, v240
    v_subrev_u32 v241, 98304, v241
    s_mul_i32 s68, s6, 1179648
    s_lshl_b32 s87, s65, 7
    s_add_u32 s68, s68, s87
    s_barrier
    v_bfe_u32 v125, v246, 4, 6
    v_and_b32 v104, 15, v125
    v_lshrrev_b32 v105, 4, v125
    s_lshl_b32 s38, s5, 4
    v_add_u32 v106, s38, v104
    v_mul_u32_u24 v96, 56, v106
    v_add_u32 v96, 147456, v96
    v_lshl_add_u32 v97, v105, 3, v96
    s_lshl_b32 s38, s4, 3
    s_add_u32 s38, s38, 157696
    v_lshl_add_u32 v98, v106, 5, s38
    s_lshl_b32 s38, s3, 11
    s_add_u32 s38, s38, 73728
    v_lshl_add_u32 v100, v104, 6, s38
    v_lshl_add_u32 v100, v105, 4, v100
    s_lshl_b32 s38, s4, 11
    s_add_u32 s38, s38, 73728
    v_lshl_add_u32 v101, v105, 9, s38
    v_lshrrev_b32 v106, 2, v104
    v_lshl_add_u32 v101, v106, 6, v101
    v_and_b32_e64 v106, 3, v104
    v_lshl_add_u32 v101, v106, 4, v101
    v_lshlrev_b32 v102, 4, v125
    s_lshl_b32 s38, s5, 4
    v_add_u32 v106, s38, v104
    v_lshlrev_b32 v106, 7, v106
    v_lshrrev_b32 v107, 1, v105
    v_lshlrev_b32 v107, 12, v107
    v_add_u32 v106, v106, v107
    v_and_b32 v107, 1, v105
    v_lshrrev_b32 v108, 1, v104
    v_xor_b32 v107, v107, v108
    v_lshl_add_u32 v106, v107, 4, v106
    s_add_u32 s38, s7, 0
    s_and_b32 s42, s38, 3
    s_lshl_b32 s42, s42, 5
    s_lshr_b32 s38, s38, 2
    s_lshl_b32 s38, s38, 13
    v_xor_b32 v112, s42, v106
    v_add_u32 v112, s38, v112
    s_add_u32 s38, s7, 1
    s_and_b32 s42, s38, 3
    s_lshl_b32 s42, s42, 5
    s_lshr_b32 s38, s38, 2
    s_lshl_b32 s38, s38, 13
    v_xor_b32 v113, s42, v106
    v_add_u32 v113, s38, v113
    s_add_u32 s38, s7, 2
    s_and_b32 s42, s38, 3
    s_lshl_b32 s42, s42, 5
    s_lshr_b32 s38, s38, 2
    s_lshl_b32 s38, s38, 13
    v_xor_b32 v114, s42, v106
    v_add_u32 v114, s38, v114
    s_add_u32 s38, s7, 3
    s_and_b32 s42, s38, 3
    s_lshl_b32 s42, s42, 5
    s_lshr_b32 s38, s38, 2
    s_lshl_b32 s38, s38, 13
    v_xor_b32 v115, s42, v106
    v_add_u32 v115, s38, v115
    ds_read_b64 v[0:1], v96 offset:0
    ds_read_b64 v[2:3], v96 offset:8
    ds_read_b64 v[4:5], v97 offset:24
    ds_read_b64 v[6:7], v98 offset:0
    v_add_u32 v103, 32768, v101
    v_add_u32 v99, 32768, v100
    s_waitcnt lgkmcnt(0)
    ds_read_b64 v[8:9], v96 offset:1792
    ds_read_b64 v[10:11], v96 offset:1800
    ds_read_b64 v[12:13], v97 offset:1816
    ds_read_b64 v[14:15], v98 offset:1024
    v_mul_f32 v16, v4, v6
    v_mul_f32_e64 v17, v4, v7
    v_fma_f32 v16, -v5, v7, v16
    v_fmac_f32 v17, v5, v6
    v_mul_f32 v18, v2, v16
    v_mul_f32_e64 v19, v2, v17
    v_fma_f32 v18, -v3, v17, v18
    v_fmac_f32 v19, v3, v16
    v_mul_f32 v20, v2, v18
    v_mul_f32_e64 v21, v2, v19
    v_fma_f32 v20, -v3, v19, v20
    v_fmac_f32 v21, v3, v18
    v_mul_f32 v22, v2, v20
    v_mul_f32_e64 v23, v2, v21
    v_fma_f32 v22, -v3, v21, v22
    v_fmac_f32 v23, v3, v20
    v_mul_f32 v24, v2, v22
    v_mul_f32_e64 v25, v2, v23
    v_fma_f32 v24, -v3, v23, v24
    v_fmac_f32 v25, v3, v22
    v_mul_f32 v26, v2, v24
    v_mul_f32_e64 v27, v2, v25
    v_fma_f32 v26, -v3, v25, v26
    v_fmac_f32 v27, v3, v24
    v_mul_f32 v28, v2, v26
    v_mul_f32_e64 v29, v2, v27
    v_fma_f32 v28, -v3, v27, v28
    v_fmac_f32 v29, v3, v26
    v_mul_f32 v30, v2, v28
    v_mul_f32_e64 v31, v2, v29
    v_fma_f32 v30, -v3, v29, v30
    v_fmac_f32 v31, v3, v28
    s_waitcnt vmcnt(17)
    v_dot2_f32_bf16 v16, v56, s90, v16
    v_dot2_f32_bf16 v17, v60, s90, v17
    v_dot2_f32_bf16 v18, v56, s91, v18
    v_dot2_f32_bf16 v19, v60, s91, v19
    v_dot2_f32_bf16 v20, v57, s90, v20
    v_dot2_f32_bf16 v21, v61, s90, v21
    v_dot2_f32_bf16 v22, v57, s91, v22
    v_dot2_f32_bf16 v23, v61, s91, v23
    v_dot2_f32_bf16 v24, v58, s90, v24
    v_dot2_f32_bf16 v25, v62, s90, v25
    v_dot2_f32_bf16 v26, v58, s91, v26
    v_dot2_f32_bf16 v27, v62, s91, v27
    v_dot2_f32_bf16 v28, v59, s90, v28
    v_dot2_f32_bf16 v29, v63, s90, v29
    v_dot2_f32_bf16 v30, v59, s91, v30
    v_dot2_f32_bf16 v31, v63, s91, v31
    v_mul_f32 v104, v1, v17
    v_mul_f32 v17, v0, v17
    v_fmac_f32_e64 v17, v1, v16
    v_fma_f32 v16, v0, v16, -v104
    v_mul_f32 v105, v1, v19
    v_mul_f32 v19, v0, v19
    v_fmac_f32_e64 v19, v1, v18
    v_fma_f32 v18, v0, v18, -v105
    v_mul_f32 v104, v1, v21
    v_mul_f32 v21, v0, v21
    v_fmac_f32_e64 v21, v1, v20
    v_fma_f32 v20, v0, v20, -v104
    v_mul_f32 v105, v1, v23
    v_mul_f32 v23, v0, v23
    v_fmac_f32_e64 v23, v1, v22
    v_fma_f32 v22, v0, v22, -v105
    v_mul_f32 v104, v1, v25
    v_mul_f32 v25, v0, v25
    v_fmac_f32_e64 v25, v1, v24
    v_fma_f32 v24, v0, v24, -v104
    v_mul_f32 v105, v1, v27
    v_mul_f32 v27, v0, v27
    v_fmac_f32_e64 v27, v1, v26
    v_fma_f32 v26, v0, v26, -v105
    v_mul_f32 v104, v1, v29
    v_mul_f32 v29, v0, v29
    v_fmac_f32_e64 v29, v1, v28
    v_fma_f32 v28, v0, v28, -v104
    v_mul_f32 v105, v1, v31
    v_mul_f32 v31, v0, v31
    v_fmac_f32_e64 v31, v1, v30
    v_fma_f32 v30, v0, v30, -v105
    v_cvt_pk_bf16_f32 v56, v16, v18
    v_cvt_pk_bf16_f32 v57, v20, v22
    v_cvt_pk_bf16_f32 v58, v24, v26
    v_cvt_pk_bf16_f32 v59, v28, v30
    ds_write_b128 v100, v[56:59] offset:0
    v_cvt_pk_bf16_f32 v60, v17, v19
    v_cvt_pk_bf16_f32 v61, v21, v23
    v_cvt_pk_bf16_f32 v62, v25, v27
    v_cvt_pk_bf16_f32 v63, v29, v31
    ds_write_b128 v100, v[60:63] offset:1024
    s_waitcnt lgkmcnt(2)
    ds_read_b64 v[0:1], v96 offset:3584
    ds_read_b64 v[2:3], v96 offset:3592
    ds_read_b64 v[4:5], v97 offset:3608
    ds_read_b64 v[6:7], v98 offset:2048
    v_mul_f32 v16, v12, v14
    v_mul_f32_e64 v17, v12, v15
    v_fma_f32 v16, -v13, v15, v16
    v_fmac_f32 v17, v13, v14
    v_mul_f32 v18, v10, v16
    v_mul_f32_e64 v19, v10, v17
    v_fma_f32 v18, -v11, v17, v18
    v_fmac_f32 v19, v11, v16
    v_mul_f32 v20, v10, v18
    v_mul_f32_e64 v21, v10, v19
    v_fma_f32 v20, -v11, v19, v20
    v_fmac_f32 v21, v11, v18
    v_mul_f32 v22, v10, v20
    v_mul_f32_e64 v23, v10, v21
    v_fma_f32 v22, -v11, v21, v22
    v_fmac_f32 v23, v11, v20
    v_mul_f32 v24, v10, v22
    v_mul_f32_e64 v25, v10, v23
    v_fma_f32 v24, -v11, v23, v24
    v_fmac_f32 v25, v11, v22
    v_mul_f32 v26, v10, v24
    v_mul_f32_e64 v27, v10, v25
    v_fma_f32 v26, -v11, v25, v26
    v_fmac_f32 v27, v11, v24
    v_mul_f32 v28, v10, v26
    v_mul_f32_e64 v29, v10, v27
    v_fma_f32 v28, -v11, v27, v28
    v_fmac_f32 v29, v11, v26
    v_mul_f32 v30, v10, v28
    v_mul_f32_e64 v31, v10, v29
    v_fma_f32 v30, -v11, v29, v30
    v_fmac_f32 v31, v11, v28
    s_waitcnt vmcnt(15)
    v_dot2_f32_bf16 v16, v64, s90, v16
    v_dot2_f32_bf16 v17, v68, s90, v17
    v_dot2_f32_bf16 v18, v64, s91, v18
    v_dot2_f32_bf16 v19, v68, s91, v19
    v_dot2_f32_bf16 v20, v65, s90, v20
    v_dot2_f32_bf16 v21, v69, s90, v21
    v_dot2_f32_bf16 v22, v65, s91, v22
    v_dot2_f32_bf16 v23, v69, s91, v23
    v_dot2_f32_bf16 v24, v66, s90, v24
    v_dot2_f32_bf16 v25, v70, s90, v25
    v_dot2_f32_bf16 v26, v66, s91, v26
    v_dot2_f32_bf16 v27, v70, s91, v27
    v_dot2_f32_bf16 v28, v67, s90, v28
    v_dot2_f32_bf16 v29, v71, s90, v29
    v_dot2_f32_bf16 v30, v67, s91, v30
    v_dot2_f32_bf16 v31, v71, s91, v31
    v_mul_f32 v104, v9, v17
    v_mul_f32 v17, v8, v17
    v_fmac_f32_e64 v17, v9, v16
    v_fma_f32 v16, v8, v16, -v104
    v_mul_f32 v105, v9, v19
    v_mul_f32 v19, v8, v19
    v_fmac_f32_e64 v19, v9, v18
    v_fma_f32 v18, v8, v18, -v105
    v_mul_f32 v104, v9, v21
    v_mul_f32 v21, v8, v21
    v_fmac_f32_e64 v21, v9, v20
    v_fma_f32 v20, v8, v20, -v104
    v_mul_f32 v105, v9, v23
    v_mul_f32 v23, v8, v23
    v_fmac_f32_e64 v23, v9, v22
    v_fma_f32 v22, v8, v22, -v105
    v_mul_f32 v104, v9, v25
    v_mul_f32 v25, v8, v25
    v_fmac_f32_e64 v25, v9, v24
    v_fma_f32 v24, v8, v24, -v104
    v_mul_f32 v105, v9, v27
    v_mul_f32 v27, v8, v27
    v_fmac_f32_e64 v27, v9, v26
    v_fma_f32 v26, v8, v26, -v105
    v_mul_f32 v104, v9, v29
    v_mul_f32 v29, v8, v29
    v_fmac_f32_e64 v29, v9, v28
    v_fma_f32 v28, v8, v28, -v104
    v_mul_f32 v105, v9, v31
    v_mul_f32 v31, v8, v31
    v_fmac_f32_e64 v31, v9, v30
    v_fma_f32 v30, v8, v30, -v105
    v_cvt_pk_bf16_f32 v64, v16, v18
    v_cvt_pk_bf16_f32 v65, v20, v22
    v_cvt_pk_bf16_f32 v66, v24, v26
    v_cvt_pk_bf16_f32 v67, v28, v30
    ds_write_b128 v100, v[64:67] offset:16384
    v_cvt_pk_bf16_f32 v68, v17, v19
    v_cvt_pk_bf16_f32 v69, v21, v23
    v_cvt_pk_bf16_f32 v70, v25, v27
    v_cvt_pk_bf16_f32 v71, v29, v31
    ds_write_b128 v100, v[68:71] offset:17408
    s_waitcnt lgkmcnt(2)
    ds_read_b64 v[8:9], v96 offset:5376
    ds_read_b64 v[10:11], v96 offset:5384
    ds_read_b64 v[12:13], v97 offset:5400
    ds_read_b64 v[14:15], v98 offset:3072
    v_mul_f32 v16, v4, v6
    v_mul_f32_e64 v17, v4, v7
    v_fma_f32 v16, -v5, v7, v16
    v_fmac_f32 v17, v5, v6
    v_mul_f32 v18, v2, v16
    v_mul_f32_e64 v19, v2, v17
    v_fma_f32 v18, -v3, v17, v18
    v_fmac_f32 v19, v3, v16
    v_mul_f32 v20, v2, v18
    v_mul_f32_e64 v21, v2, v19
    v_fma_f32 v20, -v3, v19, v20
    v_fmac_f32 v21, v3, v18
    v_mul_f32 v22, v2, v20
    v_mul_f32_e64 v23, v2, v21
    v_fma_f32 v22, -v3, v21, v22
    v_fmac_f32 v23, v3, v20
    v_mul_f32 v24, v2, v22
    v_mul_f32_e64 v25, v2, v23
    v_fma_f32 v24, -v3, v23, v24
    v_fmac_f32 v25, v3, v22
    v_mul_f32 v26, v2, v24
    v_mul_f32_e64 v27, v2, v25
    v_fma_f32 v26, -v3, v25, v26
    v_fmac_f32 v27, v3, v24
    v_mul_f32 v28, v2, v26
    v_mul_f32_e64 v29, v2, v27
    v_fma_f32 v28, -v3, v27, v28
    v_fmac_f32 v29, v3, v26
    v_mul_f32 v30, v2, v28
    v_mul_f32_e64 v31, v2, v29
    v_fma_f32 v30, -v3, v29, v30
    v_fmac_f32 v31, v3, v28
    s_waitcnt vmcnt(13)
    v_dot2_f32_bf16 v16, v72, s90, v16
    v_dot2_f32_bf16 v17, v76, s90, v17
    v_dot2_f32_bf16 v18, v72, s91, v18
    v_dot2_f32_bf16 v19, v76, s91, v19
    v_dot2_f32_bf16 v20, v73, s90, v20
    v_dot2_f32_bf16 v21, v77, s90, v21
    v_dot2_f32_bf16 v22, v73, s91, v22
    v_dot2_f32_bf16 v23, v77, s91, v23
    v_dot2_f32_bf16 v24, v74, s90, v24
    v_dot2_f32_bf16 v25, v78, s90, v25
    v_dot2_f32_bf16 v26, v74, s91, v26
    v_dot2_f32_bf16 v27, v78, s91, v27
    v_dot2_f32_bf16 v28, v75, s90, v28
    v_dot2_f32_bf16 v29, v79, s90, v29
    v_dot2_f32_bf16 v30, v75, s91, v30
    v_dot2_f32_bf16 v31, v79, s91, v31
    v_mul_f32 v104, v1, v17
    v_mul_f32 v17, v0, v17
    v_fmac_f32_e64 v17, v1, v16
    v_fma_f32 v16, v0, v16, -v104
    v_mul_f32 v105, v1, v19
    v_mul_f32 v19, v0, v19
    v_fmac_f32_e64 v19, v1, v18
    v_fma_f32 v18, v0, v18, -v105
    v_mul_f32 v104, v1, v21
    v_mul_f32 v21, v0, v21
    v_fmac_f32_e64 v21, v1, v20
    v_fma_f32 v20, v0, v20, -v104
    v_mul_f32 v105, v1, v23
    v_mul_f32 v23, v0, v23
    v_fmac_f32_e64 v23, v1, v22
    v_fma_f32 v22, v0, v22, -v105
    v_mul_f32 v104, v1, v25
    v_mul_f32 v25, v0, v25
    v_fmac_f32_e64 v25, v1, v24
    v_fma_f32 v24, v0, v24, -v104
    v_mul_f32 v105, v1, v27
    v_mul_f32 v27, v0, v27
    v_fmac_f32_e64 v27, v1, v26
    v_fma_f32 v26, v0, v26, -v105
    v_mul_f32 v104, v1, v29
    v_mul_f32 v29, v0, v29
    v_fmac_f32_e64 v29, v1, v28
    v_fma_f32 v28, v0, v28, -v104
    v_mul_f32 v105, v1, v31
    v_mul_f32 v31, v0, v31
    v_fmac_f32_e64 v31, v1, v30
    v_fma_f32 v30, v0, v30, -v105
    v_cvt_pk_bf16_f32 v72, v16, v18
    v_cvt_pk_bf16_f32 v73, v20, v22
    v_cvt_pk_bf16_f32 v74, v24, v26
    v_cvt_pk_bf16_f32 v75, v28, v30
    ds_write_b128 v100, v[72:75] offset:32768
    v_cvt_pk_bf16_f32 v76, v17, v19
    v_cvt_pk_bf16_f32 v77, v21, v23
    v_cvt_pk_bf16_f32 v78, v25, v27
    v_cvt_pk_bf16_f32 v79, v29, v31
    ds_write_b128 v100, v[76:79] offset:33792
    s_waitcnt lgkmcnt(2)
    ds_read_b64 v[0:1], v96 offset:7168
    ds_read_b64 v[2:3], v96 offset:7176
    ds_read_b64 v[4:5], v97 offset:7192
    ds_read_b64 v[6:7], v98 offset:4096
    v_mul_f32 v16, v12, v14
    v_mul_f32_e64 v17, v12, v15
    v_fma_f32 v16, -v13, v15, v16
    v_fmac_f32 v17, v13, v14
    v_mul_f32 v18, v10, v16
    v_mul_f32_e64 v19, v10, v17
    v_fma_f32 v18, -v11, v17, v18
    v_fmac_f32 v19, v11, v16
    v_mul_f32 v20, v10, v18
    v_mul_f32_e64 v21, v10, v19
    v_fma_f32 v20, -v11, v19, v20
    v_fmac_f32 v21, v11, v18
    v_mul_f32 v22, v10, v20
    v_mul_f32_e64 v23, v10, v21
    v_fma_f32 v22, -v11, v21, v22
    v_fmac_f32 v23, v11, v20
    v_mul_f32 v24, v10, v22
    v_mul_f32_e64 v25, v10, v23
    v_fma_f32 v24, -v11, v23, v24
    v_fmac_f32 v25, v11, v22
    v_mul_f32 v26, v10, v24
    v_mul_f32_e64 v27, v10, v25
    v_fma_f32 v26, -v11, v25, v26
    v_fmac_f32 v27, v11, v24
    v_mul_f32 v28, v10, v26
    v_mul_f32_e64 v29, v10, v27
    v_fma_f32 v28, -v11, v27, v28
    v_fmac_f32 v29, v11, v26
    v_mul_f32 v30, v10, v28
    v_mul_f32_e64 v31, v10, v29
    v_fma_f32 v30, -v11, v29, v30
    v_fmac_f32 v31, v11, v28
    s_waitcnt vmcnt(11)
    v_dot2_f32_bf16 v16, v80, s90, v16
    v_dot2_f32_bf16 v17, v84, s90, v17
    v_dot2_f32_bf16 v18, v80, s91, v18
    v_dot2_f32_bf16 v19, v84, s91, v19
    v_dot2_f32_bf16 v20, v81, s90, v20
    v_dot2_f32_bf16 v21, v85, s90, v21
    v_dot2_f32_bf16 v22, v81, s91, v22
    v_dot2_f32_bf16 v23, v85, s91, v23
    v_dot2_f32_bf16 v24, v82, s90, v24
    v_dot2_f32_bf16 v25, v86, s90, v25
    v_dot2_f32_bf16 v26, v82, s91, v26
    v_dot2_f32_bf16 v27, v86, s91, v27
    v_dot2_f32_bf16 v28, v83, s90, v28
    v_dot2_f32_bf16 v29, v87, s90, v29
    v_dot2_f32_bf16 v30, v83, s91, v30
    v_dot2_f32_bf16 v31, v87, s91, v31
    v_mul_f32 v104, v9, v17
    v_mul_f32 v17, v8, v17
    v_fmac_f32_e64 v17, v9, v16
    v_fma_f32 v16, v8, v16, -v104
    v_mul_f32 v105, v9, v19
    v_mul_f32 v19, v8, v19
    v_fmac_f32_e64 v19, v9, v18
    v_fma_f32 v18, v8, v18, -v105
    v_mul_f32 v104, v9, v21
    v_mul_f32 v21, v8, v21
    v_fmac_f32_e64 v21, v9, v20
    v_fma_f32 v20, v8, v20, -v104
    v_mul_f32 v105, v9, v23
    v_mul_f32 v23, v8, v23
    v_fmac_f32_e64 v23, v9, v22
    v_fma_f32 v22, v8, v22, -v105
    v_mul_f32 v104, v9, v25
    v_mul_f32 v25, v8, v25
    v_fmac_f32_e64 v25, v9, v24
    v_fma_f32 v24, v8, v24, -v104
    v_mul_f32 v105, v9, v27
    v_mul_f32 v27, v8, v27
    v_fmac_f32_e64 v27, v9, v26
    v_fma_f32 v26, v8, v26, -v105
    v_mul_f32 v104, v9, v29
    v_mul_f32 v29, v8, v29
    v_fmac_f32_e64 v29, v9, v28
    v_fma_f32 v28, v8, v28, -v104
    v_mul_f32 v105, v9, v31
    v_mul_f32 v31, v8, v31
    v_fmac_f32_e64 v31, v9, v30
    v_fma_f32 v30, v8, v30, -v105
    v_cvt_pk_bf16_f32 v80, v16, v18
    v_cvt_pk_bf16_f32 v81, v20, v22
    v_cvt_pk_bf16_f32 v82, v24, v26
    v_cvt_pk_bf16_f32 v83, v28, v30
    ds_write_b128 v100, v[80:83] offset:49152
    v_cvt_pk_bf16_f32 v84, v17, v19
    v_cvt_pk_bf16_f32 v85, v21, v23
    v_cvt_pk_bf16_f32 v86, v25, v27
    v_cvt_pk_bf16_f32 v87, v29, v31
    ds_write_b128 v100, v[84:87] offset:50176
    s_waitcnt lgkmcnt(0)
    s_barrier
    ds_read_b64_tr_b16 v[128:129], v101 offset:0
    ds_read_b64_tr_b16 v[130:131], v101 offset:256
    ds_read_b64_tr_b16 v[132:133], v101 offset:8
    ds_read_b64_tr_b16 v[134:135], v101 offset:264
    ds_read_b64_tr_b16 v[136:137], v101 offset:8192
    ds_read_b64_tr_b16 v[138:139], v101 offset:8448
    ds_read_b64_tr_b16 v[140:141], v101 offset:8200
    ds_read_b64_tr_b16 v[142:143], v101 offset:8456
    ds_read_b64_tr_b16 v[144:145], v101 offset:16384
    ds_read_b64_tr_b16 v[146:147], v101 offset:16640
    ds_read_b64_tr_b16 v[148:149], v101 offset:16392
    ds_read_b64_tr_b16 v[150:151], v101 offset:16648
    ds_read_b64_tr_b16 v[152:153], v101 offset:24576
    ds_read_b64_tr_b16 v[154:155], v101 offset:24832
    ds_read_b64_tr_b16 v[156:157], v101 offset:24584
    ds_read_b64_tr_b16 v[158:159], v101 offset:24840
    ds_read_b64_tr_b16 v[160:161], v101 offset:32768
    ds_read_b64_tr_b16 v[162:163], v101 offset:33024
    ds_read_b64_tr_b16 v[164:165], v101 offset:32776
    ds_read_b64_tr_b16 v[166:167], v101 offset:33032
    ds_read_b64_tr_b16 v[168:169], v101 offset:40960
    ds_read_b64_tr_b16 v[170:171], v101 offset:41216
    ds_read_b64_tr_b16 v[172:173], v101 offset:40968
    ds_read_b64_tr_b16 v[174:175], v101 offset:41224
    ds_read_b64_tr_b16 v[208:209], v101 offset:49152
    ds_read_b64_tr_b16 v[210:211], v101 offset:49408
    ds_read_b64_tr_b16 v[212:213], v101 offset:49160
    ds_read_b64_tr_b16 v[214:215], v101 offset:49416
    ds_read_b64_tr_b16 v[216:217], v101 offset:57344
    ds_read_b64_tr_b16 v[218:219], v101 offset:57600
    ds_read_b64_tr_b16 v[220:221], v101 offset:57352
    ds_read_b64_tr_b16 v[222:223], v101 offset:57608
    s_cmp_lg_u32 s5, 0
    s_cbranch_scc1 L_fx4
    s_waitcnt lgkmcnt(15)
    v_mul_f32 v16, v4, v6
    v_mul_f32_e64 v17, v4, v7
    v_fma_f32 v16, -v5, v7, v16
    v_fmac_f32 v17, v5, v6
    v_mul_f32 v18, v2, v16
    v_mul_f32_e64 v19, v2, v17
    v_fma_f32 v18, -v3, v17, v18
    v_fmac_f32 v19, v3, v16
    v_mul_f32 v20, v2, v18
    v_mul_f32_e64 v21, v2, v19
    v_fma_f32 v20, -v3, v19, v20
    v_fmac_f32 v21, v3, v18
    v_mul_f32 v22, v2, v20
    v_mul_f32_e64 v23, v2, v21
    v_fma_f32 v22, -v3, v21, v22
    v_fmac_f32 v23, v3, v20
    v_mul_f32 v24, v2, v22
    v_mul_f32_e64 v25, v2, v23
    v_fma_f32 v24, -v3, v23, v24
    v_fmac_f32 v25, v3, v22
    v_mul_f32 v26, v2, v24
    v_mul_f32_e64 v27, v2, v25
    v_fma_f32 v26, -v3, v25, v26
    v_fmac_f32 v27, v3, v24
    v_mul_f32 v28, v2, v26
    v_mul_f32_e64 v29, v2, v27
    v_fma_f32 v28, -v3, v27, v28
    v_fmac_f32 v29, v3, v26
    v_mul_f32 v30, v2, v28
    v_mul_f32_e64 v31, v2, v29
    v_fma_f32 v30, -v3, v29, v30
    v_fmac_f32 v31, v3, v28
    s_waitcnt vmcnt(9)
    v_dot2_f32_bf16 v16, v88, s90, v16
    v_dot2_f32_bf16 v17, v92, s90, v17
    v_dot2_f32_bf16 v18, v88, s91, v18
    v_dot2_f32_bf16 v19, v92, s91, v19
    v_dot2_f32_bf16 v20, v89, s90, v20
    v_dot2_f32_bf16 v21, v93, s90, v21
    v_dot2_f32_bf16 v22, v89, s91, v22
    v_dot2_f32_bf16 v23, v93, s91, v23
    v_dot2_f32_bf16 v24, v90, s90, v24
    v_dot2_f32_bf16 v25, v94, s90, v25
    v_dot2_f32_bf16 v26, v90, s91, v26
    v_dot2_f32_bf16 v27, v94, s91, v27
    v_dot2_f32_bf16 v28, v91, s90, v28
    v_dot2_f32_bf16 v29, v95, s90, v29
    v_dot2_f32_bf16 v30, v91, s91, v30
    v_dot2_f32_bf16 v31, v95, s91, v31
    v_mul_f32 v104, v1, v17
    v_mul_f32 v17, v0, v17
    v_fmac_f32_e64 v17, v1, v16
    v_fma_f32 v16, v0, v16, -v104
    v_mul_f32 v105, v1, v19
    v_mul_f32 v19, v0, v19
    v_fmac_f32_e64 v19, v1, v18
    v_fma_f32 v18, v0, v18, -v105
    v_mul_f32 v104, v1, v21
    v_mul_f32 v21, v0, v21
    v_fmac_f32_e64 v21, v1, v20
    v_fma_f32 v20, v0, v20, -v104
    v_mul_f32 v105, v1, v23
    v_mul_f32 v23, v0, v23
    v_fmac_f32_e64 v23, v1, v22
    v_fma_f32 v22, v0, v22, -v105
    v_mul_f32 v104, v1, v25
    v_mul_f32 v25, v0, v25
    v_fmac_f32_e64 v25, v1, v24
    v_fma_f32 v24, v0, v24, -v104
    v_mul_f32 v105, v1, v27
    v_mul_f32 v27, v0, v27
    v_fmac_f32_e64 v27, v1, v26
    v_fma_f32 v26, v0, v26, -v105
    v_mul_f32 v104, v1, v29
    v_mul_f32 v29, v0, v29
    v_fmac_f32_e64 v29, v1, v28
    v_fma_f32 v28, v0, v28, -v104
    v_mul_f32 v105, v1, v31
    v_mul_f32 v31, v0, v31
    v_fmac_f32_e64 v31, v1, v30
    v_fma_f32 v30, v0, v30, -v105
    v_cvt_pk_bf16_f32 v88, v16, v18
    v_cvt_pk_bf16_f32 v89, v20, v22
    v_cvt_pk_bf16_f32 v90, v24, v26
    v_cvt_pk_bf16_f32 v91, v28, v30
    ds_write_b128 v99, v[88:91] offset:32768
    v_cvt_pk_bf16_f32 v92, v17, v19
    v_cvt_pk_bf16_f32 v93, v21, v23
    v_cvt_pk_bf16_f32 v94, v25, v27
    v_cvt_pk_bf16_f32 v95, v29, v31
    ds_write_b128 v99, v[92:95] offset:33792
L_fx4:
    s_waitcnt lgkmcnt(0)
    s_waitcnt vmcnt(3)
    s_barrier
    ds_read_b64_tr_b16 v[224:225], v103 offset:32768
    ds_read_b64_tr_b16 v[226:227], v103 offset:33024
    ds_read_b64_tr_b16 v[228:229], v103 offset:32776
    ds_read_b64_tr_b16 v[230:231], v103 offset:33032
    s_lshl_b32 s40, s7, 4
    s_add_u32 s40, s40, s6
    s_lshl_b32 s40, s40, 2
    s_add_u32 s40, s40, s4
    s_mul_i32 s40, s40, 36
    s_add_u32 s40, s40, s5
    s_lshl_b32 s40, s40, 10
    s_add_u32 s40, s40, 33816576
    v_add_u32 v84, 49152, v112
    v_add_u32 v85, 49152, v113
    v_add_u32 v86, 49152, v114
    v_add_u32 v87, 49152, v115
    v_add_u32 v88, 98304, v112
    v_add_u32 v89, 98304, v113
    v_add_u32 v90, 98304, v114
    v_add_u32 v91, 98304, v115
    s_waitcnt lgkmcnt(0)
    s_barrier
    ds_read_b128 v[56:59], v112 offset:0
    ds_read_b128 v[60:63], v112 offset:24576
    ds_read_b128 v[64:67], v113 offset:0
    ds_read_b128 v[68:71], v113 offset:24576
    ds_read_b128 v[72:75], v114 offset:0
    s_waitcnt lgkmcnt(4)
    v_mfma_f32_16x16x32_bf16 v[0:3], v[56:59], v[128:131], 0
    v_mul_f32 v232, v176, v247
    v_mul_f32_e64 v233, v177, v247
    s_add_u32 m0, s72, 73728
    s_add_u32 s67, s73, 110592
    buffer_load_dwordx4 v52, s[8:11], s67 offen offset:0 lds
    v_mfma_f32_16x16x32_bf16 v[4:7], v[56:59], v[132:135], 0
    ds_read_b128 v[76:79], v114 offset:24576
    v_mul_f32 v234, v178, v247
    v_mul_f32_e64 v235, v179, v247
    s_waitcnt lgkmcnt(4)
    v_mfma_f32_16x16x32_bf16 v[8:11], v[60:63], v[128:131], 0
    v_exp_f32_e64 v232, v232
    s_add_u32 m0, s72, 81792
    s_add_u32 s67, s73, 110592
    buffer_load_dwordx4 v52, s[8:11], s67 offen offset:128 lds
    v_mfma_f32_16x16x32_bf16 v[12:15], v[60:63], v[132:135], 0
    ds_read_b128 v[56:59], v115 offset:0
    v_exp_f32 v233, v233
    s_waitcnt lgkmcnt(4)
    v_mfma_f32_16x16x32_bf16 v[0:3], v[64:67], v[136:139], v[0:3]
    v_exp_f32_e64 v234, v234
    s_add_u32 m0, s72, 89856
    s_add_u32 s67, s73, 110592
    buffer_load_dwordx4 v52, s[8:11], s67 offen offset:256 lds
    v_mfma_f32_16x16x32_bf16 v[4:7], v[64:67], v[140:143], v[4:7]
    ds_read_b128 v[60:63], v115 offset:24576
    v_exp_f32 v235, v235
    v_mul_f32_e64 v184, v184, v249
    s_waitcnt lgkmcnt(4)
    v_mfma_f32_16x16x32_bf16 v[8:11], v[68:71], v[136:139], v[8:11]
    v_mul_f32 v185, v185, v249
    v_mul_f32 v186, v186, v249
    s_add_u32 m0, s72, 98304
    s_add_u32 s67, s73, 221184
    buffer_load_dwordx4 v52, s[8:11], s67 offen offset:0 lds
    v_mfma_f32_16x16x32_bf16 v[12:15], v[68:71], v[140:143], v[12:15]
    ds_read_b128 v[64:67], v112 offset:8192
    v_mul_f32 v187, v187, v249
    v_add_f32_e64 v232, 1.0, v232
    s_waitcnt lgkmcnt(4)
    v_mfma_f32_16x16x32_bf16 v[0:3], v[72:75], v[144:147], v[0:3]
    v_add_f32 v233, 1.0, v233
    v_add_f32 v234, 1.0, v234
    s_add_u32 m0, s72, 106368
    s_add_u32 s67, s73, 221184
    buffer_load_dwordx4 v52, s[8:11], s67 offen offset:128 lds
    v_mfma_f32_16x16x32_bf16 v[4:7], v[72:75], v[148:151], v[4:7]
    ds_read_b128 v[68:71], v112 offset:32768
    v_add_f32 v235, 1.0, v235
    v_rcp_f32_e64 v232, v232
    s_waitcnt lgkmcnt(4)
    v_mfma_f32_16x16x32_bf16 v[8:11], v[76:79], v[144:147], v[8:11]
    v_rcp_f32_e64 v233, v233
    s_add_u32 m0, s72, 114432
    s_add_u32 s67, s73, 221184
    buffer_load_dwordx4 v52, s[8:11], s67 offen offset:256 lds
    v_mfma_f32_16x16x32_bf16 v[12:15], v[76:79], v[148:151], v[12:15]
    ds_read_b128 v[72:75], v113 offset:8192
    v_rcp_f32 v234, v234
    s_waitcnt lgkmcnt(4)
    v_mfma_f32_16x16x32_bf16 v[0:3], v[56:59], v[152:155], v[0:3]
    v_rcp_f32_e64 v235, v235
    s_add_u32 m0, s72, 122880
    s_add_u32 s67, s73, 258048
    buffer_load_dwordx4 v52, s[8:11], s67 offen offset:0 lds
    v_mfma_f32_16x16x32_bf16 v[4:7], v[56:59], v[156:159], v[4:7]
    ds_read_b128 v[76:79], v113 offset:32768
    v_mul_f32 v176, v176, v232
    v_mul_f32_e64 v177, v177, v233
    s_waitcnt lgkmcnt(4)
    v_mfma_f32_16x16x32_bf16 v[8:11], v[60:63], v[152:155], v[8:11]
    v_mul_f32 v178, v178, v234
    v_mul_f32 v179, v179, v235
    s_add_u32 m0, s72, 130944
    s_add_u32 s67, s73, 258048
    buffer_load_dwordx4 v52, s[8:11], s67 offen offset:128 lds
    v_mfma_f32_16x16x32_bf16 v[12:15], v[60:63], v[156:159], v[12:15]
    ds_read_b128 v[56:59], v114 offset:8192
    v_mul_f32 v184, v184, v176
    v_mul_f32_e64 v185, v185, v177
    s_waitcnt lgkmcnt(4)
    v_mfma_f32_16x16x32_bf16 v[0:3], v[64:67], v[160:163], v[0:3]
    v_mul_f32 v186, v186, v178
    v_mul_f32 v187, v187, v179
    s_add_u32 m0, s72, 139008
    s_add_u32 s67, s73, 258048
    buffer_load_dwordx4 v52, s[8:11], s67 offen offset:256 lds
    v_mfma_f32_16x16x32_bf16 v[4:7], v[64:67], v[164:167], v[4:7]
    ds_read_b128 v[60:63], v114 offset:32768
    v_mul_f32 v232, v192, v247
    v_mul_f32_e64 v233, v193, v247
    s_waitcnt lgkmcnt(4)
    v_mfma_f32_16x16x32_bf16 v[8:11], v[68:71], v[160:163], v[8:11]
    v_mul_f32 v234, v194, v247
    v_mul_f32 v235, v195, v247
    v_mfma_f32_16x16x32_bf16 v[12:15], v[68:71], v[164:167], v[12:15]
    ds_read_b128 v[64:67], v115 offset:8192
    v_exp_f32 v232, v232
    s_waitcnt lgkmcnt(4)
    v_mfma_f32_16x16x32_bf16 v[0:3], v[72:75], v[168:171], v[0:3]
    v_exp_f32_e64 v233, v233
    v_mfma_f32_16x16x32_bf16 v[4:7], v[72:75], v[172:175], v[4:7]
    ds_read_b128 v[68:71], v115 offset:32768
    v_exp_f32 v234, v234
    s_waitcnt lgkmcnt(4)
    v_mfma_f32_16x16x32_bf16 v[8:11], v[76:79], v[168:171], v[8:11]
    v_exp_f32 v235, v235
    v_mul_f32 v200, v200, v249
    v_mfma_f32_16x16x32_bf16 v[12:15], v[76:79], v[172:175], v[12:15]
    ds_read_b128 v[72:75], v112 offset:16384
    v_mul_f32 v201, v201, v249
    v_mul_f32_e64 v202, v202, v249
    s_waitcnt lgkmcnt(4)
    v_mfma_f32_16x16x32_bf16 v[0:3], v[56:59], v[208:211], v[0:3]
    v_mul_f32 v203, v203, v249
    v_add_f32 v232, 1.0, v232
    v_mfma_f32_16x16x32_bf16 v[4:7], v[56:59], v[212:215], v[4:7]
    ds_read_b128 v[76:79], v112 offset:40960
    v_add_f32 v233, 1.0, v233
    v_add_f32_e64 v234, 1.0, v234
    s_waitcnt lgkmcnt(4)
    v_mfma_f32_16x16x32_bf16 v[8:11], v[60:63], v[208:211], v[8:11]
    v_add_f32 v235, 1.0, v235
    v_rcp_f32 v232, v232
    v_mfma_f32_16x16x32_bf16 v[12:15], v[60:63], v[212:215], v[12:15]
    v_rcp_f32 v233, v233
    s_waitcnt lgkmcnt(3)
    v_mfma_f32_16x16x32_bf16 v[0:3], v[64:67], v[216:219], v[0:3]
    v_rcp_f32_e64 v234, v234
    v_mfma_f32_16x16x32_bf16 v[4:7], v[64:67], v[220:223], v[4:7]
    v_rcp_f32 v235, v235
    s_waitcnt lgkmcnt(2)
    v_mfma_f32_16x16x32_bf16 v[8:11], v[68:71], v[216:219], v[8:11]
    v_mul_f32 v192, v192, v232
    v_mul_f32 v193, v193, v233
    v_mfma_f32_16x16x32_bf16 v[12:15], v[68:71], v[220:223], v[12:15]
    v_mul_f32 v194, v194, v234
    v_mul_f32_e64 v195, v195, v235
    s_waitcnt lgkmcnt(1)
    v_mfma_f32_16x16x32_bf16 v[0:3], v[72:75], v[224:227], v[0:3]
    v_mul_f32 v200, v200, v192
    v_mul_f32 v201, v201, v193
    v_mfma_f32_16x16x32_bf16 v[4:7], v[72:75], v[228:231], v[4:7]
    v_mul_f32 v202, v202, v194
    v_mul_f32_e64 v203, v203, v195
    s_waitcnt lgkmcnt(0)
    v_mfma_f32_16x16x32_bf16 v[8:11], v[76:79], v[224:227], v[8:11]
    v_cvt_pk_bf16_f32 v176, v184, v185
    v_cvt_pk_bf16_f32 v177, v186, v187
    v_mfma_f32_16x16x32_bf16 v[12:15], v[76:79], v[228:231], v[12:15]
    v_cvt_pk_bf16_f32 v178, v200, v201
    v_cvt_pk_bf16_f32 v179, v202, v203
    buffer_store_dwordx4 v[176:179], v246, s[24:27], s68 offen offset:0 sc1
    s_waitcnt vmcnt(6)
    s_barrier
    ds_read_b128 v[56:59], v84 offset:0
    ds_read_b128 v[60:63], v84 offset:24576
    ds_read_b128 v[64:67], v85 offset:0
    ds_read_b128 v[68:71], v85 offset:24576
    ds_read_b128 v[72:75], v86 offset:0
    s_waitcnt lgkmcnt(4)
    v_mfma_f32_16x16x32_bf16 v[16:19], v[56:59], v[128:131], 0
    v_mul_f32 v232, v180, v248
    v_mul_f32 v233, v181, v248
    s_add_u32 m0, s72, 0
    s_add_u32 s67, s73, 294912
    buffer_load_dwordx4 v52, s[8:11], s67 offen offset:0 lds
    v_mfma_f32_16x16x32_bf16 v[20:23], v[56:59], v[132:135], 0
    ds_read_b128 v[76:79], v86 offset:24576
    v_mul_f32 v234, v182, v248
    v_mul_f32_e64 v235, v183, v248
    s_waitcnt lgkmcnt(4)
    v_mfma_f32_16x16x32_bf16 v[24:27], v[60:63], v[128:131], 0
    v_exp_f32_e64 v232, v232
    s_add_u32 m0, s72, 8064
    s_add_u32 s67, s73, 294912
    buffer_load_dwordx4 v52, s[8:11], s67 offen offset:128 lds
    v_mfma_f32_16x16x32_bf16 v[28:31], v[60:63], v[132:135], 0
    ds_read_b128 v[56:59], v87 offset:0
    v_exp_f32 v233, v233
    s_waitcnt lgkmcnt(4)
    v_mfma_f32_16x16x32_bf16 v[16:19], v[64:67], v[136:139], v[16:19]
    v_exp_f32_e64 v234, v234
    s_add_u32 m0, s72, 16128
    s_add_u32 s67, s73, 294912
    buffer_load_dwordx4 v52, s[8:11], s67 offen offset:256 lds
    v_mfma_f32_16x16x32_bf16 v[20:23], v[64:67], v[140:143], v[20:23]
    ds_read_b128 v[60:63], v87 offset:24576
    v_exp_f32 v235, v235
    v_mul_f32_e64 v188, v188, v250
    s_waitcnt lgkmcnt(4)
    v_mfma_f32_16x16x32_bf16 v[24:27], v[68:71], v[136:139], v[24:27]
    v_mul_f32 v189, v189, v250
    v_mul_f32 v190, v190, v250
    s_add_u32 m0, s72, 24576
    s_add_u32 s67, s73, 331776
    buffer_load_dwordx4 v52, s[8:11], s67 offen offset:0 lds
    v_mfma_f32_16x16x32_bf16 v[28:31], v[68:71], v[140:143], v[28:31]
    ds_read_b128 v[64:67], v84 offset:8192
    v_mul_f32 v191, v191, v250
    v_add_f32_e64 v232, 1.0, v232
    s_waitcnt lgkmcnt(4)
    v_mfma_f32_16x16x32_bf16 v[16:19], v[72:75], v[144:147], v[16:19]
    v_add_f32 v233, 1.0, v233
    v_add_f32 v234, 1.0, v234
    s_add_u32 m0, s72, 32640
    s_add_u32 s67, s73, 331776
    buffer_load_dwordx4 v52, s[8:11], s67 offen offset:128 lds
    v_mfma_f32_16x16x32_bf16 v[20:23], v[72:75], v[148:151], v[20:23]
    ds_read_b128 v[68:71], v84 offset:32768
    v_add_f32 v235, 1.0, v235
    v_rcp_f32_e64 v232, v232
    s_waitcnt lgkmcnt(4)
    v_mfma_f32_16x16x32_bf16 v[24:27], v[76:79], v[144:147], v[24:27]
    v_rcp_f32_e64 v233, v233
    s_add_u32 m0, s72, 40704
    s_add_u32 s67, s73, 331776
    buffer_load_dwordx4 v52, s[8:11], s67 offen offset:256 lds
    v_mfma_f32_16x16x32_bf16 v[28:31], v[76:79], v[148:151], v[28:31]
    ds_read_b128 v[72:75], v85 offset:8192
    v_rcp_f32 v234, v234
    s_waitcnt lgkmcnt(4)
    v_mfma_f32_16x16x32_bf16 v[16:19], v[56:59], v[152:155], v[16:19]
    v_rcp_f32_e64 v235, v235
    v_mfma_f32_16x16x32_bf16 v[20:23], v[56:59], v[156:159], v[20:23]
    ds_read_b128 v[76:79], v85 offset:32768
    v_mul_f32 v180, v180, v232
    v_mul_f32_e64 v181, v181, v233
    s_waitcnt lgkmcnt(4)
    v_mfma_f32_16x16x32_bf16 v[24:27], v[60:63], v[152:155], v[24:27]
    v_mul_f32 v182, v182, v234
    v_mul_f32 v183, v183, v235
    v_mfma_f32_16x16x32_bf16 v[28:31], v[60:63], v[156:159], v[28:31]
    ds_read_b128 v[56:59], v86 offset:8192
    v_mul_f32 v188, v188, v180
    v_mul_f32_e64 v189, v189, v181
    s_waitcnt lgkmcnt(4)
    v_mfma_f32_16x16x32_bf16 v[16:19], v[64:67], v[160:163], v[16:19]
    v_mul_f32 v190, v190, v182
    v_mul_f32 v191, v191, v183
    v_mfma_f32_16x16x32_bf16 v[20:23], v[64:67], v[164:167], v[20:23]
    ds_read_b128 v[60:63], v86 offset:32768
    v_mul_f32 v232, v196, v248
    v_mul_f32_e64 v233, v197, v248
    s_waitcnt lgkmcnt(4)
    v_mfma_f32_16x16x32_bf16 v[24:27], v[68:71], v[160:163], v[24:27]
    v_mul_f32 v234, v198, v248
    v_mul_f32_e64 v235, v199, v248
    s_add_u32 s41, s40, 0
    v_mfma_f32_16x16x32_bf16 v[28:31], v[68:71], v[164:167], v[28:31]
    ds_read_b128 v[64:67], v87 offset:8192
    v_exp_f32_e64 v232, v232
    v_cvt_pk_bf16_f32 v0, v0, v1
    s_waitcnt lgkmcnt(4)
    v_mfma_f32_16x16x32_bf16 v[16:19], v[72:75], v[168:171], v[16:19]
    v_exp_f32 v233, v233
    v_mfma_f32_16x16x32_bf16 v[20:23], v[72:75], v[172:175], v[20:23]
    ds_read_b128 v[68:71], v87 offset:32768
    v_exp_f32_e64 v234, v234
    v_cvt_pk_bf16_f32 v1, v2, v3
    s_waitcnt lgkmcnt(4)
    v_mfma_f32_16x16x32_bf16 v[24:27], v[76:79], v[168:171], v[24:27]
    v_exp_f32 v235, v235
    v_mul_f32_e64 v204, v204, v250
    v_mfma_f32_16x16x32_bf16 v[28:31], v[76:79], v[172:175], v[28:31]
    ds_read_b128 v[72:75], v84 offset:16384
    v_mul_f32 v205, v205, v250
    v_mul_f32 v206, v206, v250
    v_cvt_pk_bf16_f32 v2, v4, v5
    s_waitcnt lgkmcnt(4)
    v_mfma_f32_16x16x32_bf16 v[16:19], v[56:59], v[208:211], v[16:19]
    v_mul_f32 v207, v207, v250
    v_add_f32_e64 v232, 1.0, v232
    v_cvt_pk_bf16_f32 v3, v6, v7
    v_mfma_f32_16x16x32_bf16 v[20:23], v[56:59], v[212:215], v[20:23]
    ds_read_b128 v[76:79], v84 offset:40960
    v_add_f32 v233, 1.0, v233
    v_add_f32_e64 v234, 1.0, v234
    s_waitcnt lgkmcnt(4)
    v_mfma_f32_16x16x32_bf16 v[24:27], v[60:63], v[208:211], v[24:27]
    v_add_f32 v235, 1.0, v235
    v_rcp_f32 v232, v232
    buffer_store_dwordx4 v[0:3], v102, s[24:27], s41 offen offset:0 sc1
    v_mfma_f32_16x16x32_bf16 v[28:31], v[60:63], v[212:215], v[28:31]
    v_rcp_f32_e64 v233, v233
    v_cvt_pk_bf16_f32 v8, v8, v9
    s_waitcnt lgkmcnt(3)
    v_mfma_f32_16x16x32_bf16 v[16:19], v[64:67], v[216:219], v[16:19]
    v_rcp_f32 v234, v234
    v_cvt_pk_bf16_f32 v9, v10, v11
    v_mfma_f32_16x16x32_bf16 v[20:23], v[64:67], v[220:223], v[20:23]
    v_rcp_f32 v235, v235
    s_waitcnt lgkmcnt(2)
    v_mfma_f32_16x16x32_bf16 v[24:27], v[68:71], v[216:219], v[24:27]
    v_mul_f32 v196, v196, v232
    v_mul_f32 v197, v197, v233
    v_cvt_pk_bf16_f32 v10, v12, v13
    v_mfma_f32_16x16x32_bf16 v[28:31], v[68:71], v[220:223], v[28:31]
    v_mul_f32 v198, v198, v234
    v_mul_f32_e64 v199, v199, v235
    s_waitcnt lgkmcnt(1)
    v_mfma_f32_16x16x32_bf16 v[16:19], v[72:75], v[224:227], v[16:19]
    v_mul_f32 v204, v204, v196
    v_mul_f32 v205, v205, v197
    v_cvt_pk_bf16_f32 v11, v14, v15
    v_mfma_f32_16x16x32_bf16 v[20:23], v[72:75], v[228:231], v[20:23]
    v_mul_f32 v206, v206, v198
    v_mul_f32 v207, v207, v199
    buffer_store_dwordx4 v[8:11], v102, s[24:27], s41 offen offset:2048 sc1
    s_waitcnt lgkmcnt(0)
    v_mfma_f32_16x16x32_bf16 v[24:27], v[76:79], v[224:227], v[24:27]
    v_cvt_pk_bf16_f32 v180, v188, v189
    v_cvt_pk_bf16_f32 v181, v190, v191
    v_mfma_f32_16x16x32_bf16 v[28:31], v[76:79], v[228:231], v[28:31]
    v_cvt_pk_bf16_f32 v182, v204, v205
    v_cvt_pk_bf16_f32 v183, v206, v207
    buffer_store_dwordx4 v[180:183], v246, s[24:27], s68 offen offset:1024 sc1
    s_waitcnt vmcnt(9)
    s_barrier
    ds_read_b128 v[56:59], v88 offset:0
    ds_read_b128 v[60:63], v88 offset:24576
    ds_read_b128 v[64:67], v89 offset:0
    ds_read_b128 v[68:71], v89 offset:24576
    ds_read_b128 v[72:75], v90 offset:0
    s_waitcnt lgkmcnt(4)
    v_mfma_f32_16x16x32_bf16 v[0:3], v[56:59], v[128:131], 0
    s_add_u32 m0, s72, 49152
    s_add_u32 s67, s73, 442368
    buffer_load_dwordx4 v52, s[8:11], s67 offen offset:0 lds
    v_mfma_f32_16x16x32_bf16 v[4:7], v[56:59], v[132:135], 0
    ds_read_b128 v[76:79], v90 offset:24576
    s_waitcnt lgkmcnt(4)
    v_mfma_f32_16x16x32_bf16 v[8:11], v[60:63], v[128:131], 0
    s_add_u32 m0, s72, 57216
    s_add_u32 s67, s73, 442368
    buffer_load_dwordx4 v52, s[8:11], s67 offen offset:128 lds
    v_mfma_f32_16x16x32_bf16 v[12:15], v[60:63], v[132:135], 0
    ds_read_b128 v[56:59], v91 offset:0
    s_waitcnt lgkmcnt(4)
    v_mfma_f32_16x16x32_bf16 v[0:3], v[64:67], v[136:139], v[0:3]
    s_add_u32 m0, s72, 65280
    s_add_u32 s67, s73, 442368
    buffer_load_dwordx4 v52, s[8:11], s67 offen offset:256 lds
    v_mfma_f32_16x16x32_bf16 v[4:7], v[64:67], v[140:143], v[4:7]
    ds_read_b128 v[60:63], v91 offset:24576
    s_waitcnt lgkmcnt(4)
    v_mfma_f32_16x16x32_bf16 v[8:11], v[68:71], v[136:139], v[8:11]
    s_add_u32 m0, s72, 73728
    s_add_u32 s67, s73, 479232
    buffer_load_dwordx4 v52, s[8:11], s67 offen offset:0 lds
    v_mfma_f32_16x16x32_bf16 v[12:15], v[68:71], v[140:143], v[12:15]
    ds_read_b128 v[64:67], v88 offset:8192
    s_waitcnt lgkmcnt(4)
    v_mfma_f32_16x16x32_bf16 v[0:3], v[72:75], v[144:147], v[0:3]
    s_add_u32 m0, s72, 81792
    s_add_u32 s67, s73, 479232
    buffer_load_dwordx4 v52, s[8:11], s67 offen offset:128 lds
    v_mfma_f32_16x16x32_bf16 v[4:7], v[72:75], v[148:151], v[4:7]
    ds_read_b128 v[68:71], v88 offset:32768
    s_waitcnt lgkmcnt(4)
    v_mfma_f32_16x16x32_bf16 v[8:11], v[76:79], v[144:147], v[8:11]
    s_add_u32 m0, s72, 89856
    s_add_u32 s67, s73, 479232
    buffer_load_dwordx4 v52, s[8:11], s67 offen offset:256 lds
    v_mfma_f32_16x16x32_bf16 v[12:15], v[76:79], v[148:151], v[12:15]
    ds_read_b128 v[72:75], v89 offset:8192
    s_waitcnt lgkmcnt(4)
    v_mfma_f32_16x16x32_bf16 v[0:3], v[56:59], v[152:155], v[0:3]
    v_mfma_f32_16x16x32_bf16 v[4:7], v[56:59], v[156:159], v[4:7]
    ds_read_b128 v[76:79], v89 offset:32768
    s_waitcnt lgkmcnt(4)
    v_mfma_f32_16x16x32_bf16 v[8:11], v[60:63], v[152:155], v[8:11]
    v_mfma_f32_16x16x32_bf16 v[12:15], v[60:63], v[156:159], v[12:15]
    ds_read_b128 v[56:59], v90 offset:8192
    s_waitcnt lgkmcnt(4)
    v_mfma_f32_16x16x32_bf16 v[0:3], v[64:67], v[160:163], v[0:3]
    v_mfma_f32_16x16x32_bf16 v[4:7], v[64:67], v[164:167], v[4:7]
    ds_read_b128 v[60:63], v90 offset:32768
    s_waitcnt lgkmcnt(4)
    v_mfma_f32_16x16x32_bf16 v[8:11], v[68:71], v[160:163], v[8:11]
    s_add_u32 s41, s40, 4096
    v_mfma_f32_16x16x32_bf16 v[12:15], v[68:71], v[164:167], v[12:15]
    ds_read_b128 v[64:67], v91 offset:8192
    v_cvt_pk_bf16_f32 v16, v16, v17
    s_waitcnt lgkmcnt(4)
    v_mfma_f32_16x16x32_bf16 v[0:3], v[72:75], v[168:171], v[0:3]
    v_mfma_f32_16x16x32_bf16 v[4:7], v[72:75], v[172:175], v[4:7]
    ds_read_b128 v[68:71], v91 offset:32768
    v_cvt_pk_bf16_f32 v17, v18, v19
    s_waitcnt lgkmcnt(4)
    v_mfma_f32_16x16x32_bf16 v[8:11], v[76:79], v[168:171], v[8:11]
    v_mfma_f32_16x16x32_bf16 v[12:15], v[76:79], v[172:175], v[12:15]
    ds_read_b128 v[72:75], v88 offset:16384
    v_cvt_pk_bf16_f32 v18, v20, v21
    s_waitcnt lgkmcnt(4)
    v_mfma_f32_16x16x32_bf16 v[0:3], v[56:59], v[208:211], v[0:3]
    v_cvt_pk_bf16_f32 v19, v22, v23
    v_mfma_f32_16x16x32_bf16 v[4:7], v[56:59], v[212:215], v[4:7]
    ds_read_b128 v[76:79], v88 offset:40960
    s_waitcnt lgkmcnt(4)
    v_mfma_f32_16x16x32_bf16 v[8:11], v[60:63], v[208:211], v[8:11]
    buffer_store_dwordx4 v[16:19], v102, s[24:27], s41 offen offset:0 sc1
    v_mfma_f32_16x16x32_bf16 v[12:15], v[60:63], v[212:215], v[12:15]
    v_cvt_pk_bf16_f32 v24, v24, v25
    s_waitcnt lgkmcnt(3)
    v_mfma_f32_16x16x32_bf16 v[0:3], v[64:67], v[216:219], v[0:3]
    v_cvt_pk_bf16_f32 v25, v26, v27
    v_mfma_f32_16x16x32_bf16 v[4:7], v[64:67], v[220:223], v[4:7]
    s_waitcnt lgkmcnt(2)
    v_mfma_f32_16x16x32_bf16 v[8:11], v[68:71], v[216:219], v[8:11]
    v_cvt_pk_bf16_f32 v26, v28, v29
    v_mfma_f32_16x16x32_bf16 v[12:15], v[68:71], v[220:223], v[12:15]
    s_waitcnt lgkmcnt(1)
    v_mfma_f32_16x16x32_bf16 v[0:3], v[72:75], v[224:227], v[0:3]
    v_cvt_pk_bf16_f32 v27, v30, v31
    v_mfma_f32_16x16x32_bf16 v[4:7], v[72:75], v[228:231], v[4:7]
    buffer_store_dwordx4 v[24:27], v102, s[24:27], s41 offen offset:2048 sc1
    s_waitcnt lgkmcnt(0)
    v_mfma_f32_16x16x32_bf16 v[8:11], v[76:79], v[224:227], v[8:11]
    v_mfma_f32_16x16x32_bf16 v[12:15], v[76:79], v[228:231], v[12:15]
    s_waitcnt vmcnt(8)
    s_barrier
    s_cmp_lg_u32 s3, 0
    s_cbranch_scc1 L_fs27
    s_add_u32 s38, s97, 32768
    v_mov_b32_e64 v123, s96
    s_mov_b64 exec, 1
    buffer_store_dword v123, off, s[24:27], s38 sc1
    s_mov_b64 exec, -1
L_fs27:
    ds_read_b128 v[56:59], v112 offset:0
    ds_read_b128 v[60:63], v112 offset:24576
    ds_read_b128 v[64:67], v113 offset:0
    ds_read_b128 v[68:71], v113 offset:24576
    ds_read_b128 v[72:75], v114 offset:0
    s_waitcnt lgkmcnt(4)
    v_mfma_f32_16x16x32_bf16 v[16:19], v[56:59], v[128:131], 0
    s_add_u32 m0, s72, 98304
    s_add_u32 s67, s73, 516096
    buffer_load_dwordx4 v52, s[8:11], s67 offen offset:0 lds
    v_mfma_f32_16x16x32_bf16 v[20:23], v[56:59], v[132:135], 0
    ds_read_b128 v[76:79], v114 offset:24576
    s_waitcnt lgkmcnt(4)
    v_mfma_f32_16x16x32_bf16 v[24:27], v[60:63], v[128:131], 0
    s_add_u32 m0, s72, 106368
    s_add_u32 s67, s73, 516096
    buffer_load_dwordx4 v52, s[8:11], s67 offen offset:128 lds
    v_mfma_f32_16x16x32_bf16 v[28:31], v[60:63], v[132:135], 0
    ds_read_b128 v[56:59], v115 offset:0
    s_waitcnt lgkmcnt(4)
    v_mfma_f32_16x16x32_bf16 v[16:19], v[64:67], v[136:139], v[16:19]
    s_add_u32 m0, s72, 114432
    s_add_u32 s67, s73, 516096
    buffer_load_dwordx4 v52, s[8:11], s67 offen offset:256 lds
    v_mfma_f32_16x16x32_bf16 v[20:23], v[64:67], v[140:143], v[20:23]
    ds_read_b128 v[60:63], v115 offset:24576
    s_waitcnt lgkmcnt(4)
    v_mfma_f32_16x16x32_bf16 v[24:27], v[68:71], v[136:139], v[24:27]
    s_add_u32 m0, s72, 122880
    s_add_u32 s67, s73, 552960
    buffer_load_dwordx4 v52, s[8:11], s67 offen offset:0 lds
    v_mfma_f32_16x16x32_bf16 v[28:31], v[68:71], v[140:143], v[28:31]
    ds_read_b128 v[64:67], v112 offset:8192
    s_waitcnt lgkmcnt(4)
    v_mfma_f32_16x16x32_bf16 v[16:19], v[72:75], v[144:147], v[16:19]
    s_add_u32 m0, s72, 130944
    s_add_u32 s67, s73, 552960
    buffer_load_dwordx4 v52, s[8:11], s67 offen offset:128 lds
    v_mfma_f32_16x16x32_bf16 v[20:23], v[72:75], v[148:151], v[20:23]
    ds_read_b128 v[68:71], v112 offset:32768
    s_waitcnt lgkmcnt(4)
    v_mfma_f32_16x16x32_bf16 v[24:27], v[76:79], v[144:147], v[24:27]
    s_add_u32 m0, s72, 139008
    s_add_u32 s67, s73, 552960
    buffer_load_dwordx4 v52, s[8:11], s67 offen offset:256 lds
    v_mfma_f32_16x16x32_bf16 v[28:31], v[76:79], v[148:151], v[28:31]
    ds_read_b128 v[72:75], v113 offset:8192
    s_waitcnt lgkmcnt(4)
    v_mfma_f32_16x16x32_bf16 v[16:19], v[56:59], v[152:155], v[16:19]
    v_mfma_f32_16x16x32_bf16 v[20:23], v[56:59], v[156:159], v[20:23]
    ds_read_b128 v[76:79], v113 offset:32768
    s_waitcnt lgkmcnt(4)
    v_mfma_f32_16x16x32_bf16 v[24:27], v[60:63], v[152:155], v[24:27]
    v_mfma_f32_16x16x32_bf16 v[28:31], v[60:63], v[156:159], v[28:31]
    ds_read_b128 v[56:59], v114 offset:8192
    s_waitcnt lgkmcnt(4)
    v_mfma_f32_16x16x32_bf16 v[16:19], v[64:67], v[160:163], v[16:19]
    v_mfma_f32_16x16x32_bf16 v[20:23], v[64:67], v[164:167], v[20:23]
    ds_read_b128 v[60:63], v114 offset:32768
    s_waitcnt lgkmcnt(4)
    v_mfma_f32_16x16x32_bf16 v[24:27], v[68:71], v[160:163], v[24:27]
    s_add_u32 s41, s40, 12288
    v_mfma_f32_16x16x32_bf16 v[28:31], v[68:71], v[164:167], v[28:31]
    ds_read_b128 v[64:67], v115 offset:8192
    v_cvt_pk_bf16_f32 v0, v0, v1
    s_waitcnt lgkmcnt(4)
    v_mfma_f32_16x16x32_bf16 v[16:19], v[72:75], v[168:171], v[16:19]
    v_mfma_f32_16x16x32_bf16 v[20:23], v[72:75], v[172:175], v[20:23]
    ds_read_b128 v[68:71], v115 offset:32768
    v_cvt_pk_bf16_f32 v1, v2, v3
    s_waitcnt lgkmcnt(4)
    v_mfma_f32_16x16x32_bf16 v[24:27], v[76:79], v[168:171], v[24:27]
    v_mfma_f32_16x16x32_bf16 v[28:31], v[76:79], v[172:175], v[28:31]
    ds_read_b128 v[72:75], v112 offset:16384
    v_cvt_pk_bf16_f32 v2, v4, v5
    s_waitcnt lgkmcnt(4)
    v_mfma_f32_16x16x32_bf16 v[16:19], v[56:59], v[208:211], v[16:19]
    v_cvt_pk_bf16_f32 v3, v6, v7
    v_mfma_f32_16x16x32_bf16 v[20:23], v[56:59], v[212:215], v[20:23]
    ds_read_b128 v[76:79], v112 offset:40960
    s_waitcnt lgkmcnt(4)
    v_mfma_f32_16x16x32_bf16 v[24:27], v[60:63], v[208:211], v[24:27]
    buffer_store_dwordx4 v[0:3], v102, s[24:27], s41 offen offset:0 sc1
    v_mfma_f32_16x16x32_bf16 v[28:31], v[60:63], v[212:215], v[28:31]
    v_cvt_pk_bf16_f32 v8, v8, v9
    s_waitcnt lgkmcnt(3)
    v_mfma_f32_16x16x32_bf16 v[16:19], v[64:67], v[216:219], v[16:19]
    v_cvt_pk_bf16_f32 v9, v10, v11
    v_mfma_f32_16x16x32_bf16 v[20:23], v[64:67], v[220:223], v[20:23]
    s_waitcnt lgkmcnt(2)
    v_mfma_f32_16x16x32_bf16 v[24:27], v[68:71], v[216:219], v[24:27]
    v_cvt_pk_bf16_f32 v10, v12, v13
    v_mfma_f32_16x16x32_bf16 v[28:31], v[68:71], v[220:223], v[28:31]
    s_waitcnt lgkmcnt(1)
    v_mfma_f32_16x16x32_bf16 v[16:19], v[72:75], v[224:227], v[16:19]
    v_cvt_pk_bf16_f32 v11, v14, v15
    v_mfma_f32_16x16x32_bf16 v[20:23], v[72:75], v[228:231], v[20:23]
    buffer_store_dwordx4 v[8:11], v102, s[24:27], s41 offen offset:2048 sc1
    s_waitcnt lgkmcnt(0)
    v_mfma_f32_16x16x32_bf16 v[24:27], v[76:79], v[224:227], v[24:27]
    v_mfma_f32_16x16x32_bf16 v[28:31], v[76:79], v[228:231], v[28:31]
    s_waitcnt vmcnt(10)
    s_barrier
    ds_read_b128 v[56:59], v84 offset:0
    ds_read_b128 v[60:63], v84 offset:24576
    ds_read_b128 v[64:67], v85 offset:0
    ds_read_b128 v[68:71], v85 offset:24576
    ds_read_b128 v[72:75], v86 offset:0
    s_waitcnt lgkmcnt(4)
    v_mfma_f32_16x16x32_bf16 v[0:3], v[56:59], v[128:131], 0
    s_add_u32 m0, s72, 0
    s_add_u32 s67, s73, 147456
    buffer_load_dwordx4 v52, s[8:11], s67 offen offset:0 lds
    v_mfma_f32_16x16x32_bf16 v[4:7], v[56:59], v[132:135], 0
    ds_read_b128 v[76:79], v86 offset:24576
    s_waitcnt lgkmcnt(4)
    v_mfma_f32_16x16x32_bf16 v[8:11], v[60:63], v[128:131], 0
    s_add_u32 m0, s72, 8064
    s_add_u32 s67, s73, 147456
    buffer_load_dwordx4 v52, s[8:11], s67 offen offset:128 lds
    v_mfma_f32_16x16x32_bf16 v[12:15], v[60:63], v[132:135], 0
    ds_read_b128 v[56:59], v87 offset:0
    s_waitcnt lgkmcnt(4)
    v_mfma_f32_16x16x32_bf16 v[0:3], v[64:67], v[136:139], v[0:3]
    s_add_u32 m0, s72, 16128
    s_add_u32 s67, s73, 147456
    buffer_load_dwordx4 v52, s[8:11], s67 offen offset:256 lds
    v_mfma_f32_16x16x32_bf16 v[4:7], v[64:67], v[140:143], v[4:7]
    ds_read_b128 v[60:63], v87 offset:24576
    s_waitcnt lgkmcnt(4)
    v_mfma_f32_16x16x32_bf16 v[8:11], v[68:71], v[136:139], v[8:11]
    s_add_u32 m0, s72, 24576
    s_add_u32 s67, s73, 184320
    buffer_load_dwordx4 v52, s[8:11], s67 offen offset:0 lds
    v_mfma_f32_16x16x32_bf16 v[12:15], v[68:71], v[140:143], v[12:15]
    ds_read_b128 v[64:67], v84 offset:8192
    s_waitcnt lgkmcnt(4)
    v_mfma_f32_16x16x32_bf16 v[0:3], v[72:75], v[144:147], v[0:3]
    s_add_u32 m0, s72, 32640
    s_add_u32 s67, s73, 184320
    buffer_load_dwordx4 v52, s[8:11], s67 offen offset:128 lds
    v_mfma_f32_16x16x32_bf16 v[4:7], v[72:75], v[148:151], v[4:7]
    ds_read_b128 v[68:71], v84 offset:32768
    s_waitcnt lgkmcnt(4)
    v_mfma_f32_16x16x32_bf16 v[8:11], v[76:79], v[144:147], v[8:11]
    s_add_u32 m0, s72, 40704
    s_add_u32 s67, s73, 184320
    buffer_load_dwordx4 v52, s[8:11], s67 offen offset:256 lds
    v_mfma_f32_16x16x32_bf16 v[12:15], v[76:79], v[148:151], v[12:15]
    ds_read_b128 v[72:75], v85 offset:8192
    s_waitcnt lgkmcnt(4)
    v_mfma_f32_16x16x32_bf16 v[0:3], v[56:59], v[152:155], v[0:3]
    v_mfma_f32_16x16x32_bf16 v[4:7], v[56:59], v[156:159], v[4:7]
    ds_read_b128 v[76:79], v85 offset:32768
    s_waitcnt lgkmcnt(4)
    v_mfma_f32_16x16x32_bf16 v[8:11], v[60:63], v[152:155], v[8:11]
    v_mfma_f32_16x16x32_bf16 v[12:15], v[60:63], v[156:159], v[12:15]
    ds_read_b128 v[56:59], v86 offset:8192
    s_waitcnt lgkmcnt(4)
    v_mfma_f32_16x16x32_bf16 v[0:3], v[64:67], v[160:163], v[0:3]
    v_mfma_f32_16x16x32_bf16 v[4:7], v[64:67], v[164:167], v[4:7]
    ds_read_b128 v[60:63], v86 offset:32768
    s_waitcnt lgkmcnt(4)
    v_mfma_f32_16x16x32_bf16 v[8:11], v[68:71], v[160:163], v[8:11]
    s_add_u32 s41, s40, 16384
    v_mfma_f32_16x16x32_bf16 v[12:15], v[68:71], v[164:167], v[12:15]
    ds_read_b128 v[64:67], v87 offset:8192
    v_cvt_pk_bf16_f32 v16, v16, v17
    s_waitcnt lgkmcnt(4)
    v_mfma_f32_16x16x32_bf16 v[0:3], v[72:75], v[168:171], v[0:3]
    v_mfma_f32_16x16x32_bf16 v[4:7], v[72:75], v[172:175], v[4:7]
    ds_read_b128 v[68:71], v87 offset:32768
    v_cvt_pk_bf16_f32 v17, v18, v19
    s_waitcnt lgkmcnt(4)
    v_mfma_f32_16x16x32_bf16 v[8:11], v[76:79], v[168:171], v[8:11]
    v_mfma_f32_16x16x32_bf16 v[12:15], v[76:79], v[172:175], v[12:15]
    ds_read_b128 v[72:75], v84 offset:16384
    v_cvt_pk_bf16_f32 v18, v20, v21
    s_waitcnt lgkmcnt(4)
    v_mfma_f32_16x16x32_bf16 v[0:3], v[56:59], v[208:211], v[0:3]
    v_cvt_pk_bf16_f32 v19, v22, v23
    v_mfma_f32_16x16x32_bf16 v[4:7], v[56:59], v[212:215], v[4:7]
    ds_read_b128 v[76:79], v84 offset:40960
    s_waitcnt lgkmcnt(4)
    v_mfma_f32_16x16x32_bf16 v[8:11], v[60:63], v[208:211], v[8:11]
    buffer_store_dwordx4 v[16:19], v102, s[24:27], s41 offen offset:0 sc1
    v_mfma_f32_16x16x32_bf16 v[12:15], v[60:63], v[212:215], v[12:15]
    v_cvt_pk_bf16_f32 v24, v24, v25
    s_waitcnt lgkmcnt(3)
    v_mfma_f32_16x16x32_bf16 v[0:3], v[64:67], v[216:219], v[0:3]
    v_cvt_pk_bf16_f32 v25, v26, v27
    v_mfma_f32_16x16x32_bf16 v[4:7], v[64:67], v[220:223], v[4:7]
    s_waitcnt lgkmcnt(2)
    v_mfma_f32_16x16x32_bf16 v[8:11], v[68:71], v[216:219], v[8:11]
    v_cvt_pk_bf16_f32 v26, v28, v29
    v_mfma_f32_16x16x32_bf16 v[12:15], v[68:71], v[220:223], v[12:15]
    s_waitcnt lgkmcnt(1)
    v_mfma_f32_16x16x32_bf16 v[0:3], v[72:75], v[224:227], v[0:3]
    v_cvt_pk_bf16_f32 v27, v30, v31
    v_mfma_f32_16x16x32_bf16 v[4:7], v[72:75], v[228:231], v[4:7]
    buffer_store_dwordx4 v[24:27], v102, s[24:27], s41 offen offset:2048 sc1
    s_waitcnt lgkmcnt(0)
    v_mfma_f32_16x16x32_bf16 v[8:11], v[76:79], v[224:227], v[8:11]
    v_mfma_f32_16x16x32_bf16 v[12:15], v[76:79], v[228:231], v[12:15]
    s_waitcnt vmcnt(10)
    s_barrier
    ds_read_b128 v[56:59], v88 offset:0
    ds_read_b128 v[60:63], v88 offset:24576
    ds_read_b128 v[64:67], v89 offset:0
    ds_read_b128 v[68:71], v89 offset:24576
    ds_read_b128 v[72:75], v90 offset:0
    s_waitcnt lgkmcnt(4)
    v_mfma_f32_16x16x32_bf16 v[16:19], v[56:59], v[128:131], 0
    s_add_u32 m0, s72, 49152
    s_add_u32 s67, s73, 368640
    buffer_load_dwordx4 v52, s[8:11], s67 offen offset:0 lds
    v_mfma_f32_16x16x32_bf16 v[20:23], v[56:59], v[132:135], 0
    ds_read_b128 v[76:79], v90 offset:24576
    s_waitcnt lgkmcnt(4)
    v_mfma_f32_16x16x32_bf16 v[24:27], v[60:63], v[128:131], 0
    s_add_u32 m0, s72, 57216
    s_add_u32 s67, s73, 368640
    buffer_load_dwordx4 v52, s[8:11], s67 offen offset:128 lds
    v_mfma_f32_16x16x32_bf16 v[28:31], v[60:63], v[132:135], 0
    ds_read_b128 v[56:59], v91 offset:0
    s_waitcnt lgkmcnt(4)
    v_mfma_f32_16x16x32_bf16 v[16:19], v[64:67], v[136:139], v[16:19]
    s_add_u32 m0, s72, 65280
    s_add_u32 s67, s73, 368640
    buffer_load_dwordx4 v52, s[8:11], s67 offen offset:256 lds
    v_mfma_f32_16x16x32_bf16 v[20:23], v[64:67], v[140:143], v[20:23]
    ds_read_b128 v[60:63], v91 offset:24576
    s_waitcnt lgkmcnt(4)
    v_mfma_f32_16x16x32_bf16 v[24:27], v[68:71], v[136:139], v[24:27]
    s_add_u32 m0, s72, 73728
    s_add_u32 s67, s73, 405504
    buffer_load_dwordx4 v52, s[8:11], s67 offen offset:0 lds
    v_mfma_f32_16x16x32_bf16 v[28:31], v[68:71], v[140:143], v[28:31]
    ds_read_b128 v[64:67], v88 offset:8192
    s_waitcnt lgkmcnt(4)
    v_mfma_f32_16x16x32_bf16 v[16:19], v[72:75], v[144:147], v[16:19]
    s_add_u32 m0, s72, 81792
    s_add_u32 s67, s73, 405504
    buffer_load_dwordx4 v52, s[8:11], s67 offen offset:128 lds
    v_mfma_f32_16x16x32_bf16 v[20:23], v[72:75], v[148:151], v[20:23]
    ds_read_b128 v[68:71], v88 offset:32768
    s_waitcnt lgkmcnt(4)
    v_mfma_f32_16x16x32_bf16 v[24:27], v[76:79], v[144:147], v[24:27]
    s_add_u32 m0, s72, 89856
    s_add_u32 s67, s73, 405504
    buffer_load_dwordx4 v52, s[8:11], s67 offen offset:256 lds
    v_mfma_f32_16x16x32_bf16 v[28:31], v[76:79], v[148:151], v[28:31]
    ds_read_b128 v[72:75], v89 offset:8192
    s_waitcnt lgkmcnt(4)
    v_mfma_f32_16x16x32_bf16 v[16:19], v[56:59], v[152:155], v[16:19]
    v_mfma_f32_16x16x32_bf16 v[20:23], v[56:59], v[156:159], v[20:23]
    ds_read_b128 v[76:79], v89 offset:32768
    s_waitcnt lgkmcnt(4)
    v_mfma_f32_16x16x32_bf16 v[24:27], v[60:63], v[152:155], v[24:27]
    v_mfma_f32_16x16x32_bf16 v[28:31], v[60:63], v[156:159], v[28:31]
    ds_read_b128 v[56:59], v90 offset:8192
    s_waitcnt lgkmcnt(4)
    v_mfma_f32_16x16x32_bf16 v[16:19], v[64:67], v[160:163], v[16:19]
    v_mfma_f32_16x16x32_bf16 v[20:23], v[64:67], v[164:167], v[20:23]
    ds_read_b128 v[60:63], v90 offset:32768
    s_waitcnt lgkmcnt(4)
    v_mfma_f32_16x16x32_bf16 v[24:27], v[68:71], v[160:163], v[24:27]
    s_add_u32 s41, s40, 24576
    v_mfma_f32_16x16x32_bf16 v[28:31], v[68:71], v[164:167], v[28:31]
    ds_read_b128 v[64:67], v91 offset:8192
    v_cvt_pk_bf16_f32 v0, v0, v1
    s_waitcnt lgkmcnt(4)
    v_mfma_f32_16x16x32_bf16 v[16:19], v[72:75], v[168:171], v[16:19]
    v_mfma_f32_16x16x32_bf16 v[20:23], v[72:75], v[172:175], v[20:23]
    ds_read_b128 v[68:71], v91 offset:32768
    v_cvt_pk_bf16_f32 v1, v2, v3
    s_waitcnt lgkmcnt(4)
    v_mfma_f32_16x16x32_bf16 v[24:27], v[76:79], v[168:171], v[24:27]
    v_mfma_f32_16x16x32_bf16 v[28:31], v[76:79], v[172:175], v[28:31]
    ds_read_b128 v[72:75], v88 offset:16384
    v_cvt_pk_bf16_f32 v2, v4, v5
    s_waitcnt lgkmcnt(4)
    v_mfma_f32_16x16x32_bf16 v[16:19], v[56:59], v[208:211], v[16:19]
    v_cvt_pk_bf16_f32 v3, v6, v7
    v_mfma_f32_16x16x32_bf16 v[20:23], v[56:59], v[212:215], v[20:23]
    ds_read_b128 v[76:79], v88 offset:40960
    s_waitcnt lgkmcnt(4)
    v_mfma_f32_16x16x32_bf16 v[24:27], v[60:63], v[208:211], v[24:27]
    buffer_store_dwordx4 v[0:3], v102, s[24:27], s41 offen offset:0 sc1
    v_mfma_f32_16x16x32_bf16 v[28:31], v[60:63], v[212:215], v[28:31]
    v_cvt_pk_bf16_f32 v8, v8, v9
    s_waitcnt lgkmcnt(3)
    v_mfma_f32_16x16x32_bf16 v[16:19], v[64:67], v[216:219], v[16:19]
    v_cvt_pk_bf16_f32 v9, v10, v11
    v_mfma_f32_16x16x32_bf16 v[20:23], v[64:67], v[220:223], v[20:23]
    s_waitcnt lgkmcnt(2)
    v_mfma_f32_16x16x32_bf16 v[24:27], v[68:71], v[216:219], v[24:27]
    v_cvt_pk_bf16_f32 v10, v12, v13
    v_mfma_f32_16x16x32_bf16 v[28:31], v[68:71], v[220:223], v[28:31]
    s_waitcnt lgkmcnt(1)
    v_mfma_f32_16x16x32_bf16 v[16:19], v[72:75], v[224:227], v[16:19]
    v_cvt_pk_bf16_f32 v11, v14, v15
    v_mfma_f32_16x16x32_bf16 v[20:23], v[72:75], v[228:231], v[20:23]
    buffer_store_dwordx4 v[8:11], v102, s[24:27], s41 offen offset:2048 sc1
    s_waitcnt lgkmcnt(0)
    v_mfma_f32_16x16x32_bf16 v[24:27], v[76:79], v[224:227], v[24:27]
    v_mfma_f32_16x16x32_bf16 v[28:31], v[76:79], v[228:231], v[28:31]
    s_waitcnt vmcnt(10)
    s_barrier
    ds_read_b128 v[56:59], v112 offset:0
    ds_read_b128 v[60:63], v112 offset:24576
    ds_read_b128 v[64:67], v113 offset:0
    ds_read_b128 v[68:71], v113 offset:24576
    ds_read_b128 v[72:75], v114 offset:0
    s_waitcnt lgkmcnt(4)
    v_mfma_f32_16x16x32_bf16 v[0:3], v[56:59], v[128:131], 0
    s_add_u32 m0, s72, 98304
    s_add_u32 s67, s73, 589824
    buffer_load_dwordx4 v52, s[8:11], s67 offen offset:0 lds
    v_mfma_f32_16x16x32_bf16 v[4:7], v[56:59], v[132:135], 0
    ds_read_b128 v[76:79], v114 offset:24576
    s_waitcnt lgkmcnt(4)
    v_mfma_f32_16x16x32_bf16 v[8:11], v[60:63], v[128:131], 0
    s_add_u32 m0, s72, 106368
    s_add_u32 s67, s73, 589824
    buffer_load_dwordx4 v52, s[8:11], s67 offen offset:128 lds
    v_mfma_f32_16x16x32_bf16 v[12:15], v[60:63], v[132:135], 0
    ds_read_b128 v[56:59], v115 offset:0
    s_waitcnt lgkmcnt(4)
    v_mfma_f32_16x16x32_bf16 v[0:3], v[64:67], v[136:139], v[0:3]
    s_add_u32 m0, s72, 114432
    s_add_u32 s67, s73, 589824
    buffer_load_dwordx4 v52, s[8:11], s67 offen offset:256 lds
    v_mfma_f32_16x16x32_bf16 v[4:7], v[64:67], v[140:143], v[4:7]
    ds_read_b128 v[60:63], v115 offset:24576
    s_waitcnt lgkmcnt(4)
    v_mfma_f32_16x16x32_bf16 v[8:11], v[68:71], v[136:139], v[8:11]
    s_add_u32 m0, s72, 122880
    s_add_u32 s67, s73, 626688
    buffer_load_dwordx4 v52, s[8:11], s67 offen offset:0 lds
    v_mfma_f32_16x16x32_bf16 v[12:15], v[68:71], v[140:143], v[12:15]
    ds_read_b128 v[64:67], v112 offset:8192
    s_waitcnt lgkmcnt(4)
    v_mfma_f32_16x16x32_bf16 v[0:3], v[72:75], v[144:147], v[0:3]
    s_add_u32 m0, s72, 130944
    s_add_u32 s67, s73, 626688
    buffer_load_dwordx4 v52, s[8:11], s67 offen offset:128 lds
    v_mfma_f32_16x16x32_bf16 v[4:7], v[72:75], v[148:151], v[4:7]
    ds_read_b128 v[68:71], v112 offset:32768
    s_waitcnt lgkmcnt(4)
    v_mfma_f32_16x16x32_bf16 v[8:11], v[76:79], v[144:147], v[8:11]
    s_add_u32 m0, s72, 139008
    s_add_u32 s67, s73, 626688
    buffer_load_dwordx4 v52, s[8:11], s67 offen offset:256 lds
    v_mfma_f32_16x16x32_bf16 v[12:15], v[76:79], v[148:151], v[12:15]
    ds_read_b128 v[72:75], v113 offset:8192
    s_waitcnt lgkmcnt(4)
    v_mfma_f32_16x16x32_bf16 v[0:3], v[56:59], v[152:155], v[0:3]
    v_mfma_f32_16x16x32_bf16 v[4:7], v[56:59], v[156:159], v[4:7]
    ds_read_b128 v[76:79], v113 offset:32768
    s_waitcnt lgkmcnt(4)
    v_mfma_f32_16x16x32_bf16 v[8:11], v[60:63], v[152:155], v[8:11]
    v_mfma_f32_16x16x32_bf16 v[12:15], v[60:63], v[156:159], v[12:15]
    ds_read_b128 v[56:59], v114 offset:8192
    s_waitcnt lgkmcnt(4)
    v_mfma_f32_16x16x32_bf16 v[0:3], v[64:67], v[160:163], v[0:3]
    v_mfma_f32_16x16x32_bf16 v[4:7], v[64:67], v[164:167], v[4:7]
    ds_read_b128 v[60:63], v114 offset:32768
    s_waitcnt lgkmcnt(4)
    v_mfma_f32_16x16x32_bf16 v[8:11], v[68:71], v[160:163], v[8:11]
    s_add_u32 s41, s40, 28672
    v_mfma_f32_16x16x32_bf16 v[12:15], v[68:71], v[164:167], v[12:15]
    ds_read_b128 v[64:67], v115 offset:8192
    v_cvt_pk_bf16_f32 v16, v16, v17
    s_waitcnt lgkmcnt(4)
    v_mfma_f32_16x16x32_bf16 v[0:3], v[72:75], v[168:171], v[0:3]
    v_mfma_f32_16x16x32_bf16 v[4:7], v[72:75], v[172:175], v[4:7]
    ds_read_b128 v[68:71], v115 offset:32768
    v_cvt_pk_bf16_f32 v17, v18, v19
    s_waitcnt lgkmcnt(4)
    v_mfma_f32_16x16x32_bf16 v[8:11], v[76:79], v[168:171], v[8:11]
    v_mfma_f32_16x16x32_bf16 v[12:15], v[76:79], v[172:175], v[12:15]
    ds_read_b128 v[72:75], v112 offset:16384
    v_cvt_pk_bf16_f32 v18, v20, v21
    s_waitcnt lgkmcnt(4)
    v_mfma_f32_16x16x32_bf16 v[0:3], v[56:59], v[208:211], v[0:3]
    v_cvt_pk_bf16_f32 v19, v22, v23
    v_mfma_f32_16x16x32_bf16 v[4:7], v[56:59], v[212:215], v[4:7]
    ds_read_b128 v[76:79], v112 offset:40960
    s_waitcnt lgkmcnt(4)
    v_mfma_f32_16x16x32_bf16 v[8:11], v[60:63], v[208:211], v[8:11]
    buffer_store_dwordx4 v[16:19], v102, s[24:27], s41 offen offset:0 sc1
    v_mfma_f32_16x16x32_bf16 v[12:15], v[60:63], v[212:215], v[12:15]
    v_cvt_pk_bf16_f32 v24, v24, v25
    s_waitcnt lgkmcnt(3)
    v_mfma_f32_16x16x32_bf16 v[0:3], v[64:67], v[216:219], v[0:3]
    v_cvt_pk_bf16_f32 v25, v26, v27
    v_mfma_f32_16x16x32_bf16 v[4:7], v[64:67], v[220:223], v[4:7]
    s_waitcnt lgkmcnt(2)
    v_mfma_f32_16x16x32_bf16 v[8:11], v[68:71], v[216:219], v[8:11]
    v_cvt_pk_bf16_f32 v26, v28, v29
    v_mfma_f32_16x16x32_bf16 v[12:15], v[68:71], v[220:223], v[12:15]
    s_waitcnt lgkmcnt(1)
    v_mfma_f32_16x16x32_bf16 v[0:3], v[72:75], v[224:227], v[0:3]
    v_cvt_pk_bf16_f32 v27, v30, v31
    v_mfma_f32_16x16x32_bf16 v[4:7], v[72:75], v[228:231], v[4:7]
    buffer_store_dwordx4 v[24:27], v102, s[24:27], s41 offen offset:2048 sc1
    s_waitcnt lgkmcnt(0)
    v_mfma_f32_16x16x32_bf16 v[8:11], v[76:79], v[224:227], v[8:11]
    v_mfma_f32_16x16x32_bf16 v[12:15], v[76:79], v[228:231], v[12:15]
    s_waitcnt vmcnt(0)
    s_barrier
    s_cmp_lg_u32 s3, 0
    s_cbranch_scc1 L_fs28
    s_add_u32 s38, s97, 98304
    v_mov_b32 v123, s96
    s_mov_b64 exec, 1
    buffer_store_dword v123, off, s[24:27], s38 sc1
    s_mov_b64 exec, -1
L_fs28:
    ds_read_b128 v[56:59], v84 offset:0
    ds_read_b128 v[60:63], v84 offset:24576
    ds_read_b128 v[64:67], v85 offset:0
    ds_read_b128 v[68:71], v85 offset:24576
    ds_read_b128 v[72:75], v86 offset:0
    s_waitcnt lgkmcnt(4)
    v_mfma_f32_16x16x32_bf16 v[16:19], v[56:59], v[128:131], 0
    v_mfma_f32_16x16x32_bf16 v[20:23], v[56:59], v[132:135], 0
    ds_read_b128 v[76:79], v86 offset:24576
    s_waitcnt lgkmcnt(4)
    v_mfma_f32_16x16x32_bf16 v[24:27], v[60:63], v[128:131], 0
    v_mfma_f32_16x16x32_bf16 v[28:31], v[60:63], v[132:135], 0
    ds_read_b128 v[56:59], v87 offset:0
    s_waitcnt lgkmcnt(4)
    v_mfma_f32_16x16x32_bf16 v[16:19], v[64:67], v[136:139], v[16:19]
    v_mfma_f32_16x16x32_bf16 v[20:23], v[64:67], v[140:143], v[20:23]
    ds_read_b128 v[60:63], v87 offset:24576
    s_waitcnt lgkmcnt(4)
    v_mfma_f32_16x16x32_bf16 v[24:27], v[68:71], v[136:139], v[24:27]
    v_mfma_f32_16x16x32_bf16 v[28:31], v[68:71], v[140:143], v[28:31]
    ds_read_b128 v[64:67], v84 offset:8192
    s_waitcnt lgkmcnt(4)
    v_mfma_f32_16x16x32_bf16 v[16:19], v[72:75], v[144:147], v[16:19]
    v_mfma_f32_16x16x32_bf16 v[20:23], v[72:75], v[148:151], v[20:23]
    ds_read_b128 v[68:71], v84 offset:32768
    s_waitcnt lgkmcnt(4)
    v_mfma_f32_16x16x32_bf16 v[24:27], v[76:79], v[144:147], v[24:27]
    v_mfma_f32_16x16x32_bf16 v[28:31], v[76:79], v[148:151], v[28:31]
    ds_read_b128 v[72:75], v85 offset:8192
    s_waitcnt lgkmcnt(4)
    v_mfma_f32_16x16x32_bf16 v[16:19], v[56:59], v[152:155], v[16:19]
    v_mfma_f32_16x16x32_bf16 v[20:23], v[56:59], v[156:159], v[20:23]
    ds_read_b128 v[76:79], v85 offset:32768
    s_waitcnt lgkmcnt(4)
    v_mfma_f32_16x16x32_bf16 v[24:27], v[60:63], v[152:155], v[24:27]
    v_mfma_f32_16x16x32_bf16 v[28:31], v[60:63], v[156:159], v[28:31]
    ds_read_b128 v[56:59], v86 offset:8192
    s_waitcnt lgkmcnt(4)
    v_mfma_f32_16x16x32_bf16 v[16:19], v[64:67], v[160:163], v[16:19]
    v_mfma_f32_16x16x32_bf16 v[20:23], v[64:67], v[164:167], v[20:23]
    ds_read_b128 v[60:63], v86 offset:32768
    s_waitcnt lgkmcnt(4)
    v_mfma_f32_16x16x32_bf16 v[24:27], v[68:71], v[160:163], v[24:27]
    s_add_u32 s41, s40, 8192
    v_mfma_f32_16x16x32_bf16 v[28:31], v[68:71], v[164:167], v[28:31]
    ds_read_b128 v[64:67], v87 offset:8192
    v_cvt_pk_bf16_f32 v0, v0, v1
    s_waitcnt lgkmcnt(4)
    v_mfma_f32_16x16x32_bf16 v[16:19], v[72:75], v[168:171], v[16:19]
    v_mfma_f32_16x16x32_bf16 v[20:23], v[72:75], v[172:175], v[20:23]
    ds_read_b128 v[68:71], v87 offset:32768
    v_cvt_pk_bf16_f32 v1, v2, v3
    s_waitcnt lgkmcnt(4)
    v_mfma_f32_16x16x32_bf16 v[24:27], v[76:79], v[168:171], v[24:27]
    v_mfma_f32_16x16x32_bf16 v[28:31], v[76:79], v[172:175], v[28:31]
    ds_read_b128 v[72:75], v84 offset:16384
    v_cvt_pk_bf16_f32 v2, v4, v5
    s_waitcnt lgkmcnt(4)
    v_mfma_f32_16x16x32_bf16 v[16:19], v[56:59], v[208:211], v[16:19]
    v_cvt_pk_bf16_f32 v3, v6, v7
    v_mfma_f32_16x16x32_bf16 v[20:23], v[56:59], v[212:215], v[20:23]
    ds_read_b128 v[76:79], v84 offset:40960
    s_waitcnt lgkmcnt(4)
    v_mfma_f32_16x16x32_bf16 v[24:27], v[60:63], v[208:211], v[24:27]
    buffer_store_dwordx4 v[0:3], v102, s[24:27], s41 offen offset:0 sc1
    v_mfma_f32_16x16x32_bf16 v[28:31], v[60:63], v[212:215], v[28:31]
    v_cvt_pk_bf16_f32 v8, v8, v9
    s_waitcnt lgkmcnt(3)
    v_mfma_f32_16x16x32_bf16 v[16:19], v[64:67], v[216:219], v[16:19]
    v_cvt_pk_bf16_f32 v9, v10, v11
    v_mfma_f32_16x16x32_bf16 v[20:23], v[64:67], v[220:223], v[20:23]
    s_waitcnt lgkmcnt(2)
    v_mfma_f32_16x16x32_bf16 v[24:27], v[68:71], v[216:219], v[24:27]
    v_cvt_pk_bf16_f32 v10, v12, v13
    v_mfma_f32_16x16x32_bf16 v[28:31], v[68:71], v[220:223], v[28:31]
    s_waitcnt lgkmcnt(1)
    v_mfma_f32_16x16x32_bf16 v[16:19], v[72:75], v[224:227], v[16:19]
    v_cvt_pk_bf16_f32 v11, v14, v15
    v_mfma_f32_16x16x32_bf16 v[20:23], v[72:75], v[228:231], v[20:23]
    buffer_store_dwordx4 v[8:11], v102, s[24:27], s41 offen offset:2048 sc1
    s_waitcnt lgkmcnt(0)
    v_mfma_f32_16x16x32_bf16 v[24:27], v[76:79], v[224:227], v[24:27]
    v_mfma_f32_16x16x32_bf16 v[28:31], v[76:79], v[228:231], v[28:31]
    s_barrier
    ds_read_b128 v[56:59], v88 offset:0
    ds_read_b128 v[60:63], v88 offset:24576
    ds_read_b128 v[64:67], v89 offset:0
    ds_read_b128 v[68:71], v89 offset:24576
    ds_read_b128 v[72:75], v90 offset:0
    s_waitcnt lgkmcnt(4)
    v_mfma_f32_16x16x32_bf16 v[0:3], v[56:59], v[128:131], 0
    v_mfma_f32_16x16x32_bf16 v[4:7], v[56:59], v[132:135], 0
    ds_read_b128 v[76:79], v90 offset:24576
    s_waitcnt lgkmcnt(4)
    v_mfma_f32_16x16x32_bf16 v[8:11], v[60:63], v[128:131], 0
    v_mfma_f32_16x16x32_bf16 v[12:15], v[60:63], v[132:135], 0
    ds_read_b128 v[56:59], v91 offset:0
    s_waitcnt lgkmcnt(4)
    v_mfma_f32_16x16x32_bf16 v[0:3], v[64:67], v[136:139], v[0:3]
    v_mfma_f32_16x16x32_bf16 v[4:7], v[64:67], v[140:143], v[4:7]
    ds_read_b128 v[60:63], v91 offset:24576
    s_waitcnt lgkmcnt(4)
    v_mfma_f32_16x16x32_bf16 v[8:11], v[68:71], v[136:139], v[8:11]
    v_mfma_f32_16x16x32_bf16 v[12:15], v[68:71], v[140:143], v[12:15]
    ds_read_b128 v[64:67], v88 offset:8192
    s_waitcnt lgkmcnt(4)
    v_mfma_f32_16x16x32_bf16 v[0:3], v[72:75], v[144:147], v[0:3]
    v_mfma_f32_16x16x32_bf16 v[4:7], v[72:75], v[148:151], v[4:7]
    ds_read_b128 v[68:71], v88 offset:32768
    s_waitcnt lgkmcnt(4)
    v_mfma_f32_16x16x32_bf16 v[8:11], v[76:79], v[144:147], v[8:11]
    v_mfma_f32_16x16x32_bf16 v[12:15], v[76:79], v[148:151], v[12:15]
    ds_read_b128 v[72:75], v89 offset:8192
    s_waitcnt lgkmcnt(4)
    v_mfma_f32_16x16x32_bf16 v[0:3], v[56:59], v[152:155], v[0:3]
    v_mfma_f32_16x16x32_bf16 v[4:7], v[56:59], v[156:159], v[4:7]
    ds_read_b128 v[76:79], v89 offset:32768
    s_waitcnt lgkmcnt(4)
    v_mfma_f32_16x16x32_bf16 v[8:11], v[60:63], v[152:155], v[8:11]
    v_mfma_f32_16x16x32_bf16 v[12:15], v[60:63], v[156:159], v[12:15]
    ds_read_b128 v[56:59], v90 offset:8192
    s_waitcnt lgkmcnt(4)
    v_mfma_f32_16x16x32_bf16 v[0:3], v[64:67], v[160:163], v[0:3]
    v_mfma_f32_16x16x32_bf16 v[4:7], v[64:67], v[164:167], v[4:7]
    ds_read_b128 v[60:63], v90 offset:32768
    s_waitcnt lgkmcnt(4)
    v_mfma_f32_16x16x32_bf16 v[8:11], v[68:71], v[160:163], v[8:11]
    s_add_u32 s41, s40, 20480
    v_mfma_f32_16x16x32_bf16 v[12:15], v[68:71], v[164:167], v[12:15]
    ds_read_b128 v[64:67], v91 offset:8192
    v_cvt_pk_bf16_f32 v16, v16, v17
    s_waitcnt lgkmcnt(4)
    v_mfma_f32_16x16x32_bf16 v[0:3], v[72:75], v[168:171], v[0:3]
    v_mfma_f32_16x16x32_bf16 v[4:7], v[72:75], v[172:175], v[4:7]
    ds_read_b128 v[68:71], v91 offset:32768
    v_cvt_pk_bf16_f32 v17, v18, v19
    s_waitcnt lgkmcnt(4)
    v_mfma_f32_16x16x32_bf16 v[8:11], v[76:79], v[168:171], v[8:11]
    v_mfma_f32_16x16x32_bf16 v[12:15], v[76:79], v[172:175], v[12:15]
    ds_read_b128 v[72:75], v88 offset:16384
    v_cvt_pk_bf16_f32 v18, v20, v21
    s_waitcnt lgkmcnt(4)
    v_mfma_f32_16x16x32_bf16 v[0:3], v[56:59], v[208:211], v[0:3]
    v_cvt_pk_bf16_f32 v19, v22, v23
    v_mfma_f32_16x16x32_bf16 v[4:7], v[56:59], v[212:215], v[4:7]
    ds_read_b128 v[76:79], v88 offset:40960
    s_waitcnt lgkmcnt(4)
    v_mfma_f32_16x16x32_bf16 v[8:11], v[60:63], v[208:211], v[8:11]
    buffer_store_dwordx4 v[16:19], v102, s[24:27], s41 offen offset:0 sc1
    v_mfma_f32_16x16x32_bf16 v[12:15], v[60:63], v[212:215], v[12:15]
    v_cvt_pk_bf16_f32 v24, v24, v25
    s_waitcnt lgkmcnt(3)
    v_mfma_f32_16x16x32_bf16 v[0:3], v[64:67], v[216:219], v[0:3]
    v_cvt_pk_bf16_f32 v25, v26, v27
    v_mfma_f32_16x16x32_bf16 v[4:7], v[64:67], v[220:223], v[4:7]
    s_waitcnt lgkmcnt(2)
    v_mfma_f32_16x16x32_bf16 v[8:11], v[68:71], v[216:219], v[8:11]
    v_cvt_pk_bf16_f32 v26, v28, v29
    v_mfma_f32_16x16x32_bf16 v[12:15], v[68:71], v[220:223], v[12:15]
    s_waitcnt lgkmcnt(1)
    v_mfma_f32_16x16x32_bf16 v[0:3], v[72:75], v[224:227], v[0:3]
    v_cvt_pk_bf16_f32 v27, v30, v31
    v_mfma_f32_16x16x32_bf16 v[4:7], v[72:75], v[228:231], v[4:7]
    buffer_store_dwordx4 v[24:27], v102, s[24:27], s41 offen offset:2048 sc1
    s_waitcnt lgkmcnt(0)
    v_mfma_f32_16x16x32_bf16 v[8:11], v[76:79], v[224:227], v[8:11]
    v_mfma_f32_16x16x32_bf16 v[12:15], v[76:79], v[228:231], v[12:15]
    s_nop 7
    s_add_u32 s41, s40, 32768
    v_cvt_pk_bf16_f32 v0, v0, v1
    v_cvt_pk_bf16_f32 v1, v2, v3
    v_cvt_pk_bf16_f32 v2, v4, v5
    v_cvt_pk_bf16_f32 v3, v6, v7
    buffer_store_dwordx4 v[0:3], v102, s[24:27], s41 offen offset:0 sc1
    v_cvt_pk_bf16_f32 v8, v8, v9
    v_cvt_pk_bf16_f32 v9, v10, v11
    v_cvt_pk_bf16_f32 v10, v12, v13
    v_cvt_pk_bf16_f32 v11, v14, v15
    buffer_store_dwordx4 v[8:11], v102, s[24:27], s41 offen offset:2048 sc1
    s_waitcnt vmcnt(0)
    s_barrier
    s_cmp_lg_u32 s3, 0
    s_cbranch_scc1 L_fs29
    s_add_u32 s38, s97, 65536
    v_mov_b32_e64 v123, s96
    s_mov_b64 exec, 1
    buffer_store_dword v123, off, s[24:27], s38 sc1
    s_mov_b64 exec, -1
L_fs29:
LA_end:
    s_endpgm
L_code_end:
.section .rodata,"a"
.p2align 6
.amdhsa_kernel parallel_sum__ssm_conv_s5__glu_gated_swiglu__prompt_kernel
  .amdhsa_next_free_vgpr 256
  .amdhsa_next_free_sgpr 102
  .amdhsa_accum_offset 256
  .amdhsa_group_segment_fixed_size 0
  .amdhsa_kernarg_size 128
  .amdhsa_user_sgpr_count 2
  .amdhsa_user_sgpr_kernarg_segment_ptr 1
  .amdhsa_system_sgpr_workgroup_id_x 1
.end_amdhsa_kernel
```
